```python
import torch

def _softmax(x, axis=-1):
    return torch.softmax(x, dim=axis)
def _gelu(x):
    return torch.nn.functional.gelu(x, approximate="tanh")
def _silu(x):
    return torch.nn.functional.silu(x)
def _sigmoid(x):
    return torch.sigmoid(x)
def _layernorm(x, axis=-1, eps=1e-5):
    m = x.mean(dim=axis, keepdim=True)
    v = x.var(dim=axis, keepdim=True, unbiased=False)
    return (x - m) / torch.sqrt(v + eps)
def _scatter_add(tgt, idx, src, axis=0):
    return tgt.clone().index_add_(axis, idx, src)
def _segment_sum(src, seg, n):
    out = torch.zeros((n,) + src.shape[1:], dtype=src.dtype)
    return out.index_add_(0, seg, src)
def _pad(x, pw):
    flat = tuple(v for pair in reversed(pw) for v in pair)
    return torch.nn.functional.pad(x, flat)

kernel_name = 'recurrent_scan__ssm_conv_h3__geglu_ffn__prompt'

def setup_inputs():

    _w = (lambda a: (lambda t: t.to(torch.bfloat16) if t.is_floating_point() else t)(torch.as_tensor(a)))
    def _A_setup():
        B, S, D = 1, 2048, 1024
        ks = 4
        return {
            "q": _w((lambda *s: torch.randn(*s, dtype=torch.bfloat16) * 0.05)(B, S, D)),
            "k": _w((lambda *s: torch.randn(*s, dtype=torch.bfloat16) * 0.2)(B, S, D)),
            "v": _w((lambda *s: torch.randn(*s, dtype=torch.bfloat16) * 0.2)(B, S, D)),
            "shift_k": _w((lambda *s: torch.randn(*s, dtype=torch.bfloat16) * 0.2)(D, ks) * 0.5),
            "ssm_k": _w((lambda *s: torch.randn(*s, dtype=torch.bfloat16) * 0.2)(D, S) * (1.0 / S ** 0.5)),
            "ssm_D": _w((lambda *s: torch.randn(*s, dtype=torch.bfloat16) * 0.2)(D)),
        }
    _A_in = _A_setup()

    def _B_setup():
        B, S, D, F = 1, 2048, 1024, 3584
        return {
            "x": _w((lambda *s: torch.randn(*s, dtype=torch.bfloat16) * 0.05)(B, S, D)),
            "w_gate": _w((lambda *s: torch.randn(*s, dtype=torch.bfloat16) * 0.1)(D, F)),
            "w_up": _w((lambda *s: torch.randn(*s, dtype=torch.bfloat16) * 0.1)(D, F)),
            "w_down": _w((lambda *s: torch.randn(*s, dtype=torch.bfloat16) * 0.1)(F, D)),
        }
    _B_in = _B_setup()

    return {
        "A_q": _A_in["q"],
        "A_k": _A_in["k"],
        "A_v": _A_in["v"],
        "A_shift_k": _A_in["shift_k"],
        "A_ssm_k": _A_in["ssm_k"],
        "A_ssm_D": _A_in["ssm_D"],
        "B_x": _B_in["x"],
        "B_w_gate": _B_in["w_gate"],
        "B_w_up": _B_in["w_up"],
        "B_w_down": _B_in["w_down"],
    }

def reference(A_q, A_k, A_v, A_shift_k, A_ssm_k, A_ssm_D, B_x, B_w_gate, B_w_up, B_w_down):
    def _A_ref(q, k, v, shift_k, ssm_k, ssm_D):
        B, S, D = q.shape
        ks = shift_k.shape[-1]
        k_pad = _pad(k, ((0, 0), (ks - 1, 0), (0, 0)))
        k_shift = torch.zeros_like(k)
        for t in range(ks):
            k_shift = k_shift + k_pad[:, t:t + S, :] * shift_k[:, ks - 1 - t][None, None, :]
        kv = k_shift * v
        L = 2 * S
        kv_pad = _pad(kv, ((0, 0), (0, S), (0, 0)))
        kf_pad = _pad(ssm_k, ((0, 0), (0, S)))
        kv_f = (lambda x, axes=(-2,-1): torch.fft.rfft2(x.float(), dim=axes))(kv_pad[:, None, :, :], axes=(1, 2))
        kf_f = (lambda x, axes=(-2,-1): torch.fft.rfft2(x.float(), dim=axes))(kf_pad[:, None, :], axes=(1, 2))
        kf_f = (lambda x, *d: x.permute(*d))(kf_f, 1, 2, 0)
        y_f = kv_f * kf_f[None, :, :, :]
        y = (lambda x, s, axes=(-2,-1): torch.fft.irfft2(x, s=s, dim=axes).to(torch.bfloat16))(y_f, (1, L), axes=(1, 2))[:, 0, :S, :]
        y = y + kv * ssm_D[None, None, :]
        return q * y

    def _B_ref(x, w_gate, w_up, w_down):
        return (_gelu(x @ w_gate) * (x @ w_up)) @ w_down

    x = A_q
    xn = _layernorm(x, axis=-1)
    s = _A_ref(xn, A_k, A_v, A_shift_k, A_ssm_k, A_ssm_D)
    g = _silu(_B_ref(xn, B_w_gate, B_w_up, B_w_down))
    return x + s * g
```

```asm
; @launch kernel=recurrent_scan__ssm_conv_h3__geglu_ffn__prompt_kernel grid=(256,1,1) block=(256,1,1) lds=163840
.amdgcn_target "amdgcn-amd-amdhsa--gfx950"
.text
.globl recurrent_scan__ssm_conv_h3__geglu_ffn__prompt_kernel
.p2align 8
.type recurrent_scan__ssm_conv_h3__geglu_ffn__prompt_kernel,@function
recurrent_scan__ssm_conv_h3__geglu_ffn__prompt_kernel:
    s_cmp_ge_u32 s2, 256
    s_cbranch_scc1 L_k_end
    s_load_dwordx4 s[28:31], s[0:1], 0
    s_load_dwordx4 s[32:35], s[0:1], 56
    s_load_dwordx4 s[60:63], s[0:1], 16
    s_load_dwordx4 s[44:47], s[0:1], 88
    s_load_dwordx4 s[52:55], s[0:1], 72
    s_load_dwordx4 s[56:59], s[0:1], 32
    v_lshrrev_b32 v1, 6, v0
    v_and_b32 v221, 63, v0
    s_and_b32 s3, s2, 7
    v_readfirstlane_b32 s20, v1
    s_lshr_b32 s38, s2, 3
    s_and_b32 s40, s3, 1
    s_lshl_b32 s41, s40, 5
    s_add_u32 s41, s41, s38
    s_cmp_eq_u32 s41, 63
    s_cselect_b32 s64, 1, 0
    s_cselect_b32 s41, 14, s41
    s_sub_u32 s39, s41, 14
    s_mul_i32 s22, s39, 9363
    s_lshr_b32 s22, s22, 16
    s_mul_i32 s40, s22, 7
    s_sub_u32 s21, s39, s40
    s_lshr_b32 s39, s41, 1
    s_and_b32 s40, s41, 1
    s_add_u32 s40, s40, 7
    s_cmp_lt_u32 s41, 14
    s_cselect_b32 s22, s39, s22
    s_cselect_b32 s21, s40, s21
    s_mov_b32 s40, 105062481
    s_cmp_eq_u32 s3, 2
    s_cselect_b32 s40, 88281186, s40
    s_cmp_eq_u32 s3, 3
    s_cselect_b32 s40, 88281186, s40
    s_cmp_ge_u32 s3, 4
    s_cselect_b32 s40, 106176771, s40
    s_cmp_ge_u32 s3, 6
    s_cselect_b32 s40, 106111296, s40
    s_lshl_b32 s22, s22, 2
    s_lshr_b32 s22, s40, s22
    s_and_b32 s22, s22, 7
    s_lshr_b32 s39, s3, 1
    s_mul_i32 s39, s39, 7
    s_add_u32 s22, s22, s39
    s_mul_i32 s65, s21, 14
    s_cmp_eq_u32 s21, 8
    s_cselect_b32 s65, 113, s65
    v_lshlrev_b32 v222, 4, v221
    s_getpc_b64 s[16:17]
L_k_here:
    s_add_u32 s16, s16, L_k_main-L_k_here
    s_addc_u32 s17, s17, 0
    s_mov_b32 s18, L_k_end-L_k_main
    s_mov_b32 s19, 0x20000
    s_lshl_b32 s41, s38, 2
    s_add_u32 s41, s41, s20
    s_mul_i32 s41, s41, 640
    v_min_u32 v10, 4, v221
    v_lshlrev_b32 v10, 7, v10
    buffer_load_dword v255, v10, s[16:19], s41 offen
    v_lshrrev_b32 v0, 3, v221
    v_lshlrev_b32 v0, 11, v0
    v_and_b32 v1, 7, v221
    v_lshrrev_b32 v2, 4, v221
    v_xor_b32 v3, v1, v2
    v_lshl_add_u32 v208, v3, 4, v0
    v_xor_b32 v3, 4, v3
    v_lshl_add_u32 v209, v3, 4, v0
    v_add_u32 v209, 15360, v209
    v_add_u32 v210, 30720, v208
    v_add_u32 v211, 30720, v209
    v_mul_u32_u24 v0, 7168, v2
    v_and_b32 v1, 15, v221
    v_lshlrev_b32 v3, 1, v2
    v_xor_b32 v3, v1, v3
    v_lshl_add_u32 v212, v3, 4, v0
    v_add_u32 v213, 27648, v212
    v_xor_b32 v3, 8, v3
    v_lshl_add_u32 v214, v3, 4, v0
    v_add_u32 v214, 55296, v214
    v_add_u32 v215, 27648, v214
    s_lshl_b32 s40, s65, 15
    s_lshl_b32 s41, s20, 17
    s_add_u32 s40, s40, s41
    s_cmp_lt_u32 s21, 7
    s_cselect_b32 s6, 0, 32768
    s_add_u32 s6, s6, 458752
    s_sub_u32 s6, s6, s41
    s_mov_b32 s7, 0x20000
    s_lshl_b32 s41, s22, 8
    s_and_b32 s42, s20, 1
    s_mul_i32 s42, s42, 114688
    s_add_u32 s41, s41, s42
    s_sub_u32 s10, 7340032, s41
    s_mov_b32 s11, 0x20000
    s_cmp_eq_u32 s64, 1
    s_cselect_b32 s6, 0, s6
    s_cselect_b32 s10, 0, s10
    s_lshl_b32 s43, s20, 12
    s_lshl_b32 s26, s20, 13
    s_add_u32 s26, s26, 98304
    s_cmp_lt_u32 s20, 2
    s_waitcnt lgkmcnt(0)
    s_cselect_b32 s8, s32, s34
    s_cselect_b32 s9, s33, s35
    s_add_u32 s4, s28, s40
    s_addc_u32 s5, s29, 0
    s_add_u32 s8, s8, s41
    s_addc_u32 s9, s9, 0
    s_add_u32 m0, s26, 0
    s_mov_b32 s23, 0
    buffer_load_dwordx4 v208, s[4:7], s23 offen offset:0 lds
    buffer_load_dwordx4 v209, s[4:7], s23 offen offset:1024 lds
    buffer_load_dwordx4 v210, s[4:7], s23 offen offset:2048 lds
    buffer_load_dwordx4 v211, s[4:7], s23 offen offset:3072 lds
    s_add_u32 m0, s43, 0
    s_mov_b32 s25, 0
    buffer_load_dwordx4 v212, s[8:11], s25 offen offset:0  lds
    buffer_load_dwordx4 v213, s[8:11], s25 offen offset:1024  lds
    buffer_load_dwordx4 v214, s[8:11], s25 offen offset:2048  lds
    buffer_load_dwordx4 v215, s[8:11], s25 offen offset:3072  lds
    s_add_u32 m0, s26, 4096
    s_mov_b32 s23, 65536
    buffer_load_dwordx4 v208, s[4:7], s23 offen offset:0 lds
    buffer_load_dwordx4 v209, s[4:7], s23 offen offset:1024 lds
    buffer_load_dwordx4 v210, s[4:7], s23 offen offset:2048 lds
    buffer_load_dwordx4 v211, s[4:7], s23 offen offset:3072 lds
    s_add_u32 m0, s43, 16384
    s_mov_b32 s25, 229376
    buffer_load_dwordx4 v212, s[8:11], s25 offen offset:0  lds
    buffer_load_dwordx4 v213, s[8:11], s25 offen offset:1024  lds
    buffer_load_dwordx4 v214, s[8:11], s25 offen offset:2048  lds
    buffer_load_dwordx4 v215, s[8:11], s25 offen offset:3072  lds
    v_lshrrev_b32 v10, 1, v221
    v_mul_u32_u24 v10, 7168, v10
    v_and_b32 v11, 1, v221
    v_lshl_add_u32 v10, v11, 7, v10
    v_cmp_gt_u32 vcc, 32, v221
    v_mov_b32 v11, 2147483648
    s_add_u32 s39, s21, 2
    s_cmp_ge_u32 s39, 6
    s_cselect_b32 s40, 2, 0
    s_add_u32 s39, s39, s40
    s_mul_i32 s39, s39, 229376
    v_cndmask_b32 v10, v11, v10, vcc
    s_lshl_b32 s40, s2, 3
    s_lshl_b32 s41, s20, 1
    s_add_u32 s40, s40, s41
    v_lshrrev_b32 v4, 5, v221
    v_add_u32 v4, s40, v4
    v_and_b32 v5, 31, v221
    v_lshlrev_b32 v6, 4, v5
    v_lshl_add_u32 v228, v4, 11, v6
    s_cmp_lt_u32 s21, 9
    s_cselect_b32 s27, s39, 1073741824
    buffer_load_dword v227, v10, s[8:11], s27 offen
    s_mov_b32 s12, s28
    s_mov_b32 s13, s29
    s_mov_b32 s14, 4194304
    s_mov_b32 s15, 0x20000
    buffer_load_dwordx4 v[92:95], v228, s[12:15], 0 offen offset:0
    buffer_load_dwordx4 v[96:99], v228, s[12:15], 0 offen offset:512
    buffer_load_dwordx4 v[100:103], v228, s[12:15], 0 offen offset:1024
    buffer_load_dwordx4 v[104:107], v228, s[12:15], 0 offen offset:1536
    s_mov_b32 s39, 1073741824
    v_mov_b32 v226, v10
    s_mov_b32 s36, s46
    s_mov_b32 s37, s47
    s_branch L_k_main
    .p2align 12
L_k_main:
    s_add_u32 s48, s36, 524288
    s_addc_u32 s49, s37, 0
    s_mov_b32 s50, 50432
    s_mov_b32 s51, 0x20000
    s_mov_b32 s16, s30
    s_mov_b32 s17, s31
    s_mov_b32 s18, 4194304
    s_mov_b32 s19, 0x20000
    s_mov_b32 s30, s28
    s_mov_b32 s31, s29
    s_mov_b32 s32, s44
    s_mov_b32 s33, s45
    s_add_u32 s34, s36, 1048576
    s_addc_u32 s35, s37, 0
    s_lshl_b32 s41, s20, 6
    v_add_u32 v12, s41, v221
    v_lshlrev_b32 v13, 2, v12
    v_cmp_eq_u32 vcc, 0, v12
    s_lshl_b32 s41, s20, 8
    s_add_u32 s41, s41, s2
    v_cndmask_b32 v251, v11, v13, vcc
    s_cmp_eq_u32 s41, 249
    s_cbranch_scc0 L_k_nononce
    s_mov_b32 s41, 50176
    buffer_load_dword v10, v251, s[48:51], s41 offen sc1
    s_mov_b32 s42, 0x9e3779b1
    s_mov_b32 s12, s32
    s_mov_b32 s13, s33
    s_mov_b32 s14, 256
    s_waitcnt vmcnt(0)
    v_mul_lo_u32 v13, v10, s42
    v_add_u32 v13, 0x7f4a7c15, v13
    v_or_b32 v13, 1, v13
    v_xor_b32 v12, 2, v13
    v_cmp_eq_u32 vcc, v13, v10
    s_nop 1
    v_cndmask_b32 v13, v13, v12, vcc
    buffer_store_dword v13, v251, s[12:15], 0 offen offset:128 sc1
    buffer_store_dword v13, v251, s[12:15], 0 offen sc1
    buffer_store_dword v13, v251, s[48:51], s41 offen sc1
    s_mov_b32 s14, 4194304
L_k_nononce:
    s_mov_b32 s12, s60
    s_mov_b32 s13, s61
    v_lshlrev_b32 v14, 4, v4
    v_cmp_eq_u32 vcc, 0, v5
    s_lshr_b32 s40, s2, 4
    s_lshl_b32 s40, s40, 7
    v_cndmask_b32 v233, v11, v14, vcc
    s_lshl_b32 s41, s20, 5
    s_add_u32 s40, s40, s41
    s_and_b32 s42, s2, 15
    v_lshrrev_b32 v4, 4, v221
    v_lshl_add_u32 v4, v4, 3, s40
    v_and_b32 v5, 15, v221
    s_lshl_b32 s41, s42, 7
    v_lshl_add_u32 v6, v5, 3, s41
    v_lshl_add_u32 v229, v4, 11, v6
    v_subrev_u32 v231, 6144, v229
    v_subrev_u32 v232, 2048, v229
    s_lshl_b32 s41, s42, 9
    v_lshl_add_u32 v235, v5, 5, s41
    s_lshl_b32 s41, s40, 11
    s_lshl_b32 s27, s42, 12
    s_add_u32 s41, s41, s27
    v_lshl_add_u32 v9, v5, 6, s41
    v_and_b32 v6, 48, v221
    v_add_u32 v234, v6, v9
    v_and_b32 v6, 3, v221
    v_lshlrev_b32 v6, 6, v6
    v_and_b32 v9, 60, v221
    v_add_u32 v230, v6, v9
    v_and_b32 v10, 15, v221
    v_lshrrev_b32 v15, 4, v221
    v_lshrrev_b32 v12, 1, v10
    v_xor_b32 v12, v12, v15
    v_lshlrev_b32 v12, 4, v12
    v_lshl_add_u32 v12, v10, 7, v12
    v_add_u32 v216, 98304, v12
    v_xor_b32 v217, 64, v216
    s_mov_b32 s47, 0xffff0000
    v_bfe_u32 v12, v221, 2, 2
    v_lshl_add_u32 v13, v15, 3, v12
    v_lshlrev_b32 v13, 8, v13
    v_and_b32 v14, 1, v15
    v_lshl_add_u32 v12, v14, 2, v12
    s_lshl_b32 s41, s20, 1
    v_xor_b32 v12, s41, v12
    v_lshl_add_u32 v13, v12, 5, v13
    v_and_b32 v12, 3, v221
    v_lshl_add_u32 v218, v12, 3, v13
    v_xor_b32 v219, 32, v218
    v_add_u32 v236, 65536, v218
    v_add_u32 v237, 65536, v219
    v_bfe_u32 v12, v221, 1, 1
    v_lshrrev_b32 v13, 5, v221
    v_cmp_eq_u32 vcc, v12, v13
    v_mov_b32 v12, 0x3f803f80
    v_and_b32 v13, 1, v221
    v_cndmask_b32 v12, 0, v12, vcc
    v_mul_u32_u24 v13, 0xaaaa, v13
    v_add_u32 v220, 0x4444, v13
    v_accvgpr_write_b32 a248, v12
    v_accvgpr_write_b32 a249, v12
    v_accvgpr_write_b32 a250, v12
    v_accvgpr_write_b32 a251, v12
    v_mov_b32 v223, 0
    s_lshl_b32 s40, s2, 2
    s_add_u32 s40, s40, 45056
    s_lshl_b32 s41, s42, 8
    s_lshr_b32 s42, s2, 4
    s_lshl_b32 s27, s42, 2
    s_add_u32 s41, s41, s27
    s_add_u32 s41, s41, 46080
    v_mov_b32 v224, 2147483648
    v_writelane_b32 v224, s40, 0
    v_writelane_b32 v224, s41, 1
    s_lshl_b32 s40, s65, 3
    s_add_u32 s40, s40, 45056
    v_lshl_add_u32 v225, v221, 2, s40
    s_lshl_b32 s41, s42, 8
    s_add_u32 s41, s41, 45952
    v_lshl_add_u32 v12, v221, 2, s41
    v_cmp_gt_u32 vcc, 32, v221
    s_lshl_b32 s41, s20, 30
    v_or_b32 v224, s41, v224
    v_cndmask_b32 v225, v12, v225, vcc
    v_or_b32 v225, s41, v225
    v_accvgpr_write_b32 a240, 0
    v_accvgpr_write_b32 a241, 0
    v_accvgpr_write_b32 a242, 0
    v_accvgpr_write_b32 a243, 0
    v_accvgpr_write_b32 a244, 0
    v_accvgpr_write_b32 a245, 0
    v_accvgpr_write_b32 a246, 0
    v_accvgpr_write_b32 a247, 0
    s_waitcnt vmcnt(21)
    s_mov_b64 exec, 0
    s_cmp_eq_u32 s20, 0
    s_cbranch_scc1 L_k_w0
    s_cmp_eq_u32 s20, 1
    s_cbranch_scc1 L_k_w1
    s_cmp_eq_u32 s20, 2
    s_cbranch_scc1 L_k_w2
    s_branch L_k_w3
L_k_wback:
    s_mov_b64 exec, -1
    s_waitcnt vmcnt(5)
    s_barrier
    ds_read_b128 v[0:3], v216 offset:0
    ds_read_b64_tr_b16 v[60:61], v218 offset:0
    ds_read_b64_tr_b16 v[62:63], v218 offset:1024
    ds_read_b128 v[4:7], v217 offset:0
    ds_read_b64_tr_b16 v[76:77], v218 offset:16384
    ds_read_b64_tr_b16 v[78:79], v218 offset:17408
    ds_read_b128 v[8:11], v216 offset:2048
    ds_read_b128 v[12:15], v217 offset:2048
    ds_read_b64_tr_b16 v[64:65], v219 offset:0
    ds_read_b64_tr_b16 v[66:67], v219 offset:1024
    ds_read_b64_tr_b16 v[80:81], v219 offset:16384
    ds_read_b64_tr_b16 v[82:83], v219 offset:17408
    ds_read_b64_tr_b16 v[68:69], v218 offset:8192
    ds_read_b64_tr_b16 v[70:71], v218 offset:9216
    ds_read_b64_tr_b16 v[84:85], v218 offset:24576
    ds_read_b64_tr_b16 v[86:87], v218 offset:25600
    s_waitcnt lgkmcnt(8)
    v_mfma_f32_16x16x32_bf16 a[0:3], v[60:63], v[0:3], 0
    ds_read_b64_tr_b16 v[72:73], v219 offset:8192
    v_mfma_f32_16x16x32_bf16 a[0:3], v[76:79], v[4:7], a[0:3]
    ds_read_b64_tr_b16 v[74:75], v219 offset:9216
    v_mfma_f32_16x16x32_bf16 a[16:19], v[76:79], v[12:15], 0
    ds_read_b64_tr_b16 v[88:89], v219 offset:24576
    s_add_u32 m0, s26, 32768
    v_mfma_f32_16x16x32_bf16 a[16:19], v[60:63], v[8:11], a[16:19]
    s_mov_b32 s23, 128
    s_waitcnt lgkmcnt(7)
    v_mfma_f32_16x16x32_bf16 a[4:7], v[64:67], v[0:3], 0
    ds_read_b64_tr_b16 v[90:91], v219 offset:25600
    v_mfma_f32_16x16x32_bf16 a[4:7], v[80:83], v[4:7], a[4:7]
    ds_read_b128 v[16:19], v216 offset:4096
    v_mfma_f32_16x16x32_bf16 a[20:23], v[80:83], v[12:15], 0
    ds_read_b128 v[20:23], v217 offset:4096
    v_mfma_f32_16x16x32_bf16 a[20:23], v[64:67], v[8:11], a[20:23]
    s_waitcnt lgkmcnt(6)
    v_mfma_f32_16x16x32_bf16 a[8:11], v[68:71], v[0:3], 0
    ds_read_b128 v[24:27], v216 offset:6144
    v_mfma_f32_16x16x32_bf16 a[8:11], v[84:87], v[4:7], a[8:11]
    ds_read_b128 v[28:31], v217 offset:6144
    v_mfma_f32_16x16x32_bf16 a[24:27], v[84:87], v[12:15], 0
    ds_read_b128 v[32:35], v216 offset:8192
    v_mfma_f32_16x16x32_bf16 a[24:27], v[68:71], v[8:11], a[24:27]
    s_waitcnt lgkmcnt(5)
    v_mfma_f32_16x16x32_bf16 a[12:15], v[72:75], v[0:3], 0
    ds_read_b128 v[36:39], v217 offset:8192
    v_mfma_f32_16x16x32_bf16 a[12:15], v[88:91], v[4:7], a[12:15]
    ds_read_b128 v[40:43], v216 offset:10240
    v_mfma_f32_16x16x32_bf16 a[28:31], v[88:91], v[12:15], 0
    ds_read_b128 v[44:47], v217 offset:10240
    v_mfma_f32_16x16x32_bf16 a[28:31], v[72:75], v[8:11], a[28:31]
    s_waitcnt lgkmcnt(4)
    v_mfma_f32_16x16x32_bf16 a[32:35], v[60:63], v[16:19], 0
    ds_read_b128 v[48:51], v216 offset:12288
    v_mfma_f32_16x16x32_bf16 a[32:35], v[76:79], v[20:23], a[32:35]
    ds_read_b128 v[52:55], v217 offset:12288
    v_mfma_f32_16x16x32_bf16 a[36:39], v[80:83], v[20:23], 0
    ds_read_b128 v[0:3], v216 offset:14336
    v_mfma_f32_16x16x32_bf16 a[36:39], v[64:67], v[16:19], a[36:39]
    ds_read_b128 v[4:7], v217 offset:14336
    v_mfma_f32_16x16x32_bf16 a[40:43], v[68:71], v[16:19], 0
    ds_read_b128 v[8:11], v216 offset:16384
    v_mfma_f32_16x16x32_bf16 a[40:43], v[84:87], v[20:23], a[40:43]
    ds_read_b128 v[12:15], v217 offset:16384
    v_mfma_f32_16x16x32_bf16 a[44:47], v[88:91], v[20:23], 0
    buffer_load_dwordx4 v208, s[4:7], s23 offen offset:0 lds
    v_mfma_f32_16x16x32_bf16 a[44:47], v[72:75], v[16:19], a[44:47]
    ds_read_b128 v[16:19], v216 offset:18432
    v_mfma_f32_16x16x32_bf16 a[60:63], v[72:75], v[24:27], 0
    ds_read_b128 v[20:23], v217 offset:18432
    v_mfma_f32_16x16x32_bf16 a[60:63], v[88:91], v[28:31], a[60:63]
    buffer_load_dwordx4 v209, s[4:7], s23 offen offset:1024 lds
    v_mfma_f32_16x16x32_bf16 a[56:59], v[84:87], v[28:31], 0
    buffer_load_dwordx4 v210, s[4:7], s23 offen offset:2048 lds
    v_mfma_f32_16x16x32_bf16 a[56:59], v[68:71], v[24:27], a[56:59]
    buffer_load_dwordx4 v211, s[4:7], s23 offen offset:3072 lds
    v_smfmac_f32_16x16x64_bf16 a[240:243], a[248:251], v[60:67], v220
    s_add_u32 m0, s26, 36864
    s_mov_b32 s23, 65664
    v_mfma_f32_16x16x32_bf16 a[52:55], v[64:67], v[24:27], 0
    buffer_load_dwordx4 v208, s[4:7], s23 offen offset:0 lds
    v_mfma_f32_16x16x32_bf16 a[52:55], v[80:83], v[28:31], a[52:55]
    buffer_load_dwordx4 v209, s[4:7], s23 offen offset:1024 lds
    v_mfma_f32_16x16x32_bf16 a[48:51], v[76:79], v[28:31], 0
    buffer_load_dwordx4 v210, s[4:7], s23 offen offset:2048 lds
    v_mfma_f32_16x16x32_bf16 a[48:51], v[60:63], v[24:27], a[48:51]
    s_waitcnt lgkmcnt(8)
    v_mfma_f32_16x16x32_bf16 a[64:67], v[60:63], v[32:35], 0
    ds_read_b128 v[24:27], v216 offset:20480
    v_mfma_f32_16x16x32_bf16 a[64:67], v[76:79], v[36:39], a[64:67]
    ds_read_b128 v[28:31], v217 offset:20480
    v_mfma_f32_16x16x32_bf16 a[68:71], v[80:83], v[36:39], 0
    buffer_load_dwordx4 v211, s[4:7], s23 offen offset:3072 lds
    v_mfma_f32_16x16x32_bf16 a[68:71], v[64:67], v[32:35], a[68:71]
    s_add_u32 m0, s43, 32768
    s_mov_b32 s25, 458752
    v_mfma_f32_16x16x32_bf16 a[72:75], v[68:71], v[32:35], 0
    buffer_load_dwordx4 v212, s[8:11], s25 offen offset:0  lds
    v_mfma_f32_16x16x32_bf16 a[72:75], v[84:87], v[36:39], a[72:75]
    buffer_load_dwordx4 v213, s[8:11], s25 offen offset:1024  lds
    v_mfma_f32_16x16x32_bf16 a[76:79], v[88:91], v[36:39], 0
    buffer_load_dwordx4 v214, s[8:11], s25 offen offset:2048  lds
    v_mfma_f32_16x16x32_bf16 a[76:79], v[72:75], v[32:35], a[76:79]
    ds_read_b128 v[32:35], v216 offset:22528
    v_mfma_f32_16x16x32_bf16 a[92:95], v[72:75], v[40:43], 0
    ds_read_b128 v[36:39], v217 offset:22528
    v_mfma_f32_16x16x32_bf16 a[92:95], v[88:91], v[44:47], a[92:95]
    buffer_load_dwordx4 v215, s[8:11], s25 offen offset:3072  lds
    v_mfma_f32_16x16x32_bf16 a[88:91], v[84:87], v[44:47], 0
    s_add_u32 m0, s43, 49152
    s_mov_b32 s25, 688128
    v_mfma_f32_16x16x32_bf16 a[88:91], v[68:71], v[40:43], a[88:91]
    buffer_load_dwordx4 v212, s[8:11], s25 offen offset:0  lds
    v_smfmac_f32_16x16x64_bf16 a[244:247], a[248:251], v[68:75], v220
    buffer_load_dwordx4 v213, s[8:11], s25 offen offset:1024  lds
    v_mfma_f32_16x16x32_bf16 a[84:87], v[64:67], v[40:43], 0
    buffer_load_dwordx4 v214, s[8:11], s25 offen offset:2048  lds
    v_mfma_f32_16x16x32_bf16 a[84:87], v[80:83], v[44:47], a[84:87]
    buffer_load_dwordx4 v215, s[8:11], s25 offen offset:3072  lds
    v_mfma_f32_16x16x32_bf16 a[80:83], v[76:79], v[44:47], 0
    v_mfma_f32_16x16x32_bf16 a[80:83], v[60:63], v[40:43], a[80:83]
    s_waitcnt lgkmcnt(8)
    v_mfma_f32_16x16x32_bf16 a[96:99], v[60:63], v[48:51], 0
    ds_read_b128 v[40:43], v216 offset:28672
    v_mfma_f32_16x16x32_bf16 a[96:99], v[76:79], v[52:55], a[96:99]
    ds_read_b128 v[44:47], v217 offset:28672
    v_mfma_f32_16x16x32_bf16 a[100:103], v[80:83], v[52:55], 0
    v_mfma_f32_16x16x32_bf16 a[100:103], v[64:67], v[48:51], a[100:103]
    v_mfma_f32_16x16x32_bf16 a[104:107], v[68:71], v[48:51], 0
    v_mfma_f32_16x16x32_bf16 a[104:107], v[84:87], v[52:55], a[104:107]
    v_mfma_f32_16x16x32_bf16 a[108:111], v[88:91], v[52:55], 0
    v_mfma_f32_16x16x32_bf16 a[108:111], v[72:75], v[48:51], a[108:111]
    ds_read_b128 v[48:51], v216 offset:24576
    v_mfma_f32_16x16x32_bf16 a[124:127], v[72:75], v[0:3], 0
    ds_read_b128 v[52:55], v217 offset:24576
    v_mfma_f32_16x16x32_bf16 a[124:127], v[88:91], v[4:7], a[124:127]
    v_mfma_f32_16x16x32_bf16 a[120:123], v[84:87], v[4:7], 0
    v_mfma_f32_16x16x32_bf16 a[120:123], v[68:71], v[0:3], a[120:123]
    v_smfmac_f32_16x16x64_bf16 a[240:243], a[248:251], v[76:83], v220
    v_mfma_f32_16x16x32_bf16 a[116:119], v[64:67], v[0:3], 0
    v_mfma_f32_16x16x32_bf16 a[116:119], v[80:83], v[4:7], a[116:119]
    v_mfma_f32_16x16x32_bf16 a[112:115], v[76:79], v[4:7], 0
    v_mfma_f32_16x16x32_bf16 a[112:115], v[60:63], v[0:3], a[112:115]
    s_waitcnt lgkmcnt(8)
    v_mfma_f32_16x16x32_bf16 a[128:131], v[60:63], v[8:11], 0
    ds_read_b128 v[0:3], v216 offset:26624
    v_mfma_f32_16x16x32_bf16 a[128:131], v[76:79], v[12:15], a[128:131]
    ds_read_b128 v[4:7], v217 offset:26624
    v_mfma_f32_16x16x32_bf16 a[132:135], v[80:83], v[12:15], 0
    v_mfma_f32_16x16x32_bf16 a[132:135], v[64:67], v[8:11], a[132:135]
    v_mfma_f32_16x16x32_bf16 a[136:139], v[68:71], v[8:11], 0
    v_mfma_f32_16x16x32_bf16 a[136:139], v[84:87], v[12:15], a[136:139]
    s_waitcnt vmcnt(0) lgkmcnt(0)
    s_barrier
    v_mfma_f32_16x16x32_bf16 a[140:143], v[88:91], v[12:15], 0
    s_add_u32 m0, s26, 0
    s_mov_b32 s23, 256
    v_mfma_f32_16x16x32_bf16 a[140:143], v[72:75], v[8:11], a[140:143]
    ds_read_b128 v[8:11], v216 offset:32768
    v_mfma_f32_16x16x32_bf16 a[156:159], v[72:75], v[16:19], 0
    ds_read_b128 v[12:15], v217 offset:32768
    v_mfma_f32_16x16x32_bf16 a[156:159], v[88:91], v[20:23], a[156:159]
    buffer_load_dwordx4 v208, s[4:7], s23 offen offset:0 lds
    v_mfma_f32_16x16x32_bf16 a[152:155], v[84:87], v[20:23], 0
    buffer_load_dwordx4 v209, s[4:7], s23 offen offset:1024 lds
    v_mfma_f32_16x16x32_bf16 a[152:155], v[68:71], v[16:19], a[152:155]
    v_mfma_f32_16x16x32_bf16 a[148:151], v[64:67], v[16:19], 0
    v_mfma_f32_16x16x32_bf16 a[148:151], v[80:83], v[20:23], a[148:151]
    v_mfma_f32_16x16x32_bf16 a[144:147], v[76:79], v[20:23], 0
    v_mfma_f32_16x16x32_bf16 a[144:147], v[60:63], v[16:19], a[144:147]
    v_mfma_f32_16x16x32_bf16 a[160:163], v[60:63], v[24:27], 0
    ds_read_b128 v[16:19], v216 offset:34816
    v_mfma_f32_16x16x32_bf16 a[160:163], v[76:79], v[28:31], a[160:163]
    ds_read_b128 v[20:23], v217 offset:34816
    v_mfma_f32_16x16x32_bf16 a[164:167], v[80:83], v[28:31], 0
    buffer_load_dwordx4 v210, s[4:7], s23 offen offset:2048 lds
    v_mfma_f32_16x16x32_bf16 a[164:167], v[64:67], v[24:27], a[164:167]
    buffer_load_dwordx4 v211, s[4:7], s23 offen offset:3072 lds
    v_smfmac_f32_16x16x64_bf16 a[244:247], a[248:251], v[84:91], v220
    v_mfma_f32_16x16x32_bf16 a[168:171], v[68:71], v[24:27], 0
    v_mfma_f32_16x16x32_bf16 a[168:171], v[84:87], v[28:31], a[168:171]
    v_mfma_f32_16x16x32_bf16 a[172:175], v[88:91], v[28:31], 0
    v_mfma_f32_16x16x32_bf16 a[172:175], v[72:75], v[24:27], a[172:175]
    ds_read_b128 v[24:27], v216 offset:36864
    s_add_u32 m0, s26, 4096
    v_mfma_f32_16x16x32_bf16 a[188:191], v[72:75], v[32:35], 0
    ds_read_b128 v[28:31], v217 offset:36864
    s_mov_b32 s23, 65792
    v_mfma_f32_16x16x32_bf16 a[188:191], v[88:91], v[36:39], a[188:191]
    buffer_load_dwordx4 v208, s[4:7], s23 offen offset:0 lds
    v_mfma_f32_16x16x32_bf16 a[184:187], v[84:87], v[36:39], 0
    v_mfma_f32_16x16x32_bf16 a[184:187], v[68:71], v[32:35], a[184:187]
    buffer_load_dwordx4 v209, s[4:7], s23 offen offset:1024 lds
    v_mfma_f32_16x16x32_bf16 a[180:183], v[64:67], v[32:35], 0
    v_mfma_f32_16x16x32_bf16 a[180:183], v[80:83], v[36:39], a[180:183]
    v_mfma_f32_16x16x32_bf16 a[176:179], v[76:79], v[36:39], 0
    s_cmp_lt_u32 s21, 7
    v_mfma_f32_16x16x32_bf16 a[176:179], v[60:63], v[32:35], a[176:179]
    s_cbranch_scc1 L_k_sk1
    v_mfma_f32_16x16x32_bf16 a[224:227], v[60:63], v[40:43], 0
    v_mfma_f32_16x16x32_bf16 a[224:227], v[76:79], v[44:47], a[224:227]
    v_mfma_f32_16x16x32_bf16 a[228:231], v[80:83], v[44:47], 0
    v_mfma_f32_16x16x32_bf16 a[228:231], v[64:67], v[40:43], a[228:231]
    v_mfma_f32_16x16x32_bf16 a[232:235], v[68:71], v[40:43], 0
    v_mfma_f32_16x16x32_bf16 a[232:235], v[84:87], v[44:47], a[232:235]
    v_mfma_f32_16x16x32_bf16 a[236:239], v[88:91], v[44:47], 0
    v_mfma_f32_16x16x32_bf16 a[236:239], v[72:75], v[40:43], a[236:239]
L_k_sk1:
    ds_read_b128 v[32:35], v216 offset:38912
    buffer_load_dwordx4 v210, s[4:7], s23 offen offset:2048 lds
    v_mfma_f32_16x16x32_bf16 a[192:195], v[60:63], v[48:51], 0
    ds_read_b128 v[36:39], v217 offset:38912
    buffer_load_dwordx4 v211, s[4:7], s23 offen offset:3072 lds
    v_mfma_f32_16x16x32_bf16 a[192:195], v[76:79], v[52:55], a[192:195]
    ds_read_b128 v[40:43], v216 offset:40960
    s_add_u32 m0, s43, 65536
    v_mfma_f32_16x16x32_bf16 a[208:211], v[76:79], v[4:7], 0
    ds_read_b128 v[44:47], v217 offset:40960
    s_mov_b32 s25, 917504
    v_mfma_f32_16x16x32_bf16 a[208:211], v[60:63], v[0:3], a[208:211]
    ds_read_b64_tr_b16 v[60:61], v218 offset:32768
    buffer_load_dwordx4 v212, s[8:11], s25 offen offset:0  lds
    v_mfma_f32_16x16x32_bf16 a[196:199], v[64:67], v[48:51], 0
    ds_read_b64_tr_b16 v[62:63], v218 offset:33792
    v_mfma_f32_16x16x32_bf16 a[196:199], v[80:83], v[52:55], a[196:199]
    ds_read_b64_tr_b16 v[76:77], v218 offset:49152
    buffer_load_dwordx4 v213, s[8:11], s25 offen offset:1024  lds
    v_mfma_f32_16x16x32_bf16 a[212:215], v[80:83], v[4:7], 0
    ds_read_b64_tr_b16 v[78:79], v218 offset:50176
    v_mfma_f32_16x16x32_bf16 a[212:215], v[64:67], v[0:3], a[212:215]
    ds_read_b64_tr_b16 v[64:65], v219 offset:32768
    v_mfma_f32_16x16x32_bf16 a[200:203], v[68:71], v[48:51], 0
    ds_read_b64_tr_b16 v[66:67], v219 offset:33792
    v_mfma_f32_16x16x32_bf16 a[200:203], v[84:87], v[52:55], a[200:203]
    ds_read_b64_tr_b16 v[80:81], v219 offset:49152
    v_mfma_f32_16x16x32_bf16 a[216:219], v[84:87], v[4:7], 0
    ds_read_b64_tr_b16 v[82:83], v219 offset:50176
    buffer_load_dwordx4 v214, s[8:11], s25 offen offset:2048  lds
    v_mfma_f32_16x16x32_bf16 a[216:219], v[68:71], v[0:3], a[216:219]
    ds_read_b64_tr_b16 v[68:69], v218 offset:40960
    v_mfma_f32_16x16x32_bf16 a[204:207], v[72:75], v[48:51], 0
    ds_read_b64_tr_b16 v[70:71], v218 offset:41984
    v_mfma_f32_16x16x32_bf16 a[204:207], v[88:91], v[52:55], a[204:207]
    ds_read_b64_tr_b16 v[84:85], v218 offset:57344
    v_mfma_f32_16x16x32_bf16 a[220:223], v[88:91], v[4:7], 0
    ds_read_b64_tr_b16 v[86:87], v218 offset:58368
    buffer_load_dwordx4 v215, s[8:11], s25 offen offset:3072  lds
    v_mfma_f32_16x16x32_bf16 a[220:223], v[72:75], v[0:3], a[220:223]
    s_waitcnt lgkmcnt(8)
    v_mfma_f32_16x16x32_bf16 a[0:3], v[60:63], v[8:11], a[0:3]
    ds_read_b64_tr_b16 v[72:73], v219 offset:40960
    v_mfma_f32_16x16x32_bf16 a[0:3], v[76:79], v[12:15], a[0:3]
    ds_read_b64_tr_b16 v[74:75], v219 offset:41984
    v_lshlrev_b32 v168, 16, v92
    v_mfma_f32_16x16x32_bf16 a[16:19], v[76:79], v[20:23], a[16:19]
    ds_read_b64_tr_b16 v[88:89], v219 offset:57344
    v_and_b32 v169, s47, v92
    v_mfma_f32_16x16x32_bf16 a[16:19], v[60:63], v[16:19], a[16:19]
    s_add_u32 m0, s43, 81920
    s_waitcnt lgkmcnt(7)
    v_mfma_f32_16x16x32_bf16 a[4:7], v[64:67], v[8:11], a[4:7]
    ds_read_b64_tr_b16 v[90:91], v219 offset:58368
    s_mov_b32 s25, 1146880
    v_mfma_f32_16x16x32_bf16 a[4:7], v[80:83], v[12:15], a[4:7]
    ds_read_b128 v[48:51], v216 offset:43008
    v_lshlrev_b32 v170, 16, v93
    v_mfma_f32_16x16x32_bf16 a[20:23], v[80:83], v[20:23], a[20:23]
    ds_read_b128 v[52:55], v217 offset:43008
    v_and_b32 v171, s47, v93
    v_mfma_f32_16x16x32_bf16 a[20:23], v[64:67], v[16:19], a[20:23]
    v_lshlrev_b32 v172, 16, v94
    s_waitcnt lgkmcnt(6)
    v_mfma_f32_16x16x32_bf16 a[8:11], v[68:71], v[8:11], a[8:11]
    ds_read_b128 v[0:3], v216 offset:45056
    v_and_b32 v173, s47, v94
    v_mfma_f32_16x16x32_bf16 a[8:11], v[84:87], v[12:15], a[8:11]
    ds_read_b128 v[4:7], v217 offset:45056
    v_lshlrev_b32 v174, 16, v95
    v_mfma_f32_16x16x32_bf16 a[24:27], v[84:87], v[20:23], a[24:27]
    buffer_load_dwordx4 v212, s[8:11], s25 offen offset:0  lds
    v_mfma_f32_16x16x32_bf16 a[24:27], v[68:71], v[16:19], a[24:27]
    v_and_b32 v175, s47, v95
    s_waitcnt lgkmcnt(4)
    v_mfma_f32_16x16x32_bf16 a[12:15], v[72:75], v[8:11], a[12:15]
    buffer_load_dwordx4 v213, s[8:11], s25 offen offset:1024  lds
    v_mfma_f32_16x16x32_bf16 a[12:15], v[88:91], v[12:15], a[12:15]
    buffer_load_dwordx4 v214, s[8:11], s25 offen offset:2048  lds
    v_mfma_f32_16x16x32_bf16 a[28:31], v[88:91], v[20:23], a[28:31]
    v_lshlrev_b32 v176, 16, v96
    v_and_b32 v177, s47, v96
    v_mfma_f32_16x16x32_bf16 a[28:31], v[72:75], v[16:19], a[28:31]
    v_lshlrev_b32 v178, 16, v97
    v_mfma_f32_16x16x32_bf16 a[32:35], v[60:63], v[24:27], a[32:35]
    ds_read_b128 v[8:11], v216 offset:47104
    v_and_b32 v179, s47, v97
    v_mfma_f32_16x16x32_bf16 a[32:35], v[76:79], v[28:31], a[32:35]
    ds_read_b128 v[12:15], v217 offset:47104
    v_lshlrev_b32 v180, 16, v98
    v_mfma_f32_16x16x32_bf16 a[36:39], v[80:83], v[28:31], a[36:39]
    ds_read_b128 v[16:19], v216 offset:49152
    v_and_b32 v181, s47, v98
    v_mfma_f32_16x16x32_bf16 a[36:39], v[64:67], v[24:27], a[36:39]
    ds_read_b128 v[20:23], v217 offset:49152
    v_lshlrev_b32 v182, 16, v99
    v_mfma_f32_16x16x32_bf16 a[40:43], v[68:71], v[24:27], a[40:43]
    buffer_load_dwordx4 v215, s[8:11], s25 offen offset:3072  lds
    v_mfma_f32_16x16x32_bf16 a[40:43], v[84:87], v[28:31], a[40:43]
    s_add_u32 m0, s43, 0
    s_mov_b32 s25, 1835008
    v_mfma_f32_16x16x32_bf16 a[44:47], v[88:91], v[28:31], a[44:47]
    buffer_load_dwordx4 v212, s[8:11], s25 offen offset:0  lds
    v_mfma_f32_16x16x32_bf16 a[44:47], v[72:75], v[24:27], a[44:47]
    ds_read_b128 v[24:27], v216 offset:51200
    v_and_b32 v183, s47, v99
    v_mfma_f32_16x16x32_bf16 a[60:63], v[72:75], v[32:35], a[60:63]
    ds_read_b128 v[28:31], v217 offset:51200
    v_lshlrev_b32 v184, 16, v100
    v_mfma_f32_16x16x32_bf16 a[60:63], v[88:91], v[36:39], a[60:63]
    buffer_load_dwordx4 v213, s[8:11], s25 offen offset:1024  lds
    v_mfma_f32_16x16x32_bf16 a[56:59], v[84:87], v[36:39], a[56:59]
    v_and_b32 v185, s47, v100
    v_lshlrev_b32 v186, 16, v101
    v_mfma_f32_16x16x32_bf16 a[56:59], v[68:71], v[32:35], a[56:59]
    v_and_b32 v187, s47, v101
    v_lshlrev_b32 v188, 16, v102
    v_smfmac_f32_16x16x64_bf16 a[240:243], a[248:251], v[60:67], v220
    v_and_b32 v189, s47, v102
    v_lshlrev_b32 v190, 16, v103
    v_mfma_f32_16x16x32_bf16 a[52:55], v[64:67], v[32:35], a[52:55]
    v_and_b32 v191, s47, v103
    v_lshlrev_b32 v192, 16, v104
    v_mfma_f32_16x16x32_bf16 a[52:55], v[80:83], v[36:39], a[52:55]
    buffer_load_dwordx4 v214, s[8:11], s25 offen offset:2048  lds
    v_mfma_f32_16x16x32_bf16 a[48:51], v[76:79], v[36:39], a[48:51]
    v_and_b32 v193, s47, v104
    v_lshlrev_b32 v194, 16, v105
    v_mfma_f32_16x16x32_bf16 a[48:51], v[60:63], v[32:35], a[48:51]
    v_and_b32 v195, s47, v105
    s_waitcnt lgkmcnt(8)
    v_mfma_f32_16x16x32_bf16 a[64:67], v[60:63], v[40:43], a[64:67]
    ds_read_b128 v[32:35], v216 offset:53248
    v_lshlrev_b32 v196, 16, v106
    v_mfma_f32_16x16x32_bf16 a[64:67], v[76:79], v[44:47], a[64:67]
    ds_read_b128 v[36:39], v217 offset:53248
    v_and_b32 v197, s47, v106
    v_mfma_f32_16x16x32_bf16 a[68:71], v[80:83], v[44:47], a[68:71]
    buffer_load_dwordx4 v215, s[8:11], s25 offen offset:3072  lds
    v_mfma_f32_16x16x32_bf16 a[68:71], v[64:67], v[40:43], a[68:71]
    v_lshlrev_b32 v198, 16, v107
    v_and_b32 v199, s47, v107
    v_mfma_f32_16x16x32_bf16 a[72:75], v[68:71], v[40:43], a[72:75]
    v_add_f32 v200, v168, v169
    v_add_f32 v201, v170, v171
    v_mfma_f32_16x16x32_bf16 a[72:75], v[84:87], v[44:47], a[72:75]
    v_add_f32 v200, v200, v172
    v_add_f32 v201, v201, v173
    v_mfma_f32_16x16x32_bf16 a[76:79], v[88:91], v[44:47], a[76:79]
    s_add_u32 m0, s43, 16384
    s_mov_b32 s25, 2064384
    v_mfma_f32_16x16x32_bf16 a[76:79], v[72:75], v[40:43], a[76:79]
    ds_read_b128 v[40:43], v216 offset:55296
    v_add_f32 v200, v200, v174
    v_mfma_f32_16x16x32_bf16 a[92:95], v[72:75], v[48:51], a[92:95]
    ds_read_b128 v[44:47], v217 offset:55296
    v_add_f32 v201, v201, v175
    v_mfma_f32_16x16x32_bf16 a[92:95], v[88:91], v[52:55], a[92:95]
    buffer_load_dwordx4 v212, s[8:11], s25 offen offset:0  lds
    v_mfma_f32_16x16x32_bf16 a[88:91], v[84:87], v[52:55], a[88:91]
    buffer_load_dwordx4 v213, s[8:11], s25 offen offset:1024  lds
    v_mfma_f32_16x16x32_bf16 a[88:91], v[68:71], v[48:51], a[88:91]
    v_add_f32 v200, v200, v176
    v_add_f32 v201, v201, v177
    v_smfmac_f32_16x16x64_bf16 a[244:247], a[248:251], v[68:75], v220
    v_add_f32 v200, v200, v178
    v_add_f32 v201, v201, v179
    v_mfma_f32_16x16x32_bf16 a[84:87], v[64:67], v[48:51], a[84:87]
    v_add_f32 v200, v200, v180
    v_add_f32 v201, v201, v181
    v_mfma_f32_16x16x32_bf16 a[84:87], v[80:83], v[52:55], a[84:87]
    v_add_f32 v200, v200, v182
    v_add_f32 v201, v201, v183
    v_mfma_f32_16x16x32_bf16 a[80:83], v[76:79], v[52:55], a[80:83]
    buffer_load_dwordx4 v214, s[8:11], s25 offen offset:2048  lds
    v_mfma_f32_16x16x32_bf16 a[80:83], v[60:63], v[48:51], a[80:83]
    v_add_f32 v200, v200, v184
    s_waitcnt lgkmcnt(8)
    v_mfma_f32_16x16x32_bf16 a[96:99], v[60:63], v[0:3], a[96:99]
    ds_read_b128 v[48:51], v216 offset:61440
    v_add_f32 v201, v201, v185
    v_mfma_f32_16x16x32_bf16 a[96:99], v[76:79], v[4:7], a[96:99]
    ds_read_b128 v[52:55], v217 offset:61440
    v_add_f32 v200, v200, v186
    v_mfma_f32_16x16x32_bf16 a[100:103], v[80:83], v[4:7], a[100:103]
    buffer_load_dwordx4 v215, s[8:11], s25 offen offset:3072  lds
    v_mfma_f32_16x16x32_bf16 a[100:103], v[64:67], v[0:3], a[100:103]
    v_add_f32 v201, v201, v187
    v_add_f32 v200, v200, v188
    v_mfma_f32_16x16x32_bf16 a[104:107], v[68:71], v[0:3], a[104:107]
    v_add_f32 v201, v201, v189
    v_add_f32 v200, v200, v190
    v_mfma_f32_16x16x32_bf16 a[104:107], v[84:87], v[4:7], a[104:107]
    v_add_f32 v201, v201, v191
    v_add_f32 v200, v200, v192
    v_mfma_f32_16x16x32_bf16 a[108:111], v[88:91], v[4:7], a[108:111]
    v_add_f32 v201, v201, v193
    v_add_f32 v200, v200, v194
    v_mfma_f32_16x16x32_bf16 a[108:111], v[72:75], v[0:3], a[108:111]
    ds_read_b128 v[0:3], v216 offset:57344
    v_add_f32 v201, v201, v195
    v_mfma_f32_16x16x32_bf16 a[124:127], v[72:75], v[8:11], a[124:127]
    ds_read_b128 v[4:7], v217 offset:57344
    v_add_f32 v200, v200, v196
    v_mfma_f32_16x16x32_bf16 a[124:127], v[88:91], v[12:15], a[124:127]
    v_add_f32 v201, v201, v197
    v_add_f32 v200, v200, v198
    v_mfma_f32_16x16x32_bf16 a[120:123], v[84:87], v[12:15], a[120:123]
    v_add_f32 v201, v201, v199
    v_add_f32 v200, v200, v201
    v_mfma_f32_16x16x32_bf16 a[120:123], v[68:71], v[8:11], a[120:123]
    s_nop 1
    v_add_f32_dpp v200, v200, v200 quad_perm:[1,0,3,2] row_mask:0xf bank_mask:0xf
    v_smfmac_f32_16x16x64_bf16 a[240:243], a[248:251], v[76:83], v220
    s_nop 1
    v_add_f32_dpp v200, v200, v200 quad_perm:[2,3,0,1] row_mask:0xf bank_mask:0xf
    v_mfma_f32_16x16x32_bf16 a[116:119], v[64:67], v[8:11], a[116:119]
    s_nop 1
    v_add_f32_dpp v200, v200, v200 row_half_mirror row_mask:0xf bank_mask:0xf
    v_mfma_f32_16x16x32_bf16 a[116:119], v[80:83], v[12:15], a[116:119]
    s_nop 1
    v_add_f32_dpp v200, v200, v200 row_mirror row_mask:0xf bank_mask:0xf
    v_mfma_f32_16x16x32_bf16 a[112:115], v[76:79], v[12:15], a[112:115]
    v_mov_b32 v201, v200
    v_mfma_f32_16x16x32_bf16 a[112:115], v[60:63], v[8:11], a[112:115]
    s_waitcnt lgkmcnt(8)
    v_mfma_f32_16x16x32_bf16 a[128:131], v[60:63], v[16:19], a[128:131]
    ds_read_b128 v[8:11], v216 offset:59392
    v_mfma_f32_16x16x32_bf16 a[128:131], v[76:79], v[20:23], a[128:131]
    ds_read_b128 v[12:15], v217 offset:59392
    v_mfma_f32_16x16x32_bf16 a[132:135], v[80:83], v[20:23], a[132:135]
    s_nop 1
    v_permlane16_swap_b32 v200, v201
    v_mfma_f32_16x16x32_bf16 a[132:135], v[64:67], v[16:19], a[132:135]
    s_nop 1
    v_add_f32 v200, v200, v201
    v_mfma_f32_16x16x32_bf16 a[136:139], v[68:71], v[16:19], a[136:139]
    v_mul_f32 v200, 0x3a800000, v200
    v_mfma_f32_16x16x32_bf16 a[136:139], v[84:87], v[20:23], a[136:139]
    s_waitcnt vmcnt(8) lgkmcnt(0)
    s_barrier
    v_mfma_f32_16x16x32_bf16 a[140:143], v[88:91], v[20:23], a[140:143]
    s_add_u32 m0, s26, 32768
    s_mov_b32 s23, 512
    v_mfma_f32_16x16x32_bf16 a[140:143], v[72:75], v[16:19], a[140:143]
    ds_read_b128 v[16:19], v216 offset:0
    v_sub_f32 v168, v168, v200
    v_mfma_f32_16x16x32_bf16 a[156:159], v[72:75], v[24:27], a[156:159]
    ds_read_b128 v[20:23], v217 offset:0
    v_sub_f32 v169, v169, v200
    v_mfma_f32_16x16x32_bf16 a[156:159], v[88:91], v[28:31], a[156:159]
    buffer_load_dwordx4 v208, s[4:7], s23 offen offset:0 lds
L_k_w0:
    s_cbranch_execz L_k_w4
    v_mfma_f32_16x16x32_bf16 a[152:155], v[84:87], v[28:31], a[152:155]
    v_sub_f32 v170, v170, v200
    v_sub_f32 v171, v171, v200
    v_mfma_f32_16x16x32_bf16 a[152:155], v[68:71], v[24:27], a[152:155]
    v_sub_f32 v172, v172, v200
    v_sub_f32 v173, v173, v200
    v_mfma_f32_16x16x32_bf16 a[148:151], v[64:67], v[24:27], a[148:151]
    buffer_load_dwordx4 v209, s[4:7], s23 offen offset:1024 lds
    v_mfma_f32_16x16x32_bf16 a[148:151], v[80:83], v[28:31], a[148:151]
    v_sub_f32 v174, v174, v200
    v_sub_f32 v175, v175, v200
    v_mfma_f32_16x16x32_bf16 a[144:147], v[76:79], v[28:31], a[144:147]
    v_sub_f32 v176, v176, v200
    v_sub_f32 v177, v177, v200
    v_mfma_f32_16x16x32_bf16 a[144:147], v[60:63], v[24:27], a[144:147]
    v_sub_f32 v178, v178, v200
    v_mfma_f32_16x16x32_bf16 a[160:163], v[60:63], v[32:35], a[160:163]
    ds_read_b128 v[24:27], v216 offset:2048
    v_sub_f32 v179, v179, v200
    v_mfma_f32_16x16x32_bf16 a[160:163], v[76:79], v[36:39], a[160:163]
    ds_read_b128 v[28:31], v217 offset:2048
    v_sub_f32 v180, v180, v200
    v_mfma_f32_16x16x32_bf16 a[164:167], v[80:83], v[36:39], a[164:167]
    v_sub_f32 v181, v181, v200
    v_sub_f32 v182, v182, v200
    v_mfma_f32_16x16x32_bf16 a[164:167], v[64:67], v[32:35], a[164:167]
    buffer_load_dwordx4 v210, s[4:7], s23 offen offset:2048 lds
    v_smfmac_f32_16x16x64_bf16 a[244:247], a[248:251], v[84:91], v220
    v_sub_f32 v183, v183, v200
    v_sub_f32 v184, v184, v200
    v_mfma_f32_16x16x32_bf16 a[168:171], v[68:71], v[32:35], a[168:171]
    v_sub_f32 v185, v185, v200
    v_sub_f32 v186, v186, v200
    v_mfma_f32_16x16x32_bf16 a[168:171], v[84:87], v[36:39], a[168:171]
    v_sub_f32 v187, v187, v200
    v_sub_f32 v188, v188, v200
    v_mfma_f32_16x16x32_bf16 a[172:175], v[88:91], v[36:39], a[172:175]
    v_sub_f32 v189, v189, v200
    v_sub_f32 v190, v190, v200
    v_mfma_f32_16x16x32_bf16 a[172:175], v[72:75], v[32:35], a[172:175]
    ds_read_b128 v[32:35], v216 offset:4096
    v_sub_f32 v191, v191, v200
    v_mfma_f32_16x16x32_bf16 a[188:191], v[72:75], v[40:43], a[188:191]
    ds_read_b128 v[36:39], v217 offset:4096
    v_sub_f32 v192, v192, v200
    v_mfma_f32_16x16x32_bf16 a[188:191], v[88:91], v[44:47], a[188:191]
    buffer_load_dwordx4 v211, s[4:7], s23 offen offset:3072 lds
    v_mfma_f32_16x16x32_bf16 a[184:187], v[84:87], v[44:47], a[184:187]
    v_sub_f32 v193, v193, v200
    v_sub_f32 v194, v194, v200
    v_mfma_f32_16x16x32_bf16 a[184:187], v[68:71], v[40:43], a[184:187]
    v_sub_f32 v195, v195, v200
    v_sub_f32 v196, v196, v200
    v_mfma_f32_16x16x32_bf16 a[180:183], v[64:67], v[40:43], a[180:183]
    v_sub_f32 v197, v197, v200
    v_sub_f32 v198, v198, v200
    v_mfma_f32_16x16x32_bf16 a[180:183], v[80:83], v[44:47], a[180:183]
    v_sub_f32 v199, v199, v200
    v_mul_f32 v204, v168, v168
    v_mfma_f32_16x16x32_bf16 a[176:179], v[76:79], v[44:47], a[176:179]
    s_cmp_lt_u32 s21, 7
    v_mfma_f32_16x16x32_bf16 a[176:179], v[60:63], v[40:43], a[176:179]
    s_cbranch_scc1 L_k_sk2
    v_mfma_f32_16x16x32_bf16 a[224:227], v[60:63], v[48:51], a[224:227]
    v_mfma_f32_16x16x32_bf16 a[224:227], v[76:79], v[52:55], a[224:227]
    v_mfma_f32_16x16x32_bf16 a[228:231], v[80:83], v[52:55], a[228:231]
    v_mfma_f32_16x16x32_bf16 a[228:231], v[64:67], v[48:51], a[228:231]
    v_mfma_f32_16x16x32_bf16 a[232:235], v[68:71], v[48:51], a[232:235]
    v_mfma_f32_16x16x32_bf16 a[232:235], v[84:87], v[52:55], a[232:235]
    v_mfma_f32_16x16x32_bf16 a[236:239], v[88:91], v[52:55], a[236:239]
    v_mfma_f32_16x16x32_bf16 a[236:239], v[72:75], v[48:51], a[236:239]
L_k_sk2:
    ds_read_b128 v[40:43], v216 offset:6144
    s_add_u32 m0, s26, 36864
    v_mfma_f32_16x16x32_bf16 a[192:195], v[60:63], v[0:3], a[192:195]
    ds_read_b128 v[44:47], v217 offset:6144
    s_mov_b32 s23, 66048
    v_mfma_f32_16x16x32_bf16 a[192:195], v[76:79], v[4:7], a[192:195]
    ds_read_b128 v[48:51], v216 offset:8192
    buffer_load_dwordx4 v208, s[4:7], s23 offen offset:0 lds
    v_mfma_f32_16x16x32_bf16 a[208:211], v[76:79], v[12:15], a[208:211]
    ds_read_b128 v[52:55], v217 offset:8192
    buffer_load_dwordx4 v209, s[4:7], s23 offen offset:1024 lds
    v_mfma_f32_16x16x32_bf16 a[208:211], v[60:63], v[8:11], a[208:211]
    ds_read_b64_tr_b16 v[60:61], v236 offset:0
    v_mul_f32 v205, v169, v169
    v_mfma_f32_16x16x32_bf16 a[196:199], v[64:67], v[0:3], a[196:199]
    ds_read_b64_tr_b16 v[62:63], v236 offset:1024
    v_fmac_f32 v204, v170, v170
    v_mfma_f32_16x16x32_bf16 a[196:199], v[80:83], v[4:7], a[196:199]
    ds_read_b64_tr_b16 v[76:77], v236 offset:16384
    buffer_load_dwordx4 v210, s[4:7], s23 offen offset:2048 lds
    v_mfma_f32_16x16x32_bf16 a[212:215], v[80:83], v[12:15], a[212:215]
    ds_read_b64_tr_b16 v[78:79], v236 offset:17408
    v_fmac_f32 v205, v171, v171
    v_mfma_f32_16x16x32_bf16 a[212:215], v[64:67], v[8:11], a[212:215]
    ds_read_b64_tr_b16 v[64:65], v237 offset:0
    v_fmac_f32 v204, v172, v172
    v_mfma_f32_16x16x32_bf16 a[200:203], v[68:71], v[0:3], a[200:203]
    ds_read_b64_tr_b16 v[66:67], v237 offset:1024
    v_fmac_f32 v205, v173, v173
    v_mfma_f32_16x16x32_bf16 a[200:203], v[84:87], v[4:7], a[200:203]
    ds_read_b64_tr_b16 v[80:81], v237 offset:16384
    v_fmac_f32 v204, v174, v174
    v_mfma_f32_16x16x32_bf16 a[216:219], v[84:87], v[12:15], a[216:219]
    ds_read_b64_tr_b16 v[82:83], v237 offset:17408
    v_fmac_f32 v205, v175, v175
    v_mfma_f32_16x16x32_bf16 a[216:219], v[68:71], v[8:11], a[216:219]
    ds_read_b64_tr_b16 v[68:69], v236 offset:8192
    v_fmac_f32 v204, v176, v176
    v_mfma_f32_16x16x32_bf16 a[204:207], v[72:75], v[0:3], a[204:207]
    ds_read_b64_tr_b16 v[70:71], v236 offset:9216
    buffer_load_dwordx4 v211, s[4:7], s23 offen offset:3072 lds
    v_mfma_f32_16x16x32_bf16 a[204:207], v[88:91], v[4:7], a[204:207]
    ds_read_b64_tr_b16 v[84:85], v236 offset:24576
    v_fmac_f32 v205, v177, v177
    v_mfma_f32_16x16x32_bf16 a[220:223], v[88:91], v[12:15], a[220:223]
    ds_read_b64_tr_b16 v[86:87], v236 offset:25600
    v_fmac_f32 v204, v178, v178
    v_mfma_f32_16x16x32_bf16 a[220:223], v[72:75], v[8:11], a[220:223]
    v_fmac_f32 v205, v179, v179
    s_waitcnt lgkmcnt(8)
    v_mfma_f32_16x16x32_bf16 a[0:3], v[60:63], v[16:19], a[0:3]
    ds_read_b64_tr_b16 v[72:73], v237 offset:8192
    v_fmac_f32 v204, v180, v180
    v_mfma_f32_16x16x32_bf16 a[0:3], v[76:79], v[20:23], a[0:3]
    ds_read_b64_tr_b16 v[74:75], v237 offset:9216
    v_fmac_f32 v205, v181, v181
    v_mfma_f32_16x16x32_bf16 a[16:19], v[76:79], v[28:31], a[16:19]
    ds_read_b64_tr_b16 v[88:89], v237 offset:24576
    v_fmac_f32 v204, v182, v182
    v_mfma_f32_16x16x32_bf16 a[16:19], v[60:63], v[24:27], a[16:19]
    s_add_u32 m0, s43, 32768
    s_waitcnt lgkmcnt(7)
    v_mfma_f32_16x16x32_bf16 a[4:7], v[64:67], v[16:19], a[4:7]
    ds_read_b64_tr_b16 v[90:91], v237 offset:25600
    s_mov_b32 s25, 2293760
    v_mfma_f32_16x16x32_bf16 a[4:7], v[80:83], v[20:23], a[4:7]
    ds_read_b128 v[0:3], v216 offset:10240
    v_fmac_f32 v205, v183, v183
    v_mfma_f32_16x16x32_bf16 a[20:23], v[80:83], v[28:31], a[20:23]
    ds_read_b128 v[4:7], v217 offset:10240
    v_fmac_f32 v204, v184, v184
    v_mfma_f32_16x16x32_bf16 a[20:23], v[64:67], v[24:27], a[20:23]
    v_fmac_f32 v205, v185, v185
    s_waitcnt lgkmcnt(6)
    v_mfma_f32_16x16x32_bf16 a[8:11], v[68:71], v[16:19], a[8:11]
    ds_read_b128 v[8:11], v216 offset:12288
    v_fmac_f32 v204, v186, v186
    v_mfma_f32_16x16x32_bf16 a[8:11], v[84:87], v[20:23], a[8:11]
    ds_read_b128 v[12:15], v217 offset:12288
    v_fmac_f32 v205, v187, v187
    v_mfma_f32_16x16x32_bf16 a[24:27], v[84:87], v[28:31], a[24:27]
    buffer_load_dwordx4 v212, s[8:11], s25 offen offset:0  lds
    v_mfma_f32_16x16x32_bf16 a[24:27], v[68:71], v[24:27], a[24:27]
    v_fmac_f32 v204, v188, v188
    s_waitcnt lgkmcnt(4)
    v_mfma_f32_16x16x32_bf16 a[12:15], v[72:75], v[16:19], a[12:15]
    buffer_load_dwordx4 v213, s[8:11], s25 offen offset:1024  lds
    v_mfma_f32_16x16x32_bf16 a[12:15], v[88:91], v[20:23], a[12:15]
    buffer_load_dwordx2 v[108:109], v231, s[16:19], 0 offen offset:0
    v_mfma_f32_16x16x32_bf16 a[28:31], v[88:91], v[28:31], a[28:31]
    v_fmac_f32 v205, v189, v189
    v_fmac_f32 v204, v190, v190
    v_mfma_f32_16x16x32_bf16 a[28:31], v[72:75], v[24:27], a[28:31]
    v_fmac_f32 v205, v191, v191
    v_mfma_f32_16x16x32_bf16 a[32:35], v[60:63], v[32:35], a[32:35]
    ds_read_b128 v[16:19], v216 offset:14336
    v_fmac_f32 v204, v192, v192
    v_mfma_f32_16x16x32_bf16 a[32:35], v[76:79], v[36:39], a[32:35]
    ds_read_b128 v[20:23], v217 offset:14336
    v_fmac_f32 v205, v193, v193
    v_mfma_f32_16x16x32_bf16 a[36:39], v[80:83], v[36:39], a[36:39]
    ds_read_b128 v[24:27], v216 offset:16384
    v_fmac_f32 v204, v194, v194
    v_mfma_f32_16x16x32_bf16 a[36:39], v[64:67], v[32:35], a[36:39]
    ds_read_b128 v[28:31], v217 offset:16384
    v_fmac_f32 v205, v195, v195
    v_mfma_f32_16x16x32_bf16 a[40:43], v[68:71], v[32:35], a[40:43]
    buffer_load_dwordx4 v214, s[8:11], s25 offen offset:2048  lds
    v_mfma_f32_16x16x32_bf16 a[40:43], v[84:87], v[36:39], a[40:43]
    v_fmac_f32 v204, v196, v196
    v_fmac_f32 v205, v197, v197
    v_mfma_f32_16x16x32_bf16 a[44:47], v[88:91], v[36:39], a[44:47]
    v_fmac_f32 v204, v198, v198
    v_fmac_f32 v205, v199, v199
    v_mfma_f32_16x16x32_bf16 a[44:47], v[72:75], v[32:35], a[44:47]
    ds_read_b128 v[32:35], v216 offset:18432
    v_add_f32 v204, v204, v205
    v_mfma_f32_16x16x32_bf16 a[60:63], v[72:75], v[40:43], a[60:63]
    ds_read_b128 v[36:39], v217 offset:18432
    v_mfma_f32_16x16x32_bf16 a[60:63], v[88:91], v[44:47], a[60:63]
    buffer_load_dwordx4 v215, s[8:11], s25 offen offset:3072  lds
    v_mfma_f32_16x16x32_bf16 a[56:59], v[84:87], v[44:47], a[56:59]
    buffer_load_dwordx2 v[110:111], v231, s[16:19], 0 offen offset:2048
    v_mfma_f32_16x16x32_bf16 a[56:59], v[68:71], v[40:43], a[56:59]
    s_nop 1
    v_add_f32_dpp v204, v204, v204 quad_perm:[1,0,3,2] row_mask:0xf bank_mask:0xf
    v_smfmac_f32_16x16x64_bf16 a[240:243], a[248:251], v[60:67], v220
    s_nop 1
    v_add_f32_dpp v204, v204, v204 quad_perm:[2,3,0,1] row_mask:0xf bank_mask:0xf
    v_mfma_f32_16x16x32_bf16 a[52:55], v[64:67], v[40:43], a[52:55]
    s_nop 1
    v_add_f32_dpp v204, v204, v204 row_half_mirror row_mask:0xf bank_mask:0xf
    v_mfma_f32_16x16x32_bf16 a[52:55], v[80:83], v[44:47], a[52:55]
    s_add_u32 m0, s43, 49152
    s_mov_b32 s25, 2523136
    v_mfma_f32_16x16x32_bf16 a[48:51], v[76:79], v[44:47], a[48:51]
    buffer_load_dwordx4 v212, s[8:11], s25 offen offset:0  lds
    v_mfma_f32_16x16x32_bf16 a[48:51], v[60:63], v[40:43], a[48:51]
    s_waitcnt lgkmcnt(8)
    v_mfma_f32_16x16x32_bf16 a[64:67], v[60:63], v[48:51], a[64:67]
    ds_read_b128 v[40:43], v216 offset:20480
    v_mfma_f32_16x16x32_bf16 a[64:67], v[76:79], v[52:55], a[64:67]
    ds_read_b128 v[44:47], v217 offset:20480
    v_mfma_f32_16x16x32_bf16 a[68:71], v[80:83], v[52:55], a[68:71]
    s_nop 1
    v_add_f32_dpp v204, v204, v204 row_mirror row_mask:0xf bank_mask:0xf
    v_mfma_f32_16x16x32_bf16 a[68:71], v[64:67], v[48:51], a[68:71]
    buffer_load_dwordx4 v213, s[8:11], s25 offen offset:1024  lds
    v_mfma_f32_16x16x32_bf16 a[72:75], v[68:71], v[48:51], a[72:75]
    v_mov_b32 v205, v204
    v_mfma_f32_16x16x32_bf16 a[72:75], v[84:87], v[52:55], a[72:75]
    s_nop 1
    v_permlane16_swap_b32 v204, v205
    v_mfma_f32_16x16x32_bf16 a[76:79], v[88:91], v[52:55], a[76:79]
    s_nop 1
    v_add_f32 v204, v204, v205
    v_mfma_f32_16x16x32_bf16 a[76:79], v[72:75], v[48:51], a[76:79]
    ds_read_b128 v[48:51], v216 offset:22528
    v_mfma_f32_16x16x32_bf16 a[92:95], v[72:75], v[0:3], a[92:95]
    ds_read_b128 v[52:55], v217 offset:22528
    v_mfma_f32_16x16x32_bf16 a[92:95], v[88:91], v[4:7], a[92:95]
    v_mul_f32 v204, 0x3a800000, v204
    v_mfma_f32_16x16x32_bf16 a[88:91], v[84:87], v[4:7], a[88:91]
    buffer_load_dwordx4 v214, s[8:11], s25 offen offset:2048  lds
    v_mfma_f32_16x16x32_bf16 a[88:91], v[68:71], v[0:3], a[88:91]
    buffer_load_dwordx2 v[112:113], v232, s[16:19], 0 offen offset:0
    v_smfmac_f32_16x16x64_bf16 a[244:247], a[248:251], v[68:75], v220
    v_cvt_pk_bf16_f32 v200, v200, v200
    v_and_b32 v200, s47, v200
    v_mfma_f32_16x16x32_bf16 a[84:87], v[64:67], v[0:3], a[84:87]
    v_cvt_pk_bf16_f32 v204, v204, v204
    v_and_b32 v204, s47, v204
    v_mfma_f32_16x16x32_bf16 a[84:87], v[80:83], v[4:7], a[84:87]
    v_add_f32 v204, 0x3727c5ac, v204
    v_mfma_f32_16x16x32_bf16 a[80:83], v[76:79], v[4:7], a[80:83]
    v_cvt_pk_bf16_f32 v204, v204, v204
    v_and_b32 v204, s47, v204
    v_mfma_f32_16x16x32_bf16 a[80:83], v[60:63], v[0:3], a[80:83]
    s_waitcnt lgkmcnt(8)
    v_mfma_f32_16x16x32_bf16 a[96:99], v[60:63], v[8:11], a[96:99]
    ds_read_b128 v[0:3], v216 offset:28672
    v_mfma_f32_16x16x32_bf16 a[96:99], v[76:79], v[12:15], a[96:99]
    ds_read_b128 v[4:7], v217 offset:28672
    v_mfma_f32_16x16x32_bf16 a[100:103], v[80:83], v[12:15], a[100:103]
    buffer_load_dwordx4 v215, s[8:11], s25 offen offset:3072  lds
    v_mfma_f32_16x16x32_bf16 a[100:103], v[64:67], v[8:11], a[100:103]
    v_sqrt_f32 v204, v204
    s_nop 0
    v_mfma_f32_16x16x32_bf16 a[104:107], v[68:71], v[8:11], a[104:107]
    v_cvt_pk_bf16_f32 v204, v204, v204
    v_and_b32 v204, s47, v204
    v_mfma_f32_16x16x32_bf16 a[104:107], v[84:87], v[12:15], a[104:107]
    v_rcp_f32 v168, v204
    v_mul_f32 v203, v204, v204
    v_mfma_f32_16x16x32_bf16 a[108:111], v[88:91], v[12:15], a[108:111]
    v_mul_f32 v201, 0xc0135761, v168
    v_mfma_f32_16x16x32_bf16 a[108:111], v[72:75], v[8:11], a[108:111]
    ds_read_b128 v[8:11], v216 offset:24576
    v_mul_f32 v169, v168, v168
    v_mfma_f32_16x16x32_bf16 a[124:127], v[72:75], v[16:19], a[124:127]
    ds_read_b128 v[12:15], v217 offset:24576
    v_mfma_f32_16x16x32_bf16 a[124:127], v[88:91], v[20:23], a[124:127]
    v_mul_f32 v168, 0xbdd2d3e8, v168
    v_mfma_f32_16x16x32_bf16 a[120:123], v[84:87], v[20:23], a[120:123]
    v_mul_f32 v202, v168, v169
    v_mfma_f32_16x16x32_bf16 a[120:123], v[68:71], v[16:19], a[120:123]
    v_smfmac_f32_16x16x64_bf16 a[240:243], a[248:251], v[76:83], v220
    s_mov_b32 s28, 0
    v_mfma_f32_16x16x32_bf16 a[116:119], v[64:67], v[16:19], a[116:119]
    buffer_load_dwordx2 v[114:115], v229, s[16:19], s28 offen offset:0
    v_mfma_f32_16x16x32_bf16 a[116:119], v[80:83], v[20:23], a[116:119]
    v_mfma_f32_16x16x32_bf16 a[112:115], v[76:79], v[20:23], a[112:115]
    v_mfma_f32_16x16x32_bf16 a[112:115], v[60:63], v[16:19], a[112:115]
    s_waitcnt lgkmcnt(8)
    v_mfma_f32_16x16x32_bf16 a[128:131], v[60:63], v[24:27], a[128:131]
    ds_read_b128 v[16:19], v216 offset:26624
    v_mfma_f32_16x16x32_bf16 a[128:131], v[76:79], v[28:31], a[128:131]
    ds_read_b128 v[20:23], v217 offset:26624
    v_mfma_f32_16x16x32_bf16 a[132:135], v[80:83], v[28:31], a[132:135]
    v_mfma_f32_16x16x32_bf16 a[132:135], v[64:67], v[24:27], a[132:135]
    v_mfma_f32_16x16x32_bf16 a[136:139], v[68:71], v[24:27], a[136:139]
    v_mfma_f32_16x16x32_bf16 a[136:139], v[84:87], v[28:31], a[136:139]
    s_waitcnt vmcnt(12) lgkmcnt(0)
    s_barrier
    v_mfma_f32_16x16x32_bf16 a[140:143], v[88:91], v[28:31], a[140:143]
    s_add_u32 m0, s26, 0
    s_mov_b32 s23, 640
    v_mfma_f32_16x16x32_bf16 a[140:143], v[72:75], v[24:27], a[140:143]
    ds_read_b128 v[24:27], v216 offset:32768
    v_mfma_f32_16x16x32_bf16 a[156:159], v[72:75], v[32:35], a[156:159]
    ds_read_b128 v[28:31], v217 offset:32768
    v_mfma_f32_16x16x32_bf16 a[156:159], v[88:91], v[36:39], a[156:159]
    buffer_load_dwordx4 v208, s[4:7], s23 offen offset:0 lds
    v_mfma_f32_16x16x32_bf16 a[152:155], v[84:87], v[36:39], a[152:155]
    v_mfma_f32_16x16x32_bf16 a[152:155], v[68:71], v[32:35], a[152:155]
    v_mfma_f32_16x16x32_bf16 a[148:151], v[64:67], v[32:35], a[148:151]
    buffer_load_dwordx4 v209, s[4:7], s23 offen offset:1024 lds
    v_mfma_f32_16x16x32_bf16 a[148:151], v[80:83], v[36:39], a[148:151]
    buffer_load_dwordx2 v[130:131], v229, s[12:15], s28 offen offset:0
    v_mfma_f32_16x16x32_bf16 a[144:147], v[76:79], v[36:39], a[144:147]
    v_mfma_f32_16x16x32_bf16 a[144:147], v[60:63], v[32:35], a[144:147]
    v_mfma_f32_16x16x32_bf16 a[160:163], v[60:63], v[40:43], a[160:163]
    ds_read_b128 v[32:35], v216 offset:34816
    v_mfma_f32_16x16x32_bf16 a[160:163], v[76:79], v[44:47], a[160:163]
    ds_read_b128 v[36:39], v217 offset:34816
    v_mfma_f32_16x16x32_bf16 a[164:167], v[80:83], v[44:47], a[164:167]
    v_mfma_f32_16x16x32_bf16 a[164:167], v[64:67], v[40:43], a[164:167]
    buffer_load_dwordx4 v210, s[4:7], s23 offen offset:2048 lds
    v_smfmac_f32_16x16x64_bf16 a[244:247], a[248:251], v[84:91], v220
    v_mfma_f32_16x16x32_bf16 a[168:171], v[68:71], v[40:43], a[168:171]
    v_mfma_f32_16x16x32_bf16 a[168:171], v[84:87], v[44:47], a[168:171]
    v_mfma_f32_16x16x32_bf16 a[172:175], v[88:91], v[44:47], a[172:175]
    v_mfma_f32_16x16x32_bf16 a[172:175], v[72:75], v[40:43], a[172:175]
    ds_read_b128 v[40:43], v216 offset:36864
    v_mfma_f32_16x16x32_bf16 a[188:191], v[72:75], v[48:51], a[188:191]
    ds_read_b128 v[44:47], v217 offset:36864
    v_mfma_f32_16x16x32_bf16 a[188:191], v[88:91], v[52:55], a[188:191]
    buffer_load_dwordx4 v211, s[4:7], s23 offen offset:3072 lds
    v_mfma_f32_16x16x32_bf16 a[184:187], v[84:87], v[52:55], a[184:187]
    v_mfma_f32_16x16x32_bf16 a[184:187], v[68:71], v[48:51], a[184:187]
    v_mfma_f32_16x16x32_bf16 a[180:183], v[64:67], v[48:51], a[180:183]
    v_mfma_f32_16x16x32_bf16 a[180:183], v[80:83], v[52:55], a[180:183]
    v_mfma_f32_16x16x32_bf16 a[176:179], v[76:79], v[52:55], a[176:179]
    s_cmp_lt_u32 s21, 7
    v_mfma_f32_16x16x32_bf16 a[176:179], v[60:63], v[48:51], a[176:179]
    s_cbranch_scc1 L_k_sk3
    v_mfma_f32_16x16x32_bf16 a[224:227], v[60:63], v[0:3], a[224:227]
    v_mfma_f32_16x16x32_bf16 a[224:227], v[76:79], v[4:7], a[224:227]
    v_mfma_f32_16x16x32_bf16 a[228:231], v[80:83], v[4:7], a[228:231]
    v_mfma_f32_16x16x32_bf16 a[228:231], v[64:67], v[0:3], a[228:231]
    v_mfma_f32_16x16x32_bf16 a[232:235], v[68:71], v[0:3], a[232:235]
    v_mfma_f32_16x16x32_bf16 a[232:235], v[84:87], v[4:7], a[232:235]
    v_mfma_f32_16x16x32_bf16 a[236:239], v[88:91], v[4:7], a[236:239]
    v_mfma_f32_16x16x32_bf16 a[236:239], v[72:75], v[0:3], a[236:239]
L_k_sk3:
    ds_read_b128 v[48:51], v216 offset:38912
    s_add_u32 m0, s26, 4096
    v_mfma_f32_16x16x32_bf16 a[192:195], v[60:63], v[8:11], a[192:195]
    ds_read_b128 v[52:55], v217 offset:38912
    s_mov_b32 s23, 66176
    v_mfma_f32_16x16x32_bf16 a[192:195], v[76:79], v[12:15], a[192:195]
    ds_read_b128 v[0:3], v216 offset:40960
    buffer_load_dwordx4 v208, s[4:7], s23 offen offset:0 lds
    v_mfma_f32_16x16x32_bf16 a[208:211], v[76:79], v[20:23], a[208:211]
    ds_read_b128 v[4:7], v217 offset:40960
    buffer_load_dwordx4 v209, s[4:7], s23 offen offset:1024 lds
    v_mfma_f32_16x16x32_bf16 a[208:211], v[60:63], v[16:19], a[208:211]
    ds_read_b64_tr_b16 v[60:61], v218 offset:0
    buffer_load_dwordx2 v[116:117], v229, s[16:19], s28 offen offset:2048
    v_mfma_f32_16x16x32_bf16 a[196:199], v[64:67], v[8:11], a[196:199]
    ds_read_b64_tr_b16 v[62:63], v218 offset:1024
    v_mfma_f32_16x16x32_bf16 a[196:199], v[80:83], v[12:15], a[196:199]
    ds_read_b64_tr_b16 v[76:77], v218 offset:16384
    buffer_load_dwordx4 v210, s[4:7], s23 offen offset:2048 lds
    v_mfma_f32_16x16x32_bf16 a[212:215], v[80:83], v[20:23], a[212:215]
    ds_read_b64_tr_b16 v[78:79], v218 offset:17408
    v_mfma_f32_16x16x32_bf16 a[212:215], v[64:67], v[16:19], a[212:215]
    ds_read_b64_tr_b16 v[64:65], v219 offset:0
    v_mfma_f32_16x16x32_bf16 a[200:203], v[68:71], v[8:11], a[200:203]
    ds_read_b64_tr_b16 v[66:67], v219 offset:1024
    v_mfma_f32_16x16x32_bf16 a[200:203], v[84:87], v[12:15], a[200:203]
    ds_read_b64_tr_b16 v[80:81], v219 offset:16384
    v_mfma_f32_16x16x32_bf16 a[216:219], v[84:87], v[20:23], a[216:219]
    ds_read_b64_tr_b16 v[82:83], v219 offset:17408
    v_mfma_f32_16x16x32_bf16 a[216:219], v[68:71], v[16:19], a[216:219]
    ds_read_b64_tr_b16 v[68:69], v218 offset:8192
    v_mfma_f32_16x16x32_bf16 a[204:207], v[72:75], v[8:11], a[204:207]
    ds_read_b64_tr_b16 v[70:71], v218 offset:9216
    buffer_load_dwordx4 v211, s[4:7], s23 offen offset:3072 lds
    v_mfma_f32_16x16x32_bf16 a[204:207], v[88:91], v[12:15], a[204:207]
    ds_read_b64_tr_b16 v[84:85], v218 offset:24576
    v_mfma_f32_16x16x32_bf16 a[220:223], v[88:91], v[20:23], a[220:223]
    ds_read_b64_tr_b16 v[86:87], v218 offset:25600
    v_mfma_f32_16x16x32_bf16 a[220:223], v[72:75], v[16:19], a[220:223]
    s_waitcnt lgkmcnt(8)
    v_mfma_f32_16x16x32_bf16 a[0:3], v[60:63], v[24:27], a[0:3]
    ds_read_b64_tr_b16 v[72:73], v219 offset:8192
    v_mfma_f32_16x16x32_bf16 a[0:3], v[76:79], v[28:31], a[0:3]
    ds_read_b64_tr_b16 v[74:75], v219 offset:9216
    v_mfma_f32_16x16x32_bf16 a[16:19], v[76:79], v[36:39], a[16:19]
    ds_read_b64_tr_b16 v[88:89], v219 offset:24576
    v_mfma_f32_16x16x32_bf16 a[16:19], v[60:63], v[32:35], a[16:19]
    s_add_u32 m0, s43, 65536
    s_waitcnt lgkmcnt(7)
    v_mfma_f32_16x16x32_bf16 a[4:7], v[64:67], v[24:27], a[4:7]
    ds_read_b64_tr_b16 v[90:91], v219 offset:25600
    s_mov_b32 s25, 2752512
    v_mfma_f32_16x16x32_bf16 a[4:7], v[80:83], v[28:31], a[4:7]
    ds_read_b128 v[8:11], v216 offset:43008
    v_mfma_f32_16x16x32_bf16 a[20:23], v[80:83], v[36:39], a[20:23]
    ds_read_b128 v[12:15], v217 offset:43008
    v_mfma_f32_16x16x32_bf16 a[20:23], v[64:67], v[32:35], a[20:23]
    s_waitcnt lgkmcnt(6)
    v_mfma_f32_16x16x32_bf16 a[8:11], v[68:71], v[24:27], a[8:11]
    ds_read_b128 v[16:19], v216 offset:45056
    v_mfma_f32_16x16x32_bf16 a[8:11], v[84:87], v[28:31], a[8:11]
    ds_read_b128 v[20:23], v217 offset:45056
    v_mfma_f32_16x16x32_bf16 a[24:27], v[84:87], v[36:39], a[24:27]
    buffer_load_dwordx4 v212, s[8:11], s25 offen offset:0  lds
    v_mfma_f32_16x16x32_bf16 a[24:27], v[68:71], v[32:35], a[24:27]
    s_waitcnt lgkmcnt(4)
    v_mfma_f32_16x16x32_bf16 a[12:15], v[72:75], v[24:27], a[12:15]
    buffer_load_dwordx4 v213, s[8:11], s25 offen offset:1024  lds
    v_mfma_f32_16x16x32_bf16 a[12:15], v[88:91], v[28:31], a[12:15]
    buffer_load_dwordx2 v[132:133], v229, s[12:15], s28 offen offset:2048
    v_mfma_f32_16x16x32_bf16 a[28:31], v[88:91], v[36:39], a[28:31]
    v_mfma_f32_16x16x32_bf16 a[28:31], v[72:75], v[32:35], a[28:31]
    v_mfma_f32_16x16x32_bf16 a[32:35], v[60:63], v[40:43], a[32:35]
    ds_read_b128 v[24:27], v216 offset:47104
    v_mfma_f32_16x16x32_bf16 a[32:35], v[76:79], v[44:47], a[32:35]
    ds_read_b128 v[28:31], v217 offset:47104
    v_mfma_f32_16x16x32_bf16 a[36:39], v[80:83], v[44:47], a[36:39]
    ds_read_b128 v[32:35], v216 offset:49152
    v_mfma_f32_16x16x32_bf16 a[36:39], v[64:67], v[40:43], a[36:39]
    ds_read_b128 v[36:39], v217 offset:49152
    v_mfma_f32_16x16x32_bf16 a[40:43], v[68:71], v[40:43], a[40:43]
    buffer_load_dwordx4 v214, s[8:11], s25 offen offset:2048  lds
    v_mfma_f32_16x16x32_bf16 a[40:43], v[84:87], v[44:47], a[40:43]
    v_mfma_f32_16x16x32_bf16 a[44:47], v[88:91], v[44:47], a[44:47]
    v_mfma_f32_16x16x32_bf16 a[44:47], v[72:75], v[40:43], a[44:47]
    ds_read_b128 v[40:43], v216 offset:51200
    v_mfma_f32_16x16x32_bf16 a[60:63], v[72:75], v[48:51], a[60:63]
    ds_read_b128 v[44:47], v217 offset:51200
    v_mfma_f32_16x16x32_bf16 a[60:63], v[88:91], v[52:55], a[60:63]
    buffer_load_dwordx4 v215, s[8:11], s25 offen offset:3072  lds
    v_mfma_f32_16x16x32_bf16 a[56:59], v[84:87], v[52:55], a[56:59]
    s_mov_b32 s28, 4096
    v_mfma_f32_16x16x32_bf16 a[56:59], v[68:71], v[48:51], a[56:59]
    buffer_load_dwordx2 v[118:119], v229, s[16:19], s28 offen offset:0
    v_smfmac_f32_16x16x64_bf16 a[240:243], a[248:251], v[60:67], v220
    v_mfma_f32_16x16x32_bf16 a[52:55], v[64:67], v[48:51], a[52:55]
    v_mfma_f32_16x16x32_bf16 a[52:55], v[80:83], v[52:55], a[52:55]
    s_add_u32 m0, s43, 81920
    s_mov_b32 s25, 2981888
    v_mfma_f32_16x16x32_bf16 a[48:51], v[76:79], v[52:55], a[48:51]
    buffer_load_dwordx4 v212, s[8:11], s25 offen offset:0  lds
    v_mfma_f32_16x16x32_bf16 a[48:51], v[60:63], v[48:51], a[48:51]
    s_waitcnt lgkmcnt(8)
    v_mfma_f32_16x16x32_bf16 a[64:67], v[60:63], v[0:3], a[64:67]
    ds_read_b128 v[48:51], v216 offset:53248
    v_mfma_f32_16x16x32_bf16 a[64:67], v[76:79], v[4:7], a[64:67]
    ds_read_b128 v[52:55], v217 offset:53248
    v_mfma_f32_16x16x32_bf16 a[68:71], v[80:83], v[4:7], a[68:71]
    v_mfma_f32_16x16x32_bf16 a[68:71], v[64:67], v[0:3], a[68:71]
    buffer_load_dwordx4 v213, s[8:11], s25 offen offset:1024  lds
    v_mfma_f32_16x16x32_bf16 a[72:75], v[68:71], v[0:3], a[72:75]
    v_mfma_f32_16x16x32_bf16 a[72:75], v[84:87], v[4:7], a[72:75]
    v_mfma_f32_16x16x32_bf16 a[76:79], v[88:91], v[4:7], a[76:79]
    v_mfma_f32_16x16x32_bf16 a[76:79], v[72:75], v[0:3], a[76:79]
    ds_read_b128 v[0:3], v216 offset:55296
    v_mfma_f32_16x16x32_bf16 a[92:95], v[72:75], v[8:11], a[92:95]
    ds_read_b128 v[4:7], v217 offset:55296
    v_mfma_f32_16x16x32_bf16 a[92:95], v[88:91], v[12:15], a[92:95]
    v_mfma_f32_16x16x32_bf16 a[88:91], v[84:87], v[12:15], a[88:91]
    buffer_load_dwordx4 v214, s[8:11], s25 offen offset:2048  lds
    v_mfma_f32_16x16x32_bf16 a[88:91], v[68:71], v[8:11], a[88:91]
    buffer_load_dwordx2 v[134:135], v229, s[12:15], s28 offen offset:0
    v_smfmac_f32_16x16x64_bf16 a[244:247], a[248:251], v[68:75], v220
    v_mfma_f32_16x16x32_bf16 a[84:87], v[64:67], v[8:11], a[84:87]
    v_mfma_f32_16x16x32_bf16 a[84:87], v[80:83], v[12:15], a[84:87]
    v_mfma_f32_16x16x32_bf16 a[80:83], v[76:79], v[12:15], a[80:83]
    v_mfma_f32_16x16x32_bf16 a[80:83], v[60:63], v[8:11], a[80:83]
    s_waitcnt lgkmcnt(8)
    v_mfma_f32_16x16x32_bf16 a[96:99], v[60:63], v[16:19], a[96:99]
    ds_read_b128 v[8:11], v216 offset:61440
    v_mfma_f32_16x16x32_bf16 a[96:99], v[76:79], v[20:23], a[96:99]
    ds_read_b128 v[12:15], v217 offset:61440
    v_mfma_f32_16x16x32_bf16 a[100:103], v[80:83], v[20:23], a[100:103]
    buffer_load_dwordx4 v215, s[8:11], s25 offen offset:3072  lds
    v_mfma_f32_16x16x32_bf16 a[100:103], v[64:67], v[16:19], a[100:103]
    v_mfma_f32_16x16x32_bf16 a[104:107], v[68:71], v[16:19], a[104:107]
    v_mfma_f32_16x16x32_bf16 a[104:107], v[84:87], v[20:23], a[104:107]
    v_mfma_f32_16x16x32_bf16 a[108:111], v[88:91], v[20:23], a[108:111]
    v_mfma_f32_16x16x32_bf16 a[108:111], v[72:75], v[16:19], a[108:111]
    ds_read_b128 v[16:19], v216 offset:57344
    v_mfma_f32_16x16x32_bf16 a[124:127], v[72:75], v[24:27], a[124:127]
    ds_read_b128 v[20:23], v217 offset:57344
    v_mfma_f32_16x16x32_bf16 a[124:127], v[88:91], v[28:31], a[124:127]
    v_mfma_f32_16x16x32_bf16 a[120:123], v[84:87], v[28:31], a[120:123]
    v_mfma_f32_16x16x32_bf16 a[120:123], v[68:71], v[24:27], a[120:123]
    v_smfmac_f32_16x16x64_bf16 a[240:243], a[248:251], v[76:83], v220
    buffer_load_dwordx2 v[120:121], v229, s[16:19], s28 offen offset:2048
    v_mfma_f32_16x16x32_bf16 a[116:119], v[64:67], v[24:27], a[116:119]
    v_mfma_f32_16x16x32_bf16 a[116:119], v[80:83], v[28:31], a[116:119]
    v_mfma_f32_16x16x32_bf16 a[112:115], v[76:79], v[28:31], a[112:115]
    v_mfma_f32_16x16x32_bf16 a[112:115], v[60:63], v[24:27], a[112:115]
    s_waitcnt lgkmcnt(8)
    v_mfma_f32_16x16x32_bf16 a[128:131], v[60:63], v[32:35], a[128:131]
    ds_read_b128 v[24:27], v216 offset:59392
    v_mfma_f32_16x16x32_bf16 a[128:131], v[76:79], v[36:39], a[128:131]
    ds_read_b128 v[28:31], v217 offset:59392
    v_mfma_f32_16x16x32_bf16 a[132:135], v[80:83], v[36:39], a[132:135]
    v_mfma_f32_16x16x32_bf16 a[132:135], v[64:67], v[32:35], a[132:135]
    v_mfma_f32_16x16x32_bf16 a[136:139], v[68:71], v[32:35], a[136:139]
    v_mfma_f32_16x16x32_bf16 a[136:139], v[84:87], v[36:39], a[136:139]
    s_waitcnt vmcnt(12) lgkmcnt(0)
    s_barrier
    v_mfma_f32_16x16x32_bf16 a[140:143], v[88:91], v[36:39], a[140:143]
    s_add_u32 m0, s26, 32768
    s_mov_b32 s23, 768
    v_mfma_f32_16x16x32_bf16 a[140:143], v[72:75], v[32:35], a[140:143]
    ds_read_b128 v[32:35], v216 offset:0
    v_mfma_f32_16x16x32_bf16 a[156:159], v[72:75], v[40:43], a[156:159]
    ds_read_b128 v[36:39], v217 offset:0
    v_mfma_f32_16x16x32_bf16 a[156:159], v[88:91], v[44:47], a[156:159]
    buffer_load_dwordx4 v208, s[4:7], s23 offen offset:0 lds
    v_mfma_f32_16x16x32_bf16 a[152:155], v[84:87], v[44:47], a[152:155]
    v_mfma_f32_16x16x32_bf16 a[152:155], v[68:71], v[40:43], a[152:155]
    v_mfma_f32_16x16x32_bf16 a[148:151], v[64:67], v[40:43], a[148:151]
    buffer_load_dwordx4 v209, s[4:7], s23 offen offset:1024 lds
    v_mfma_f32_16x16x32_bf16 a[148:151], v[80:83], v[44:47], a[148:151]
    buffer_load_dwordx2 v[136:137], v229, s[12:15], s28 offen offset:2048
    v_mfma_f32_16x16x32_bf16 a[144:147], v[76:79], v[44:47], a[144:147]
    v_mfma_f32_16x16x32_bf16 a[144:147], v[60:63], v[40:43], a[144:147]
    v_mfma_f32_16x16x32_bf16 a[160:163], v[60:63], v[48:51], a[160:163]
    ds_read_b128 v[40:43], v216 offset:2048
    v_mfma_f32_16x16x32_bf16 a[160:163], v[76:79], v[52:55], a[160:163]
    ds_read_b128 v[44:47], v217 offset:2048
    v_mfma_f32_16x16x32_bf16 a[164:167], v[80:83], v[52:55], a[164:167]
    v_mfma_f32_16x16x32_bf16 a[164:167], v[64:67], v[48:51], a[164:167]
    buffer_load_dwordx4 v210, s[4:7], s23 offen offset:2048 lds
    v_smfmac_f32_16x16x64_bf16 a[244:247], a[248:251], v[84:91], v220
    v_mfma_f32_16x16x32_bf16 a[168:171], v[68:71], v[48:51], a[168:171]
    v_mfma_f32_16x16x32_bf16 a[168:171], v[84:87], v[52:55], a[168:171]
    v_mfma_f32_16x16x32_bf16 a[172:175], v[88:91], v[52:55], a[172:175]
    v_mfma_f32_16x16x32_bf16 a[172:175], v[72:75], v[48:51], a[172:175]
    ds_read_b128 v[48:51], v216 offset:4096
    v_mfma_f32_16x16x32_bf16 a[188:191], v[72:75], v[0:3], a[188:191]
    ds_read_b128 v[52:55], v217 offset:4096
    v_mfma_f32_16x16x32_bf16 a[188:191], v[88:91], v[4:7], a[188:191]
    buffer_load_dwordx4 v211, s[4:7], s23 offen offset:3072 lds
    v_mfma_f32_16x16x32_bf16 a[184:187], v[84:87], v[4:7], a[184:187]
    v_mfma_f32_16x16x32_bf16 a[184:187], v[68:71], v[0:3], a[184:187]
    v_mfma_f32_16x16x32_bf16 a[180:183], v[64:67], v[0:3], a[180:183]
    v_mfma_f32_16x16x32_bf16 a[180:183], v[80:83], v[4:7], a[180:183]
    v_mfma_f32_16x16x32_bf16 a[176:179], v[76:79], v[4:7], a[176:179]
    s_cmp_lt_u32 s21, 7
    v_mfma_f32_16x16x32_bf16 a[176:179], v[60:63], v[0:3], a[176:179]
    s_cbranch_scc1 L_k_sk4
    v_mfma_f32_16x16x32_bf16 a[224:227], v[60:63], v[8:11], a[224:227]
    v_mfma_f32_16x16x32_bf16 a[224:227], v[76:79], v[12:15], a[224:227]
    v_mfma_f32_16x16x32_bf16 a[228:231], v[80:83], v[12:15], a[228:231]
    v_mfma_f32_16x16x32_bf16 a[228:231], v[64:67], v[8:11], a[228:231]
    v_mfma_f32_16x16x32_bf16 a[232:235], v[68:71], v[8:11], a[232:235]
    v_mfma_f32_16x16x32_bf16 a[232:235], v[84:87], v[12:15], a[232:235]
    v_mfma_f32_16x16x32_bf16 a[236:239], v[88:91], v[12:15], a[236:239]
    v_mfma_f32_16x16x32_bf16 a[236:239], v[72:75], v[8:11], a[236:239]
L_k_sk4:
    ds_read_b128 v[0:3], v216 offset:6144
    s_add_u32 m0, s26, 36864
    v_mfma_f32_16x16x32_bf16 a[192:195], v[60:63], v[16:19], a[192:195]
    ds_read_b128 v[4:7], v217 offset:6144
    s_mov_b32 s23, 66304
    v_mfma_f32_16x16x32_bf16 a[192:195], v[76:79], v[20:23], a[192:195]
    ds_read_b128 v[8:11], v216 offset:8192
    buffer_load_dwordx4 v208, s[4:7], s23 offen offset:0 lds
L_k_w1:
    s_cbranch_execz L_k_w5
    v_mfma_f32_16x16x32_bf16 a[208:211], v[76:79], v[28:31], a[208:211]
    ds_read_b128 v[12:15], v217 offset:8192
    buffer_load_dwordx4 v209, s[4:7], s23 offen offset:1024 lds
    v_mfma_f32_16x16x32_bf16 a[208:211], v[60:63], v[24:27], a[208:211]
    ds_read_b64_tr_b16 v[60:61], v218 offset:32768
    s_mov_b32 s28, 8192
    v_mfma_f32_16x16x32_bf16 a[196:199], v[64:67], v[16:19], a[196:199]
    ds_read_b64_tr_b16 v[62:63], v218 offset:33792
    buffer_load_dwordx2 v[122:123], v229, s[16:19], s28 offen offset:0
    v_mfma_f32_16x16x32_bf16 a[196:199], v[80:83], v[20:23], a[196:199]
    ds_read_b64_tr_b16 v[76:77], v218 offset:49152
    buffer_load_dwordx4 v210, s[4:7], s23 offen offset:2048 lds
    v_mfma_f32_16x16x32_bf16 a[212:215], v[80:83], v[28:31], a[212:215]
    ds_read_b64_tr_b16 v[78:79], v218 offset:50176
    v_mfma_f32_16x16x32_bf16 a[212:215], v[64:67], v[24:27], a[212:215]
    ds_read_b64_tr_b16 v[64:65], v219 offset:32768
    v_mfma_f32_16x16x32_bf16 a[200:203], v[68:71], v[16:19], a[200:203]
    ds_read_b64_tr_b16 v[66:67], v219 offset:33792
    v_mfma_f32_16x16x32_bf16 a[200:203], v[84:87], v[20:23], a[200:203]
    ds_read_b64_tr_b16 v[80:81], v219 offset:49152
    v_mfma_f32_16x16x32_bf16 a[216:219], v[84:87], v[28:31], a[216:219]
    ds_read_b64_tr_b16 v[82:83], v219 offset:50176
    v_mfma_f32_16x16x32_bf16 a[216:219], v[68:71], v[24:27], a[216:219]
    ds_read_b64_tr_b16 v[68:69], v218 offset:40960
    v_mfma_f32_16x16x32_bf16 a[204:207], v[72:75], v[16:19], a[204:207]
    ds_read_b64_tr_b16 v[70:71], v218 offset:41984
    buffer_load_dwordx4 v211, s[4:7], s23 offen offset:3072 lds
    v_mfma_f32_16x16x32_bf16 a[204:207], v[88:91], v[20:23], a[204:207]
    ds_read_b64_tr_b16 v[84:85], v218 offset:57344
    v_mfma_f32_16x16x32_bf16 a[220:223], v[88:91], v[28:31], a[220:223]
    ds_read_b64_tr_b16 v[86:87], v218 offset:58368
    v_mfma_f32_16x16x32_bf16 a[220:223], v[72:75], v[24:27], a[220:223]
    s_waitcnt lgkmcnt(8)
    v_mfma_f32_16x16x32_bf16 a[0:3], v[60:63], v[32:35], a[0:3]
    ds_read_b64_tr_b16 v[72:73], v219 offset:40960
    v_mfma_f32_16x16x32_bf16 a[0:3], v[76:79], v[36:39], a[0:3]
    ds_read_b64_tr_b16 v[74:75], v219 offset:41984
    v_mfma_f32_16x16x32_bf16 a[16:19], v[76:79], v[44:47], a[16:19]
    ds_read_b64_tr_b16 v[88:89], v219 offset:57344
    v_mfma_f32_16x16x32_bf16 a[16:19], v[60:63], v[40:43], a[16:19]
    s_add_u32 m0, s43, 0
    s_waitcnt lgkmcnt(7)
    v_mfma_f32_16x16x32_bf16 a[4:7], v[64:67], v[32:35], a[4:7]
    ds_read_b64_tr_b16 v[90:91], v219 offset:58368
    s_mov_b32 s25, 3211264
    v_mfma_f32_16x16x32_bf16 a[4:7], v[80:83], v[36:39], a[4:7]
    ds_read_b128 v[16:19], v216 offset:10240
    v_mfma_f32_16x16x32_bf16 a[20:23], v[80:83], v[44:47], a[20:23]
    ds_read_b128 v[20:23], v217 offset:10240
    v_mfma_f32_16x16x32_bf16 a[20:23], v[64:67], v[40:43], a[20:23]
    s_waitcnt lgkmcnt(6)
    v_mfma_f32_16x16x32_bf16 a[8:11], v[68:71], v[32:35], a[8:11]
    ds_read_b128 v[24:27], v216 offset:12288
    v_mfma_f32_16x16x32_bf16 a[8:11], v[84:87], v[36:39], a[8:11]
    ds_read_b128 v[28:31], v217 offset:12288
    v_mfma_f32_16x16x32_bf16 a[24:27], v[84:87], v[44:47], a[24:27]
    buffer_load_dwordx4 v212, s[8:11], s25 offen offset:0  lds
    v_mfma_f32_16x16x32_bf16 a[24:27], v[68:71], v[40:43], a[24:27]
    s_waitcnt lgkmcnt(4)
    v_mfma_f32_16x16x32_bf16 a[12:15], v[72:75], v[32:35], a[12:15]
    buffer_load_dwordx4 v213, s[8:11], s25 offen offset:1024  lds
    v_mfma_f32_16x16x32_bf16 a[12:15], v[88:91], v[36:39], a[12:15]
    buffer_load_dwordx2 v[138:139], v229, s[12:15], s28 offen offset:0
    v_mfma_f32_16x16x32_bf16 a[28:31], v[88:91], v[44:47], a[28:31]
    v_mfma_f32_16x16x32_bf16 a[28:31], v[72:75], v[40:43], a[28:31]
    v_mfma_f32_16x16x32_bf16 a[32:35], v[60:63], v[48:51], a[32:35]
    ds_read_b128 v[32:35], v216 offset:14336
    v_mfma_f32_16x16x32_bf16 a[32:35], v[76:79], v[52:55], a[32:35]
    ds_read_b128 v[36:39], v217 offset:14336
    v_mfma_f32_16x16x32_bf16 a[36:39], v[80:83], v[52:55], a[36:39]
    ds_read_b128 v[40:43], v216 offset:16384
    v_mfma_f32_16x16x32_bf16 a[36:39], v[64:67], v[48:51], a[36:39]
    ds_read_b128 v[44:47], v217 offset:16384
    v_mfma_f32_16x16x32_bf16 a[40:43], v[68:71], v[48:51], a[40:43]
    buffer_load_dwordx4 v214, s[8:11], s25 offen offset:2048  lds
    v_mfma_f32_16x16x32_bf16 a[40:43], v[84:87], v[52:55], a[40:43]
    v_mfma_f32_16x16x32_bf16 a[44:47], v[88:91], v[52:55], a[44:47]
    v_mfma_f32_16x16x32_bf16 a[44:47], v[72:75], v[48:51], a[44:47]
    ds_read_b128 v[48:51], v216 offset:18432
    v_mfma_f32_16x16x32_bf16 a[60:63], v[72:75], v[0:3], a[60:63]
    ds_read_b128 v[52:55], v217 offset:18432
    v_mfma_f32_16x16x32_bf16 a[60:63], v[88:91], v[4:7], a[60:63]
    buffer_load_dwordx4 v215, s[8:11], s25 offen offset:3072  lds
    v_mfma_f32_16x16x32_bf16 a[56:59], v[84:87], v[4:7], a[56:59]
    buffer_load_dwordx2 v[124:125], v229, s[16:19], s28 offen offset:2048
    v_mfma_f32_16x16x32_bf16 a[56:59], v[68:71], v[0:3], a[56:59]
    v_smfmac_f32_16x16x64_bf16 a[240:243], a[248:251], v[60:67], v220
    v_mfma_f32_16x16x32_bf16 a[52:55], v[64:67], v[0:3], a[52:55]
    v_mfma_f32_16x16x32_bf16 a[52:55], v[80:83], v[4:7], a[52:55]
    s_add_u32 m0, s43, 16384
    s_mov_b32 s25, 3440640
    v_mfma_f32_16x16x32_bf16 a[48:51], v[76:79], v[4:7], a[48:51]
    buffer_load_dwordx4 v212, s[8:11], s25 offen offset:0  lds
    v_mfma_f32_16x16x32_bf16 a[48:51], v[60:63], v[0:3], a[48:51]
    s_waitcnt lgkmcnt(8)
    v_mfma_f32_16x16x32_bf16 a[64:67], v[60:63], v[8:11], a[64:67]
    ds_read_b128 v[0:3], v216 offset:20480
    v_mfma_f32_16x16x32_bf16 a[64:67], v[76:79], v[12:15], a[64:67]
    ds_read_b128 v[4:7], v217 offset:20480
    v_mfma_f32_16x16x32_bf16 a[68:71], v[80:83], v[12:15], a[68:71]
    v_mfma_f32_16x16x32_bf16 a[68:71], v[64:67], v[8:11], a[68:71]
    buffer_load_dwordx4 v213, s[8:11], s25 offen offset:1024  lds
    v_mfma_f32_16x16x32_bf16 a[72:75], v[68:71], v[8:11], a[72:75]
    v_mfma_f32_16x16x32_bf16 a[72:75], v[84:87], v[12:15], a[72:75]
    v_mfma_f32_16x16x32_bf16 a[76:79], v[88:91], v[12:15], a[76:79]
    v_mfma_f32_16x16x32_bf16 a[76:79], v[72:75], v[8:11], a[76:79]
    ds_read_b128 v[8:11], v216 offset:22528
    v_mfma_f32_16x16x32_bf16 a[92:95], v[72:75], v[16:19], a[92:95]
    ds_read_b128 v[12:15], v217 offset:22528
    v_mfma_f32_16x16x32_bf16 a[92:95], v[88:91], v[20:23], a[92:95]
    v_mfma_f32_16x16x32_bf16 a[88:91], v[84:87], v[20:23], a[88:91]
    buffer_load_dwordx4 v214, s[8:11], s25 offen offset:2048  lds
    v_mfma_f32_16x16x32_bf16 a[88:91], v[68:71], v[16:19], a[88:91]
    buffer_load_dwordx2 v[140:141], v229, s[12:15], s28 offen offset:2048
    v_smfmac_f32_16x16x64_bf16 a[244:247], a[248:251], v[68:75], v220
    v_mfma_f32_16x16x32_bf16 a[84:87], v[64:67], v[16:19], a[84:87]
    v_mfma_f32_16x16x32_bf16 a[84:87], v[80:83], v[20:23], a[84:87]
    v_mfma_f32_16x16x32_bf16 a[80:83], v[76:79], v[20:23], a[80:83]
    v_mfma_f32_16x16x32_bf16 a[80:83], v[60:63], v[16:19], a[80:83]
    s_waitcnt lgkmcnt(8)
    v_mfma_f32_16x16x32_bf16 a[96:99], v[60:63], v[24:27], a[96:99]
    ds_read_b128 v[16:19], v216 offset:28672
    v_mfma_f32_16x16x32_bf16 a[96:99], v[76:79], v[28:31], a[96:99]
    ds_read_b128 v[20:23], v217 offset:28672
    v_mfma_f32_16x16x32_bf16 a[100:103], v[80:83], v[28:31], a[100:103]
    buffer_load_dwordx4 v215, s[8:11], s25 offen offset:3072  lds
    v_mfma_f32_16x16x32_bf16 a[100:103], v[64:67], v[24:27], a[100:103]
    v_mfma_f32_16x16x32_bf16 a[104:107], v[68:71], v[24:27], a[104:107]
    v_mfma_f32_16x16x32_bf16 a[104:107], v[84:87], v[28:31], a[104:107]
    v_mfma_f32_16x16x32_bf16 a[108:111], v[88:91], v[28:31], a[108:111]
    v_mfma_f32_16x16x32_bf16 a[108:111], v[72:75], v[24:27], a[108:111]
    ds_read_b128 v[24:27], v216 offset:24576
    v_mfma_f32_16x16x32_bf16 a[124:127], v[72:75], v[32:35], a[124:127]
    ds_read_b128 v[28:31], v217 offset:24576
    v_mfma_f32_16x16x32_bf16 a[124:127], v[88:91], v[36:39], a[124:127]
    v_mfma_f32_16x16x32_bf16 a[120:123], v[84:87], v[36:39], a[120:123]
    v_mfma_f32_16x16x32_bf16 a[120:123], v[68:71], v[32:35], a[120:123]
    v_smfmac_f32_16x16x64_bf16 a[240:243], a[248:251], v[76:83], v220
    s_mov_b32 s28, 12288
    v_mfma_f32_16x16x32_bf16 a[116:119], v[64:67], v[32:35], a[116:119]
    buffer_load_dwordx2 v[126:127], v229, s[16:19], s28 offen offset:0
    v_mfma_f32_16x16x32_bf16 a[116:119], v[80:83], v[36:39], a[116:119]
    v_mfma_f32_16x16x32_bf16 a[112:115], v[76:79], v[36:39], a[112:115]
    v_mfma_f32_16x16x32_bf16 a[112:115], v[60:63], v[32:35], a[112:115]
    s_waitcnt lgkmcnt(8)
    v_mfma_f32_16x16x32_bf16 a[128:131], v[60:63], v[40:43], a[128:131]
    ds_read_b128 v[32:35], v216 offset:26624
    v_mfma_f32_16x16x32_bf16 a[128:131], v[76:79], v[44:47], a[128:131]
    ds_read_b128 v[36:39], v217 offset:26624
    v_mfma_f32_16x16x32_bf16 a[132:135], v[80:83], v[44:47], a[132:135]
    v_mfma_f32_16x16x32_bf16 a[132:135], v[64:67], v[40:43], a[132:135]
    v_mfma_f32_16x16x32_bf16 a[136:139], v[68:71], v[40:43], a[136:139]
    v_mfma_f32_16x16x32_bf16 a[136:139], v[84:87], v[44:47], a[136:139]
    s_waitcnt vmcnt(12) lgkmcnt(0)
    s_barrier
    v_mfma_f32_16x16x32_bf16 a[140:143], v[88:91], v[44:47], a[140:143]
    s_add_u32 m0, s26, 0
    s_mov_b32 s23, 896
    v_mfma_f32_16x16x32_bf16 a[140:143], v[72:75], v[40:43], a[140:143]
    ds_read_b128 v[40:43], v216 offset:32768
    v_mfma_f32_16x16x32_bf16 a[156:159], v[72:75], v[48:51], a[156:159]
    ds_read_b128 v[44:47], v217 offset:32768
    v_mfma_f32_16x16x32_bf16 a[156:159], v[88:91], v[52:55], a[156:159]
    buffer_load_dwordx4 v208, s[4:7], s23 offen offset:0 lds
    v_mfma_f32_16x16x32_bf16 a[152:155], v[84:87], v[52:55], a[152:155]
    v_mfma_f32_16x16x32_bf16 a[152:155], v[68:71], v[48:51], a[152:155]
    v_mfma_f32_16x16x32_bf16 a[148:151], v[64:67], v[48:51], a[148:151]
    buffer_load_dwordx4 v209, s[4:7], s23 offen offset:1024 lds
    v_mfma_f32_16x16x32_bf16 a[148:151], v[80:83], v[52:55], a[148:151]
    buffer_load_dwordx2 v[142:143], v229, s[12:15], s28 offen offset:0
    v_mfma_f32_16x16x32_bf16 a[144:147], v[76:79], v[52:55], a[144:147]
    v_mfma_f32_16x16x32_bf16 a[144:147], v[60:63], v[48:51], a[144:147]
    v_mfma_f32_16x16x32_bf16 a[160:163], v[60:63], v[0:3], a[160:163]
    ds_read_b128 v[48:51], v216 offset:34816
    v_mfma_f32_16x16x32_bf16 a[160:163], v[76:79], v[4:7], a[160:163]
    ds_read_b128 v[52:55], v217 offset:34816
    v_mfma_f32_16x16x32_bf16 a[164:167], v[80:83], v[4:7], a[164:167]
    v_mfma_f32_16x16x32_bf16 a[164:167], v[64:67], v[0:3], a[164:167]
    buffer_load_dwordx4 v210, s[4:7], s23 offen offset:2048 lds
    v_smfmac_f32_16x16x64_bf16 a[244:247], a[248:251], v[84:91], v220
    v_mfma_f32_16x16x32_bf16 a[168:171], v[68:71], v[0:3], a[168:171]
    v_mfma_f32_16x16x32_bf16 a[168:171], v[84:87], v[4:7], a[168:171]
    v_mfma_f32_16x16x32_bf16 a[172:175], v[88:91], v[4:7], a[172:175]
    v_mfma_f32_16x16x32_bf16 a[172:175], v[72:75], v[0:3], a[172:175]
    ds_read_b128 v[0:3], v216 offset:36864
    v_mfma_f32_16x16x32_bf16 a[188:191], v[72:75], v[8:11], a[188:191]
    ds_read_b128 v[4:7], v217 offset:36864
    v_mfma_f32_16x16x32_bf16 a[188:191], v[88:91], v[12:15], a[188:191]
    buffer_load_dwordx4 v211, s[4:7], s23 offen offset:3072 lds
    v_mfma_f32_16x16x32_bf16 a[184:187], v[84:87], v[12:15], a[184:187]
    v_mfma_f32_16x16x32_bf16 a[184:187], v[68:71], v[8:11], a[184:187]
    v_mfma_f32_16x16x32_bf16 a[180:183], v[64:67], v[8:11], a[180:183]
    v_mfma_f32_16x16x32_bf16 a[180:183], v[80:83], v[12:15], a[180:183]
    v_mfma_f32_16x16x32_bf16 a[176:179], v[76:79], v[12:15], a[176:179]
    s_cmp_lt_u32 s21, 7
    v_mfma_f32_16x16x32_bf16 a[176:179], v[60:63], v[8:11], a[176:179]
    s_cbranch_scc1 L_k_sk5
    v_mfma_f32_16x16x32_bf16 a[224:227], v[60:63], v[16:19], a[224:227]
    v_mfma_f32_16x16x32_bf16 a[224:227], v[76:79], v[20:23], a[224:227]
    v_mfma_f32_16x16x32_bf16 a[228:231], v[80:83], v[20:23], a[228:231]
    v_mfma_f32_16x16x32_bf16 a[228:231], v[64:67], v[16:19], a[228:231]
    v_mfma_f32_16x16x32_bf16 a[232:235], v[68:71], v[16:19], a[232:235]
    v_mfma_f32_16x16x32_bf16 a[232:235], v[84:87], v[20:23], a[232:235]
    v_mfma_f32_16x16x32_bf16 a[236:239], v[88:91], v[20:23], a[236:239]
    v_mfma_f32_16x16x32_bf16 a[236:239], v[72:75], v[16:19], a[236:239]
L_k_sk5:
    ds_read_b128 v[8:11], v216 offset:38912
    s_add_u32 m0, s26, 4096
    v_mfma_f32_16x16x32_bf16 a[192:195], v[60:63], v[24:27], a[192:195]
    ds_read_b128 v[12:15], v217 offset:38912
    s_mov_b32 s23, 66432
    v_mfma_f32_16x16x32_bf16 a[192:195], v[76:79], v[28:31], a[192:195]
    ds_read_b128 v[16:19], v216 offset:40960
    buffer_load_dwordx4 v208, s[4:7], s23 offen offset:0 lds
    v_mfma_f32_16x16x32_bf16 a[208:211], v[76:79], v[36:39], a[208:211]
    ds_read_b128 v[20:23], v217 offset:40960
    buffer_load_dwordx4 v209, s[4:7], s23 offen offset:1024 lds
    v_mfma_f32_16x16x32_bf16 a[208:211], v[60:63], v[32:35], a[208:211]
    ds_read_b64_tr_b16 v[60:61], v236 offset:0
    buffer_load_dwordx2 v[128:129], v229, s[16:19], s28 offen offset:2048
    v_mfma_f32_16x16x32_bf16 a[196:199], v[64:67], v[24:27], a[196:199]
    ds_read_b64_tr_b16 v[62:63], v236 offset:1024
    v_mfma_f32_16x16x32_bf16 a[196:199], v[80:83], v[28:31], a[196:199]
    ds_read_b64_tr_b16 v[76:77], v236 offset:16384
    buffer_load_dwordx4 v210, s[4:7], s23 offen offset:2048 lds
    v_mfma_f32_16x16x32_bf16 a[212:215], v[80:83], v[36:39], a[212:215]
    ds_read_b64_tr_b16 v[78:79], v236 offset:17408
    v_mfma_f32_16x16x32_bf16 a[212:215], v[64:67], v[32:35], a[212:215]
    ds_read_b64_tr_b16 v[64:65], v237 offset:0
    v_mfma_f32_16x16x32_bf16 a[200:203], v[68:71], v[24:27], a[200:203]
    ds_read_b64_tr_b16 v[66:67], v237 offset:1024
    v_mfma_f32_16x16x32_bf16 a[200:203], v[84:87], v[28:31], a[200:203]
    ds_read_b64_tr_b16 v[80:81], v237 offset:16384
    v_mfma_f32_16x16x32_bf16 a[216:219], v[84:87], v[36:39], a[216:219]
    ds_read_b64_tr_b16 v[82:83], v237 offset:17408
    v_mfma_f32_16x16x32_bf16 a[216:219], v[68:71], v[32:35], a[216:219]
    ds_read_b64_tr_b16 v[68:69], v236 offset:8192
    v_mfma_f32_16x16x32_bf16 a[204:207], v[72:75], v[24:27], a[204:207]
    ds_read_b64_tr_b16 v[70:71], v236 offset:9216
    buffer_load_dwordx4 v211, s[4:7], s23 offen offset:3072 lds
    v_mfma_f32_16x16x32_bf16 a[204:207], v[88:91], v[28:31], a[204:207]
    ds_read_b64_tr_b16 v[84:85], v236 offset:24576
    v_mfma_f32_16x16x32_bf16 a[220:223], v[88:91], v[36:39], a[220:223]
    ds_read_b64_tr_b16 v[86:87], v236 offset:25600
    v_mfma_f32_16x16x32_bf16 a[220:223], v[72:75], v[32:35], a[220:223]
    s_waitcnt lgkmcnt(8)
    v_mfma_f32_16x16x32_bf16 a[0:3], v[60:63], v[40:43], a[0:3]
    ds_read_b64_tr_b16 v[72:73], v237 offset:8192
    v_mfma_f32_16x16x32_bf16 a[0:3], v[76:79], v[44:47], a[0:3]
    ds_read_b64_tr_b16 v[74:75], v237 offset:9216
    v_mfma_f32_16x16x32_bf16 a[16:19], v[76:79], v[52:55], a[16:19]
    ds_read_b64_tr_b16 v[88:89], v237 offset:24576
    v_mfma_f32_16x16x32_bf16 a[16:19], v[60:63], v[48:51], a[16:19]
    s_add_u32 m0, s43, 32768
    s_waitcnt lgkmcnt(7)
    v_mfma_f32_16x16x32_bf16 a[4:7], v[64:67], v[40:43], a[4:7]
    ds_read_b64_tr_b16 v[90:91], v237 offset:25600
    s_mov_b32 s25, 3670016
    v_mfma_f32_16x16x32_bf16 a[4:7], v[80:83], v[44:47], a[4:7]
    ds_read_b128 v[24:27], v216 offset:43008
    v_mfma_f32_16x16x32_bf16 a[20:23], v[80:83], v[52:55], a[20:23]
    ds_read_b128 v[28:31], v217 offset:43008
    v_mfma_f32_16x16x32_bf16 a[20:23], v[64:67], v[48:51], a[20:23]
    s_waitcnt lgkmcnt(6)
    v_mfma_f32_16x16x32_bf16 a[8:11], v[68:71], v[40:43], a[8:11]
    ds_read_b128 v[32:35], v216 offset:45056
    v_mfma_f32_16x16x32_bf16 a[8:11], v[84:87], v[44:47], a[8:11]
    ds_read_b128 v[36:39], v217 offset:45056
    v_mfma_f32_16x16x32_bf16 a[24:27], v[84:87], v[52:55], a[24:27]
    buffer_load_dwordx4 v212, s[8:11], s25 offen offset:0  lds
    v_mfma_f32_16x16x32_bf16 a[24:27], v[68:71], v[48:51], a[24:27]
    s_waitcnt lgkmcnt(4)
    v_mfma_f32_16x16x32_bf16 a[12:15], v[72:75], v[40:43], a[12:15]
    buffer_load_dwordx4 v213, s[8:11], s25 offen offset:1024  lds
    v_mfma_f32_16x16x32_bf16 a[12:15], v[88:91], v[44:47], a[12:15]
    buffer_load_dwordx2 v[144:145], v229, s[12:15], s28 offen offset:2048
    v_mfma_f32_16x16x32_bf16 a[28:31], v[88:91], v[52:55], a[28:31]
    v_mfma_f32_16x16x32_bf16 a[28:31], v[72:75], v[48:51], a[28:31]
    v_mfma_f32_16x16x32_bf16 a[32:35], v[60:63], v[0:3], a[32:35]
    ds_read_b128 v[40:43], v216 offset:47104
    v_mfma_f32_16x16x32_bf16 a[32:35], v[76:79], v[4:7], a[32:35]
    ds_read_b128 v[44:47], v217 offset:47104
    v_mfma_f32_16x16x32_bf16 a[36:39], v[80:83], v[4:7], a[36:39]
    ds_read_b128 v[48:51], v216 offset:49152
    v_mfma_f32_16x16x32_bf16 a[36:39], v[64:67], v[0:3], a[36:39]
    ds_read_b128 v[52:55], v217 offset:49152
    v_mfma_f32_16x16x32_bf16 a[40:43], v[68:71], v[0:3], a[40:43]
    buffer_load_dwordx4 v214, s[8:11], s25 offen offset:2048  lds
    v_mfma_f32_16x16x32_bf16 a[40:43], v[84:87], v[4:7], a[40:43]
    v_mfma_f32_16x16x32_bf16 a[44:47], v[88:91], v[4:7], a[44:47]
    v_mfma_f32_16x16x32_bf16 a[44:47], v[72:75], v[0:3], a[44:47]
    ds_read_b128 v[0:3], v216 offset:51200
    v_mfma_f32_16x16x32_bf16 a[60:63], v[72:75], v[8:11], a[60:63]
    ds_read_b128 v[4:7], v217 offset:51200
    v_mfma_f32_16x16x32_bf16 a[60:63], v[88:91], v[12:15], a[60:63]
    buffer_load_dwordx4 v215, s[8:11], s25 offen offset:3072  lds
    v_mfma_f32_16x16x32_bf16 a[56:59], v[84:87], v[12:15], a[56:59]
    s_mov_b32 s12, s62
    s_mov_b32 s13, s63
    v_mfma_f32_16x16x32_bf16 a[56:59], v[68:71], v[8:11], a[56:59]
    s_mov_b32 s14, 8192
    v_smfmac_f32_16x16x64_bf16 a[240:243], a[248:251], v[60:67], v220
    buffer_load_dwordx4 v[146:149], v235, s[12:15], 0 offen offset:0
    v_mfma_f32_16x16x32_bf16 a[52:55], v[64:67], v[8:11], a[52:55]
    v_mfma_f32_16x16x32_bf16 a[52:55], v[80:83], v[12:15], a[52:55]
    s_add_u32 m0, s43, 49152
    s_mov_b32 s25, 3899392
    v_mfma_f32_16x16x32_bf16 a[48:51], v[76:79], v[12:15], a[48:51]
    buffer_load_dwordx4 v212, s[8:11], s25 offen offset:0  lds
    v_mfma_f32_16x16x32_bf16 a[48:51], v[60:63], v[8:11], a[48:51]
    s_waitcnt lgkmcnt(8)
    v_mfma_f32_16x16x32_bf16 a[64:67], v[60:63], v[16:19], a[64:67]
    ds_read_b128 v[8:11], v216 offset:53248
    v_mfma_f32_16x16x32_bf16 a[64:67], v[76:79], v[20:23], a[64:67]
    ds_read_b128 v[12:15], v217 offset:53248
    v_mfma_f32_16x16x32_bf16 a[68:71], v[80:83], v[20:23], a[68:71]
    v_mfma_f32_16x16x32_bf16 a[68:71], v[64:67], v[16:19], a[68:71]
    buffer_load_dwordx4 v213, s[8:11], s25 offen offset:1024  lds
    v_mfma_f32_16x16x32_bf16 a[72:75], v[68:71], v[16:19], a[72:75]
    v_mfma_f32_16x16x32_bf16 a[72:75], v[84:87], v[20:23], a[72:75]
    v_mfma_f32_16x16x32_bf16 a[76:79], v[88:91], v[20:23], a[76:79]
    v_mfma_f32_16x16x32_bf16 a[76:79], v[72:75], v[16:19], a[76:79]
    ds_read_b128 v[16:19], v216 offset:55296
    v_mfma_f32_16x16x32_bf16 a[92:95], v[72:75], v[24:27], a[92:95]
    ds_read_b128 v[20:23], v217 offset:55296
    v_mfma_f32_16x16x32_bf16 a[92:95], v[88:91], v[28:31], a[92:95]
    v_mfma_f32_16x16x32_bf16 a[88:91], v[84:87], v[28:31], a[88:91]
    buffer_load_dwordx4 v214, s[8:11], s25 offen offset:2048  lds
    v_mfma_f32_16x16x32_bf16 a[88:91], v[68:71], v[24:27], a[88:91]
    buffer_load_dwordx4 v[150:153], v235, s[12:15], 0 offen offset:16
    v_smfmac_f32_16x16x64_bf16 a[244:247], a[248:251], v[68:75], v220
    v_mfma_f32_16x16x32_bf16 a[84:87], v[64:67], v[24:27], a[84:87]
    v_mfma_f32_16x16x32_bf16 a[84:87], v[80:83], v[28:31], a[84:87]
    v_mfma_f32_16x16x32_bf16 a[80:83], v[76:79], v[28:31], a[80:83]
    v_mfma_f32_16x16x32_bf16 a[80:83], v[60:63], v[24:27], a[80:83]
    s_waitcnt lgkmcnt(8)
    v_mfma_f32_16x16x32_bf16 a[96:99], v[60:63], v[32:35], a[96:99]
    ds_read_b128 v[24:27], v216 offset:61440
    v_mfma_f32_16x16x32_bf16 a[96:99], v[76:79], v[36:39], a[96:99]
    ds_read_b128 v[28:31], v217 offset:61440
    v_mfma_f32_16x16x32_bf16 a[100:103], v[80:83], v[36:39], a[100:103]
    buffer_load_dwordx4 v215, s[8:11], s25 offen offset:3072  lds
    v_mfma_f32_16x16x32_bf16 a[100:103], v[64:67], v[32:35], a[100:103]
    v_mfma_f32_16x16x32_bf16 a[104:107], v[68:71], v[32:35], a[104:107]
    v_mfma_f32_16x16x32_bf16 a[104:107], v[84:87], v[36:39], a[104:107]
    v_mfma_f32_16x16x32_bf16 a[108:111], v[88:91], v[36:39], a[108:111]
    v_mfma_f32_16x16x32_bf16 a[108:111], v[72:75], v[32:35], a[108:111]
    ds_read_b128 v[32:35], v216 offset:57344
    v_mfma_f32_16x16x32_bf16 a[124:127], v[72:75], v[40:43], a[124:127]
    ds_read_b128 v[36:39], v217 offset:57344
    v_mfma_f32_16x16x32_bf16 a[124:127], v[88:91], v[44:47], a[124:127]
    v_mfma_f32_16x16x32_bf16 a[120:123], v[84:87], v[44:47], a[120:123]
    v_mfma_f32_16x16x32_bf16 a[120:123], v[68:71], v[40:43], a[120:123]
    v_smfmac_f32_16x16x64_bf16 a[240:243], a[248:251], v[76:83], v220
    v_mfma_f32_16x16x32_bf16 a[116:119], v[64:67], v[40:43], a[116:119]
    v_mfma_f32_16x16x32_bf16 a[116:119], v[80:83], v[44:47], a[116:119]
    v_mfma_f32_16x16x32_bf16 a[112:115], v[76:79], v[44:47], a[112:115]
    v_mfma_f32_16x16x32_bf16 a[112:115], v[60:63], v[40:43], a[112:115]
    s_waitcnt lgkmcnt(8)
    v_mfma_f32_16x16x32_bf16 a[128:131], v[60:63], v[48:51], a[128:131]
    ds_read_b128 v[40:43], v216 offset:59392
    v_mfma_f32_16x16x32_bf16 a[128:131], v[76:79], v[52:55], a[128:131]
    ds_read_b128 v[44:47], v217 offset:59392
    v_mfma_f32_16x16x32_bf16 a[132:135], v[80:83], v[52:55], a[132:135]
    v_mfma_f32_16x16x32_bf16 a[132:135], v[64:67], v[48:51], a[132:135]
    v_mfma_f32_16x16x32_bf16 a[136:139], v[68:71], v[48:51], a[136:139]
    v_mfma_f32_16x16x32_bf16 a[136:139], v[84:87], v[52:55], a[136:139]
    s_waitcnt vmcnt(11) lgkmcnt(0)
    s_barrier
    v_mfma_f32_16x16x32_bf16 a[140:143], v[88:91], v[52:55], a[140:143]
    s_add_u32 m0, s26, 32768
    s_mov_b32 s23, 1024
    v_mfma_f32_16x16x32_bf16 a[140:143], v[72:75], v[48:51], a[140:143]
    ds_read_b128 v[48:51], v216 offset:0
    v_mfma_f32_16x16x32_bf16 a[156:159], v[72:75], v[0:3], a[156:159]
    ds_read_b128 v[52:55], v217 offset:0
    v_mfma_f32_16x16x32_bf16 a[156:159], v[88:91], v[4:7], a[156:159]
    buffer_load_dwordx4 v208, s[4:7], s23 offen offset:0 lds
    v_mfma_f32_16x16x32_bf16 a[152:155], v[84:87], v[4:7], a[152:155]
    v_mfma_f32_16x16x32_bf16 a[152:155], v[68:71], v[0:3], a[152:155]
    v_mfma_f32_16x16x32_bf16 a[148:151], v[64:67], v[0:3], a[148:151]
    buffer_load_dwordx4 v209, s[4:7], s23 offen offset:1024 lds
    v_mfma_f32_16x16x32_bf16 a[148:151], v[80:83], v[4:7], a[148:151]
    v_mfma_f32_16x16x32_bf16 a[144:147], v[76:79], v[4:7], a[144:147]
    v_mfma_f32_16x16x32_bf16 a[144:147], v[60:63], v[0:3], a[144:147]
    v_mfma_f32_16x16x32_bf16 a[160:163], v[60:63], v[8:11], a[160:163]
    ds_read_b128 v[0:3], v216 offset:2048
    v_mfma_f32_16x16x32_bf16 a[160:163], v[76:79], v[12:15], a[160:163]
    ds_read_b128 v[4:7], v217 offset:2048
    v_mfma_f32_16x16x32_bf16 a[164:167], v[80:83], v[12:15], a[164:167]
    v_mfma_f32_16x16x32_bf16 a[164:167], v[64:67], v[8:11], a[164:167]
    buffer_load_dwordx4 v210, s[4:7], s23 offen offset:2048 lds
    v_smfmac_f32_16x16x64_bf16 a[244:247], a[248:251], v[84:91], v220
    v_mfma_f32_16x16x32_bf16 a[168:171], v[68:71], v[8:11], a[168:171]
    v_mfma_f32_16x16x32_bf16 a[168:171], v[84:87], v[12:15], a[168:171]
    v_mfma_f32_16x16x32_bf16 a[172:175], v[88:91], v[12:15], a[172:175]
    v_mfma_f32_16x16x32_bf16 a[172:175], v[72:75], v[8:11], a[172:175]
    ds_read_b128 v[8:11], v216 offset:4096
    v_mfma_f32_16x16x32_bf16 a[188:191], v[72:75], v[16:19], a[188:191]
    ds_read_b128 v[12:15], v217 offset:4096
    v_mfma_f32_16x16x32_bf16 a[188:191], v[88:91], v[20:23], a[188:191]
    buffer_load_dwordx4 v211, s[4:7], s23 offen offset:3072 lds
    v_mfma_f32_16x16x32_bf16 a[184:187], v[84:87], v[20:23], a[184:187]
    v_mfma_f32_16x16x32_bf16 a[184:187], v[68:71], v[16:19], a[184:187]
    v_mfma_f32_16x16x32_bf16 a[180:183], v[64:67], v[16:19], a[180:183]
    v_mfma_f32_16x16x32_bf16 a[180:183], v[80:83], v[20:23], a[180:183]
    v_mfma_f32_16x16x32_bf16 a[176:179], v[76:79], v[20:23], a[176:179]
    s_cmp_lt_u32 s21, 7
    v_mfma_f32_16x16x32_bf16 a[176:179], v[60:63], v[16:19], a[176:179]
    s_cbranch_scc1 L_k_sk6
    v_mfma_f32_16x16x32_bf16 a[224:227], v[60:63], v[24:27], a[224:227]
    v_mfma_f32_16x16x32_bf16 a[224:227], v[76:79], v[28:31], a[224:227]
    v_mfma_f32_16x16x32_bf16 a[228:231], v[80:83], v[28:31], a[228:231]
    v_mfma_f32_16x16x32_bf16 a[228:231], v[64:67], v[24:27], a[228:231]
    v_mfma_f32_16x16x32_bf16 a[232:235], v[68:71], v[24:27], a[232:235]
    v_mfma_f32_16x16x32_bf16 a[232:235], v[84:87], v[28:31], a[232:235]
    v_mfma_f32_16x16x32_bf16 a[236:239], v[88:91], v[28:31], a[236:239]
    v_mfma_f32_16x16x32_bf16 a[236:239], v[72:75], v[24:27], a[236:239]
L_k_sk6:
    ds_read_b128 v[16:19], v216 offset:6144
    s_add_u32 m0, s26, 36864
    v_mfma_f32_16x16x32_bf16 a[192:195], v[60:63], v[32:35], a[192:195]
    ds_read_b128 v[20:23], v217 offset:6144
    s_mov_b32 s23, 66560
    v_mfma_f32_16x16x32_bf16 a[192:195], v[76:79], v[36:39], a[192:195]
    ds_read_b128 v[24:27], v216 offset:8192
    buffer_load_dwordx4 v208, s[4:7], s23 offen offset:0 lds
    v_mfma_f32_16x16x32_bf16 a[208:211], v[76:79], v[44:47], a[208:211]
    ds_read_b128 v[28:31], v217 offset:8192
    buffer_load_dwordx4 v209, s[4:7], s23 offen offset:1024 lds
    v_mfma_f32_16x16x32_bf16 a[208:211], v[60:63], v[40:43], a[208:211]
    ds_read_b64_tr_b16 v[60:61], v218 offset:0
    v_mfma_f32_16x16x32_bf16 a[196:199], v[64:67], v[32:35], a[196:199]
    ds_read_b64_tr_b16 v[62:63], v218 offset:1024
    v_mfma_f32_16x16x32_bf16 a[196:199], v[80:83], v[36:39], a[196:199]
    ds_read_b64_tr_b16 v[76:77], v218 offset:16384
    buffer_load_dwordx4 v210, s[4:7], s23 offen offset:2048 lds
    v_mfma_f32_16x16x32_bf16 a[212:215], v[80:83], v[44:47], a[212:215]
    ds_read_b64_tr_b16 v[78:79], v218 offset:17408
    v_mfma_f32_16x16x32_bf16 a[212:215], v[64:67], v[40:43], a[212:215]
    ds_read_b64_tr_b16 v[64:65], v219 offset:0
    v_mfma_f32_16x16x32_bf16 a[200:203], v[68:71], v[32:35], a[200:203]
    ds_read_b64_tr_b16 v[66:67], v219 offset:1024
    v_mfma_f32_16x16x32_bf16 a[200:203], v[84:87], v[36:39], a[200:203]
    ds_read_b64_tr_b16 v[80:81], v219 offset:16384
    v_mfma_f32_16x16x32_bf16 a[216:219], v[84:87], v[44:47], a[216:219]
    ds_read_b64_tr_b16 v[82:83], v219 offset:17408
    v_mfma_f32_16x16x32_bf16 a[216:219], v[68:71], v[40:43], a[216:219]
    ds_read_b64_tr_b16 v[68:69], v218 offset:8192
    v_mfma_f32_16x16x32_bf16 a[204:207], v[72:75], v[32:35], a[204:207]
    ds_read_b64_tr_b16 v[70:71], v218 offset:9216
    buffer_load_dwordx4 v211, s[4:7], s23 offen offset:3072 lds
    v_mfma_f32_16x16x32_bf16 a[204:207], v[88:91], v[36:39], a[204:207]
    ds_read_b64_tr_b16 v[84:85], v218 offset:24576
    v_mfma_f32_16x16x32_bf16 a[220:223], v[88:91], v[44:47], a[220:223]
    ds_read_b64_tr_b16 v[86:87], v218 offset:25600
    v_mfma_f32_16x16x32_bf16 a[220:223], v[72:75], v[40:43], a[220:223]
    s_waitcnt lgkmcnt(8)
    v_mfma_f32_16x16x32_bf16 a[0:3], v[60:63], v[48:51], a[0:3]
    ds_read_b64_tr_b16 v[72:73], v219 offset:8192
    s_waitcnt vmcnt(9)
    v_mfma_f32_16x16x32_bf16 a[0:3], v[76:79], v[52:55], a[0:3]
    ds_read_b64_tr_b16 v[74:75], v219 offset:9216
    s_mov_b32 s12, s36
    v_mfma_f32_16x16x32_bf16 a[16:19], v[76:79], v[4:7], a[16:19]
    ds_read_b64_tr_b16 v[88:89], v219 offset:24576
    s_mov_b32 s13, s37
    v_mfma_f32_16x16x32_bf16 a[16:19], v[60:63], v[0:3], a[16:19]
    s_add_u32 m0, s43, 65536
    s_waitcnt lgkmcnt(7)
    v_mfma_f32_16x16x32_bf16 a[4:7], v[64:67], v[48:51], a[4:7]
    ds_read_b64_tr_b16 v[90:91], v219 offset:25600
    s_mov_b32 s25, 4128768
    v_mfma_f32_16x16x32_bf16 a[4:7], v[80:83], v[52:55], a[4:7]
    ds_read_b128 v[32:35], v216 offset:10240
    s_mov_b32 s14, 32768
    v_mfma_f32_16x16x32_bf16 a[20:23], v[80:83], v[4:7], a[20:23]
    ds_read_b128 v[36:39], v217 offset:10240
    v_mfma_f32_16x16x32_bf16 a[20:23], v[64:67], v[0:3], a[20:23]
    s_waitcnt lgkmcnt(6)
    v_mfma_f32_16x16x32_bf16 a[8:11], v[68:71], v[48:51], a[8:11]
    ds_read_b128 v[40:43], v216 offset:12288
    v_mfma_f32_16x16x32_bf16 a[8:11], v[84:87], v[52:55], a[8:11]
    ds_read_b128 v[44:47], v217 offset:12288
    v_mfma_f32_16x16x32_bf16 a[24:27], v[84:87], v[4:7], a[24:27]
    buffer_load_dwordx4 v212, s[8:11], s25 offen offset:0  lds
    v_mfma_f32_16x16x32_bf16 a[24:27], v[68:71], v[0:3], a[24:27]
    s_waitcnt lgkmcnt(4)
    v_mfma_f32_16x16x32_bf16 a[12:15], v[72:75], v[48:51], a[12:15]
    buffer_load_dwordx4 v213, s[8:11], s25 offen offset:1024  lds
    v_mfma_f32_16x16x32_bf16 a[12:15], v[88:91], v[52:55], a[12:15]
    buffer_store_dwordx4 v[200:203], v233, s[12:15], 0 offen sc1
    v_mfma_f32_16x16x32_bf16 a[28:31], v[88:91], v[4:7], a[28:31]
    s_mov_b32 s16, s34
    s_mov_b32 s17, s35
    v_mfma_f32_16x16x32_bf16 a[28:31], v[72:75], v[0:3], a[28:31]
    v_lshlrev_b32 v176, 16, v146
    v_mfma_f32_16x16x32_bf16 a[32:35], v[60:63], v[8:11], a[32:35]
    ds_read_b128 v[48:51], v216 offset:14336
    v_and_b32 v177, s47, v146
    v_mfma_f32_16x16x32_bf16 a[32:35], v[76:79], v[12:15], a[32:35]
    ds_read_b128 v[52:55], v217 offset:14336
    v_lshlrev_b32 v178, 16, v147
    v_mfma_f32_16x16x32_bf16 a[36:39], v[80:83], v[12:15], a[36:39]
    ds_read_b128 v[0:3], v216 offset:16384
    v_and_b32 v179, s47, v147
    v_mfma_f32_16x16x32_bf16 a[36:39], v[64:67], v[8:11], a[36:39]
    ds_read_b128 v[4:7], v217 offset:16384
    v_lshlrev_b32 v180, 16, v148
    v_mfma_f32_16x16x32_bf16 a[40:43], v[68:71], v[8:11], a[40:43]
    buffer_load_dwordx4 v214, s[8:11], s25 offen offset:2048  lds
    v_mfma_f32_16x16x32_bf16 a[40:43], v[84:87], v[12:15], a[40:43]
    v_and_b32 v181, s47, v148
    v_lshlrev_b32 v182, 16, v149
    v_mfma_f32_16x16x32_bf16 a[44:47], v[88:91], v[12:15], a[44:47]
    v_and_b32 v183, s47, v149
    v_lshlrev_b32 v154, 16, v108
    v_mfma_f32_16x16x32_bf16 a[44:47], v[72:75], v[8:11], a[44:47]
    ds_read_b128 v[8:11], v216 offset:18432
    v_and_b32 v155, s47, v108
    v_mfma_f32_16x16x32_bf16 a[60:63], v[72:75], v[16:19], a[60:63]
    ds_read_b128 v[12:15], v217 offset:18432
    v_lshlrev_b32 v156, 16, v110
    v_mfma_f32_16x16x32_bf16 a[60:63], v[88:91], v[20:23], a[60:63]
    buffer_load_dwordx4 v215, s[8:11], s25 offen offset:3072  lds
    v_mfma_f32_16x16x32_bf16 a[56:59], v[84:87], v[20:23], a[56:59]
    v_and_b32 v157, s47, v110
    v_lshlrev_b32 v158, 16, v112
    v_mfma_f32_16x16x32_bf16 a[56:59], v[68:71], v[16:19], a[56:59]
    v_and_b32 v159, s47, v112
    v_lshlrev_b32 v160, 16, v114
    v_smfmac_f32_16x16x64_bf16 a[240:243], a[248:251], v[60:67], v220
    v_and_b32 v161, s47, v114
    v_lshlrev_b32 v162, 16, v116
    v_mfma_f32_16x16x32_bf16 a[52:55], v[64:67], v[16:19], a[52:55]
    v_and_b32 v163, s47, v116
    v_lshlrev_b32 v164, 16, v118
    v_mfma_f32_16x16x32_bf16 a[52:55], v[80:83], v[20:23], a[52:55]
    s_add_u32 m0, s43, 81920
    s_mov_b32 s25, 4358144
    v_mfma_f32_16x16x32_bf16 a[48:51], v[76:79], v[20:23], a[48:51]
L_k_w2:
    s_cbranch_execz L_k_w6
    buffer_load_dwordx4 v212, s[8:11], s25 offen offset:0  lds
    v_mfma_f32_16x16x32_bf16 a[48:51], v[60:63], v[16:19], a[48:51]
    v_and_b32 v165, s47, v118
    s_waitcnt lgkmcnt(8)
    v_mfma_f32_16x16x32_bf16 a[64:67], v[60:63], v[24:27], a[64:67]
    ds_read_b128 v[16:19], v216 offset:20480
    v_lshlrev_b32 v166, 16, v120
    v_mfma_f32_16x16x32_bf16 a[64:67], v[76:79], v[28:31], a[64:67]
    ds_read_b128 v[20:23], v217 offset:20480
    v_and_b32 v167, s47, v120
    v_mfma_f32_16x16x32_bf16 a[68:71], v[80:83], v[28:31], a[68:71]
    v_lshlrev_b32 v168, 16, v122
    v_and_b32 v169, s47, v122
    v_mfma_f32_16x16x32_bf16 a[68:71], v[64:67], v[24:27], a[68:71]
    buffer_load_dwordx4 v213, s[8:11], s25 offen offset:1024  lds
    v_mfma_f32_16x16x32_bf16 a[72:75], v[68:71], v[24:27], a[72:75]
    v_lshlrev_b32 v170, 16, v124
    v_and_b32 v171, s47, v124
    v_mfma_f32_16x16x32_bf16 a[72:75], v[84:87], v[28:31], a[72:75]
    v_lshlrev_b32 v172, 16, v126
    v_and_b32 v173, s47, v126
    v_mfma_f32_16x16x32_bf16 a[76:79], v[88:91], v[28:31], a[76:79]
    v_lshlrev_b32 v174, 16, v128
    v_and_b32 v175, s47, v128
    v_mfma_f32_16x16x32_bf16 a[76:79], v[72:75], v[24:27], a[76:79]
    ds_read_b128 v[24:27], v216 offset:22528
    v_lshlrev_b32 v184, 16, v130
    v_mfma_f32_16x16x32_bf16 a[92:95], v[72:75], v[32:35], a[92:95]
    ds_read_b128 v[28:31], v217 offset:22528
    v_and_b32 v185, s47, v130
    v_mfma_f32_16x16x32_bf16 a[92:95], v[88:91], v[36:39], a[92:95]
    v_lshlrev_b32 v186, 16, v132
    v_and_b32 v187, s47, v132
    v_mfma_f32_16x16x32_bf16 a[88:91], v[84:87], v[36:39], a[88:91]
    buffer_load_dwordx4 v214, s[8:11], s25 offen offset:2048  lds
    v_mfma_f32_16x16x32_bf16 a[88:91], v[68:71], v[32:35], a[88:91]
    v_lshlrev_b32 v188, 16, v134
    v_and_b32 v189, s47, v134
    v_smfmac_f32_16x16x64_bf16 a[244:247], a[248:251], v[68:75], v220
    v_lshlrev_b32 v190, 16, v136
    v_and_b32 v191, s47, v136
    v_mfma_f32_16x16x32_bf16 a[84:87], v[64:67], v[32:35], a[84:87]
    v_mul_f32 v192, v154, v179
    v_mul_f32 v193, v155, v183
    v_mfma_f32_16x16x32_bf16 a[84:87], v[80:83], v[36:39], a[84:87]
    v_mul_f32 v194, v156, v179
    v_mul_f32 v195, v157, v183
    v_mfma_f32_16x16x32_bf16 a[80:83], v[76:79], v[36:39], a[80:83]
    v_mul_f32 v196, v158, v179
    v_mul_f32 v197, v159, v183
    v_mfma_f32_16x16x32_bf16 a[80:83], v[60:63], v[32:35], a[80:83]
    v_mul_f32 v198, v160, v179
    s_waitcnt lgkmcnt(8)
    v_mfma_f32_16x16x32_bf16 a[96:99], v[60:63], v[40:43], a[96:99]
    ds_read_b128 v[32:35], v216 offset:28672
    v_mul_f32 v199, v161, v183
    v_mfma_f32_16x16x32_bf16 a[96:99], v[76:79], v[44:47], a[96:99]
    ds_read_b128 v[36:39], v217 offset:28672
    v_fmac_f32 v192, v156, v178
    v_mfma_f32_16x16x32_bf16 a[100:103], v[80:83], v[44:47], a[100:103]
    buffer_load_dwordx4 v215, s[8:11], s25 offen offset:3072  lds
    v_mfma_f32_16x16x32_bf16 a[100:103], v[64:67], v[40:43], a[100:103]
    v_fmac_f32 v193, v157, v182
    v_fmac_f32 v194, v158, v178
    v_mfma_f32_16x16x32_bf16 a[104:107], v[68:71], v[40:43], a[104:107]
    v_fmac_f32 v195, v159, v182
    v_fmac_f32 v196, v160, v178
    v_mfma_f32_16x16x32_bf16 a[104:107], v[84:87], v[44:47], a[104:107]
    v_fmac_f32 v197, v161, v182
    v_fmac_f32 v198, v162, v178
    v_mfma_f32_16x16x32_bf16 a[108:111], v[88:91], v[44:47], a[108:111]
    v_fmac_f32 v199, v163, v182
    v_fmac_f32 v192, v158, v177
    v_mfma_f32_16x16x32_bf16 a[108:111], v[72:75], v[40:43], a[108:111]
    ds_read_b128 v[40:43], v216 offset:24576
    v_fmac_f32 v193, v159, v181
    v_mfma_f32_16x16x32_bf16 a[124:127], v[72:75], v[48:51], a[124:127]
    ds_read_b128 v[44:47], v217 offset:24576
    v_fmac_f32 v194, v160, v177
    v_mfma_f32_16x16x32_bf16 a[124:127], v[88:91], v[52:55], a[124:127]
    v_fmac_f32 v195, v161, v181
    v_fmac_f32 v196, v162, v177
    v_mfma_f32_16x16x32_bf16 a[120:123], v[84:87], v[52:55], a[120:123]
    v_fmac_f32 v197, v163, v181
    v_fmac_f32 v198, v164, v177
    v_mfma_f32_16x16x32_bf16 a[120:123], v[68:71], v[48:51], a[120:123]
    v_fmac_f32 v199, v165, v181
    v_fmac_f32 v192, v160, v176
    v_smfmac_f32_16x16x64_bf16 a[240:243], a[248:251], v[76:83], v220
    v_fmac_f32 v193, v161, v180
    v_fmac_f32 v194, v162, v176
    v_mfma_f32_16x16x32_bf16 a[116:119], v[64:67], v[48:51], a[116:119]
    v_fmac_f32 v195, v163, v180
    v_fmac_f32 v196, v164, v176
    v_mfma_f32_16x16x32_bf16 a[116:119], v[80:83], v[52:55], a[116:119]
    v_fmac_f32 v197, v165, v180
    v_fmac_f32 v198, v166, v176
    v_mfma_f32_16x16x32_bf16 a[112:115], v[76:79], v[52:55], a[112:115]
    v_fmac_f32 v199, v167, v180
    v_mul_f32 v192, v192, v184
    v_mfma_f32_16x16x32_bf16 a[112:115], v[60:63], v[48:51], a[112:115]
    v_mul_f32 v193, v193, v185
    s_waitcnt lgkmcnt(8)
    v_mfma_f32_16x16x32_bf16 a[128:131], v[60:63], v[0:3], a[128:131]
    ds_read_b128 v[48:51], v216 offset:26624
    v_mul_f32 v194, v194, v186
    v_mfma_f32_16x16x32_bf16 a[128:131], v[76:79], v[4:7], a[128:131]
    ds_read_b128 v[52:55], v217 offset:26624
    v_mul_f32 v195, v195, v187
    v_mfma_f32_16x16x32_bf16 a[132:135], v[80:83], v[4:7], a[132:135]
    v_mul_f32 v196, v196, v188
    v_mul_f32 v197, v197, v189
    v_mfma_f32_16x16x32_bf16 a[132:135], v[64:67], v[0:3], a[132:135]
    v_mul_f32 v198, v198, v190
    v_mul_f32 v199, v199, v191
    v_mfma_f32_16x16x32_bf16 a[136:139], v[68:71], v[0:3], a[136:139]
    v_cvt_pk_bf16_f32 v92, v192, v194
    v_cvt_pk_bf16_f32 v93, v196, v198
    v_mfma_f32_16x16x32_bf16 a[136:139], v[84:87], v[4:7], a[136:139]
    s_waitcnt vmcnt(9) lgkmcnt(0)
    s_barrier
    v_mfma_f32_16x16x32_bf16 a[140:143], v[88:91], v[4:7], a[140:143]
    s_add_u32 m0, s26, 0
    s_mov_b32 s23, 1152
    v_mfma_f32_16x16x32_bf16 a[140:143], v[72:75], v[0:3], a[140:143]
    ds_read_b128 v[0:3], v216 offset:32768
    v_cvt_pk_bf16_f32 v96, v193, v195
    v_mfma_f32_16x16x32_bf16 a[156:159], v[72:75], v[8:11], a[156:159]
    ds_read_b128 v[4:7], v217 offset:32768
    v_cvt_pk_bf16_f32 v97, v197, v199
    v_mfma_f32_16x16x32_bf16 a[156:159], v[88:91], v[12:15], a[156:159]
    buffer_load_dwordx4 v208, s[4:7], s23 offen offset:0 lds
    v_mfma_f32_16x16x32_bf16 a[152:155], v[84:87], v[12:15], a[152:155]
    v_lshlrev_b32 v184, 16, v138
    v_and_b32 v185, s47, v138
    v_mfma_f32_16x16x32_bf16 a[152:155], v[68:71], v[8:11], a[152:155]
    v_lshlrev_b32 v186, 16, v140
    v_and_b32 v187, s47, v140
    v_mfma_f32_16x16x32_bf16 a[148:151], v[64:67], v[8:11], a[148:151]
    buffer_load_dwordx4 v209, s[4:7], s23 offen offset:1024 lds
    v_mfma_f32_16x16x32_bf16 a[148:151], v[80:83], v[12:15], a[148:151]
    v_lshlrev_b32 v188, 16, v142
    v_and_b32 v189, s47, v142
    v_mfma_f32_16x16x32_bf16 a[144:147], v[76:79], v[12:15], a[144:147]
    v_lshlrev_b32 v190, 16, v144
    v_and_b32 v191, s47, v144
    v_mfma_f32_16x16x32_bf16 a[144:147], v[60:63], v[8:11], a[144:147]
    v_mul_f32 v192, v162, v179
    v_mfma_f32_16x16x32_bf16 a[160:163], v[60:63], v[16:19], a[160:163]
    ds_read_b128 v[8:11], v216 offset:34816
    v_mul_f32 v193, v163, v183
    v_mfma_f32_16x16x32_bf16 a[160:163], v[76:79], v[20:23], a[160:163]
    ds_read_b128 v[12:15], v217 offset:34816
    v_mul_f32 v194, v164, v179
    v_mfma_f32_16x16x32_bf16 a[164:167], v[80:83], v[20:23], a[164:167]
    v_mul_f32 v195, v165, v183
    v_mul_f32 v196, v166, v179
    v_mfma_f32_16x16x32_bf16 a[164:167], v[64:67], v[16:19], a[164:167]
    buffer_load_dwordx4 v210, s[4:7], s23 offen offset:2048 lds
    v_smfmac_f32_16x16x64_bf16 a[244:247], a[248:251], v[84:91], v220
    v_mul_f32 v197, v167, v183
    v_mul_f32 v198, v168, v179
    v_mfma_f32_16x16x32_bf16 a[168:171], v[68:71], v[16:19], a[168:171]
    v_mul_f32 v199, v169, v183
    v_fmac_f32 v192, v164, v178
    v_mfma_f32_16x16x32_bf16 a[168:171], v[84:87], v[20:23], a[168:171]
    v_fmac_f32 v193, v165, v182
    v_fmac_f32 v194, v166, v178
    v_mfma_f32_16x16x32_bf16 a[172:175], v[88:91], v[20:23], a[172:175]
    v_fmac_f32 v195, v167, v182
    v_fmac_f32 v196, v168, v178
    v_mfma_f32_16x16x32_bf16 a[172:175], v[72:75], v[16:19], a[172:175]
    ds_read_b128 v[16:19], v216 offset:36864
    v_fmac_f32 v197, v169, v182
    v_mfma_f32_16x16x32_bf16 a[188:191], v[72:75], v[24:27], a[188:191]
    ds_read_b128 v[20:23], v217 offset:36864
    v_fmac_f32 v198, v170, v178
    v_mfma_f32_16x16x32_bf16 a[188:191], v[88:91], v[28:31], a[188:191]
    buffer_load_dwordx4 v211, s[4:7], s23 offen offset:3072 lds
    v_mfma_f32_16x16x32_bf16 a[184:187], v[84:87], v[28:31], a[184:187]
    v_fmac_f32 v199, v171, v182
    v_fmac_f32 v192, v166, v177
    v_mfma_f32_16x16x32_bf16 a[184:187], v[68:71], v[24:27], a[184:187]
    v_fmac_f32 v193, v167, v181
    v_fmac_f32 v194, v168, v177
    v_mfma_f32_16x16x32_bf16 a[180:183], v[64:67], v[24:27], a[180:183]
    v_fmac_f32 v195, v169, v181
    v_fmac_f32 v196, v170, v177
    v_mfma_f32_16x16x32_bf16 a[180:183], v[80:83], v[28:31], a[180:183]
    v_fmac_f32 v197, v171, v181
    v_fmac_f32 v198, v172, v177
    v_mfma_f32_16x16x32_bf16 a[176:179], v[76:79], v[28:31], a[176:179]
    s_cmp_lt_u32 s21, 7
    v_mfma_f32_16x16x32_bf16 a[176:179], v[60:63], v[24:27], a[176:179]
    s_cbranch_scc1 L_k_sk7
    v_mfma_f32_16x16x32_bf16 a[224:227], v[60:63], v[32:35], a[224:227]
    v_mfma_f32_16x16x32_bf16 a[224:227], v[76:79], v[36:39], a[224:227]
    v_mfma_f32_16x16x32_bf16 a[228:231], v[80:83], v[36:39], a[228:231]
    v_mfma_f32_16x16x32_bf16 a[228:231], v[64:67], v[32:35], a[228:231]
    v_mfma_f32_16x16x32_bf16 a[232:235], v[68:71], v[32:35], a[232:235]
    v_mfma_f32_16x16x32_bf16 a[232:235], v[84:87], v[36:39], a[232:235]
    v_mfma_f32_16x16x32_bf16 a[236:239], v[88:91], v[36:39], a[236:239]
    v_mfma_f32_16x16x32_bf16 a[236:239], v[72:75], v[32:35], a[236:239]
L_k_sk7:
    ds_read_b128 v[24:27], v216 offset:38912
    s_add_u32 m0, s26, 4096
    v_mfma_f32_16x16x32_bf16 a[192:195], v[60:63], v[40:43], a[192:195]
    ds_read_b128 v[28:31], v217 offset:38912
    s_mov_b32 s23, 66688
    v_mfma_f32_16x16x32_bf16 a[192:195], v[76:79], v[44:47], a[192:195]
    ds_read_b128 v[32:35], v216 offset:40960
    buffer_load_dwordx4 v208, s[4:7], s23 offen offset:0 lds
    v_mfma_f32_16x16x32_bf16 a[208:211], v[76:79], v[52:55], a[208:211]
    ds_read_b128 v[36:39], v217 offset:40960
    buffer_load_dwordx4 v209, s[4:7], s23 offen offset:1024 lds
    v_mfma_f32_16x16x32_bf16 a[208:211], v[60:63], v[48:51], a[208:211]
    ds_read_b64_tr_b16 v[60:61], v218 offset:32768
    v_fmac_f32 v199, v173, v181
    v_mfma_f32_16x16x32_bf16 a[196:199], v[64:67], v[40:43], a[196:199]
    ds_read_b64_tr_b16 v[62:63], v218 offset:33792
    v_fmac_f32 v192, v168, v176
    v_mfma_f32_16x16x32_bf16 a[196:199], v[80:83], v[44:47], a[196:199]
    ds_read_b64_tr_b16 v[76:77], v218 offset:49152
    buffer_load_dwordx4 v210, s[4:7], s23 offen offset:2048 lds
    v_mfma_f32_16x16x32_bf16 a[212:215], v[80:83], v[52:55], a[212:215]
    ds_read_b64_tr_b16 v[78:79], v218 offset:50176
    v_fmac_f32 v193, v169, v180
    v_mfma_f32_16x16x32_bf16 a[212:215], v[64:67], v[48:51], a[212:215]
    ds_read_b64_tr_b16 v[64:65], v219 offset:32768
    v_fmac_f32 v194, v170, v176
    v_mfma_f32_16x16x32_bf16 a[200:203], v[68:71], v[40:43], a[200:203]
    ds_read_b64_tr_b16 v[66:67], v219 offset:33792
    v_fmac_f32 v195, v171, v180
    v_mfma_f32_16x16x32_bf16 a[200:203], v[84:87], v[44:47], a[200:203]
    ds_read_b64_tr_b16 v[80:81], v219 offset:49152
    v_fmac_f32 v196, v172, v176
    v_mfma_f32_16x16x32_bf16 a[216:219], v[84:87], v[52:55], a[216:219]
    ds_read_b64_tr_b16 v[82:83], v219 offset:50176
    v_fmac_f32 v197, v173, v180
    v_mfma_f32_16x16x32_bf16 a[216:219], v[68:71], v[48:51], a[216:219]
    ds_read_b64_tr_b16 v[68:69], v218 offset:40960
    v_fmac_f32 v198, v174, v176
    v_mfma_f32_16x16x32_bf16 a[204:207], v[72:75], v[40:43], a[204:207]
    ds_read_b64_tr_b16 v[70:71], v218 offset:41984
    buffer_load_dwordx4 v211, s[4:7], s23 offen offset:3072 lds
    v_mfma_f32_16x16x32_bf16 a[204:207], v[88:91], v[44:47], a[204:207]
    ds_read_b64_tr_b16 v[84:85], v218 offset:57344
    v_fmac_f32 v199, v175, v180
    v_mfma_f32_16x16x32_bf16 a[220:223], v[88:91], v[52:55], a[220:223]
    ds_read_b64_tr_b16 v[86:87], v218 offset:58368
    v_mul_f32 v192, v192, v184
    v_mfma_f32_16x16x32_bf16 a[220:223], v[72:75], v[48:51], a[220:223]
    v_mul_f32 v193, v193, v185
    s_waitcnt lgkmcnt(8)
    v_mfma_f32_16x16x32_bf16 a[0:3], v[60:63], v[0:3], a[0:3]
    ds_read_b64_tr_b16 v[72:73], v219 offset:40960
    v_mul_f32 v194, v194, v186
    v_mfma_f32_16x16x32_bf16 a[0:3], v[76:79], v[4:7], a[0:3]
    ds_read_b64_tr_b16 v[74:75], v219 offset:41984
    v_mul_f32 v195, v195, v187
    v_mfma_f32_16x16x32_bf16 a[16:19], v[76:79], v[12:15], a[16:19]
    ds_read_b64_tr_b16 v[88:89], v219 offset:57344
    v_mul_f32 v196, v196, v188
    v_mfma_f32_16x16x32_bf16 a[16:19], v[60:63], v[8:11], a[16:19]
    s_add_u32 m0, s43, 0
    s_waitcnt lgkmcnt(7)
    v_mfma_f32_16x16x32_bf16 a[4:7], v[64:67], v[0:3], a[4:7]
    ds_read_b64_tr_b16 v[90:91], v219 offset:58368
    s_mov_b32 s25, 4587520
    v_mfma_f32_16x16x32_bf16 a[4:7], v[80:83], v[4:7], a[4:7]
    ds_read_b128 v[40:43], v216 offset:43008
    v_mul_f32 v197, v197, v189
    v_mfma_f32_16x16x32_bf16 a[20:23], v[80:83], v[12:15], a[20:23]
    ds_read_b128 v[44:47], v217 offset:43008
    v_mul_f32 v198, v198, v190
    v_mfma_f32_16x16x32_bf16 a[20:23], v[64:67], v[8:11], a[20:23]
    v_mul_f32 v199, v199, v191
    s_waitcnt lgkmcnt(6)
    v_mfma_f32_16x16x32_bf16 a[8:11], v[68:71], v[0:3], a[8:11]
    ds_read_b128 v[48:51], v216 offset:45056
    v_cvt_pk_bf16_f32 v94, v192, v194
    v_mfma_f32_16x16x32_bf16 a[8:11], v[84:87], v[4:7], a[8:11]
    ds_read_b128 v[52:55], v217 offset:45056
    v_cvt_pk_bf16_f32 v95, v196, v198
    v_mfma_f32_16x16x32_bf16 a[24:27], v[84:87], v[12:15], a[24:27]
    buffer_load_dwordx4 v212, s[8:11], s25 offen offset:0  lds
    v_mfma_f32_16x16x32_bf16 a[24:27], v[68:71], v[8:11], a[24:27]
    v_cvt_pk_bf16_f32 v98, v193, v195
    s_waitcnt lgkmcnt(4)
    v_mfma_f32_16x16x32_bf16 a[12:15], v[72:75], v[0:3], a[12:15]
    buffer_load_dwordx4 v213, s[8:11], s25 offen offset:1024  lds
    v_mfma_f32_16x16x32_bf16 a[12:15], v[88:91], v[4:7], a[12:15]
    v_cvt_pk_bf16_f32 v99, v197, v199
    v_mfma_f32_16x16x32_bf16 a[28:31], v[88:91], v[12:15], a[28:31]
    buffer_store_dwordx4 v[92:95], v234, s[16:19], 0 offen offset:0 sc1
    v_mfma_f32_16x16x32_bf16 a[28:31], v[72:75], v[8:11], a[28:31]
    v_mfma_f32_16x16x32_bf16 a[32:35], v[60:63], v[16:19], a[32:35]
    ds_read_b128 v[0:3], v216 offset:47104
    v_mfma_f32_16x16x32_bf16 a[32:35], v[76:79], v[20:23], a[32:35]
    ds_read_b128 v[4:7], v217 offset:47104
    v_mfma_f32_16x16x32_bf16 a[36:39], v[80:83], v[20:23], a[36:39]
    ds_read_b128 v[8:11], v216 offset:49152
    v_mfma_f32_16x16x32_bf16 a[36:39], v[64:67], v[16:19], a[36:39]
    ds_read_b128 v[12:15], v217 offset:49152
    v_mfma_f32_16x16x32_bf16 a[40:43], v[68:71], v[16:19], a[40:43]
    buffer_load_dwordx4 v214, s[8:11], s25 offen offset:2048  lds
    v_mfma_f32_16x16x32_bf16 a[40:43], v[84:87], v[20:23], a[40:43]
    buffer_store_dwordx4 v[96:99], v234, s[16:19], 0 offen offset:1024 sc1
    v_mfma_f32_16x16x32_bf16 a[44:47], v[88:91], v[20:23], a[44:47]
    v_lshlrev_b32 v176, 16, v150
    v_and_b32 v177, s47, v150
    v_mfma_f32_16x16x32_bf16 a[44:47], v[72:75], v[16:19], a[44:47]
    ds_read_b128 v[16:19], v216 offset:51200
    v_lshlrev_b32 v178, 16, v151
    v_mfma_f32_16x16x32_bf16 a[60:63], v[72:75], v[24:27], a[60:63]
    ds_read_b128 v[20:23], v217 offset:51200
    v_and_b32 v179, s47, v151
    v_mfma_f32_16x16x32_bf16 a[60:63], v[88:91], v[28:31], a[60:63]
    buffer_load_dwordx4 v215, s[8:11], s25 offen offset:3072  lds
    v_mfma_f32_16x16x32_bf16 a[56:59], v[84:87], v[28:31], a[56:59]
    v_lshlrev_b32 v180, 16, v152
    v_and_b32 v181, s47, v152
    v_mfma_f32_16x16x32_bf16 a[56:59], v[68:71], v[24:27], a[56:59]
    v_lshlrev_b32 v182, 16, v153
    v_and_b32 v183, s47, v153
    v_smfmac_f32_16x16x64_bf16 a[240:243], a[248:251], v[60:67], v220
    v_lshlrev_b32 v154, 16, v109
    v_and_b32 v155, s47, v109
    v_mfma_f32_16x16x32_bf16 a[52:55], v[64:67], v[24:27], a[52:55]
    v_lshlrev_b32 v156, 16, v111
    v_and_b32 v157, s47, v111
    v_mfma_f32_16x16x32_bf16 a[52:55], v[80:83], v[28:31], a[52:55]
    s_add_u32 m0, s43, 16384
    s_mov_b32 s25, 4816896
    v_mfma_f32_16x16x32_bf16 a[48:51], v[76:79], v[28:31], a[48:51]
    buffer_load_dwordx4 v212, s[8:11], s25 offen offset:0  lds
    v_mfma_f32_16x16x32_bf16 a[48:51], v[60:63], v[24:27], a[48:51]
    v_lshlrev_b32 v158, 16, v113
    s_waitcnt lgkmcnt(8)
    v_mfma_f32_16x16x32_bf16 a[64:67], v[60:63], v[32:35], a[64:67]
    ds_read_b128 v[24:27], v216 offset:53248
    v_and_b32 v159, s47, v113
    v_mfma_f32_16x16x32_bf16 a[64:67], v[76:79], v[36:39], a[64:67]
    ds_read_b128 v[28:31], v217 offset:53248
    v_lshlrev_b32 v160, 16, v115
    v_mfma_f32_16x16x32_bf16 a[68:71], v[80:83], v[36:39], a[68:71]
    v_and_b32 v161, s47, v115
    v_lshlrev_b32 v162, 16, v117
    v_mfma_f32_16x16x32_bf16 a[68:71], v[64:67], v[32:35], a[68:71]
    buffer_load_dwordx4 v213, s[8:11], s25 offen offset:1024  lds
    v_mfma_f32_16x16x32_bf16 a[72:75], v[68:71], v[32:35], a[72:75]
    v_and_b32 v163, s47, v117
    v_lshlrev_b32 v164, 16, v119
    v_mfma_f32_16x16x32_bf16 a[72:75], v[84:87], v[36:39], a[72:75]
    v_and_b32 v165, s47, v119
    v_lshlrev_b32 v166, 16, v121
    v_mfma_f32_16x16x32_bf16 a[76:79], v[88:91], v[36:39], a[76:79]
    v_and_b32 v167, s47, v121
    v_lshlrev_b32 v168, 16, v123
    v_mfma_f32_16x16x32_bf16 a[76:79], v[72:75], v[32:35], a[76:79]
    ds_read_b128 v[32:35], v216 offset:55296
    v_and_b32 v169, s47, v123
    v_mfma_f32_16x16x32_bf16 a[92:95], v[72:75], v[40:43], a[92:95]
    ds_read_b128 v[36:39], v217 offset:55296
    v_lshlrev_b32 v170, 16, v125
    v_mfma_f32_16x16x32_bf16 a[92:95], v[88:91], v[44:47], a[92:95]
    v_and_b32 v171, s47, v125
    v_lshlrev_b32 v172, 16, v127
    v_mfma_f32_16x16x32_bf16 a[88:91], v[84:87], v[44:47], a[88:91]
    buffer_load_dwordx4 v214, s[8:11], s25 offen offset:2048  lds
    v_mfma_f32_16x16x32_bf16 a[88:91], v[68:71], v[40:43], a[88:91]
    v_and_b32 v173, s47, v127
    v_lshlrev_b32 v174, 16, v129
    v_smfmac_f32_16x16x64_bf16 a[244:247], a[248:251], v[68:75], v220
    v_and_b32 v175, s47, v129
    v_lshlrev_b32 v184, 16, v131
    v_mfma_f32_16x16x32_bf16 a[84:87], v[64:67], v[40:43], a[84:87]
    v_and_b32 v185, s47, v131
    v_lshlrev_b32 v186, 16, v133
    v_mfma_f32_16x16x32_bf16 a[84:87], v[80:83], v[44:47], a[84:87]
    v_and_b32 v187, s47, v133
    v_lshlrev_b32 v188, 16, v135
    v_mfma_f32_16x16x32_bf16 a[80:83], v[76:79], v[44:47], a[80:83]
    v_and_b32 v189, s47, v135
    v_lshlrev_b32 v190, 16, v137
    v_mfma_f32_16x16x32_bf16 a[80:83], v[60:63], v[40:43], a[80:83]
    v_and_b32 v191, s47, v137
    s_waitcnt lgkmcnt(8)
    v_mfma_f32_16x16x32_bf16 a[96:99], v[60:63], v[48:51], a[96:99]
    ds_read_b128 v[40:43], v216 offset:61440
    v_mul_f32 v192, v154, v179
    v_mfma_f32_16x16x32_bf16 a[96:99], v[76:79], v[52:55], a[96:99]
    ds_read_b128 v[44:47], v217 offset:61440
    v_mul_f32 v193, v155, v183
    v_mfma_f32_16x16x32_bf16 a[100:103], v[80:83], v[52:55], a[100:103]
    buffer_load_dwordx4 v215, s[8:11], s25 offen offset:3072  lds
    v_mfma_f32_16x16x32_bf16 a[100:103], v[64:67], v[48:51], a[100:103]
    v_mul_f32 v194, v156, v179
    v_mul_f32 v195, v157, v183
    v_mfma_f32_16x16x32_bf16 a[104:107], v[68:71], v[48:51], a[104:107]
    v_mul_f32 v196, v158, v179
    v_mul_f32 v197, v159, v183
    v_mfma_f32_16x16x32_bf16 a[104:107], v[84:87], v[52:55], a[104:107]
    v_mul_f32 v198, v160, v179
    v_mul_f32 v199, v161, v183
    v_mfma_f32_16x16x32_bf16 a[108:111], v[88:91], v[52:55], a[108:111]
    v_fmac_f32 v192, v156, v178
    v_fmac_f32 v193, v157, v182
    v_mfma_f32_16x16x32_bf16 a[108:111], v[72:75], v[48:51], a[108:111]
    ds_read_b128 v[48:51], v216 offset:57344
    v_fmac_f32 v194, v158, v178
    v_mfma_f32_16x16x32_bf16 a[124:127], v[72:75], v[0:3], a[124:127]
    ds_read_b128 v[52:55], v217 offset:57344
    v_fmac_f32 v195, v159, v182
    v_mfma_f32_16x16x32_bf16 a[124:127], v[88:91], v[4:7], a[124:127]
    v_fmac_f32 v196, v160, v178
    v_fmac_f32 v197, v161, v182
    v_mfma_f32_16x16x32_bf16 a[120:123], v[84:87], v[4:7], a[120:123]
    v_fmac_f32 v198, v162, v178
    v_fmac_f32 v199, v163, v182
    v_mfma_f32_16x16x32_bf16 a[120:123], v[68:71], v[0:3], a[120:123]
    v_fmac_f32 v192, v158, v177
    v_fmac_f32 v193, v159, v181
    v_smfmac_f32_16x16x64_bf16 a[240:243], a[248:251], v[76:83], v220
    v_fmac_f32 v194, v160, v177
    v_fmac_f32 v195, v161, v181
    v_mfma_f32_16x16x32_bf16 a[116:119], v[64:67], v[0:3], a[116:119]
    v_fmac_f32 v196, v162, v177
    v_fmac_f32 v197, v163, v181
    v_mfma_f32_16x16x32_bf16 a[116:119], v[80:83], v[4:7], a[116:119]
    v_fmac_f32 v198, v164, v177
    v_fmac_f32 v199, v165, v181
    v_mfma_f32_16x16x32_bf16 a[112:115], v[76:79], v[4:7], a[112:115]
    v_fmac_f32 v192, v160, v176
    v_fmac_f32 v193, v161, v180
    v_mfma_f32_16x16x32_bf16 a[112:115], v[60:63], v[0:3], a[112:115]
    v_fmac_f32 v194, v162, v176
    s_waitcnt lgkmcnt(8)
    v_mfma_f32_16x16x32_bf16 a[128:131], v[60:63], v[8:11], a[128:131]
    ds_read_b128 v[0:3], v216 offset:59392
    v_fmac_f32 v195, v163, v180
    v_mfma_f32_16x16x32_bf16 a[128:131], v[76:79], v[12:15], a[128:131]
    ds_read_b128 v[4:7], v217 offset:59392
    v_fmac_f32 v196, v164, v176
    v_mfma_f32_16x16x32_bf16 a[132:135], v[80:83], v[12:15], a[132:135]
    v_fmac_f32 v197, v165, v180
    v_fmac_f32 v198, v166, v176
    v_mfma_f32_16x16x32_bf16 a[132:135], v[64:67], v[8:11], a[132:135]
    v_fmac_f32 v199, v167, v180
    v_mul_f32 v192, v192, v184
    v_mfma_f32_16x16x32_bf16 a[136:139], v[68:71], v[8:11], a[136:139]
    v_mul_f32 v193, v193, v185
    v_mul_f32 v194, v194, v186
    v_mfma_f32_16x16x32_bf16 a[136:139], v[84:87], v[12:15], a[136:139]
    s_waitcnt vmcnt(10) lgkmcnt(0)
    s_barrier
    v_mfma_f32_16x16x32_bf16 a[140:143], v[88:91], v[12:15], a[140:143]
    s_add_u32 m0, s26, 32768
    s_mov_b32 s23, 1280
    v_mfma_f32_16x16x32_bf16 a[140:143], v[72:75], v[8:11], a[140:143]
    ds_read_b128 v[8:11], v216 offset:0
    v_mul_f32 v195, v195, v187
    v_mfma_f32_16x16x32_bf16 a[156:159], v[72:75], v[16:19], a[156:159]
    ds_read_b128 v[12:15], v217 offset:0
    v_mul_f32 v196, v196, v188
    v_mfma_f32_16x16x32_bf16 a[156:159], v[88:91], v[20:23], a[156:159]
    buffer_load_dwordx4 v208, s[4:7], s23 offen offset:0 lds
    v_mfma_f32_16x16x32_bf16 a[152:155], v[84:87], v[20:23], a[152:155]
    v_mul_f32 v197, v197, v189
    v_mul_f32 v198, v198, v190
    v_mfma_f32_16x16x32_bf16 a[152:155], v[68:71], v[16:19], a[152:155]
    v_mul_f32 v199, v199, v191
    v_cvt_pk_bf16_f32 v100, v192, v194
    v_mfma_f32_16x16x32_bf16 a[148:151], v[64:67], v[16:19], a[148:151]
    buffer_load_dwordx4 v209, s[4:7], s23 offen offset:1024 lds
    v_mfma_f32_16x16x32_bf16 a[148:151], v[80:83], v[20:23], a[148:151]
    v_cvt_pk_bf16_f32 v101, v196, v198
    v_cvt_pk_bf16_f32 v104, v193, v195
    v_mfma_f32_16x16x32_bf16 a[144:147], v[76:79], v[20:23], a[144:147]
    v_cvt_pk_bf16_f32 v105, v197, v199
    v_lshlrev_b32 v184, 16, v139
    v_mfma_f32_16x16x32_bf16 a[144:147], v[60:63], v[16:19], a[144:147]
    v_and_b32 v185, s47, v139
    v_mfma_f32_16x16x32_bf16 a[160:163], v[60:63], v[24:27], a[160:163]
    ds_read_b128 v[16:19], v216 offset:2048
    v_lshlrev_b32 v186, 16, v141
    v_mfma_f32_16x16x32_bf16 a[160:163], v[76:79], v[28:31], a[160:163]
    ds_read_b128 v[20:23], v217 offset:2048
    v_and_b32 v187, s47, v141
    v_mfma_f32_16x16x32_bf16 a[164:167], v[80:83], v[28:31], a[164:167]
    v_lshlrev_b32 v188, 16, v143
    v_and_b32 v189, s47, v143
    v_mfma_f32_16x16x32_bf16 a[164:167], v[64:67], v[24:27], a[164:167]
    buffer_load_dwordx4 v210, s[4:7], s23 offen offset:2048 lds
    v_smfmac_f32_16x16x64_bf16 a[244:247], a[248:251], v[84:91], v220
    v_lshlrev_b32 v190, 16, v145
    v_and_b32 v191, s47, v145
    v_mfma_f32_16x16x32_bf16 a[168:171], v[68:71], v[24:27], a[168:171]
    v_mul_f32 v192, v162, v179
    v_mul_f32 v193, v163, v183
    v_mfma_f32_16x16x32_bf16 a[168:171], v[84:87], v[28:31], a[168:171]
    v_mul_f32 v194, v164, v179
    v_mul_f32 v195, v165, v183
    v_mfma_f32_16x16x32_bf16 a[172:175], v[88:91], v[28:31], a[172:175]
    v_mul_f32 v196, v166, v179
    v_mul_f32 v197, v167, v183
    v_mfma_f32_16x16x32_bf16 a[172:175], v[72:75], v[24:27], a[172:175]
    ds_read_b128 v[24:27], v216 offset:4096
    v_mul_f32 v198, v168, v179
    v_mfma_f32_16x16x32_bf16 a[188:191], v[72:75], v[32:35], a[188:191]
    ds_read_b128 v[28:31], v217 offset:4096
    v_mul_f32 v199, v169, v183
    v_mfma_f32_16x16x32_bf16 a[188:191], v[88:91], v[36:39], a[188:191]
    buffer_load_dwordx4 v211, s[4:7], s23 offen offset:3072 lds
    v_mfma_f32_16x16x32_bf16 a[184:187], v[84:87], v[36:39], a[184:187]
    v_fmac_f32 v192, v164, v178
    v_fmac_f32 v193, v165, v182
    v_mfma_f32_16x16x32_bf16 a[184:187], v[68:71], v[32:35], a[184:187]
    v_fmac_f32 v194, v166, v178
    v_fmac_f32 v195, v167, v182
    v_mfma_f32_16x16x32_bf16 a[180:183], v[64:67], v[32:35], a[180:183]
    v_fmac_f32 v196, v168, v178
    v_fmac_f32 v197, v169, v182
    v_mfma_f32_16x16x32_bf16 a[180:183], v[80:83], v[36:39], a[180:183]
    v_fmac_f32 v198, v170, v178
    v_fmac_f32 v199, v171, v182
    v_mfma_f32_16x16x32_bf16 a[176:179], v[76:79], v[36:39], a[176:179]
    s_cmp_lt_u32 s21, 7
    v_mfma_f32_16x16x32_bf16 a[176:179], v[60:63], v[32:35], a[176:179]
    s_cbranch_scc1 L_k_sk8
    v_mfma_f32_16x16x32_bf16 a[224:227], v[60:63], v[40:43], a[224:227]
    v_mfma_f32_16x16x32_bf16 a[224:227], v[76:79], v[44:47], a[224:227]
    v_mfma_f32_16x16x32_bf16 a[228:231], v[80:83], v[44:47], a[228:231]
    v_mfma_f32_16x16x32_bf16 a[228:231], v[64:67], v[40:43], a[228:231]
    v_mfma_f32_16x16x32_bf16 a[232:235], v[68:71], v[40:43], a[232:235]
    v_mfma_f32_16x16x32_bf16 a[232:235], v[84:87], v[44:47], a[232:235]
    v_mfma_f32_16x16x32_bf16 a[236:239], v[88:91], v[44:47], a[236:239]
    v_mfma_f32_16x16x32_bf16 a[236:239], v[72:75], v[40:43], a[236:239]
L_k_sk8:
    ds_read_b128 v[32:35], v216 offset:6144
    s_add_u32 m0, s26, 36864
    v_mfma_f32_16x16x32_bf16 a[192:195], v[60:63], v[48:51], a[192:195]
    ds_read_b128 v[36:39], v217 offset:6144
    s_mov_b32 s23, 66816
    v_mfma_f32_16x16x32_bf16 a[192:195], v[76:79], v[52:55], a[192:195]
    ds_read_b128 v[40:43], v216 offset:8192
    buffer_load_dwordx4 v208, s[4:7], s23 offen offset:0 lds
    v_mfma_f32_16x16x32_bf16 a[208:211], v[76:79], v[4:7], a[208:211]
    ds_read_b128 v[44:47], v217 offset:8192
    buffer_load_dwordx4 v209, s[4:7], s23 offen offset:1024 lds
    v_mfma_f32_16x16x32_bf16 a[208:211], v[60:63], v[0:3], a[208:211]
    ds_read_b64_tr_b16 v[60:61], v236 offset:0
    v_fmac_f32 v192, v166, v177
    v_mfma_f32_16x16x32_bf16 a[196:199], v[64:67], v[48:51], a[196:199]
    ds_read_b64_tr_b16 v[62:63], v236 offset:1024
    v_fmac_f32 v193, v167, v181
    v_mfma_f32_16x16x32_bf16 a[196:199], v[80:83], v[52:55], a[196:199]
    ds_read_b64_tr_b16 v[76:77], v236 offset:16384
    buffer_load_dwordx4 v210, s[4:7], s23 offen offset:2048 lds
    v_mfma_f32_16x16x32_bf16 a[212:215], v[80:83], v[4:7], a[212:215]
    ds_read_b64_tr_b16 v[78:79], v236 offset:17408
    v_fmac_f32 v194, v168, v177
    v_mfma_f32_16x16x32_bf16 a[212:215], v[64:67], v[0:3], a[212:215]
    ds_read_b64_tr_b16 v[64:65], v237 offset:0
    v_fmac_f32 v195, v169, v181
    v_mfma_f32_16x16x32_bf16 a[200:203], v[68:71], v[48:51], a[200:203]
    ds_read_b64_tr_b16 v[66:67], v237 offset:1024
    v_fmac_f32 v196, v170, v177
    v_mfma_f32_16x16x32_bf16 a[200:203], v[84:87], v[52:55], a[200:203]
    ds_read_b64_tr_b16 v[80:81], v237 offset:16384
    v_fmac_f32 v197, v171, v181
    v_mfma_f32_16x16x32_bf16 a[216:219], v[84:87], v[4:7], a[216:219]
    ds_read_b64_tr_b16 v[82:83], v237 offset:17408
    v_fmac_f32 v198, v172, v177
    v_mfma_f32_16x16x32_bf16 a[216:219], v[68:71], v[0:3], a[216:219]
    ds_read_b64_tr_b16 v[68:69], v236 offset:8192
    v_fmac_f32 v199, v173, v181
    v_mfma_f32_16x16x32_bf16 a[204:207], v[72:75], v[48:51], a[204:207]
    ds_read_b64_tr_b16 v[70:71], v236 offset:9216
    buffer_load_dwordx4 v211, s[4:7], s23 offen offset:3072 lds
    v_mfma_f32_16x16x32_bf16 a[204:207], v[88:91], v[52:55], a[204:207]
    ds_read_b64_tr_b16 v[84:85], v236 offset:24576
    v_fmac_f32 v192, v168, v176
    v_mfma_f32_16x16x32_bf16 a[220:223], v[88:91], v[4:7], a[220:223]
    ds_read_b64_tr_b16 v[86:87], v236 offset:25600
    v_fmac_f32 v193, v169, v180
    v_mfma_f32_16x16x32_bf16 a[220:223], v[72:75], v[0:3], a[220:223]
    v_fmac_f32 v194, v170, v176
    s_waitcnt lgkmcnt(8)
    v_mfma_f32_16x16x32_bf16 a[0:3], v[60:63], v[8:11], a[0:3]
    ds_read_b64_tr_b16 v[72:73], v237 offset:8192
    v_fmac_f32 v195, v171, v180
    v_mfma_f32_16x16x32_bf16 a[0:3], v[76:79], v[12:15], a[0:3]
    ds_read_b64_tr_b16 v[74:75], v237 offset:9216
    v_fmac_f32 v196, v172, v176
    v_mfma_f32_16x16x32_bf16 a[16:19], v[76:79], v[20:23], a[16:19]
    ds_read_b64_tr_b16 v[88:89], v237 offset:24576
    v_fmac_f32 v197, v173, v180
    v_mfma_f32_16x16x32_bf16 a[16:19], v[60:63], v[16:19], a[16:19]
    s_add_u32 m0, s43, 32768
    s_waitcnt lgkmcnt(7)
    v_mfma_f32_16x16x32_bf16 a[4:7], v[64:67], v[8:11], a[4:7]
    ds_read_b64_tr_b16 v[90:91], v237 offset:25600
    s_mov_b32 s25, 5505024
    v_mfma_f32_16x16x32_bf16 a[4:7], v[80:83], v[12:15], a[4:7]
    ds_read_b128 v[48:51], v216 offset:10240
    v_fmac_f32 v198, v174, v176
    v_mfma_f32_16x16x32_bf16 a[20:23], v[80:83], v[20:23], a[20:23]
    ds_read_b128 v[52:55], v217 offset:10240
    v_fmac_f32 v199, v175, v180
    v_mfma_f32_16x16x32_bf16 a[20:23], v[64:67], v[16:19], a[20:23]
    v_mul_f32 v192, v192, v184
    s_waitcnt lgkmcnt(6)
    v_mfma_f32_16x16x32_bf16 a[8:11], v[68:71], v[8:11], a[8:11]
    ds_read_b128 v[0:3], v216 offset:12288
    v_mul_f32 v193, v193, v185
    v_mfma_f32_16x16x32_bf16 a[8:11], v[84:87], v[12:15], a[8:11]
    ds_read_b128 v[4:7], v217 offset:12288
    v_mul_f32 v194, v194, v186
    v_mfma_f32_16x16x32_bf16 a[24:27], v[84:87], v[20:23], a[24:27]
    buffer_load_dwordx4 v212, s[8:11], s25 offen offset:0  lds
    v_mfma_f32_16x16x32_bf16 a[24:27], v[68:71], v[16:19], a[24:27]
    v_mul_f32 v195, v195, v187
    s_waitcnt lgkmcnt(4)
    v_mfma_f32_16x16x32_bf16 a[12:15], v[72:75], v[8:11], a[12:15]
    buffer_load_dwordx4 v213, s[8:11], s25 offen offset:1024  lds
    v_mfma_f32_16x16x32_bf16 a[12:15], v[88:91], v[12:15], a[12:15]
    v_mul_f32 v196, v196, v188
    v_mul_f32 v197, v197, v189
    v_mfma_f32_16x16x32_bf16 a[28:31], v[88:91], v[20:23], a[28:31]
    v_mul_f32 v198, v198, v190
    v_mul_f32 v199, v199, v191
    v_mfma_f32_16x16x32_bf16 a[28:31], v[72:75], v[16:19], a[28:31]
    v_cvt_pk_bf16_f32 v102, v192, v194
    v_mfma_f32_16x16x32_bf16 a[32:35], v[60:63], v[24:27], a[32:35]
    ds_read_b128 v[8:11], v216 offset:14336
    v_cvt_pk_bf16_f32 v103, v196, v198
    v_mfma_f32_16x16x32_bf16 a[32:35], v[76:79], v[28:31], a[32:35]
    ds_read_b128 v[12:15], v217 offset:14336
    v_cvt_pk_bf16_f32 v106, v193, v195
    v_mfma_f32_16x16x32_bf16 a[36:39], v[80:83], v[28:31], a[36:39]
    ds_read_b128 v[16:19], v216 offset:16384
L_k_w3:
    s_cbranch_execz L_k_w7
    v_cvt_pk_bf16_f32 v107, v197, v199
    v_mfma_f32_16x16x32_bf16 a[36:39], v[64:67], v[24:27], a[36:39]
    ds_read_b128 v[20:23], v217 offset:16384
    v_mfma_f32_16x16x32_bf16 a[40:43], v[68:71], v[24:27], a[40:43]
    buffer_load_dwordx4 v214, s[8:11], s25 offen offset:2048  lds
    v_mfma_f32_16x16x32_bf16 a[40:43], v[84:87], v[28:31], a[40:43]
    buffer_store_dwordx4 v[100:103], v234, s[16:19], 0 offen offset:2048 sc1
    v_mfma_f32_16x16x32_bf16 a[44:47], v[88:91], v[28:31], a[44:47]
    buffer_store_dwordx4 v[104:107], v234, s[16:19], 0 offen offset:3072 sc1
    v_mfma_f32_16x16x32_bf16 a[44:47], v[72:75], v[24:27], a[44:47]
    ds_read_b128 v[24:27], v216 offset:18432
    s_mov_b32 s12, s32
    v_mfma_f32_16x16x32_bf16 a[60:63], v[72:75], v[32:35], a[60:63]
    ds_read_b128 v[28:31], v217 offset:18432
    s_mov_b32 s13, s33
    v_mfma_f32_16x16x32_bf16 a[60:63], v[88:91], v[36:39], a[60:63]
    buffer_load_dwordx4 v215, s[8:11], s25 offen offset:3072  lds
    v_mfma_f32_16x16x32_bf16 a[56:59], v[84:87], v[36:39], a[56:59]
    s_mov_b32 s14, 256
    v_mfma_f32_16x16x32_bf16 a[56:59], v[68:71], v[32:35], a[56:59]
    buffer_load_dword v252, v223, s[12:15], 0 offen
    v_smfmac_f32_16x16x64_bf16 a[240:243], a[248:251], v[60:67], v220
    v_mfma_f32_16x16x32_bf16 a[52:55], v[64:67], v[32:35], a[52:55]
    v_mfma_f32_16x16x32_bf16 a[52:55], v[80:83], v[36:39], a[52:55]
    s_add_u32 m0, s43, 49152
    s_mov_b32 s25, 5734400
    v_mfma_f32_16x16x32_bf16 a[48:51], v[76:79], v[36:39], a[48:51]
    buffer_load_dwordx4 v212, s[8:11], s25 offen offset:0  lds
    v_mfma_f32_16x16x32_bf16 a[48:51], v[60:63], v[32:35], a[48:51]
    s_waitcnt lgkmcnt(8)
    v_mfma_f32_16x16x32_bf16 a[64:67], v[60:63], v[40:43], a[64:67]
    ds_read_b128 v[32:35], v216 offset:20480
    v_mfma_f32_16x16x32_bf16 a[64:67], v[76:79], v[44:47], a[64:67]
    ds_read_b128 v[36:39], v217 offset:20480
    v_mfma_f32_16x16x32_bf16 a[68:71], v[80:83], v[44:47], a[68:71]
    v_mfma_f32_16x16x32_bf16 a[68:71], v[64:67], v[40:43], a[68:71]
    buffer_load_dwordx4 v213, s[8:11], s25 offen offset:1024  lds
    v_mfma_f32_16x16x32_bf16 a[72:75], v[68:71], v[40:43], a[72:75]
    v_mfma_f32_16x16x32_bf16 a[72:75], v[84:87], v[44:47], a[72:75]
    v_mfma_f32_16x16x32_bf16 a[76:79], v[88:91], v[44:47], a[76:79]
    v_mfma_f32_16x16x32_bf16 a[76:79], v[72:75], v[40:43], a[76:79]
    ds_read_b128 v[40:43], v216 offset:22528
    v_mfma_f32_16x16x32_bf16 a[92:95], v[72:75], v[48:51], a[92:95]
    ds_read_b128 v[44:47], v217 offset:22528
    v_mfma_f32_16x16x32_bf16 a[92:95], v[88:91], v[52:55], a[92:95]
    v_mfma_f32_16x16x32_bf16 a[88:91], v[84:87], v[52:55], a[88:91]
    buffer_load_dwordx4 v214, s[8:11], s25 offen offset:2048  lds
    v_mfma_f32_16x16x32_bf16 a[88:91], v[68:71], v[48:51], a[88:91]
    v_smfmac_f32_16x16x64_bf16 a[244:247], a[248:251], v[68:75], v220
    v_mfma_f32_16x16x32_bf16 a[84:87], v[64:67], v[48:51], a[84:87]
    v_mfma_f32_16x16x32_bf16 a[84:87], v[80:83], v[52:55], a[84:87]
    v_mfma_f32_16x16x32_bf16 a[80:83], v[76:79], v[52:55], a[80:83]
    v_mfma_f32_16x16x32_bf16 a[80:83], v[60:63], v[48:51], a[80:83]
    s_waitcnt lgkmcnt(8)
    v_mfma_f32_16x16x32_bf16 a[96:99], v[60:63], v[0:3], a[96:99]
    ds_read_b128 v[48:51], v216 offset:28672
    v_mfma_f32_16x16x32_bf16 a[96:99], v[76:79], v[4:7], a[96:99]
    ds_read_b128 v[52:55], v217 offset:28672
    v_mfma_f32_16x16x32_bf16 a[100:103], v[80:83], v[4:7], a[100:103]
    buffer_load_dwordx4 v215, s[8:11], s25 offen offset:3072  lds
    v_mfma_f32_16x16x32_bf16 a[100:103], v[64:67], v[0:3], a[100:103]
    v_mfma_f32_16x16x32_bf16 a[104:107], v[68:71], v[0:3], a[104:107]
    v_mfma_f32_16x16x32_bf16 a[104:107], v[84:87], v[4:7], a[104:107]
    v_mfma_f32_16x16x32_bf16 a[108:111], v[88:91], v[4:7], a[108:111]
    v_mfma_f32_16x16x32_bf16 a[108:111], v[72:75], v[0:3], a[108:111]
    ds_read_b128 v[0:3], v216 offset:24576
    v_mfma_f32_16x16x32_bf16 a[124:127], v[72:75], v[8:11], a[124:127]
    ds_read_b128 v[4:7], v217 offset:24576
    v_mfma_f32_16x16x32_bf16 a[124:127], v[88:91], v[12:15], a[124:127]
    v_mfma_f32_16x16x32_bf16 a[120:123], v[84:87], v[12:15], a[120:123]
    v_mfma_f32_16x16x32_bf16 a[120:123], v[68:71], v[8:11], a[120:123]
    v_smfmac_f32_16x16x64_bf16 a[240:243], a[248:251], v[76:83], v220
    v_mfma_f32_16x16x32_bf16 a[116:119], v[64:67], v[8:11], a[116:119]
    v_mfma_f32_16x16x32_bf16 a[116:119], v[80:83], v[12:15], a[116:119]
    v_mfma_f32_16x16x32_bf16 a[112:115], v[76:79], v[12:15], a[112:115]
    v_mfma_f32_16x16x32_bf16 a[112:115], v[60:63], v[8:11], a[112:115]
    s_waitcnt lgkmcnt(8)
    v_mfma_f32_16x16x32_bf16 a[128:131], v[60:63], v[16:19], a[128:131]
    ds_read_b128 v[8:11], v216 offset:26624
    v_mfma_f32_16x16x32_bf16 a[128:131], v[76:79], v[20:23], a[128:131]
    ds_read_b128 v[12:15], v217 offset:26624
    v_mfma_f32_16x16x32_bf16 a[132:135], v[80:83], v[20:23], a[132:135]
    v_mfma_f32_16x16x32_bf16 a[132:135], v[64:67], v[16:19], a[132:135]
    v_mfma_f32_16x16x32_bf16 a[136:139], v[68:71], v[16:19], a[136:139]
    v_mfma_f32_16x16x32_bf16 a[136:139], v[84:87], v[20:23], a[136:139]
    s_waitcnt vmcnt(11) lgkmcnt(0)
    s_barrier
    v_mfma_f32_16x16x32_bf16 a[140:143], v[88:91], v[20:23], a[140:143]
    s_add_u32 m0, s26, 0
    s_mov_b32 s23, 1536
    v_mfma_f32_16x16x32_bf16 a[140:143], v[72:75], v[16:19], a[140:143]
    ds_read_b128 v[16:19], v216 offset:32768
    v_mfma_f32_16x16x32_bf16 a[156:159], v[72:75], v[24:27], a[156:159]
    ds_read_b128 v[20:23], v217 offset:32768
    v_mfma_f32_16x16x32_bf16 a[156:159], v[88:91], v[28:31], a[156:159]
    buffer_load_dwordx4 v208, s[4:7], s23 offen offset:0 lds
    v_mfma_f32_16x16x32_bf16 a[152:155], v[84:87], v[28:31], a[152:155]
    v_mfma_f32_16x16x32_bf16 a[152:155], v[68:71], v[24:27], a[152:155]
    v_mfma_f32_16x16x32_bf16 a[148:151], v[64:67], v[24:27], a[148:151]
    buffer_load_dwordx4 v209, s[4:7], s23 offen offset:1024 lds
    v_mfma_f32_16x16x32_bf16 a[148:151], v[80:83], v[28:31], a[148:151]
    v_mfma_f32_16x16x32_bf16 a[144:147], v[76:79], v[28:31], a[144:147]
    v_mfma_f32_16x16x32_bf16 a[144:147], v[60:63], v[24:27], a[144:147]
    v_mfma_f32_16x16x32_bf16 a[160:163], v[60:63], v[32:35], a[160:163]
    ds_read_b128 v[24:27], v216 offset:34816
    v_mfma_f32_16x16x32_bf16 a[160:163], v[76:79], v[36:39], a[160:163]
    ds_read_b128 v[28:31], v217 offset:34816
    v_mfma_f32_16x16x32_bf16 a[164:167], v[80:83], v[36:39], a[164:167]
    v_mfma_f32_16x16x32_bf16 a[164:167], v[64:67], v[32:35], a[164:167]
    buffer_load_dwordx4 v210, s[4:7], s23 offen offset:2048 lds
    v_smfmac_f32_16x16x64_bf16 a[244:247], a[248:251], v[84:91], v220
    v_mfma_f32_16x16x32_bf16 a[168:171], v[68:71], v[32:35], a[168:171]
    v_mfma_f32_16x16x32_bf16 a[168:171], v[84:87], v[36:39], a[168:171]
    v_mfma_f32_16x16x32_bf16 a[172:175], v[88:91], v[36:39], a[172:175]
    v_mfma_f32_16x16x32_bf16 a[172:175], v[72:75], v[32:35], a[172:175]
    ds_read_b128 v[32:35], v216 offset:36864
    v_mfma_f32_16x16x32_bf16 a[188:191], v[72:75], v[40:43], a[188:191]
    ds_read_b128 v[36:39], v217 offset:36864
    v_mfma_f32_16x16x32_bf16 a[188:191], v[88:91], v[44:47], a[188:191]
    buffer_load_dwordx4 v211, s[4:7], s23 offen offset:3072 lds
    v_mfma_f32_16x16x32_bf16 a[184:187], v[84:87], v[44:47], a[184:187]
    v_mfma_f32_16x16x32_bf16 a[184:187], v[68:71], v[40:43], a[184:187]
    v_mfma_f32_16x16x32_bf16 a[180:183], v[64:67], v[40:43], a[180:183]
    v_mfma_f32_16x16x32_bf16 a[180:183], v[80:83], v[44:47], a[180:183]
    v_mfma_f32_16x16x32_bf16 a[176:179], v[76:79], v[44:47], a[176:179]
    s_cmp_lt_u32 s21, 7
    v_mfma_f32_16x16x32_bf16 a[176:179], v[60:63], v[40:43], a[176:179]
    s_cbranch_scc1 L_k_sk9
    v_mfma_f32_16x16x32_bf16 a[224:227], v[60:63], v[48:51], a[224:227]
    v_mfma_f32_16x16x32_bf16 a[224:227], v[76:79], v[52:55], a[224:227]
    v_mfma_f32_16x16x32_bf16 a[228:231], v[80:83], v[52:55], a[228:231]
    v_mfma_f32_16x16x32_bf16 a[228:231], v[64:67], v[48:51], a[228:231]
    v_mfma_f32_16x16x32_bf16 a[232:235], v[68:71], v[48:51], a[232:235]
    v_mfma_f32_16x16x32_bf16 a[232:235], v[84:87], v[52:55], a[232:235]
    v_mfma_f32_16x16x32_bf16 a[236:239], v[88:91], v[52:55], a[236:239]
    v_mfma_f32_16x16x32_bf16 a[236:239], v[72:75], v[48:51], a[236:239]
L_k_sk9:
    ds_read_b128 v[40:43], v216 offset:38912
    s_add_u32 m0, s26, 4096
    v_mfma_f32_16x16x32_bf16 a[192:195], v[60:63], v[0:3], a[192:195]
    ds_read_b128 v[44:47], v217 offset:38912
    s_mov_b32 s23, 67072
    v_mfma_f32_16x16x32_bf16 a[192:195], v[76:79], v[4:7], a[192:195]
    ds_read_b128 v[48:51], v216 offset:40960
    buffer_load_dwordx4 v208, s[4:7], s23 offen offset:0 lds
    v_mfma_f32_16x16x32_bf16 a[208:211], v[76:79], v[12:15], a[208:211]
    ds_read_b128 v[52:55], v217 offset:40960
    buffer_load_dwordx4 v209, s[4:7], s23 offen offset:1024 lds
    v_mfma_f32_16x16x32_bf16 a[208:211], v[60:63], v[8:11], a[208:211]
    ds_read_b64_tr_b16 v[60:61], v218 offset:0
    v_mfma_f32_16x16x32_bf16 a[196:199], v[64:67], v[0:3], a[196:199]
    ds_read_b64_tr_b16 v[62:63], v218 offset:1024
    v_mfma_f32_16x16x32_bf16 a[196:199], v[80:83], v[4:7], a[196:199]
    ds_read_b64_tr_b16 v[76:77], v218 offset:16384
    buffer_load_dwordx4 v210, s[4:7], s23 offen offset:2048 lds
    v_mfma_f32_16x16x32_bf16 a[212:215], v[80:83], v[12:15], a[212:215]
    ds_read_b64_tr_b16 v[78:79], v218 offset:17408
    v_mfma_f32_16x16x32_bf16 a[212:215], v[64:67], v[8:11], a[212:215]
    ds_read_b64_tr_b16 v[64:65], v219 offset:0
    v_mfma_f32_16x16x32_bf16 a[200:203], v[68:71], v[0:3], a[200:203]
    ds_read_b64_tr_b16 v[66:67], v219 offset:1024
    v_mfma_f32_16x16x32_bf16 a[200:203], v[84:87], v[4:7], a[200:203]
    ds_read_b64_tr_b16 v[80:81], v219 offset:16384
    v_mfma_f32_16x16x32_bf16 a[216:219], v[84:87], v[12:15], a[216:219]
    ds_read_b64_tr_b16 v[82:83], v219 offset:17408
    v_mfma_f32_16x16x32_bf16 a[216:219], v[68:71], v[8:11], a[216:219]
    ds_read_b64_tr_b16 v[68:69], v218 offset:8192
    v_mfma_f32_16x16x32_bf16 a[204:207], v[72:75], v[0:3], a[204:207]
    ds_read_b64_tr_b16 v[70:71], v218 offset:9216
    buffer_load_dwordx4 v211, s[4:7], s23 offen offset:3072 lds
    v_mfma_f32_16x16x32_bf16 a[204:207], v[88:91], v[4:7], a[204:207]
    ds_read_b64_tr_b16 v[84:85], v218 offset:24576
    v_mfma_f32_16x16x32_bf16 a[220:223], v[88:91], v[12:15], a[220:223]
    ds_read_b64_tr_b16 v[86:87], v218 offset:25600
    v_mfma_f32_16x16x32_bf16 a[220:223], v[72:75], v[8:11], a[220:223]
    s_waitcnt lgkmcnt(8)
    v_mfma_f32_16x16x32_bf16 a[0:3], v[60:63], v[16:19], a[0:3]
    ds_read_b64_tr_b16 v[72:73], v219 offset:8192
    v_mfma_f32_16x16x32_bf16 a[0:3], v[76:79], v[20:23], a[0:3]
    ds_read_b64_tr_b16 v[74:75], v219 offset:9216
    v_mfma_f32_16x16x32_bf16 a[16:19], v[76:79], v[28:31], a[16:19]
    ds_read_b64_tr_b16 v[88:89], v219 offset:24576
    v_mfma_f32_16x16x32_bf16 a[16:19], v[60:63], v[24:27], a[16:19]
    s_add_u32 m0, s43, 65536
    s_waitcnt lgkmcnt(7)
    v_mfma_f32_16x16x32_bf16 a[4:7], v[64:67], v[16:19], a[4:7]
    ds_read_b64_tr_b16 v[90:91], v219 offset:25600
    s_mov_b32 s25, 5963776
    v_mfma_f32_16x16x32_bf16 a[4:7], v[80:83], v[20:23], a[4:7]
    ds_read_b128 v[0:3], v216 offset:43008
    v_mfma_f32_16x16x32_bf16 a[20:23], v[80:83], v[28:31], a[20:23]
    ds_read_b128 v[4:7], v217 offset:43008
    v_mfma_f32_16x16x32_bf16 a[20:23], v[64:67], v[24:27], a[20:23]
    s_waitcnt lgkmcnt(6)
    v_mfma_f32_16x16x32_bf16 a[8:11], v[68:71], v[16:19], a[8:11]
    ds_read_b128 v[8:11], v216 offset:45056
    v_mfma_f32_16x16x32_bf16 a[8:11], v[84:87], v[20:23], a[8:11]
    ds_read_b128 v[12:15], v217 offset:45056
    v_mfma_f32_16x16x32_bf16 a[24:27], v[84:87], v[28:31], a[24:27]
    buffer_load_dwordx4 v212, s[8:11], s25 offen offset:0  lds
    v_mfma_f32_16x16x32_bf16 a[24:27], v[68:71], v[24:27], a[24:27]
    s_mov_b32 s16, s52
    s_waitcnt lgkmcnt(4)
    v_mfma_f32_16x16x32_bf16 a[12:15], v[72:75], v[16:19], a[12:15]
    buffer_load_dwordx4 v213, s[8:11], s25 offen offset:1024  lds
    v_mfma_f32_16x16x32_bf16 a[12:15], v[88:91], v[20:23], a[12:15]
    s_mov_b32 s17, s53
    s_mov_b32 s18, 7340032
    v_mfma_f32_16x16x32_bf16 a[28:31], v[88:91], v[28:31], a[28:31]
    s_lshl_b32 s61, s2, 2
    s_add_u32 s61, s61, s20
    v_mfma_f32_16x16x32_bf16 a[28:31], v[72:75], v[24:27], a[28:31]
    s_lshr_b32 s28, s22, 2
    v_mfma_f32_16x16x32_bf16 a[32:35], v[60:63], v[32:35], a[32:35]
    ds_read_b128 v[16:19], v216 offset:47104
    s_mul_i32 s28, s28, 9
    v_mfma_f32_16x16x32_bf16 a[32:35], v[76:79], v[36:39], a[32:35]
    ds_read_b128 v[20:23], v217 offset:47104
    s_add_u32 s28, s28, s21
    v_mfma_f32_16x16x32_bf16 a[36:39], v[80:83], v[36:39], a[36:39]
    ds_read_b128 v[24:27], v216 offset:49152
    s_and_b32 s42, s22, 3
    v_mfma_f32_16x16x32_bf16 a[36:39], v[64:67], v[32:35], a[36:39]
    ds_read_b128 v[28:31], v217 offset:49152
    s_lshr_b32 s41, s3, 1
    v_mfma_f32_16x16x32_bf16 a[40:43], v[68:71], v[32:35], a[40:43]
    buffer_load_dwordx4 v214, s[8:11], s25 offen offset:2048  lds
    v_mfma_f32_16x16x32_bf16 a[40:43], v[84:87], v[36:39], a[40:43]
    s_cmp_eq_u32 s64, 1
    s_cselect_b32 s28, 63, s28
    s_cselect_b32 s42, s41, s42
    v_mfma_f32_16x16x32_bf16 a[44:47], v[88:91], v[36:39], a[44:47]
    s_lshl_b32 s28, s28, 2
    s_add_u32 s28, s28, s20
    v_mfma_f32_16x16x32_bf16 a[44:47], v[72:75], v[32:35], a[44:47]
    ds_read_b128 v[32:35], v216 offset:51200
    s_lshl_b32 s42, s42, 2
    v_mfma_f32_16x16x32_bf16 a[60:63], v[72:75], v[40:43], a[60:63]
    ds_read_b128 v[36:39], v217 offset:51200
    s_lshr_b32 s42, 0x2130, s42
    v_mfma_f32_16x16x32_bf16 a[60:63], v[88:91], v[44:47], a[60:63]
    buffer_load_dwordx4 v215, s[8:11], s25 offen offset:3072  lds
    v_mfma_f32_16x16x32_bf16 a[56:59], v[84:87], v[44:47], a[56:59]
    s_and_b32 s42, s42, 3
    s_lshr_b32 s41, s28, 7
    v_mfma_f32_16x16x32_bf16 a[56:59], v[68:71], v[40:43], a[56:59]
    s_mul_i32 s41, s41, 384
    s_add_u32 s28, s28, s41
    v_smfmac_f32_16x16x64_bf16 a[240:243], a[248:251], v[60:67], v220
    s_lshl_b32 s42, s42, 7
    s_add_u32 s28, s28, s42
    v_mfma_f32_16x16x32_bf16 a[52:55], v[64:67], v[40:43], a[52:55]
    s_mul_i32 s28, s28, 7168
    s_mov_b32 s45, s28
    v_mfma_f32_16x16x32_bf16 a[52:55], v[80:83], v[44:47], a[52:55]
    s_add_u32 m0, s43, 81920
    s_mov_b32 s25, 6193152
    v_mfma_f32_16x16x32_bf16 a[48:51], v[76:79], v[44:47], a[48:51]
    buffer_load_dwordx4 v212, s[8:11], s25 offen offset:0  lds
    v_mfma_f32_16x16x32_bf16 a[48:51], v[60:63], v[40:43], a[48:51]
    v_min_u32 v254, 7, v221
    s_waitcnt lgkmcnt(8)
    v_mfma_f32_16x16x32_bf16 a[64:67], v[60:63], v[48:51], a[64:67]
    ds_read_b128 v[40:43], v216 offset:53248
    v_lshlrev_b32 v254, 7, v254
    v_mfma_f32_16x16x32_bf16 a[64:67], v[76:79], v[52:55], a[64:67]
    ds_read_b128 v[44:47], v217 offset:53248
    s_and_b32 s42, s22, 3
    v_mfma_f32_16x16x32_bf16 a[68:71], v[80:83], v[52:55], a[68:71]
    s_cmp_eq_u32 s42, 1
    s_cselect_b32 s18, 0, s18
    v_mfma_f32_16x16x32_bf16 a[68:71], v[64:67], v[48:51], a[68:71]
    buffer_load_dwordx4 v213, s[8:11], s25 offen offset:1024  lds
    v_mfma_f32_16x16x32_bf16 a[72:75], v[68:71], v[48:51], a[72:75]
    v_mfma_f32_16x16x32_bf16 a[72:75], v[84:87], v[52:55], a[72:75]
    v_mfma_f32_16x16x32_bf16 a[76:79], v[88:91], v[52:55], a[76:79]
    v_mfma_f32_16x16x32_bf16 a[76:79], v[72:75], v[48:51], a[76:79]
    ds_read_b128 v[48:51], v216 offset:55296
    v_mfma_f32_16x16x32_bf16 a[92:95], v[72:75], v[0:3], a[92:95]
    ds_read_b128 v[52:55], v217 offset:55296
    v_mfma_f32_16x16x32_bf16 a[92:95], v[88:91], v[4:7], a[92:95]
    v_mfma_f32_16x16x32_bf16 a[88:91], v[84:87], v[4:7], a[88:91]
    buffer_load_dwordx4 v214, s[8:11], s25 offen offset:2048  lds
    v_mfma_f32_16x16x32_bf16 a[88:91], v[68:71], v[0:3], a[88:91]
    v_smfmac_f32_16x16x64_bf16 a[244:247], a[248:251], v[68:75], v220
    v_mfma_f32_16x16x32_bf16 a[84:87], v[64:67], v[0:3], a[84:87]
    buffer_load_dword v255, v254, s[16:19], s28 offen
    v_mfma_f32_16x16x32_bf16 a[84:87], v[80:83], v[4:7], a[84:87]
    s_add_u32 s28, s28, 1024
    v_mfma_f32_16x16x32_bf16 a[80:83], v[76:79], v[4:7], a[80:83]
    v_mfma_f32_16x16x32_bf16 a[80:83], v[60:63], v[0:3], a[80:83]
    s_waitcnt lgkmcnt(8)
    v_mfma_f32_16x16x32_bf16 a[96:99], v[60:63], v[8:11], a[96:99]
    ds_read_b128 v[0:3], v216 offset:61440
    v_mfma_f32_16x16x32_bf16 a[96:99], v[76:79], v[12:15], a[96:99]
    ds_read_b128 v[4:7], v217 offset:61440
    v_mfma_f32_16x16x32_bf16 a[100:103], v[80:83], v[12:15], a[100:103]
    buffer_load_dwordx4 v215, s[8:11], s25 offen offset:3072  lds
    v_mfma_f32_16x16x32_bf16 a[100:103], v[64:67], v[8:11], a[100:103]
    v_mfma_f32_16x16x32_bf16 a[104:107], v[68:71], v[8:11], a[104:107]
    v_mfma_f32_16x16x32_bf16 a[104:107], v[84:87], v[12:15], a[104:107]
    v_mfma_f32_16x16x32_bf16 a[108:111], v[88:91], v[12:15], a[108:111]
    v_mfma_f32_16x16x32_bf16 a[108:111], v[72:75], v[8:11], a[108:111]
    ds_read_b128 v[8:11], v216 offset:57344
    v_mfma_f32_16x16x32_bf16 a[124:127], v[72:75], v[16:19], a[124:127]
    ds_read_b128 v[12:15], v217 offset:57344
    v_mfma_f32_16x16x32_bf16 a[124:127], v[88:91], v[20:23], a[124:127]
    v_mfma_f32_16x16x32_bf16 a[120:123], v[84:87], v[20:23], a[120:123]
    v_mfma_f32_16x16x32_bf16 a[120:123], v[68:71], v[16:19], a[120:123]
    v_smfmac_f32_16x16x64_bf16 a[240:243], a[248:251], v[76:83], v220
    v_mfma_f32_16x16x32_bf16 a[116:119], v[64:67], v[16:19], a[116:119]
    v_mfma_f32_16x16x32_bf16 a[116:119], v[80:83], v[20:23], a[116:119]
    v_mfma_f32_16x16x32_bf16 a[112:115], v[76:79], v[20:23], a[112:115]
    v_mfma_f32_16x16x32_bf16 a[112:115], v[60:63], v[16:19], a[112:115]
    s_waitcnt lgkmcnt(8)
    v_mfma_f32_16x16x32_bf16 a[128:131], v[60:63], v[24:27], a[128:131]
    ds_read_b128 v[16:19], v216 offset:59392
    v_mfma_f32_16x16x32_bf16 a[128:131], v[76:79], v[28:31], a[128:131]
    ds_read_b128 v[20:23], v217 offset:59392
    v_mfma_f32_16x16x32_bf16 a[132:135], v[80:83], v[28:31], a[132:135]
    v_mfma_f32_16x16x32_bf16 a[132:135], v[64:67], v[24:27], a[132:135]
    v_mfma_f32_16x16x32_bf16 a[136:139], v[68:71], v[24:27], a[136:139]
    v_mfma_f32_16x16x32_bf16 a[136:139], v[84:87], v[28:31], a[136:139]
    s_waitcnt vmcnt(21)
    s_waitcnt vmcnt(9) lgkmcnt(0)
    s_barrier
    v_mfma_f32_16x16x32_bf16 a[140:143], v[88:91], v[28:31], a[140:143]
    s_add_u32 m0, s26, 32768
    s_mov_b32 s23, 1664
    v_mfma_f32_16x16x32_bf16 a[140:143], v[72:75], v[24:27], a[140:143]
    ds_read_b128 v[24:27], v216 offset:0
    v_mfma_f32_16x16x32_bf16 a[156:159], v[72:75], v[32:35], a[156:159]
    ds_read_b128 v[28:31], v217 offset:0
    v_mfma_f32_16x16x32_bf16 a[156:159], v[88:91], v[36:39], a[156:159]
    buffer_load_dwordx4 v208, s[4:7], s23 offen offset:0 lds
    v_mfma_f32_16x16x32_bf16 a[152:155], v[84:87], v[36:39], a[152:155]
    v_mfma_f32_16x16x32_bf16 a[152:155], v[68:71], v[32:35], a[152:155]
    v_mfma_f32_16x16x32_bf16 a[148:151], v[64:67], v[32:35], a[148:151]
    buffer_load_dwordx4 v209, s[4:7], s23 offen offset:1024 lds
    v_mfma_f32_16x16x32_bf16 a[148:151], v[80:83], v[36:39], a[148:151]
    v_mfma_f32_16x16x32_bf16 a[144:147], v[76:79], v[36:39], a[144:147]
    v_mfma_f32_16x16x32_bf16 a[144:147], v[60:63], v[32:35], a[144:147]
    v_mfma_f32_16x16x32_bf16 a[160:163], v[60:63], v[40:43], a[160:163]
    ds_read_b128 v[32:35], v216 offset:2048
    v_mfma_f32_16x16x32_bf16 a[160:163], v[76:79], v[44:47], a[160:163]
    ds_read_b128 v[36:39], v217 offset:2048
    v_mfma_f32_16x16x32_bf16 a[164:167], v[80:83], v[44:47], a[164:167]
    v_mfma_f32_16x16x32_bf16 a[164:167], v[64:67], v[40:43], a[164:167]
    buffer_load_dwordx4 v210, s[4:7], s23 offen offset:2048 lds
    v_smfmac_f32_16x16x64_bf16 a[244:247], a[248:251], v[84:91], v220
    v_mfma_f32_16x16x32_bf16 a[168:171], v[68:71], v[40:43], a[168:171]
    v_mfma_f32_16x16x32_bf16 a[168:171], v[84:87], v[44:47], a[168:171]
    v_mfma_f32_16x16x32_bf16 a[172:175], v[88:91], v[44:47], a[172:175]
    v_mfma_f32_16x16x32_bf16 a[172:175], v[72:75], v[40:43], a[172:175]
    ds_read_b128 v[40:43], v216 offset:4096
    v_mfma_f32_16x16x32_bf16 a[188:191], v[72:75], v[48:51], a[188:191]
    ds_read_b128 v[44:47], v217 offset:4096
    v_mfma_f32_16x16x32_bf16 a[188:191], v[88:91], v[52:55], a[188:191]
    buffer_load_dwordx4 v211, s[4:7], s23 offen offset:3072 lds
    v_mfma_f32_16x16x32_bf16 a[184:187], v[84:87], v[52:55], a[184:187]
    v_mfma_f32_16x16x32_bf16 a[184:187], v[68:71], v[48:51], a[184:187]
    v_mfma_f32_16x16x32_bf16 a[180:183], v[64:67], v[48:51], a[180:183]
    v_mfma_f32_16x16x32_bf16 a[180:183], v[80:83], v[52:55], a[180:183]
    v_mfma_f32_16x16x32_bf16 a[176:179], v[76:79], v[52:55], a[176:179]
    s_cmp_lt_u32 s21, 7
    v_mfma_f32_16x16x32_bf16 a[176:179], v[60:63], v[48:51], a[176:179]
    s_cbranch_scc1 L_k_sk10
    v_mfma_f32_16x16x32_bf16 a[224:227], v[60:63], v[0:3], a[224:227]
    v_mfma_f32_16x16x32_bf16 a[224:227], v[76:79], v[4:7], a[224:227]
    v_mfma_f32_16x16x32_bf16 a[228:231], v[80:83], v[4:7], a[228:231]
    v_mfma_f32_16x16x32_bf16 a[228:231], v[64:67], v[0:3], a[228:231]
    v_mfma_f32_16x16x32_bf16 a[232:235], v[68:71], v[0:3], a[232:235]
    v_mfma_f32_16x16x32_bf16 a[232:235], v[84:87], v[4:7], a[232:235]
    v_mfma_f32_16x16x32_bf16 a[236:239], v[88:91], v[4:7], a[236:239]
    v_mfma_f32_16x16x32_bf16 a[236:239], v[72:75], v[0:3], a[236:239]
L_k_sk10:
    ds_read_b128 v[48:51], v216 offset:6144
    s_add_u32 m0, s26, 36864
    v_mfma_f32_16x16x32_bf16 a[192:195], v[60:63], v[8:11], a[192:195]
    ds_read_b128 v[52:55], v217 offset:6144
    s_mov_b32 s23, 67200
    v_mfma_f32_16x16x32_bf16 a[192:195], v[76:79], v[12:15], a[192:195]
    ds_read_b128 v[0:3], v216 offset:8192
    buffer_load_dwordx4 v208, s[4:7], s23 offen offset:0 lds
    v_mfma_f32_16x16x32_bf16 a[208:211], v[76:79], v[20:23], a[208:211]
    ds_read_b128 v[4:7], v217 offset:8192
    buffer_load_dwordx4 v209, s[4:7], s23 offen offset:1024 lds
    v_mfma_f32_16x16x32_bf16 a[208:211], v[60:63], v[16:19], a[208:211]
    ds_read_b64_tr_b16 v[60:61], v218 offset:32768
    buffer_load_dword v255, v254, s[16:19], s28 offen
    v_mfma_f32_16x16x32_bf16 a[196:199], v[64:67], v[8:11], a[196:199]
    ds_read_b64_tr_b16 v[62:63], v218 offset:33792
    s_add_u32 s28, s28, 1024
    v_mfma_f32_16x16x32_bf16 a[196:199], v[80:83], v[12:15], a[196:199]
    ds_read_b64_tr_b16 v[76:77], v218 offset:49152
    buffer_load_dwordx4 v210, s[4:7], s23 offen offset:2048 lds
    v_mfma_f32_16x16x32_bf16 a[212:215], v[80:83], v[20:23], a[212:215]
    ds_read_b64_tr_b16 v[78:79], v218 offset:50176
    s_mov_b32 s41, 0
L_k_nc:
    v_readfirstlane_b32 s44, v252
    s_add_u32 s41, s41, 1
    s_nop 3
    s_cmp_lg_u32 s44, 0
    s_cbranch_scc1 L_k_nc_ok
    s_cmp_gt_u32 s41, 400000
    s_cbranch_scc1 L_k_nc_ok
    s_sleep 2
    buffer_load_dword v252, v223, s[12:15], 0 offen offset:128 sc1
    s_waitcnt vmcnt(0)
    s_branch L_k_nc
L_k_nc_ok:
    v_mfma_f32_16x16x32_bf16 a[212:215], v[64:67], v[16:19], a[212:215]
    ds_read_b64_tr_b16 v[64:65], v219 offset:32768
    buffer_store_dword v252, v224, s[48:51], 0 offen sc1
    v_mfma_f32_16x16x32_bf16 a[200:203], v[68:71], v[8:11], a[200:203]
    ds_read_b64_tr_b16 v[66:67], v219 offset:33792
    v_mfma_f32_16x16x32_bf16 a[200:203], v[84:87], v[12:15], a[200:203]
    ds_read_b64_tr_b16 v[80:81], v219 offset:49152
    v_mfma_f32_16x16x32_bf16 a[216:219], v[84:87], v[20:23], a[216:219]
    ds_read_b64_tr_b16 v[82:83], v219 offset:50176
    v_mfma_f32_16x16x32_bf16 a[216:219], v[68:71], v[16:19], a[216:219]
    ds_read_b64_tr_b16 v[68:69], v218 offset:40960
    v_mfma_f32_16x16x32_bf16 a[204:207], v[72:75], v[8:11], a[204:207]
    ds_read_b64_tr_b16 v[70:71], v218 offset:41984
    buffer_load_dwordx4 v211, s[4:7], s23 offen offset:3072 lds
    v_mfma_f32_16x16x32_bf16 a[204:207], v[88:91], v[12:15], a[204:207]
    ds_read_b64_tr_b16 v[84:85], v218 offset:57344
    v_mfma_f32_16x16x32_bf16 a[220:223], v[88:91], v[20:23], a[220:223]
    ds_read_b64_tr_b16 v[86:87], v218 offset:58368
    v_mfma_f32_16x16x32_bf16 a[220:223], v[72:75], v[16:19], a[220:223]
    s_waitcnt lgkmcnt(8)
    v_mfma_f32_16x16x32_bf16 a[0:3], v[60:63], v[24:27], a[0:3]
    ds_read_b64_tr_b16 v[72:73], v219 offset:40960
    s_lshr_b32 s39, s38, 2
    v_mfma_f32_16x16x32_bf16 a[0:3], v[76:79], v[28:31], a[0:3]
    ds_read_b64_tr_b16 v[74:75], v219 offset:41984
    s_lshl_b32 s39, s39, 2
    v_mfma_f32_16x16x32_bf16 a[16:19], v[76:79], v[36:39], a[16:19]
    ds_read_b64_tr_b16 v[88:89], v219 offset:57344
    s_lshr_b32 s39, 1466183968, s39
    v_mfma_f32_16x16x32_bf16 a[16:19], v[60:63], v[32:35], a[16:19]
    s_add_u32 m0, s43, 0
    s_waitcnt lgkmcnt(7)
    v_mfma_f32_16x16x32_bf16 a[4:7], v[64:67], v[24:27], a[4:7]
    ds_read_b64_tr_b16 v[90:91], v219 offset:58368
    s_mov_b32 s25, 1376256
    v_mfma_f32_16x16x32_bf16 a[4:7], v[80:83], v[28:31], a[4:7]
    ds_read_b128 v[8:11], v216 offset:10240
    s_and_b32 s39, s39, 7
    v_mfma_f32_16x16x32_bf16 a[20:23], v[80:83], v[36:39], a[20:23]
    ds_read_b128 v[12:15], v217 offset:10240
    s_lshl_b32 s39, s39, 2
    v_mfma_f32_16x16x32_bf16 a[20:23], v[64:67], v[32:35], a[20:23]
    s_and_b32 s92, s38, 3
    s_waitcnt lgkmcnt(6)
    v_mfma_f32_16x16x32_bf16 a[8:11], v[68:71], v[24:27], a[8:11]
    ds_read_b128 v[16:19], v216 offset:12288
    s_add_u32 s92, s92, s39
    v_mfma_f32_16x16x32_bf16 a[8:11], v[84:87], v[28:31], a[8:11]
    ds_read_b128 v[20:23], v217 offset:12288
    s_lshr_b32 s93, s3, 2
    v_mfma_f32_16x16x32_bf16 a[24:27], v[84:87], v[36:39], a[24:27]
    buffer_load_dwordx4 v212, s[8:11], s25 offen offset:0  lds
    v_mfma_f32_16x16x32_bf16 a[24:27], v[68:71], v[32:35], a[24:27]
    s_lshl_b32 s93, s93, 3
    s_waitcnt lgkmcnt(4)
    v_mfma_f32_16x16x32_bf16 a[12:15], v[72:75], v[24:27], a[12:15]
    buffer_load_dwordx4 v213, s[8:11], s25 offen offset:1024  lds
    v_mfma_f32_16x16x32_bf16 a[12:15], v[88:91], v[28:31], a[12:15]
    s_and_b32 s39, s92, 3
    s_add_u32 s93, s93, s39
    v_mfma_f32_16x16x32_bf16 a[28:31], v[88:91], v[36:39], a[28:31]
    s_lshr_b32 s39, s92, 4
    s_lshl_b32 s39, s39, 2
    v_mfma_f32_16x16x32_bf16 a[28:31], v[72:75], v[32:35], a[28:31]
    s_add_u32 s93, s93, s39
    v_mfma_f32_16x16x32_bf16 a[32:35], v[60:63], v[40:43], a[32:35]
    ds_read_b128 v[24:27], v216 offset:14336
    s_and_b32 s94, s3, 2
    v_mfma_f32_16x16x32_bf16 a[32:35], v[76:79], v[44:47], a[32:35]
    ds_read_b128 v[28:31], v217 offset:14336
    s_lshl_b32 s94, s94, 1
    v_mfma_f32_16x16x32_bf16 a[36:39], v[80:83], v[44:47], a[36:39]
    ds_read_b128 v[32:35], v216 offset:16384
    s_bfe_u32 s39, s92, 0x20002
    v_mfma_f32_16x16x32_bf16 a[36:39], v[64:67], v[40:43], a[36:39]
    ds_read_b128 v[36:39], v217 offset:16384
    s_add_u32 s94, s94, s39
    v_mfma_f32_16x16x32_bf16 a[40:43], v[68:71], v[40:43], a[40:43]
    buffer_load_dwordx4 v214, s[8:11], s25 offen offset:2048  lds
    v_mfma_f32_16x16x32_bf16 a[40:43], v[84:87], v[44:47], a[40:43]
    s_and_b32 s95, s3, 1
    s_lshl_b32 s41, s20, 14
    v_mfma_f32_16x16x32_bf16 a[44:47], v[88:91], v[44:47], a[44:47]
    s_lshl_b32 s42, s94, 8
    s_add_u32 s41, s41, s42
    v_mfma_f32_16x16x32_bf16 a[44:47], v[72:75], v[40:43], a[44:47]
    ds_read_b128 v[40:43], v216 offset:18432
    s_mul_i32 s39, s95, 3670016
    v_mfma_f32_16x16x32_bf16 a[60:63], v[72:75], v[48:51], a[60:63]
    ds_read_b128 v[44:47], v217 offset:18432
    v_accvgpr_read_b32 v92, a0
    v_mfma_f32_16x16x32_bf16 a[60:63], v[88:91], v[52:55], a[60:63]
    buffer_load_dwordx4 v215, s[8:11], s25 offen offset:3072  lds
    v_mfma_f32_16x16x32_bf16 a[56:59], v[84:87], v[52:55], a[56:59]
    v_accvgpr_read_b32 v93, a1
    v_accvgpr_read_b32 v94, a2
    v_mfma_f32_16x16x32_bf16 a[56:59], v[68:71], v[48:51], a[56:59]
    v_accvgpr_read_b32 v95, a3
    v_accvgpr_read_b32 v96, a4
    v_smfmac_f32_16x16x64_bf16 a[240:243], a[248:251], v[60:67], v220
    v_accvgpr_read_b32 v97, a5
    v_accvgpr_read_b32 v98, a6
    v_mfma_f32_16x16x32_bf16 a[52:55], v[64:67], v[48:51], a[52:55]
    v_accvgpr_read_b32 v99, a7
    v_accvgpr_read_b32 v100, a8
    v_mfma_f32_16x16x32_bf16 a[52:55], v[80:83], v[52:55], a[52:55]
    s_add_u32 m0, s43, 16384
    s_mov_b32 s25, 1605632
    v_mfma_f32_16x16x32_bf16 a[48:51], v[76:79], v[52:55], a[48:51]
    buffer_load_dwordx4 v212, s[8:11], s25 offen offset:0  lds
    v_mfma_f32_16x16x32_bf16 a[48:51], v[60:63], v[48:51], a[48:51]
    v_accvgpr_read_b32 v101, a9
    s_waitcnt lgkmcnt(8)
    v_mfma_f32_16x16x32_bf16 a[64:67], v[60:63], v[0:3], a[64:67]
    ds_read_b128 v[48:51], v216 offset:20480
    v_accvgpr_read_b32 v102, a10
    v_mfma_f32_16x16x32_bf16 a[64:67], v[76:79], v[4:7], a[64:67]
    ds_read_b128 v[52:55], v217 offset:20480
    v_accvgpr_read_b32 v103, a11
    v_mfma_f32_16x16x32_bf16 a[68:71], v[80:83], v[4:7], a[68:71]
    v_accvgpr_read_b32 v104, a12
    v_accvgpr_read_b32 v105, a13
    v_mfma_f32_16x16x32_bf16 a[68:71], v[64:67], v[0:3], a[68:71]
    buffer_load_dwordx4 v213, s[8:11], s25 offen offset:1024  lds
    v_mfma_f32_16x16x32_bf16 a[72:75], v[68:71], v[0:3], a[72:75]
    v_accvgpr_read_b32 v106, a14
    v_accvgpr_read_b32 v107, a15
    v_mfma_f32_16x16x32_bf16 a[72:75], v[84:87], v[4:7], a[72:75]
    v_accvgpr_read_b32 v108, a16
    v_accvgpr_read_b32 v109, a17
    v_mfma_f32_16x16x32_bf16 a[76:79], v[88:91], v[4:7], a[76:79]
    v_accvgpr_read_b32 v110, a18
    v_accvgpr_read_b32 v111, a19
    v_mfma_f32_16x16x32_bf16 a[76:79], v[72:75], v[0:3], a[76:79]
    ds_read_b128 v[0:3], v216 offset:22528
    v_accvgpr_read_b32 v112, a20
    v_mfma_f32_16x16x32_bf16 a[92:95], v[72:75], v[8:11], a[92:95]
    ds_read_b128 v[4:7], v217 offset:22528
    v_accvgpr_read_b32 v113, a21
    v_mfma_f32_16x16x32_bf16 a[92:95], v[88:91], v[12:15], a[92:95]
    v_accvgpr_read_b32 v114, a22
    v_accvgpr_read_b32 v115, a23
    v_mfma_f32_16x16x32_bf16 a[88:91], v[84:87], v[12:15], a[88:91]
    buffer_load_dwordx4 v214, s[8:11], s25 offen offset:2048  lds
    v_mfma_f32_16x16x32_bf16 a[88:91], v[68:71], v[8:11], a[88:91]
L_k_w4:
    s_cbranch_execz L_k_w8
    v_accvgpr_read_b32 v116, a24
    v_accvgpr_read_b32 v117, a25
    v_smfmac_f32_16x16x64_bf16 a[244:247], a[248:251], v[68:75], v220
    v_accvgpr_read_b32 v118, a26
    v_accvgpr_read_b32 v119, a27
    v_mfma_f32_16x16x32_bf16 a[84:87], v[64:67], v[8:11], a[84:87]
    buffer_load_dword v255, v254, s[16:19], s28 offen
    v_mfma_f32_16x16x32_bf16 a[84:87], v[80:83], v[12:15], a[84:87]
    s_add_u32 s28, s28, 1024
    v_accvgpr_read_b32 v120, a28
    v_mfma_f32_16x16x32_bf16 a[80:83], v[76:79], v[12:15], a[80:83]
    v_accvgpr_read_b32 v121, a29
    v_accvgpr_read_b32 v122, a30
    v_mfma_f32_16x16x32_bf16 a[80:83], v[60:63], v[8:11], a[80:83]
    v_accvgpr_read_b32 v123, a31
    s_waitcnt lgkmcnt(8)
    v_mfma_f32_16x16x32_bf16 a[96:99], v[60:63], v[16:19], a[96:99]
    ds_read_b128 v[8:11], v216 offset:28672
    v_accvgpr_read_b32 v124, a32
    v_mfma_f32_16x16x32_bf16 a[96:99], v[76:79], v[20:23], a[96:99]
    ds_read_b128 v[12:15], v217 offset:28672
    v_accvgpr_read_b32 v125, a33
    v_mfma_f32_16x16x32_bf16 a[100:103], v[80:83], v[20:23], a[100:103]
    buffer_load_dwordx4 v215, s[8:11], s25 offen offset:3072  lds
    v_mfma_f32_16x16x32_bf16 a[100:103], v[64:67], v[16:19], a[100:103]
    v_accvgpr_read_b32 v126, a34
    v_accvgpr_read_b32 v127, a35
    v_mfma_f32_16x16x32_bf16 a[104:107], v[68:71], v[16:19], a[104:107]
    v_accvgpr_read_b32 v128, a36
    v_accvgpr_read_b32 v129, a37
    v_mfma_f32_16x16x32_bf16 a[104:107], v[84:87], v[20:23], a[104:107]
    v_accvgpr_read_b32 v130, a38
    v_accvgpr_read_b32 v131, a39
    v_mfma_f32_16x16x32_bf16 a[108:111], v[88:91], v[20:23], a[108:111]
    v_accvgpr_read_b32 v132, a40
    v_accvgpr_read_b32 v133, a41
    v_mfma_f32_16x16x32_bf16 a[108:111], v[72:75], v[16:19], a[108:111]
    ds_read_b128 v[16:19], v216 offset:24576
    v_accvgpr_read_b32 v134, a42
    v_mfma_f32_16x16x32_bf16 a[124:127], v[72:75], v[24:27], a[124:127]
    ds_read_b128 v[20:23], v217 offset:24576
    v_accvgpr_read_b32 v135, a43
    v_mfma_f32_16x16x32_bf16 a[124:127], v[88:91], v[28:31], a[124:127]
    v_accvgpr_read_b32 v136, a44
    v_accvgpr_read_b32 v137, a45
    v_mfma_f32_16x16x32_bf16 a[120:123], v[84:87], v[28:31], a[120:123]
    v_accvgpr_read_b32 v138, a46
    v_accvgpr_read_b32 v139, a47
    v_mfma_f32_16x16x32_bf16 a[120:123], v[68:71], v[24:27], a[120:123]
    s_add_u32 s39, s39, s41
    v_smfmac_f32_16x16x64_bf16 a[240:243], a[248:251], v[76:83], v220
    s_add_u32 s88, s52, s39
    s_addc_u32 s89, s53, 0
    v_mfma_f32_16x16x32_bf16 a[116:119], v[64:67], v[24:27], a[116:119]
    s_sub_u32 s90, 3670016, s41
    s_mov_b32 s91, 0x20000
    v_mfma_f32_16x16x32_bf16 a[116:119], v[80:83], v[28:31], a[116:119]
    s_lshl_b32 s96, s94, 7
    s_lshl_b32 s39, s95, 6
    v_mfma_f32_16x16x32_bf16 a[112:115], v[76:79], v[28:31], a[112:115]
    s_add_u32 s96, s96, s39
    s_lshl_b32 s97, s93, 2
    v_mfma_f32_16x16x32_bf16 a[112:115], v[60:63], v[24:27], a[112:115]
    s_add_u32 s97, s97, s20
    s_waitcnt lgkmcnt(8)
    v_mfma_f32_16x16x32_bf16 a[128:131], v[60:63], v[32:35], a[128:131]
    ds_read_b128 v[24:27], v216 offset:26624
    s_mul_i32 s41, s97, 112
    v_mfma_f32_16x16x32_bf16 a[128:131], v[76:79], v[36:39], a[128:131]
    ds_read_b128 v[28:31], v217 offset:26624
    s_mul_i32 s42, s95, 56
    v_mfma_f32_16x16x32_bf16 a[132:135], v[80:83], v[36:39], a[132:135]
    s_add_u32 s41, s41, s42
    s_mul_i32 s41, s41, 3072
    v_mfma_f32_16x16x32_bf16 a[132:135], v[64:67], v[32:35], a[132:135]
    s_add_u32 s41, s41, 16777216
    v_mfma_f32_16x16x32_bf16 a[136:139], v[68:71], v[32:35], a[136:139]
    s_add_u32 s84, s36, s41
    s_addc_u32 s85, s37, 0
    v_mfma_f32_16x16x32_bf16 a[136:139], v[84:87], v[36:39], a[136:139]
    s_waitcnt vmcnt(9) lgkmcnt(0)
    s_barrier
    v_mfma_f32_16x16x32_bf16 a[140:143], v[88:91], v[36:39], a[140:143]
    s_add_u32 m0, s26, 0
    s_mov_b32 s23, 384
    v_mfma_f32_16x16x32_bf16 a[140:143], v[72:75], v[32:35], a[140:143]
    ds_read_b128 v[32:35], v216 offset:32768
    s_mov_b32 s86, 172032
    v_mfma_f32_16x16x32_bf16 a[156:159], v[72:75], v[40:43], a[156:159]
    ds_read_b128 v[36:39], v217 offset:32768
    s_mov_b32 s87, 0x20000
    v_mfma_f32_16x16x32_bf16 a[156:159], v[88:91], v[44:47], a[156:159]
    buffer_load_dwordx4 v208, s[4:7], s23 offen offset:0 lds
    v_mfma_f32_16x16x32_bf16 a[152:155], v[84:87], v[44:47], a[152:155]
    s_lshl_b32 s97, s97, 5
    s_lshl_b32 s98, s20, 12
    v_mfma_f32_16x16x32_bf16 a[152:155], v[68:71], v[40:43], a[152:155]
    s_lshl_b32 s99, s21, 8
    s_lshl_b32 s39, s22, 2
    v_mfma_f32_16x16x32_bf16 a[148:151], v[64:67], v[40:43], a[148:151]
    buffer_load_dwordx4 v209, s[4:7], s23 offen offset:1024 lds
    v_mfma_f32_16x16x32_bf16 a[148:151], v[80:83], v[44:47], a[148:151]
    s_add_u32 s99, s99, s39
    s_lshl_b32 s39, s64, 30
    v_mfma_f32_16x16x32_bf16 a[144:147], v[76:79], v[44:47], a[144:147]
    s_add_u32 s99, s99, s39
    s_lshl_b32 s24, s93, 3
    v_mfma_f32_16x16x32_bf16 a[144:147], v[60:63], v[40:43], a[144:147]
    s_mul_i32 s100, s24, 4682
    v_mfma_f32_16x16x32_bf16 a[160:163], v[60:63], v[48:51], a[160:163]
    ds_read_b128 v[40:43], v216 offset:34816
    s_lshr_b32 s100, s100, 16
    v_mfma_f32_16x16x32_bf16 a[160:163], v[76:79], v[52:55], a[160:163]
    ds_read_b128 v[44:47], v217 offset:34816
    s_min_u32 s100, s100, 7
    v_mfma_f32_16x16x32_bf16 a[164:167], v[80:83], v[52:55], a[164:167]
    s_cmp_ge_u32 s24, 113
    s_cselect_b32 s100, 8, s100
    v_mfma_f32_16x16x32_bf16 a[164:167], v[64:67], v[48:51], a[164:167]
    buffer_load_dwordx4 v210, s[4:7], s23 offen offset:2048 lds
    v_smfmac_f32_16x16x64_bf16 a[244:247], a[248:251], v[84:91], v220
    s_add_u32 s24, s24, 7
    s_mul_i32 s101, s24, 4682
    v_mfma_f32_16x16x32_bf16 a[168:171], v[68:71], v[48:51], a[168:171]
    s_lshr_b32 s101, s101, 16
    s_min_u32 s101, s101, 7
    v_mfma_f32_16x16x32_bf16 a[168:171], v[84:87], v[52:55], a[168:171]
    s_cmp_ge_u32 s24, 113
    s_cselect_b32 s101, 8, s101
    v_mfma_f32_16x16x32_bf16 a[172:175], v[88:91], v[52:55], a[172:175]
    s_sub_u32 s101, s101, s100
    s_lshl_b32 s101, s101, 8
    v_mfma_f32_16x16x32_bf16 a[172:175], v[72:75], v[48:51], a[172:175]
    ds_read_b128 v[48:51], v216 offset:36864
    s_lshl_b32 s100, s100, 8
    v_mfma_f32_16x16x32_bf16 a[188:191], v[72:75], v[0:3], a[188:191]
    ds_read_b128 v[52:55], v217 offset:36864
    s_mul_i32 s24, s95, 48
    v_mfma_f32_16x16x32_bf16 a[188:191], v[88:91], v[4:7], a[188:191]
    buffer_load_dwordx4 v211, s[4:7], s23 offen offset:3072 lds
    v_mfma_f32_16x16x32_bf16 a[184:187], v[84:87], v[4:7], a[184:187]
    s_add_u32 s100, s100, s24
    s_lshl_b32 s92, s92, 3
    v_mfma_f32_16x16x32_bf16 a[184:187], v[68:71], v[0:3], a[184:187]
    s_add_u32 s92, s92, s3
    s_lshl_b32 s92, s92, 15
    v_mfma_f32_16x16x32_bf16 a[180:183], v[64:67], v[0:3], a[180:183]
    s_lshl_b32 s39, s20, 13
    s_add_u32 s92, s92, s39
    v_mfma_f32_16x16x32_bf16 a[180:183], v[80:83], v[4:7], a[180:183]
    v_mfma_f32_16x16x32_bf16 a[176:179], v[76:79], v[4:7], a[176:179]
    s_cmp_lt_u32 s21, 7
    v_mfma_f32_16x16x32_bf16 a[176:179], v[60:63], v[0:3], a[176:179]
    s_cbranch_scc1 L_k_sk11
    v_mfma_f32_16x16x32_bf16 a[224:227], v[60:63], v[8:11], a[224:227]
    v_mfma_f32_16x16x32_bf16 a[224:227], v[76:79], v[12:15], a[224:227]
    v_mfma_f32_16x16x32_bf16 a[228:231], v[80:83], v[12:15], a[228:231]
    v_mfma_f32_16x16x32_bf16 a[228:231], v[64:67], v[8:11], a[228:231]
    v_mfma_f32_16x16x32_bf16 a[232:235], v[68:71], v[8:11], a[232:235]
    v_mfma_f32_16x16x32_bf16 a[232:235], v[84:87], v[12:15], a[232:235]
    v_mfma_f32_16x16x32_bf16 a[236:239], v[88:91], v[12:15], a[236:239]
    v_mfma_f32_16x16x32_bf16 a[236:239], v[72:75], v[8:11], a[236:239]
L_k_sk11:
    ds_read_b128 v[0:3], v216 offset:38912
    s_add_u32 m0, s26, 4096
    v_mfma_f32_16x16x32_bf16 a[192:195], v[60:63], v[16:19], a[192:195]
    ds_read_b128 v[4:7], v217 offset:38912
    s_mov_b32 s23, 65920
    v_mfma_f32_16x16x32_bf16 a[192:195], v[76:79], v[20:23], a[192:195]
    ds_read_b128 v[8:11], v216 offset:40960
    buffer_load_dwordx4 v208, s[4:7], s23 offen offset:0 lds
    v_mfma_f32_16x16x32_bf16 a[208:211], v[76:79], v[28:31], a[208:211]
    ds_read_b128 v[12:15], v217 offset:40960
    buffer_load_dwordx4 v209, s[4:7], s23 offen offset:1024 lds
    v_mfma_f32_16x16x32_bf16 a[208:211], v[60:63], v[24:27], a[208:211]
    ds_read_b64_tr_b16 v[60:61], v236 offset:0
    buffer_load_dword v255, v254, s[16:19], s28 offen
    v_mfma_f32_16x16x32_bf16 a[196:199], v[64:67], v[16:19], a[196:199]
    ds_read_b64_tr_b16 v[62:63], v236 offset:1024
    s_add_u32 s28, s28, 1024
    v_mfma_f32_16x16x32_bf16 a[196:199], v[80:83], v[20:23], a[196:199]
    ds_read_b64_tr_b16 v[76:77], v236 offset:16384
    buffer_load_dwordx4 v210, s[4:7], s23 offen offset:2048 lds
    v_mfma_f32_16x16x32_bf16 a[212:215], v[80:83], v[28:31], a[212:215]
    ds_read_b64_tr_b16 v[78:79], v236 offset:17408
    v_mfma_f32_16x16x32_bf16 a[212:215], v[64:67], v[24:27], a[212:215]
    ds_read_b64_tr_b16 v[64:65], v237 offset:0
    v_mfma_f32_16x16x32_bf16 a[200:203], v[68:71], v[16:19], a[200:203]
    ds_read_b64_tr_b16 v[66:67], v237 offset:1024
    v_mfma_f32_16x16x32_bf16 a[200:203], v[84:87], v[20:23], a[200:203]
    ds_read_b64_tr_b16 v[80:81], v237 offset:16384
    v_mfma_f32_16x16x32_bf16 a[216:219], v[84:87], v[28:31], a[216:219]
    ds_read_b64_tr_b16 v[82:83], v237 offset:17408
    v_mfma_f32_16x16x32_bf16 a[216:219], v[68:71], v[24:27], a[216:219]
    ds_read_b64_tr_b16 v[68:69], v236 offset:8192
    v_mfma_f32_16x16x32_bf16 a[204:207], v[72:75], v[16:19], a[204:207]
    ds_read_b64_tr_b16 v[70:71], v236 offset:9216
    buffer_load_dwordx4 v211, s[4:7], s23 offen offset:3072 lds
    v_mfma_f32_16x16x32_bf16 a[204:207], v[88:91], v[20:23], a[204:207]
    ds_read_b64_tr_b16 v[84:85], v236 offset:24576
    v_mfma_f32_16x16x32_bf16 a[220:223], v[88:91], v[28:31], a[220:223]
    ds_read_b64_tr_b16 v[86:87], v236 offset:25600
    v_mfma_f32_16x16x32_bf16 a[220:223], v[72:75], v[24:27], a[220:223]
    s_waitcnt lgkmcnt(8)
    v_mfma_f32_16x16x32_bf16 v[92:95], v[60:63], v[32:35], v[92:95]
    ds_read_b64_tr_b16 v[72:73], v237 offset:8192
    v_mfma_f32_16x16x32_bf16 v[92:95], v[76:79], v[36:39], v[92:95]
    ds_read_b64_tr_b16 v[74:75], v237 offset:9216
    v_mfma_f32_16x16x32_bf16 v[108:111], v[76:79], v[44:47], v[108:111]
    ds_read_b64_tr_b16 v[88:89], v237 offset:24576
    v_mfma_f32_16x16x32_bf16 v[108:111], v[60:63], v[40:43], v[108:111]
    s_add_u32 m0, s43, 32768
    s_waitcnt lgkmcnt(7)
    v_mfma_f32_16x16x32_bf16 v[96:99], v[64:67], v[32:35], v[96:99]
    ds_read_b64_tr_b16 v[90:91], v237 offset:25600
    s_mov_b32 s25, 6422528
    v_mfma_f32_16x16x32_bf16 v[96:99], v[80:83], v[36:39], v[96:99]
    ds_read_b128 v[16:19], v216 offset:43008
    v_mfma_f32_16x16x32_bf16 v[112:115], v[80:83], v[44:47], v[112:115]
    ds_read_b128 v[20:23], v217 offset:43008
    v_mfma_f32_16x16x32_bf16 v[112:115], v[64:67], v[40:43], v[112:115]
    s_waitcnt lgkmcnt(6)
    v_mfma_f32_16x16x32_bf16 v[100:103], v[68:71], v[32:35], v[100:103]
    ds_read_b128 v[24:27], v216 offset:45056
    v_mfma_f32_16x16x32_bf16 v[100:103], v[84:87], v[36:39], v[100:103]
    ds_read_b128 v[28:31], v217 offset:45056
    v_mfma_f32_16x16x32_bf16 v[116:119], v[84:87], v[44:47], v[116:119]
    buffer_load_dwordx4 v212, s[8:11], s25 offen offset:0  lds
    v_mfma_f32_16x16x32_bf16 v[116:119], v[68:71], v[40:43], v[116:119]
    s_waitcnt lgkmcnt(4)
    v_mfma_f32_16x16x32_bf16 v[104:107], v[72:75], v[32:35], v[104:107]
    buffer_load_dwordx4 v213, s[8:11], s25 offen offset:1024  lds
    v_mfma_f32_16x16x32_bf16 v[104:107], v[88:91], v[36:39], v[104:107]
    v_mfma_f32_16x16x32_bf16 v[120:123], v[88:91], v[44:47], v[120:123]
    v_mfma_f32_16x16x32_bf16 v[120:123], v[72:75], v[40:43], v[120:123]
    v_mfma_f32_16x16x32_bf16 v[124:127], v[60:63], v[48:51], v[124:127]
    ds_read_b128 v[32:35], v216 offset:47104
    v_mfma_f32_16x16x32_bf16 v[124:127], v[76:79], v[52:55], v[124:127]
    ds_read_b128 v[36:39], v217 offset:47104
    v_mfma_f32_16x16x32_bf16 v[128:131], v[80:83], v[52:55], v[128:131]
    ds_read_b128 v[40:43], v216 offset:49152
    v_mfma_f32_16x16x32_bf16 v[128:131], v[64:67], v[48:51], v[128:131]
    ds_read_b128 v[44:47], v217 offset:49152
    v_mfma_f32_16x16x32_bf16 v[132:135], v[68:71], v[48:51], v[132:135]
    buffer_load_dwordx4 v214, s[8:11], s25 offen offset:2048  lds
    v_mfma_f32_16x16x32_bf16 v[132:135], v[84:87], v[52:55], v[132:135]
    v_mfma_f32_16x16x32_bf16 v[136:139], v[88:91], v[52:55], v[136:139]
    v_mfma_f32_16x16x32_bf16 v[136:139], v[72:75], v[48:51], v[136:139]
    ds_read_b128 v[48:51], v216 offset:51200
    v_mfma_f32_16x16x32_bf16 a[60:63], v[72:75], v[0:3], a[60:63]
    ds_read_b128 v[52:55], v217 offset:51200
    v_mfma_f32_16x16x32_bf16 a[60:63], v[88:91], v[4:7], a[60:63]
    buffer_load_dwordx4 v215, s[8:11], s25 offen offset:3072  lds
    v_mfma_f32_16x16x32_bf16 a[56:59], v[84:87], v[4:7], a[56:59]
    v_mfma_f32_16x16x32_bf16 a[56:59], v[68:71], v[0:3], a[56:59]
    v_smfmac_f32_16x16x64_bf16 a[240:243], a[248:251], v[60:67], v220
    v_mfma_f32_16x16x32_bf16 a[52:55], v[64:67], v[0:3], a[52:55]
    v_mfma_f32_16x16x32_bf16 a[52:55], v[80:83], v[4:7], a[52:55]
    s_add_u32 m0, s43, 49152
    s_mov_b32 s25, 6651904
    v_mfma_f32_16x16x32_bf16 a[48:51], v[76:79], v[4:7], a[48:51]
    buffer_load_dwordx4 v212, s[8:11], s25 offen offset:0  lds
    v_mfma_f32_16x16x32_bf16 a[48:51], v[60:63], v[0:3], a[48:51]
    s_waitcnt lgkmcnt(8)
    v_mfma_f32_16x16x32_bf16 a[64:67], v[60:63], v[8:11], a[64:67]
    ds_read_b128 v[0:3], v216 offset:53248
    v_mfma_f32_16x16x32_bf16 a[64:67], v[76:79], v[12:15], a[64:67]
    ds_read_b128 v[4:7], v217 offset:53248
    v_mfma_f32_16x16x32_bf16 a[68:71], v[80:83], v[12:15], a[68:71]
    v_mfma_f32_16x16x32_bf16 a[68:71], v[64:67], v[8:11], a[68:71]
    buffer_load_dwordx4 v213, s[8:11], s25 offen offset:1024  lds
    v_mfma_f32_16x16x32_bf16 a[72:75], v[68:71], v[8:11], a[72:75]
    v_mfma_f32_16x16x32_bf16 a[72:75], v[84:87], v[12:15], a[72:75]
    v_mfma_f32_16x16x32_bf16 a[76:79], v[88:91], v[12:15], a[76:79]
    v_mfma_f32_16x16x32_bf16 a[76:79], v[72:75], v[8:11], a[76:79]
    ds_read_b128 v[8:11], v216 offset:55296
    v_mfma_f32_16x16x32_bf16 a[92:95], v[72:75], v[16:19], a[92:95]
    ds_read_b128 v[12:15], v217 offset:55296
    v_accvgpr_read_b32 v140, a48
    v_mfma_f32_16x16x32_bf16 a[92:95], v[88:91], v[20:23], a[92:95]
    v_accvgpr_read_b32 v141, a49
    v_accvgpr_read_b32 v142, a50
    v_mfma_f32_16x16x32_bf16 a[88:91], v[84:87], v[20:23], a[88:91]
    buffer_load_dwordx4 v214, s[8:11], s25 offen offset:2048  lds
    v_mfma_f32_16x16x32_bf16 a[88:91], v[68:71], v[16:19], a[88:91]
    v_accvgpr_read_b32 v143, a51
    v_accvgpr_read_b32 v144, a52
    v_smfmac_f32_16x16x64_bf16 a[244:247], a[248:251], v[68:75], v220
    v_accvgpr_read_b32 v145, a53
    v_accvgpr_read_b32 v146, a54
    v_mfma_f32_16x16x32_bf16 a[84:87], v[64:67], v[16:19], a[84:87]
    buffer_load_dword v255, v254, s[16:19], s28 offen
    v_mfma_f32_16x16x32_bf16 a[84:87], v[80:83], v[20:23], a[84:87]
    s_add_u32 s28, s28, 1024
    v_accvgpr_read_b32 v147, a55
    v_mfma_f32_16x16x32_bf16 a[80:83], v[76:79], v[20:23], a[80:83]
    v_accvgpr_read_b32 v148, a56
    v_accvgpr_read_b32 v149, a57
    v_mfma_f32_16x16x32_bf16 a[80:83], v[60:63], v[16:19], a[80:83]
    v_accvgpr_read_b32 v150, a58
    s_waitcnt lgkmcnt(8)
    v_mfma_f32_16x16x32_bf16 a[96:99], v[60:63], v[24:27], a[96:99]
    ds_read_b128 v[16:19], v216 offset:61440
    v_accvgpr_read_b32 v151, a59
    v_mfma_f32_16x16x32_bf16 a[96:99], v[76:79], v[28:31], a[96:99]
    ds_read_b128 v[20:23], v217 offset:61440
    v_accvgpr_read_b32 v152, a60
    v_mfma_f32_16x16x32_bf16 a[100:103], v[80:83], v[28:31], a[100:103]
    buffer_load_dwordx4 v215, s[8:11], s25 offen offset:3072  lds
    v_mfma_f32_16x16x32_bf16 a[100:103], v[64:67], v[24:27], a[100:103]
    v_accvgpr_read_b32 v153, a61
    v_accvgpr_read_b32 v154, a62
    v_mfma_f32_16x16x32_bf16 a[104:107], v[68:71], v[24:27], a[104:107]
    v_accvgpr_read_b32 v155, a63
    v_accvgpr_read_b32 v156, a64
    v_mfma_f32_16x16x32_bf16 a[104:107], v[84:87], v[28:31], a[104:107]
    v_accvgpr_read_b32 v157, a65
    v_accvgpr_read_b32 v158, a66
    v_mfma_f32_16x16x32_bf16 a[108:111], v[88:91], v[28:31], a[108:111]
    v_accvgpr_read_b32 v159, a67
    v_accvgpr_read_b32 v160, a68
    v_mfma_f32_16x16x32_bf16 a[108:111], v[72:75], v[24:27], a[108:111]
    ds_read_b128 v[24:27], v216 offset:57344
    v_accvgpr_read_b32 v161, a69
    v_mfma_f32_16x16x32_bf16 a[124:127], v[72:75], v[32:35], a[124:127]
    ds_read_b128 v[28:31], v217 offset:57344
    v_accvgpr_read_b32 v162, a70
    v_mfma_f32_16x16x32_bf16 a[124:127], v[88:91], v[36:39], a[124:127]
    v_accvgpr_read_b32 v163, a71
    v_accvgpr_read_b32 v164, a72
    v_mfma_f32_16x16x32_bf16 a[120:123], v[84:87], v[36:39], a[120:123]
    v_accvgpr_read_b32 v165, a73
    v_accvgpr_read_b32 v166, a74
    v_mfma_f32_16x16x32_bf16 a[120:123], v[68:71], v[32:35], a[120:123]
    v_accvgpr_read_b32 v167, a75
    v_accvgpr_read_b32 v168, a76
    v_smfmac_f32_16x16x64_bf16 a[240:243], a[248:251], v[76:83], v220
    v_accvgpr_read_b32 v169, a77
    v_accvgpr_read_b32 v170, a78
    v_mfma_f32_16x16x32_bf16 a[116:119], v[64:67], v[32:35], a[116:119]
    v_accvgpr_read_b32 v171, a79
    v_accvgpr_read_b32 v172, a80
    v_mfma_f32_16x16x32_bf16 a[116:119], v[80:83], v[36:39], a[116:119]
    v_accvgpr_read_b32 v173, a81
    v_accvgpr_read_b32 v174, a82
    v_mfma_f32_16x16x32_bf16 a[112:115], v[76:79], v[36:39], a[112:115]
    v_accvgpr_read_b32 v175, a83
    v_accvgpr_read_b32 v176, a84
    v_mfma_f32_16x16x32_bf16 a[112:115], v[60:63], v[32:35], a[112:115]
    v_accvgpr_read_b32 v177, a85
    s_waitcnt lgkmcnt(8)
    v_mfma_f32_16x16x32_bf16 a[128:131], v[60:63], v[40:43], a[128:131]
    ds_read_b128 v[32:35], v216 offset:59392
    v_accvgpr_read_b32 v178, a86
    v_mfma_f32_16x16x32_bf16 a[128:131], v[76:79], v[44:47], a[128:131]
    ds_read_b128 v[36:39], v217 offset:59392
    v_accvgpr_read_b32 v179, a87
    v_mfma_f32_16x16x32_bf16 a[132:135], v[80:83], v[44:47], a[132:135]
    v_accvgpr_read_b32 v180, a88
    v_accvgpr_read_b32 v181, a89
    v_mfma_f32_16x16x32_bf16 a[132:135], v[64:67], v[40:43], a[132:135]
    v_accvgpr_read_b32 v182, a90
    v_accvgpr_read_b32 v183, a91
    v_mfma_f32_16x16x32_bf16 a[136:139], v[68:71], v[40:43], a[136:139]
    v_accvgpr_read_b32 v184, a92
    v_accvgpr_read_b32 v185, a93
    v_mfma_f32_16x16x32_bf16 a[136:139], v[84:87], v[44:47], a[136:139]
    s_waitcnt vmcnt(9) lgkmcnt(0)
    s_barrier
    v_mfma_f32_16x16x32_bf16 a[140:143], v[88:91], v[44:47], a[140:143]
    s_add_u32 m0, s26, 32768
    s_mov_b32 s23, 1792
    v_mfma_f32_16x16x32_bf16 a[140:143], v[72:75], v[40:43], a[140:143]
    ds_read_b128 v[40:43], v216 offset:0
    v_accvgpr_read_b32 v186, a94
    v_mfma_f32_16x16x32_bf16 a[156:159], v[72:75], v[48:51], a[156:159]
    ds_read_b128 v[44:47], v217 offset:0
    v_accvgpr_read_b32 v187, a95
    v_mfma_f32_16x16x32_bf16 a[156:159], v[88:91], v[52:55], a[156:159]
    buffer_load_dwordx4 v208, s[4:7], s23 offen offset:0 lds
    v_mfma_f32_16x16x32_bf16 a[152:155], v[84:87], v[52:55], a[152:155]
    v_mfma_f32_16x16x32_bf16 a[152:155], v[68:71], v[48:51], a[152:155]
    v_mfma_f32_16x16x32_bf16 a[148:151], v[64:67], v[48:51], a[148:151]
    buffer_load_dwordx4 v209, s[4:7], s23 offen offset:1024 lds
    v_mfma_f32_16x16x32_bf16 a[148:151], v[80:83], v[52:55], a[148:151]
    v_mfma_f32_16x16x32_bf16 a[144:147], v[76:79], v[52:55], a[144:147]
    v_mfma_f32_16x16x32_bf16 a[144:147], v[60:63], v[48:51], a[144:147]
    v_mfma_f32_16x16x32_bf16 a[160:163], v[60:63], v[0:3], a[160:163]
    ds_read_b128 v[48:51], v216 offset:2048
    v_mfma_f32_16x16x32_bf16 a[160:163], v[76:79], v[4:7], a[160:163]
    ds_read_b128 v[52:55], v217 offset:2048
    v_mfma_f32_16x16x32_bf16 a[164:167], v[80:83], v[4:7], a[164:167]
    v_mfma_f32_16x16x32_bf16 a[164:167], v[64:67], v[0:3], a[164:167]
    buffer_load_dwordx4 v210, s[4:7], s23 offen offset:2048 lds
    v_smfmac_f32_16x16x64_bf16 a[244:247], a[248:251], v[84:91], v220
    v_mfma_f32_16x16x32_bf16 a[168:171], v[68:71], v[0:3], a[168:171]
    v_mfma_f32_16x16x32_bf16 a[168:171], v[84:87], v[4:7], a[168:171]
    v_mfma_f32_16x16x32_bf16 a[172:175], v[88:91], v[4:7], a[172:175]
    v_mfma_f32_16x16x32_bf16 a[172:175], v[72:75], v[0:3], a[172:175]
    ds_read_b128 v[0:3], v216 offset:4096
    v_mfma_f32_16x16x32_bf16 a[188:191], v[72:75], v[8:11], a[188:191]
    ds_read_b128 v[4:7], v217 offset:4096
    v_mfma_f32_16x16x32_bf16 a[188:191], v[88:91], v[12:15], a[188:191]
    buffer_load_dwordx4 v211, s[4:7], s23 offen offset:3072 lds
    v_mfma_f32_16x16x32_bf16 a[184:187], v[84:87], v[12:15], a[184:187]
    v_mfma_f32_16x16x32_bf16 a[184:187], v[68:71], v[8:11], a[184:187]
    v_mfma_f32_16x16x32_bf16 a[180:183], v[64:67], v[8:11], a[180:183]
    v_mfma_f32_16x16x32_bf16 a[180:183], v[80:83], v[12:15], a[180:183]
    v_mfma_f32_16x16x32_bf16 a[176:179], v[76:79], v[12:15], a[176:179]
    s_cmp_lt_u32 s21, 7
    v_mfma_f32_16x16x32_bf16 a[176:179], v[60:63], v[8:11], a[176:179]
    s_cbranch_scc1 L_k_sk12
    v_mfma_f32_16x16x32_bf16 a[224:227], v[60:63], v[16:19], a[224:227]
    v_mfma_f32_16x16x32_bf16 a[224:227], v[76:79], v[20:23], a[224:227]
    v_mfma_f32_16x16x32_bf16 a[228:231], v[80:83], v[20:23], a[228:231]
    v_mfma_f32_16x16x32_bf16 a[228:231], v[64:67], v[16:19], a[228:231]
    v_mfma_f32_16x16x32_bf16 a[232:235], v[68:71], v[16:19], a[232:235]
    v_mfma_f32_16x16x32_bf16 a[232:235], v[84:87], v[20:23], a[232:235]
    v_mfma_f32_16x16x32_bf16 a[236:239], v[88:91], v[20:23], a[236:239]
    v_mfma_f32_16x16x32_bf16 a[236:239], v[72:75], v[16:19], a[236:239]
L_k_sk12:
    ds_read_b128 v[8:11], v216 offset:6144
    s_add_u32 m0, s26, 36864
    v_mfma_f32_16x16x32_bf16 a[192:195], v[60:63], v[24:27], a[192:195]
    ds_read_b128 v[12:15], v217 offset:6144
    s_mov_b32 s23, 67328
    v_mfma_f32_16x16x32_bf16 a[192:195], v[76:79], v[28:31], a[192:195]
    ds_read_b128 v[16:19], v216 offset:8192
    buffer_load_dwordx4 v208, s[4:7], s23 offen offset:0 lds
    v_mfma_f32_16x16x32_bf16 a[208:211], v[76:79], v[36:39], a[208:211]
    ds_read_b128 v[20:23], v217 offset:8192
    buffer_load_dwordx4 v209, s[4:7], s23 offen offset:1024 lds
    v_mfma_f32_16x16x32_bf16 a[208:211], v[60:63], v[32:35], a[208:211]
    ds_read_b64_tr_b16 v[60:61], v218 offset:0
    buffer_load_dword v255, v254, s[16:19], s28 offen
    v_mfma_f32_16x16x32_bf16 a[196:199], v[64:67], v[24:27], a[196:199]
    ds_read_b64_tr_b16 v[62:63], v218 offset:1024
    s_add_u32 s28, s28, 1024
    v_mfma_f32_16x16x32_bf16 a[196:199], v[80:83], v[28:31], a[196:199]
    ds_read_b64_tr_b16 v[76:77], v218 offset:16384
    buffer_load_dwordx4 v210, s[4:7], s23 offen offset:2048 lds
    v_mfma_f32_16x16x32_bf16 a[212:215], v[80:83], v[36:39], a[212:215]
    ds_read_b64_tr_b16 v[78:79], v218 offset:17408
    v_mfma_f32_16x16x32_bf16 a[212:215], v[64:67], v[32:35], a[212:215]
    ds_read_b64_tr_b16 v[64:65], v219 offset:0
    v_mfma_f32_16x16x32_bf16 a[200:203], v[68:71], v[24:27], a[200:203]
    ds_read_b64_tr_b16 v[66:67], v219 offset:1024
    v_mfma_f32_16x16x32_bf16 a[200:203], v[84:87], v[28:31], a[200:203]
    ds_read_b64_tr_b16 v[80:81], v219 offset:16384
    v_mfma_f32_16x16x32_bf16 a[216:219], v[84:87], v[36:39], a[216:219]
    ds_read_b64_tr_b16 v[82:83], v219 offset:17408
    v_mfma_f32_16x16x32_bf16 a[216:219], v[68:71], v[32:35], a[216:219]
    ds_read_b64_tr_b16 v[68:69], v218 offset:8192
    v_mfma_f32_16x16x32_bf16 a[204:207], v[72:75], v[24:27], a[204:207]
    ds_read_b64_tr_b16 v[70:71], v218 offset:9216
    buffer_load_dwordx4 v211, s[4:7], s23 offen offset:3072 lds
    v_mfma_f32_16x16x32_bf16 a[204:207], v[88:91], v[28:31], a[204:207]
    ds_read_b64_tr_b16 v[84:85], v218 offset:24576
    v_mfma_f32_16x16x32_bf16 a[220:223], v[88:91], v[36:39], a[220:223]
    ds_read_b64_tr_b16 v[86:87], v218 offset:25600
    v_mfma_f32_16x16x32_bf16 a[220:223], v[72:75], v[32:35], a[220:223]
    s_waitcnt lgkmcnt(8)
    v_mfma_f32_16x16x32_bf16 v[92:95], v[60:63], v[40:43], v[92:95]
    ds_read_b64_tr_b16 v[72:73], v219 offset:8192
    v_mfma_f32_16x16x32_bf16 v[92:95], v[76:79], v[44:47], v[92:95]
    ds_read_b64_tr_b16 v[74:75], v219 offset:9216
    v_mfma_f32_16x16x32_bf16 v[108:111], v[76:79], v[52:55], v[108:111]
    ds_read_b64_tr_b16 v[88:89], v219 offset:24576
    v_mfma_f32_16x16x32_bf16 v[108:111], v[60:63], v[48:51], v[108:111]
    s_add_u32 m0, s43, 65536
    s_waitcnt lgkmcnt(7)
    v_mfma_f32_16x16x32_bf16 v[96:99], v[64:67], v[40:43], v[96:99]
    ds_read_b64_tr_b16 v[90:91], v219 offset:25600
    s_mov_b32 s25, 5046272
    v_mfma_f32_16x16x32_bf16 v[96:99], v[80:83], v[44:47], v[96:99]
    ds_read_b128 v[24:27], v216 offset:10240
    v_mfma_f32_16x16x32_bf16 v[112:115], v[80:83], v[52:55], v[112:115]
    ds_read_b128 v[28:31], v217 offset:10240
    v_mfma_f32_16x16x32_bf16 v[112:115], v[64:67], v[48:51], v[112:115]
    s_waitcnt lgkmcnt(6)
    v_mfma_f32_16x16x32_bf16 v[100:103], v[68:71], v[40:43], v[100:103]
    ds_read_b128 v[32:35], v216 offset:12288
    v_mfma_f32_16x16x32_bf16 v[100:103], v[84:87], v[44:47], v[100:103]
    ds_read_b128 v[36:39], v217 offset:12288
    v_mfma_f32_16x16x32_bf16 v[116:119], v[84:87], v[52:55], v[116:119]
    buffer_load_dwordx4 v212, s[8:11], s25 offen offset:0  lds
    v_mfma_f32_16x16x32_bf16 v[116:119], v[68:71], v[48:51], v[116:119]
    s_waitcnt lgkmcnt(4)
    v_mfma_f32_16x16x32_bf16 v[104:107], v[72:75], v[40:43], v[104:107]
    buffer_load_dwordx4 v213, s[8:11], s25 offen offset:1024  lds
    v_mfma_f32_16x16x32_bf16 v[104:107], v[88:91], v[44:47], v[104:107]
    v_mfma_f32_16x16x32_bf16 v[120:123], v[88:91], v[52:55], v[120:123]
    v_mfma_f32_16x16x32_bf16 v[120:123], v[72:75], v[48:51], v[120:123]
    v_mfma_f32_16x16x32_bf16 v[124:127], v[60:63], v[0:3], v[124:127]
    ds_read_b128 v[40:43], v216 offset:14336
    v_mfma_f32_16x16x32_bf16 v[124:127], v[76:79], v[4:7], v[124:127]
    ds_read_b128 v[44:47], v217 offset:14336
    v_mfma_f32_16x16x32_bf16 v[128:131], v[80:83], v[4:7], v[128:131]
    ds_read_b128 v[48:51], v216 offset:16384
    v_mfma_f32_16x16x32_bf16 v[128:131], v[64:67], v[0:3], v[128:131]
    ds_read_b128 v[52:55], v217 offset:16384
    v_mfma_f32_16x16x32_bf16 v[132:135], v[68:71], v[0:3], v[132:135]
    buffer_load_dwordx4 v214, s[8:11], s25 offen offset:2048  lds
    v_mfma_f32_16x16x32_bf16 v[132:135], v[84:87], v[4:7], v[132:135]
    buffer_load_dword v223, v225, s[48:51], 0 offen sc1
    v_mfma_f32_16x16x32_bf16 v[136:139], v[88:91], v[4:7], v[136:139]
    v_mfma_f32_16x16x32_bf16 v[136:139], v[72:75], v[0:3], v[136:139]
    ds_read_b128 v[0:3], v216 offset:18432
    v_mfma_f32_16x16x32_bf16 v[152:155], v[72:75], v[8:11], v[152:155]
    ds_read_b128 v[4:7], v217 offset:18432
    v_mfma_f32_16x16x32_bf16 v[152:155], v[88:91], v[12:15], v[152:155]
    buffer_load_dwordx4 v215, s[8:11], s25 offen offset:3072  lds
    v_mfma_f32_16x16x32_bf16 v[148:151], v[84:87], v[12:15], v[148:151]
    v_mfma_f32_16x16x32_bf16 v[148:151], v[68:71], v[8:11], v[148:151]
    v_smfmac_f32_16x16x64_bf16 a[240:243], a[248:251], v[60:67], v220
    v_mfma_f32_16x16x32_bf16 v[144:147], v[64:67], v[8:11], v[144:147]
    v_mfma_f32_16x16x32_bf16 v[144:147], v[80:83], v[12:15], v[144:147]
    s_add_u32 m0, s43, 81920
    s_mov_b32 s25, 5275648
    v_mfma_f32_16x16x32_bf16 v[140:143], v[76:79], v[12:15], v[140:143]
    buffer_load_dwordx4 v212, s[8:11], s25 offen offset:0  lds
    v_mfma_f32_16x16x32_bf16 v[140:143], v[60:63], v[8:11], v[140:143]
    s_waitcnt lgkmcnt(8)
    v_mfma_f32_16x16x32_bf16 v[156:159], v[60:63], v[16:19], v[156:159]
    ds_read_b128 v[8:11], v216 offset:20480
    v_mfma_f32_16x16x32_bf16 v[156:159], v[76:79], v[20:23], v[156:159]
    ds_read_b128 v[12:15], v217 offset:20480
    v_mfma_f32_16x16x32_bf16 v[160:163], v[80:83], v[20:23], v[160:163]
    v_mfma_f32_16x16x32_bf16 v[160:163], v[64:67], v[16:19], v[160:163]
    buffer_load_dwordx4 v213, s[8:11], s25 offen offset:1024  lds
    v_mfma_f32_16x16x32_bf16 v[164:167], v[68:71], v[16:19], v[164:167]
    v_mfma_f32_16x16x32_bf16 v[164:167], v[84:87], v[20:23], v[164:167]
    v_mfma_f32_16x16x32_bf16 v[168:171], v[88:91], v[20:23], v[168:171]
    v_mfma_f32_16x16x32_bf16 v[168:171], v[72:75], v[16:19], v[168:171]
    ds_read_b128 v[16:19], v216 offset:22528
    v_mfma_f32_16x16x32_bf16 v[184:187], v[72:75], v[24:27], v[184:187]
    ds_read_b128 v[20:23], v217 offset:22528
    v_mfma_f32_16x16x32_bf16 v[184:187], v[88:91], v[28:31], v[184:187]
    v_mfma_f32_16x16x32_bf16 v[180:183], v[84:87], v[28:31], v[180:183]
    buffer_load_dwordx4 v214, s[8:11], s25 offen offset:2048  lds
    v_mfma_f32_16x16x32_bf16 v[180:183], v[68:71], v[24:27], v[180:183]
    v_smfmac_f32_16x16x64_bf16 a[244:247], a[248:251], v[68:75], v220
    v_mfma_f32_16x16x32_bf16 v[176:179], v[64:67], v[24:27], v[176:179]
    buffer_load_dword v255, v254, s[16:19], s28 offen
L_k_w5:
    s_cbranch_execz L_k_w9
    v_mfma_f32_16x16x32_bf16 v[176:179], v[80:83], v[28:31], v[176:179]
    s_add_u32 s28, s28, 1024
    v_mfma_f32_16x16x32_bf16 v[172:175], v[76:79], v[28:31], v[172:175]
    v_mfma_f32_16x16x32_bf16 v[172:175], v[60:63], v[24:27], v[172:175]
    s_waitcnt lgkmcnt(8)
    v_mfma_f32_16x16x32_bf16 a[96:99], v[60:63], v[32:35], a[96:99]
    ds_read_b128 v[24:27], v216 offset:28672
    v_mfma_f32_16x16x32_bf16 a[96:99], v[76:79], v[36:39], a[96:99]
    ds_read_b128 v[28:31], v217 offset:28672
    v_mfma_f32_16x16x32_bf16 a[100:103], v[80:83], v[36:39], a[100:103]
    buffer_load_dwordx4 v215, s[8:11], s25 offen offset:3072  lds
    v_mfma_f32_16x16x32_bf16 a[100:103], v[64:67], v[32:35], a[100:103]
    v_mfma_f32_16x16x32_bf16 a[104:107], v[68:71], v[32:35], a[104:107]
    v_mfma_f32_16x16x32_bf16 a[104:107], v[84:87], v[36:39], a[104:107]
    v_mfma_f32_16x16x32_bf16 a[108:111], v[88:91], v[36:39], a[108:111]
    v_mfma_f32_16x16x32_bf16 a[108:111], v[72:75], v[32:35], a[108:111]
    ds_read_b128 v[32:35], v216 offset:24576
    v_mfma_f32_16x16x32_bf16 a[124:127], v[72:75], v[40:43], a[124:127]
    ds_read_b128 v[36:39], v217 offset:24576
    v_mfma_f32_16x16x32_bf16 a[124:127], v[88:91], v[44:47], a[124:127]
    v_mfma_f32_16x16x32_bf16 a[120:123], v[84:87], v[44:47], a[120:123]
    v_mfma_f32_16x16x32_bf16 a[120:123], v[68:71], v[40:43], a[120:123]
    v_smfmac_f32_16x16x64_bf16 a[240:243], a[248:251], v[76:83], v220
    v_mfma_f32_16x16x32_bf16 a[116:119], v[64:67], v[40:43], a[116:119]
    v_mfma_f32_16x16x32_bf16 a[116:119], v[80:83], v[44:47], a[116:119]
    v_mfma_f32_16x16x32_bf16 a[112:115], v[76:79], v[44:47], a[112:115]
    v_mfma_f32_16x16x32_bf16 a[112:115], v[60:63], v[40:43], a[112:115]
    v_accvgpr_read_b32 v188, a96
    s_waitcnt lgkmcnt(8)
    v_mfma_f32_16x16x32_bf16 a[128:131], v[60:63], v[48:51], a[128:131]
    ds_read_b128 v[40:43], v216 offset:26624
    v_accvgpr_read_b32 v189, a97
    v_mfma_f32_16x16x32_bf16 a[128:131], v[76:79], v[52:55], a[128:131]
    ds_read_b128 v[44:47], v217 offset:26624
    v_accvgpr_read_b32 v190, a98
    v_mfma_f32_16x16x32_bf16 a[132:135], v[80:83], v[52:55], a[132:135]
    v_accvgpr_read_b32 v191, a99
    v_accvgpr_read_b32 v192, a100
    v_mfma_f32_16x16x32_bf16 a[132:135], v[64:67], v[48:51], a[132:135]
    v_accvgpr_read_b32 v193, a101
    v_accvgpr_read_b32 v194, a102
    v_mfma_f32_16x16x32_bf16 a[136:139], v[68:71], v[48:51], a[136:139]
    v_accvgpr_read_b32 v195, a103
    v_accvgpr_read_b32 v196, a104
    v_mfma_f32_16x16x32_bf16 a[136:139], v[84:87], v[52:55], a[136:139]
    s_waitcnt vmcnt(10) lgkmcnt(0)
    s_barrier
    v_mfma_f32_16x16x32_bf16 a[140:143], v[88:91], v[52:55], a[140:143]
    s_add_u32 m0, s26, 0
    s_mov_b32 s23, 1408
    v_mfma_f32_16x16x32_bf16 a[140:143], v[72:75], v[48:51], a[140:143]
    ds_read_b128 a[48:51], v216 offset:32768
    v_accvgpr_read_b32 v197, a105
    v_mfma_f32_16x16x32_bf16 a[156:159], v[72:75], v[0:3], a[156:159]
    ds_read_b128 a[52:55], v217 offset:32768
    v_accvgpr_read_b32 v198, a106
    v_mfma_f32_16x16x32_bf16 a[156:159], v[88:91], v[4:7], a[156:159]
    buffer_load_dwordx4 v208, s[4:7], s23 offen offset:0 lds
    v_mfma_f32_16x16x32_bf16 a[152:155], v[84:87], v[4:7], a[152:155]
    v_accvgpr_read_b32 v199, a107
    v_accvgpr_read_b32 v200, a108
    v_mfma_f32_16x16x32_bf16 a[152:155], v[68:71], v[0:3], a[152:155]
    v_accvgpr_read_b32 v201, a109
    v_accvgpr_read_b32 v202, a110
    v_mfma_f32_16x16x32_bf16 a[148:151], v[64:67], v[0:3], a[148:151]
    buffer_load_dwordx4 v209, s[4:7], s23 offen offset:1024 lds
    v_mfma_f32_16x16x32_bf16 a[148:151], v[80:83], v[4:7], a[148:151]
    v_accvgpr_read_b32 v203, a111
    v_mfma_f32_16x16x32_bf16 a[144:147], v[76:79], v[4:7], a[144:147]
    v_mfma_f32_16x16x32_bf16 a[144:147], v[60:63], v[0:3], a[144:147]
    v_mfma_f32_16x16x32_bf16 a[160:163], v[60:63], v[8:11], a[160:163]
    ds_read_b128 a[0:3], v216 offset:34816
    v_mfma_f32_16x16x32_bf16 a[160:163], v[76:79], v[12:15], a[160:163]
    ds_read_b128 a[4:7], v217 offset:34816
    v_mfma_f32_16x16x32_bf16 a[164:167], v[80:83], v[12:15], a[164:167]
    v_mfma_f32_16x16x32_bf16 a[164:167], v[64:67], v[8:11], a[164:167]
    buffer_load_dwordx4 v210, s[4:7], s23 offen offset:2048 lds
    v_smfmac_f32_16x16x64_bf16 a[244:247], a[248:251], v[84:91], v220
    v_mfma_f32_16x16x32_bf16 a[168:171], v[68:71], v[8:11], a[168:171]
    v_mfma_f32_16x16x32_bf16 a[168:171], v[84:87], v[12:15], a[168:171]
    v_mfma_f32_16x16x32_bf16 a[172:175], v[88:91], v[12:15], a[172:175]
    v_mfma_f32_16x16x32_bf16 a[172:175], v[72:75], v[8:11], a[172:175]
    ds_read_b128 a[8:11], v216 offset:36864
    v_mfma_f32_16x16x32_bf16 a[188:191], v[72:75], v[16:19], a[188:191]
    ds_read_b128 a[12:15], v217 offset:36864
    s_mov_b32 s16, s56
    v_mfma_f32_16x16x32_bf16 a[188:191], v[88:91], v[20:23], a[188:191]
    buffer_load_dwordx4 v211, s[4:7], s23 offen offset:3072 lds
    v_mfma_f32_16x16x32_bf16 a[184:187], v[84:87], v[20:23], a[184:187]
    s_mov_b32 s17, s57
    s_mov_b32 s18, 4194304
    v_mfma_f32_16x16x32_bf16 a[184:187], v[68:71], v[16:19], a[184:187]
    s_lshl_b32 s28, s61, 12
    v_mfma_f32_16x16x32_bf16 a[180:183], v[64:67], v[16:19], a[180:183]
    v_mfma_f32_16x16x32_bf16 a[180:183], v[80:83], v[20:23], a[180:183]
    v_mfma_f32_16x16x32_bf16 a[176:179], v[76:79], v[20:23], a[176:179]
    s_cmp_lt_u32 s21, 7
    v_mfma_f32_16x16x32_bf16 a[176:179], v[60:63], v[16:19], a[176:179]
    s_cbranch_scc1 L_k_sk13
    v_mfma_f32_16x16x32_bf16 a[224:227], v[60:63], v[24:27], a[224:227]
    v_mfma_f32_16x16x32_bf16 a[224:227], v[76:79], v[28:31], a[224:227]
    v_mfma_f32_16x16x32_bf16 a[228:231], v[80:83], v[28:31], a[228:231]
    v_mfma_f32_16x16x32_bf16 a[228:231], v[64:67], v[24:27], a[228:231]
    v_mfma_f32_16x16x32_bf16 a[232:235], v[68:71], v[24:27], a[232:235]
    v_mfma_f32_16x16x32_bf16 a[232:235], v[84:87], v[28:31], a[232:235]
    v_mfma_f32_16x16x32_bf16 a[236:239], v[88:91], v[28:31], a[236:239]
    v_mfma_f32_16x16x32_bf16 a[236:239], v[72:75], v[24:27], a[236:239]
L_k_sk13:
    ds_read_b128 a[16:19], v216 offset:38912
    s_add_u32 m0, s26, 4096
    v_mfma_f32_16x16x32_bf16 a[192:195], v[60:63], v[32:35], a[192:195]
    ds_read_b128 a[20:23], v217 offset:38912
    s_mov_b32 s23, 66944
    v_mfma_f32_16x16x32_bf16 a[192:195], v[76:79], v[36:39], a[192:195]
    ds_read_b128 a[24:27], v216 offset:40960
    buffer_load_dwordx4 v208, s[4:7], s23 offen offset:0 lds
    v_mfma_f32_16x16x32_bf16 a[208:211], v[76:79], v[44:47], a[208:211]
    ds_read_b128 a[28:31], v217 offset:40960
    buffer_load_dwordx4 v209, s[4:7], s23 offen offset:1024 lds
    v_mfma_f32_16x16x32_bf16 a[208:211], v[60:63], v[40:43], a[208:211]
    ds_read_b64_tr_b16 a[64:65], v218 offset:32768
    buffer_load_dword v255, v254, s[16:19], s28 offen
    v_mfma_f32_16x16x32_bf16 a[196:199], v[64:67], v[32:35], a[196:199]
    ds_read_b64_tr_b16 a[66:67], v218 offset:33792
    s_add_u32 s28, s28, 1024
    v_mfma_f32_16x16x32_bf16 a[196:199], v[80:83], v[36:39], a[196:199]
    ds_read_b64_tr_b16 a[80:81], v218 offset:49152
    buffer_load_dwordx4 v210, s[4:7], s23 offen offset:2048 lds
    v_mfma_f32_16x16x32_bf16 a[212:215], v[80:83], v[44:47], a[212:215]
    ds_read_b64_tr_b16 a[82:83], v218 offset:50176
    v_mfma_f32_16x16x32_bf16 a[212:215], v[64:67], v[40:43], a[212:215]
    ds_read_b64_tr_b16 a[68:69], v219 offset:32768
    v_mfma_f32_16x16x32_bf16 a[200:203], v[68:71], v[32:35], a[200:203]
    ds_read_b64_tr_b16 a[70:71], v219 offset:33792
    v_mfma_f32_16x16x32_bf16 a[200:203], v[84:87], v[36:39], a[200:203]
    ds_read_b64_tr_b16 a[84:85], v219 offset:49152
    v_mfma_f32_16x16x32_bf16 a[216:219], v[84:87], v[44:47], a[216:219]
    ds_read_b64_tr_b16 a[86:87], v219 offset:50176
    v_mfma_f32_16x16x32_bf16 a[216:219], v[68:71], v[40:43], a[216:219]
    ds_read_b64_tr_b16 a[72:73], v218 offset:40960
    v_mfma_f32_16x16x32_bf16 a[204:207], v[72:75], v[32:35], a[204:207]
    ds_read_b64_tr_b16 a[74:75], v218 offset:41984
    buffer_load_dwordx4 v211, s[4:7], s23 offen offset:3072 lds
    v_mfma_f32_16x16x32_bf16 a[204:207], v[88:91], v[36:39], a[204:207]
    ds_read_b64_tr_b16 a[88:89], v218 offset:57344
    v_mfma_f32_16x16x32_bf16 a[220:223], v[88:91], v[44:47], a[220:223]
    ds_read_b64_tr_b16 a[90:91], v218 offset:58368
    v_mfma_f32_16x16x32_bf16 a[220:223], v[72:75], v[40:43], a[220:223]
    s_waitcnt lgkmcnt(8)
    v_mfma_f32_16x16x32_bf16 v[92:95], a[64:67], a[48:51], v[92:95]
    ds_read_b64_tr_b16 a[76:77], v219 offset:40960
    v_mfma_f32_16x16x32_bf16 v[92:95], a[80:83], a[52:55], v[92:95]
    ds_read_b64_tr_b16 a[78:79], v219 offset:41984
    v_mfma_f32_16x16x32_bf16 v[108:111], a[80:83], a[4:7], v[108:111]
    ds_read_b64_tr_b16 a[92:93], v219 offset:57344
    v_mfma_f32_16x16x32_bf16 v[108:111], a[64:67], a[0:3], v[108:111]
    s_add_u32 m0, s43, 0
    s_waitcnt lgkmcnt(7)
    v_mfma_f32_16x16x32_bf16 v[96:99], a[68:71], a[48:51], v[96:99]
    ds_read_b64_tr_b16 a[94:95], v219 offset:58368
    s_mov_b32 s25, 6881280
    v_mfma_f32_16x16x32_bf16 v[96:99], a[84:87], a[52:55], v[96:99]
    ds_read_b128 a[32:35], v216 offset:43008
    v_mfma_f32_16x16x32_bf16 v[112:115], a[84:87], a[4:7], v[112:115]
    ds_read_b128 a[36:39], v217 offset:43008
    v_mfma_f32_16x16x32_bf16 v[112:115], a[68:71], a[0:3], v[112:115]
    s_waitcnt lgkmcnt(6)
    v_mfma_f32_16x16x32_bf16 v[100:103], a[72:75], a[48:51], v[100:103]
    ds_read_b128 a[40:43], v216 offset:45056
    v_mfma_f32_16x16x32_bf16 v[100:103], a[88:91], a[52:55], v[100:103]
    ds_read_b128 a[44:47], v217 offset:45056
    v_mfma_f32_16x16x32_bf16 v[116:119], a[88:91], a[4:7], v[116:119]
    buffer_load_dwordx4 v212, s[8:11], s25 offen offset:0  lds
    v_mfma_f32_16x16x32_bf16 v[116:119], a[72:75], a[0:3], v[116:119]
    s_waitcnt lgkmcnt(4)
    v_mfma_f32_16x16x32_bf16 v[104:107], a[76:79], a[48:51], v[104:107]
    buffer_load_dwordx4 v213, s[8:11], s25 offen offset:1024  lds
    v_mfma_f32_16x16x32_bf16 v[104:107], a[92:95], a[52:55], v[104:107]
    v_mfma_f32_16x16x32_bf16 v[120:123], a[92:95], a[4:7], v[120:123]
    v_mfma_f32_16x16x32_bf16 v[120:123], a[76:79], a[0:3], v[120:123]
    v_mfma_f32_16x16x32_bf16 v[124:127], a[64:67], a[8:11], v[124:127]
    ds_read_b128 a[48:51], v216 offset:47104
    v_mfma_f32_16x16x32_bf16 v[124:127], a[80:83], a[12:15], v[124:127]
    ds_read_b128 a[52:55], v217 offset:47104
    v_mfma_f32_16x16x32_bf16 v[128:131], a[84:87], a[12:15], v[128:131]
    ds_read_b128 a[0:3], v216 offset:49152
    v_mfma_f32_16x16x32_bf16 v[128:131], a[68:71], a[8:11], v[128:131]
    ds_read_b128 a[4:7], v217 offset:49152
    v_mfma_f32_16x16x32_bf16 v[132:135], a[72:75], a[8:11], v[132:135]
    buffer_load_dwordx4 v214, s[8:11], s25 offen offset:2048  lds
    v_mfma_f32_16x16x32_bf16 v[132:135], a[88:91], a[12:15], v[132:135]
    v_mfma_f32_16x16x32_bf16 v[136:139], a[92:95], a[12:15], v[136:139]
    v_mfma_f32_16x16x32_bf16 v[136:139], a[76:79], a[8:11], v[136:139]
    ds_read_b128 a[8:11], v216 offset:51200
    v_mfma_f32_16x16x32_bf16 v[152:155], a[76:79], a[16:19], v[152:155]
    ds_read_b128 a[12:15], v217 offset:51200
    v_mfma_f32_16x16x32_bf16 v[152:155], a[92:95], a[20:23], v[152:155]
    buffer_load_dwordx4 v215, s[8:11], s25 offen offset:3072  lds
    v_mfma_f32_16x16x32_bf16 v[148:151], a[88:91], a[20:23], v[148:151]
    v_mfma_f32_16x16x32_bf16 v[148:151], a[72:75], a[16:19], v[148:151]
    v_smfmac_f32_16x16x64_bf16 a[240:243], a[248:251], a[64:71], v220
    v_mfma_f32_16x16x32_bf16 v[144:147], a[68:71], a[16:19], v[144:147]
    v_mfma_f32_16x16x32_bf16 v[144:147], a[84:87], a[20:23], v[144:147]
    s_add_u32 m0, s43, 16384
    s_mov_b32 s25, 7110656
    v_mfma_f32_16x16x32_bf16 v[140:143], a[80:83], a[20:23], v[140:143]
    buffer_load_dwordx4 v212, s[8:11], s25 offen offset:0  lds
    v_mfma_f32_16x16x32_bf16 v[140:143], a[64:67], a[16:19], v[140:143]
    s_waitcnt lgkmcnt(8)
    v_mfma_f32_16x16x32_bf16 v[156:159], a[64:67], a[24:27], v[156:159]
    ds_read_b128 a[16:19], v216 offset:53248
    v_mfma_f32_16x16x32_bf16 v[156:159], a[80:83], a[28:31], v[156:159]
    ds_read_b128 a[20:23], v217 offset:53248
    v_mfma_f32_16x16x32_bf16 v[160:163], a[84:87], a[28:31], v[160:163]
    v_mfma_f32_16x16x32_bf16 v[160:163], a[68:71], a[24:27], v[160:163]
    buffer_load_dwordx4 v213, s[8:11], s25 offen offset:1024  lds
    v_mfma_f32_16x16x32_bf16 v[164:167], a[72:75], a[24:27], v[164:167]
    v_mfma_f32_16x16x32_bf16 v[164:167], a[88:91], a[28:31], v[164:167]
    v_mfma_f32_16x16x32_bf16 v[168:171], a[92:95], a[28:31], v[168:171]
    v_mfma_f32_16x16x32_bf16 v[168:171], a[76:79], a[24:27], v[168:171]
    ds_read_b128 a[24:27], v216 offset:55296
    v_mfma_f32_16x16x32_bf16 v[184:187], a[76:79], a[32:35], v[184:187]
    ds_read_b128 a[28:31], v217 offset:55296
    v_mfma_f32_16x16x32_bf16 v[184:187], a[92:95], a[36:39], v[184:187]
    v_mfma_f32_16x16x32_bf16 v[180:183], a[88:91], a[36:39], v[180:183]
    buffer_load_dwordx4 v214, s[8:11], s25 offen offset:2048  lds
    v_mfma_f32_16x16x32_bf16 v[180:183], a[72:75], a[32:35], v[180:183]
    v_smfmac_f32_16x16x64_bf16 a[244:247], a[248:251], a[72:79], v220
    v_mfma_f32_16x16x32_bf16 v[176:179], a[68:71], a[32:35], v[176:179]
    buffer_load_dword v255, v254, s[16:19], s28 offen
    v_mfma_f32_16x16x32_bf16 v[176:179], a[84:87], a[36:39], v[176:179]
    s_add_u32 s28, s28, 1024
    v_mfma_f32_16x16x32_bf16 v[172:175], a[80:83], a[36:39], v[172:175]
    v_mfma_f32_16x16x32_bf16 v[172:175], a[64:67], a[32:35], v[172:175]
    s_waitcnt lgkmcnt(8)
    v_mfma_f32_16x16x32_bf16 v[188:191], a[64:67], a[40:43], v[188:191]
    ds_read_b128 a[32:35], v216 offset:61440
    v_mfma_f32_16x16x32_bf16 v[188:191], a[80:83], a[44:47], v[188:191]
    ds_read_b128 a[36:39], v217 offset:61440
    v_mfma_f32_16x16x32_bf16 v[192:195], a[84:87], a[44:47], v[192:195]
    buffer_load_dwordx4 v215, s[8:11], s25 offen offset:3072  lds
    v_mfma_f32_16x16x32_bf16 v[192:195], a[68:71], a[40:43], v[192:195]
    v_mfma_f32_16x16x32_bf16 v[196:199], a[72:75], a[40:43], v[196:199]
    v_mfma_f32_16x16x32_bf16 v[196:199], a[88:91], a[44:47], v[196:199]
    v_mfma_f32_16x16x32_bf16 v[200:203], a[92:95], a[44:47], v[200:203]
    v_mfma_f32_16x16x32_bf16 v[200:203], a[76:79], a[40:43], v[200:203]
    ds_read_b128 a[40:43], v216 offset:57344
    v_mfma_f32_16x16x32_bf16 a[124:127], a[76:79], a[48:51], a[124:127]
    ds_read_b128 a[44:47], v217 offset:57344
    v_mfma_f32_16x16x32_bf16 a[124:127], a[92:95], a[52:55], a[124:127]
    v_mfma_f32_16x16x32_bf16 a[120:123], a[88:91], a[52:55], a[120:123]
    v_mfma_f32_16x16x32_bf16 a[120:123], a[72:75], a[48:51], a[120:123]
    v_smfmac_f32_16x16x64_bf16 a[240:243], a[248:251], a[80:87], v220
    v_mfma_f32_16x16x32_bf16 a[116:119], a[68:71], a[48:51], a[116:119]
    v_mfma_f32_16x16x32_bf16 a[116:119], a[84:87], a[52:55], a[116:119]
    v_mfma_f32_16x16x32_bf16 a[112:115], a[80:83], a[52:55], a[112:115]
    v_mfma_f32_16x16x32_bf16 a[112:115], a[64:67], a[48:51], a[112:115]
    s_waitcnt lgkmcnt(8)
    v_mfma_f32_16x16x32_bf16 a[128:131], a[64:67], a[0:3], a[128:131]
    ds_read_b128 a[48:51], v216 offset:59392
    v_mfma_f32_16x16x32_bf16 a[128:131], a[80:83], a[4:7], a[128:131]
    ds_read_b128 a[52:55], v217 offset:59392
    v_mfma_f32_16x16x32_bf16 a[132:135], a[84:87], a[4:7], a[132:135]
    v_mfma_f32_16x16x32_bf16 a[132:135], a[68:71], a[0:3], a[132:135]
    v_mfma_f32_16x16x32_bf16 a[136:139], a[72:75], a[0:3], a[136:139]
    v_mfma_f32_16x16x32_bf16 a[136:139], a[88:91], a[4:7], a[136:139]
    s_waitcnt vmcnt(24)
    s_cmp_eq_u32 s20, 0
    s_cbranch_scc0 L_k_pc_ok
    s_mov_b32 s41, 0
L_k_pc:
    v_cmp_eq_u32 vcc, s44, v223
    s_add_u32 s41, s41, 1
    s_nop 3
    s_andn2_b32 vcc_lo, 1073741823, vcc_lo
    s_andn2_b32 vcc_hi, 65535, vcc_hi
    s_cmp_eq_u64 vcc, 0
    s_cbranch_scc1 L_k_pc_ok
    s_cmp_gt_u32 s41, 400000
    s_cbranch_scc1 L_k_pc_ok
    s_sleep 4
    buffer_load_dword v223, v225, s[48:51], 0 offen sc1
    s_waitcnt vmcnt(0)
    s_branch L_k_pc
L_k_pc_ok:
    s_waitcnt vmcnt(9) lgkmcnt(0)
    s_barrier
    v_mfma_f32_16x16x32_bf16 a[140:143], a[92:95], a[4:7], a[140:143]
    s_add_u32 m0, s26, 32768
    s_mov_b32 s23, 1920
    v_mfma_f32_16x16x32_bf16 a[140:143], a[76:79], a[0:3], a[140:143]
    ds_read_b128 a[0:3], v216 offset:0
    v_mfma_f32_16x16x32_bf16 a[156:159], a[76:79], a[8:11], a[156:159]
    ds_read_b128 a[4:7], v217 offset:0
    v_accvgpr_read_b32 v0, a112
    v_mfma_f32_16x16x32_bf16 a[156:159], a[92:95], a[12:15], a[156:159]
    buffer_load_dwordx4 v208, s[4:7], s23 offen offset:0 lds
    v_mfma_f32_16x16x32_bf16 a[152:155], a[88:91], a[12:15], a[152:155]
    v_accvgpr_read_b32 v1, a113
    v_accvgpr_read_b32 v2, a114
    v_mfma_f32_16x16x32_bf16 a[152:155], a[72:75], a[8:11], a[152:155]
    v_accvgpr_read_b32 v3, a115
    v_accvgpr_read_b32 v4, a116
    v_mfma_f32_16x16x32_bf16 a[148:151], a[68:71], a[8:11], a[148:151]
    buffer_load_dwordx4 v209, s[4:7], s23 offen offset:1024 lds
    v_mfma_f32_16x16x32_bf16 a[148:151], a[84:87], a[12:15], a[148:151]
    v_accvgpr_read_b32 v5, a117
    v_accvgpr_read_b32 v6, a118
    v_mfma_f32_16x16x32_bf16 a[144:147], a[80:83], a[12:15], a[144:147]
    v_accvgpr_read_b32 v7, a119
    v_accvgpr_read_b32 v8, a120
    v_mfma_f32_16x16x32_bf16 a[144:147], a[64:67], a[8:11], a[144:147]
    v_accvgpr_read_b32 v9, a121
    v_mfma_f32_16x16x32_bf16 a[160:163], a[64:67], a[16:19], a[160:163]
    ds_read_b128 a[8:11], v216 offset:2048
    v_accvgpr_read_b32 v10, a122
    v_mfma_f32_16x16x32_bf16 a[160:163], a[80:83], a[20:23], a[160:163]
    ds_read_b128 a[12:15], v217 offset:2048
    v_accvgpr_read_b32 v11, a123
    v_mfma_f32_16x16x32_bf16 a[164:167], a[84:87], a[20:23], a[164:167]
    v_accvgpr_read_b32 v12, a124
    v_accvgpr_read_b32 v13, a125
    v_mfma_f32_16x16x32_bf16 a[164:167], a[68:71], a[16:19], a[164:167]
    buffer_load_dwordx4 v210, s[4:7], s23 offen offset:2048 lds
    v_smfmac_f32_16x16x64_bf16 a[244:247], a[248:251], a[88:95], v220
    v_accvgpr_read_b32 v14, a126
    v_accvgpr_read_b32 v15, a127
    v_mfma_f32_16x16x32_bf16 a[168:171], a[72:75], a[16:19], a[168:171]
    v_accvgpr_read_b32 v16, a128
    v_accvgpr_read_b32 v17, a129
    v_mfma_f32_16x16x32_bf16 a[168:171], a[88:91], a[20:23], a[168:171]
    v_accvgpr_read_b32 v18, a130
    v_accvgpr_read_b32 v19, a131
    v_mfma_f32_16x16x32_bf16 a[172:175], a[92:95], a[20:23], a[172:175]
    v_accvgpr_read_b32 v20, a132
    v_accvgpr_read_b32 v21, a133
    v_mfma_f32_16x16x32_bf16 a[172:175], a[76:79], a[16:19], a[172:175]
    ds_read_b128 a[16:19], v216 offset:4096
    v_accvgpr_read_b32 v22, a134
    v_mfma_f32_16x16x32_bf16 a[188:191], a[76:79], a[24:27], a[188:191]
    ds_read_b128 a[20:23], v217 offset:4096
    v_accvgpr_read_b32 v23, a135
    v_mfma_f32_16x16x32_bf16 a[188:191], a[92:95], a[28:31], a[188:191]
    buffer_load_dwordx4 v211, s[4:7], s23 offen offset:3072 lds
    v_mfma_f32_16x16x32_bf16 a[184:187], a[88:91], a[28:31], a[184:187]
    v_accvgpr_read_b32 v24, a136
    v_accvgpr_read_b32 v25, a137
    v_mfma_f32_16x16x32_bf16 a[184:187], a[72:75], a[24:27], a[184:187]
    v_accvgpr_read_b32 v26, a138
    v_accvgpr_read_b32 v27, a139
    v_mfma_f32_16x16x32_bf16 a[180:183], a[68:71], a[24:27], a[180:183]
    v_accvgpr_read_b32 v28, a140
    v_accvgpr_read_b32 v29, a141
    v_mfma_f32_16x16x32_bf16 a[180:183], a[84:87], a[28:31], a[180:183]
    v_accvgpr_read_b32 v30, a142
    v_accvgpr_read_b32 v31, a143
    v_mfma_f32_16x16x32_bf16 a[176:179], a[80:83], a[28:31], a[176:179]
    s_cmp_lt_u32 s21, 7
    v_mfma_f32_16x16x32_bf16 a[176:179], a[64:67], a[24:27], a[176:179]
    s_cbranch_scc1 L_k_sk14
    v_mfma_f32_16x16x32_bf16 a[224:227], a[64:67], a[32:35], a[224:227]
    v_mfma_f32_16x16x32_bf16 a[224:227], a[80:83], a[36:39], a[224:227]
    v_mfma_f32_16x16x32_bf16 a[228:231], a[84:87], a[36:39], a[228:231]
    v_mfma_f32_16x16x32_bf16 a[228:231], a[68:71], a[32:35], a[228:231]
    v_mfma_f32_16x16x32_bf16 a[232:235], a[72:75], a[32:35], a[232:235]
    v_mfma_f32_16x16x32_bf16 a[232:235], a[88:91], a[36:39], a[232:235]
    v_mfma_f32_16x16x32_bf16 a[236:239], a[92:95], a[36:39], a[236:239]
    v_mfma_f32_16x16x32_bf16 a[236:239], a[76:79], a[32:35], a[236:239]
L_k_sk14:
    ds_read_b128 a[24:27], v216 offset:6144
    s_add_u32 m0, s26, 36864
    v_mfma_f32_16x16x32_bf16 a[192:195], a[64:67], a[40:43], a[192:195]
    ds_read_b128 a[28:31], v217 offset:6144
    s_mov_b32 s23, 67456
    v_mfma_f32_16x16x32_bf16 a[192:195], a[80:83], a[44:47], a[192:195]
    ds_read_b128 a[32:35], v216 offset:8192
    buffer_load_dwordx4 v208, s[4:7], s23 offen offset:0 lds
    v_mfma_f32_16x16x32_bf16 a[208:211], a[80:83], a[52:55], a[208:211]
    ds_read_b128 a[36:39], v217 offset:8192
    buffer_load_dwordx4 v209, s[4:7], s23 offen offset:1024 lds
    v_mfma_f32_16x16x32_bf16 a[208:211], a[64:67], a[48:51], a[208:211]
    ds_read_b64_tr_b16 a[64:65], v236 offset:0
    buffer_load_dword v255, v254, s[16:19], s28 offen
    v_mfma_f32_16x16x32_bf16 a[196:199], a[68:71], a[40:43], a[196:199]
    ds_read_b64_tr_b16 a[66:67], v236 offset:1024
    s_add_u32 s28, s28, 1024
    v_mfma_f32_16x16x32_bf16 a[196:199], a[84:87], a[44:47], a[196:199]
    ds_read_b64_tr_b16 a[80:81], v236 offset:16384
    buffer_load_dwordx4 v210, s[4:7], s23 offen offset:2048 lds
    v_mfma_f32_16x16x32_bf16 a[212:215], a[84:87], a[52:55], a[212:215]
    ds_read_b64_tr_b16 a[82:83], v236 offset:17408
    v_mfma_f32_16x16x32_bf16 a[212:215], a[68:71], a[48:51], a[212:215]
    ds_read_b64_tr_b16 a[68:69], v237 offset:0
    v_mfma_f32_16x16x32_bf16 a[200:203], a[72:75], a[40:43], a[200:203]
    ds_read_b64_tr_b16 a[70:71], v237 offset:1024
    v_mfma_f32_16x16x32_bf16 a[200:203], a[88:91], a[44:47], a[200:203]
    ds_read_b64_tr_b16 a[84:85], v237 offset:16384
    v_mfma_f32_16x16x32_bf16 a[216:219], a[88:91], a[52:55], a[216:219]
    ds_read_b64_tr_b16 a[86:87], v237 offset:17408
    v_mfma_f32_16x16x32_bf16 a[216:219], a[72:75], a[48:51], a[216:219]
    ds_read_b64_tr_b16 a[72:73], v236 offset:8192
    v_mfma_f32_16x16x32_bf16 a[204:207], a[76:79], a[40:43], a[204:207]
    ds_read_b64_tr_b16 a[74:75], v236 offset:9216
    buffer_load_dwordx4 v211, s[4:7], s23 offen offset:3072 lds
    v_mfma_f32_16x16x32_bf16 a[204:207], a[92:95], a[44:47], a[204:207]
    ds_read_b64_tr_b16 a[88:89], v236 offset:24576
    v_mfma_f32_16x16x32_bf16 a[220:223], a[92:95], a[52:55], a[220:223]
    ds_read_b64_tr_b16 a[90:91], v236 offset:25600
    v_mfma_f32_16x16x32_bf16 a[220:223], a[76:79], a[48:51], a[220:223]
    s_waitcnt lgkmcnt(8)
    v_mfma_f32_16x16x32_bf16 v[92:95], a[64:67], a[0:3], v[92:95]
    ds_read_b64_tr_b16 a[76:77], v237 offset:8192
    v_mfma_f32_16x16x32_bf16 v[92:95], a[80:83], a[4:7], v[92:95]
    ds_read_b64_tr_b16 a[78:79], v237 offset:9216
    v_mfma_f32_16x16x32_bf16 v[108:111], a[80:83], a[12:15], v[108:111]
    ds_read_b64_tr_b16 a[92:93], v237 offset:24576
    v_mfma_f32_16x16x32_bf16 v[108:111], a[64:67], a[8:11], v[108:111]
    s_waitcnt lgkmcnt(7)
    v_mfma_f32_16x16x32_bf16 v[96:99], a[68:71], a[0:3], v[96:99]
    ds_read_b64_tr_b16 a[94:95], v237 offset:25600
    v_mfma_f32_16x16x32_bf16 v[96:99], a[84:87], a[4:7], v[96:99]
    ds_read_b128 a[40:43], v216 offset:10240
    v_mfma_f32_16x16x32_bf16 v[112:115], a[84:87], a[12:15], v[112:115]
    ds_read_b128 a[44:47], v217 offset:10240
    v_mfma_f32_16x16x32_bf16 v[112:115], a[68:71], a[8:11], v[112:115]
    s_waitcnt lgkmcnt(6)
    v_mfma_f32_16x16x32_bf16 v[100:103], a[72:75], a[0:3], v[100:103]
    ds_read_b128 a[48:51], v216 offset:12288
    v_mfma_f32_16x16x32_bf16 v[100:103], a[88:91], a[4:7], v[100:103]
    ds_read_b128 a[52:55], v217 offset:12288
    v_mfma_f32_16x16x32_bf16 v[116:119], a[88:91], a[12:15], v[116:119]
    v_mfma_f32_16x16x32_bf16 v[116:119], a[72:75], a[8:11], v[116:119]
    s_waitcnt lgkmcnt(4)
    v_mfma_f32_16x16x32_bf16 v[104:107], a[76:79], a[0:3], v[104:107]
    v_mfma_f32_16x16x32_bf16 v[104:107], a[92:95], a[4:7], v[104:107]
    v_mfma_f32_16x16x32_bf16 v[120:123], a[92:95], a[12:15], v[120:123]
    v_mfma_f32_16x16x32_bf16 v[120:123], a[76:79], a[8:11], v[120:123]
    v_mfma_f32_16x16x32_bf16 v[124:127], a[64:67], a[16:19], v[124:127]
    ds_read_b128 a[0:3], v216 offset:14336
    v_mfma_f32_16x16x32_bf16 v[124:127], a[80:83], a[20:23], v[124:127]
    ds_read_b128 a[4:7], v217 offset:14336
    v_mfma_f32_16x16x32_bf16 v[128:131], a[84:87], a[20:23], v[128:131]
    ds_read_b128 a[8:11], v216 offset:16384
    v_mfma_f32_16x16x32_bf16 v[128:131], a[68:71], a[16:19], v[128:131]
    ds_read_b128 a[12:15], v217 offset:16384
    v_mfma_f32_16x16x32_bf16 v[132:135], a[72:75], a[16:19], v[132:135]
    v_mfma_f32_16x16x32_bf16 v[132:135], a[88:91], a[20:23], v[132:135]
    v_mfma_f32_16x16x32_bf16 v[136:139], a[92:95], a[20:23], v[136:139]
    v_mfma_f32_16x16x32_bf16 v[136:139], a[76:79], a[16:19], v[136:139]
    ds_read_b128 a[16:19], v216 offset:18432
    v_mfma_f32_16x16x32_bf16 v[152:155], a[76:79], a[24:27], v[152:155]
    ds_read_b128 a[20:23], v217 offset:18432
    v_mfma_f32_16x16x32_bf16 v[152:155], a[92:95], a[28:31], v[152:155]
    v_mfma_f32_16x16x32_bf16 v[148:151], a[88:91], a[28:31], v[148:151]
    v_mfma_f32_16x16x32_bf16 v[148:151], a[72:75], a[24:27], v[148:151]
    v_smfmac_f32_16x16x64_bf16 a[240:243], a[248:251], a[64:71], v220
    v_mfma_f32_16x16x32_bf16 v[144:147], a[68:71], a[24:27], v[144:147]
    v_mfma_f32_16x16x32_bf16 v[144:147], a[84:87], a[28:31], v[144:147]
    v_mfma_f32_16x16x32_bf16 v[140:143], a[80:83], a[28:31], v[140:143]
    v_mfma_f32_16x16x32_bf16 v[140:143], a[64:67], a[24:27], v[140:143]
    s_waitcnt lgkmcnt(8)
    v_mfma_f32_16x16x32_bf16 v[156:159], a[64:67], a[32:35], v[156:159]
    ds_read_b128 a[24:27], v216 offset:20480
    v_mfma_f32_16x16x32_bf16 v[156:159], a[80:83], a[36:39], v[156:159]
    ds_read_b128 a[28:31], v217 offset:20480
    v_mfma_f32_16x16x32_bf16 v[160:163], a[84:87], a[36:39], v[160:163]
    v_mfma_f32_16x16x32_bf16 v[160:163], a[68:71], a[32:35], v[160:163]
    v_mfma_f32_16x16x32_bf16 v[164:167], a[72:75], a[32:35], v[164:167]
    v_mfma_f32_16x16x32_bf16 v[164:167], a[88:91], a[36:39], v[164:167]
    v_mfma_f32_16x16x32_bf16 v[168:171], a[92:95], a[36:39], v[168:171]
    v_mfma_f32_16x16x32_bf16 v[168:171], a[76:79], a[32:35], v[168:171]
    ds_read_b128 a[32:35], v216 offset:22528
    v_mfma_f32_16x16x32_bf16 v[184:187], a[76:79], a[40:43], v[184:187]
    ds_read_b128 a[36:39], v217 offset:22528
    v_mfma_f32_16x16x32_bf16 v[184:187], a[92:95], a[44:47], v[184:187]
    v_mfma_f32_16x16x32_bf16 v[180:183], a[88:91], a[44:47], v[180:183]
    v_mfma_f32_16x16x32_bf16 v[180:183], a[72:75], a[40:43], v[180:183]
    v_smfmac_f32_16x16x64_bf16 a[244:247], a[248:251], a[72:79], v220
    v_mfma_f32_16x16x32_bf16 v[176:179], a[68:71], a[40:43], v[176:179]
    buffer_load_dword v255, v254, s[16:19], s28 offen
    v_mfma_f32_16x16x32_bf16 v[176:179], a[84:87], a[44:47], v[176:179]
    s_add_u32 s28, s28, 1024
    v_mfma_f32_16x16x32_bf16 v[172:175], a[80:83], a[44:47], v[172:175]
    v_mfma_f32_16x16x32_bf16 v[172:175], a[64:67], a[40:43], v[172:175]
    s_waitcnt lgkmcnt(8)
    v_mfma_f32_16x16x32_bf16 v[188:191], a[64:67], a[48:51], v[188:191]
    ds_read_b128 a[40:43], v216 offset:28672
    v_mfma_f32_16x16x32_bf16 v[188:191], a[80:83], a[52:55], v[188:191]
    ds_read_b128 a[44:47], v217 offset:28672
    v_mfma_f32_16x16x32_bf16 v[192:195], a[84:87], a[52:55], v[192:195]
    v_mfma_f32_16x16x32_bf16 v[192:195], a[68:71], a[48:51], v[192:195]
    v_mfma_f32_16x16x32_bf16 v[196:199], a[72:75], a[48:51], v[196:199]
    v_mfma_f32_16x16x32_bf16 v[196:199], a[88:91], a[52:55], v[196:199]
    v_mfma_f32_16x16x32_bf16 v[200:203], a[92:95], a[52:55], v[200:203]
    v_mfma_f32_16x16x32_bf16 v[200:203], a[76:79], a[48:51], v[200:203]
    ds_read_b128 a[48:51], v216 offset:24576
    v_mfma_f32_16x16x32_bf16 v[12:15], a[76:79], a[0:3], v[12:15]
    ds_read_b128 a[52:55], v217 offset:24576
    v_mfma_f32_16x16x32_bf16 v[12:15], a[92:95], a[4:7], v[12:15]
    v_mfma_f32_16x16x32_bf16 v[8:11], a[88:91], a[4:7], v[8:11]
    v_mfma_f32_16x16x32_bf16 v[8:11], a[72:75], a[0:3], v[8:11]
    v_smfmac_f32_16x16x64_bf16 a[240:243], a[248:251], a[80:87], v220
    v_mfma_f32_16x16x32_bf16 v[4:7], a[68:71], a[0:3], v[4:7]
    v_mfma_f32_16x16x32_bf16 v[4:7], a[84:87], a[4:7], v[4:7]
    v_mfma_f32_16x16x32_bf16 v[0:3], a[80:83], a[4:7], v[0:3]
    v_mfma_f32_16x16x32_bf16 v[0:3], a[64:67], a[0:3], v[0:3]
    s_waitcnt lgkmcnt(8)
    v_mfma_f32_16x16x32_bf16 v[16:19], a[64:67], a[8:11], v[16:19]
    ds_read_b128 a[0:3], v216 offset:26624
    v_mfma_f32_16x16x32_bf16 v[16:19], a[80:83], a[12:15], v[16:19]
    ds_read_b128 a[4:7], v217 offset:26624
    v_mfma_f32_16x16x32_bf16 v[20:23], a[84:87], a[12:15], v[20:23]
    v_mfma_f32_16x16x32_bf16 v[20:23], a[68:71], a[8:11], v[20:23]
    v_mfma_f32_16x16x32_bf16 v[24:27], a[72:75], a[8:11], v[24:27]
    v_mfma_f32_16x16x32_bf16 v[24:27], a[88:91], a[12:15], v[24:27]
    s_waitcnt vmcnt(1) lgkmcnt(0)
    s_barrier
    v_mfma_f32_16x16x32_bf16 v[28:31], a[92:95], a[12:15], v[28:31]
    s_mov_b32 s12, s36
    s_mov_b32 s13, s37
    v_mfma_f32_16x16x32_bf16 v[28:31], a[76:79], a[8:11], v[28:31]
    ds_read_b128 a[8:11], v216 offset:32768
    s_lshl_b32 s40, s65, 8
    v_mfma_f32_16x16x32_bf16 a[156:159], a[76:79], a[16:19], a[156:159]
    ds_read_b128 a[12:15], v217 offset:32768
    s_add_u32 s14, s40, 3840
    v_mfma_f32_16x16x32_bf16 a[156:159], a[92:95], a[20:23], a[156:159]
    s_lshl_b32 s29, s20, 12
    s_add_u32 m0, s29, 98304
    v_mfma_f32_16x16x32_bf16 a[152:155], a[88:91], a[20:23], a[152:155]
    v_mfma_f32_16x16x32_bf16 a[152:155], a[72:75], a[16:19], a[152:155]
    v_mfma_f32_16x16x32_bf16 a[148:151], a[68:71], a[16:19], a[148:151]
    buffer_load_dwordx4 v222, s[12:15], s40 offen offset:0 lds
    v_mfma_f32_16x16x32_bf16 a[148:151], a[84:87], a[20:23], a[148:151]
    v_mfma_f32_16x16x32_bf16 a[144:147], a[80:83], a[20:23], a[144:147]
    v_mfma_f32_16x16x32_bf16 a[144:147], a[64:67], a[16:19], a[144:147]
    v_mfma_f32_16x16x32_bf16 a[160:163], a[64:67], a[24:27], a[160:163]
    ds_read_b128 a[16:19], v216 offset:34816
    v_mfma_f32_16x16x32_bf16 a[160:163], a[80:83], a[28:31], a[160:163]
L_k_w6:
    s_cbranch_execz L_k_w10
    ds_read_b128 a[20:23], v217 offset:34816
    v_mfma_f32_16x16x32_bf16 a[164:167], a[84:87], a[28:31], a[164:167]
    buffer_load_dwordx4 v222, s[12:15], s40 offen offset:1024 lds
    v_mfma_f32_16x16x32_bf16 a[164:167], a[68:71], a[24:27], a[164:167]
    v_smfmac_f32_16x16x64_bf16 a[244:247], a[248:251], a[88:95], v220
    v_mfma_f32_16x16x32_bf16 a[168:171], a[72:75], a[24:27], a[168:171]
    v_mfma_f32_16x16x32_bf16 a[168:171], a[88:91], a[28:31], a[168:171]
    buffer_load_dwordx4 v222, s[12:15], s40 offen offset:2048 lds
    v_mfma_f32_16x16x32_bf16 a[172:175], a[92:95], a[28:31], a[172:175]
    v_mfma_f32_16x16x32_bf16 a[172:175], a[76:79], a[24:27], a[172:175]
    ds_read_b128 a[24:27], v216 offset:36864
    v_accvgpr_read_b32 v32, a144
    v_mfma_f32_16x16x32_bf16 a[188:191], a[76:79], a[32:35], a[188:191]
    ds_read_b128 a[28:31], v217 offset:36864
    v_accvgpr_read_b32 v33, a145
    v_mfma_f32_16x16x32_bf16 a[188:191], a[92:95], a[36:39], a[188:191]
    v_accvgpr_read_b32 v34, a146
    v_accvgpr_read_b32 v35, a147
    v_mfma_f32_16x16x32_bf16 a[184:187], a[88:91], a[36:39], a[184:187]
    buffer_load_dwordx4 v222, s[12:15], s40 offen offset:3072 lds
    v_mfma_f32_16x16x32_bf16 a[184:187], a[72:75], a[32:35], a[184:187]
    v_accvgpr_read_b32 v36, a148
    v_accvgpr_read_b32 v37, a149
    v_mfma_f32_16x16x32_bf16 a[180:183], a[68:71], a[32:35], a[180:183]
    v_accvgpr_read_b32 v38, a150
    v_accvgpr_read_b32 v39, a151
    v_mfma_f32_16x16x32_bf16 a[180:183], a[84:87], a[36:39], a[180:183]
    v_accvgpr_read_b32 v40, a152
    v_accvgpr_read_b32 v41, a153
    v_mfma_f32_16x16x32_bf16 a[176:179], a[80:83], a[36:39], a[176:179]
    s_cmp_lt_u32 s21, 7
    v_mfma_f32_16x16x32_bf16 a[176:179], a[64:67], a[32:35], a[176:179]
    s_cbranch_scc1 L_k_sk15
    v_mfma_f32_16x16x32_bf16 a[224:227], a[64:67], a[40:43], a[224:227]
    v_mfma_f32_16x16x32_bf16 a[224:227], a[80:83], a[44:47], a[224:227]
    v_mfma_f32_16x16x32_bf16 a[228:231], a[84:87], a[44:47], a[228:231]
    v_mfma_f32_16x16x32_bf16 a[228:231], a[68:71], a[40:43], a[228:231]
    v_mfma_f32_16x16x32_bf16 a[232:235], a[72:75], a[40:43], a[232:235]
    v_mfma_f32_16x16x32_bf16 a[232:235], a[88:91], a[44:47], a[232:235]
    v_mfma_f32_16x16x32_bf16 a[236:239], a[92:95], a[44:47], a[236:239]
    v_mfma_f32_16x16x32_bf16 a[236:239], a[76:79], a[40:43], a[236:239]
L_k_sk15:
    ds_read_b128 a[32:35], v216 offset:38912
    v_accvgpr_read_b32 v42, a154
    v_mfma_f32_16x16x32_bf16 a[192:195], a[64:67], a[48:51], a[192:195]
    ds_read_b128 a[36:39], v217 offset:38912
    v_accvgpr_read_b32 v43, a155
    v_mfma_f32_16x16x32_bf16 a[192:195], a[80:83], a[52:55], a[192:195]
    ds_read_b128 a[40:43], v216 offset:40960
    v_accvgpr_read_b32 v44, a156
    v_mfma_f32_16x16x32_bf16 a[208:211], a[80:83], a[4:7], a[208:211]
    ds_read_b128 a[44:47], v217 offset:40960
    v_accvgpr_read_b32 v45, a157
    v_mfma_f32_16x16x32_bf16 a[208:211], a[64:67], a[0:3], a[208:211]
    ds_read_b64_tr_b16 a[64:65], v218 offset:0
    v_accvgpr_read_b32 v46, a158
    v_mfma_f32_16x16x32_bf16 a[196:199], a[68:71], a[48:51], a[196:199]
    ds_read_b64_tr_b16 a[66:67], v218 offset:1024
    v_accvgpr_read_b32 v47, a159
    v_mfma_f32_16x16x32_bf16 a[196:199], a[84:87], a[52:55], a[196:199]
    ds_read_b64_tr_b16 a[80:81], v218 offset:16384
    v_mfma_f32_16x16x32_bf16 a[212:215], a[84:87], a[4:7], a[212:215]
    ds_read_b64_tr_b16 a[82:83], v218 offset:17408
    v_mfma_f32_16x16x32_bf16 a[212:215], a[68:71], a[0:3], a[212:215]
    ds_read_b64_tr_b16 a[68:69], v219 offset:0
    v_mfma_f32_16x16x32_bf16 a[200:203], a[72:75], a[48:51], a[200:203]
    ds_read_b64_tr_b16 a[70:71], v219 offset:1024
    v_accvgpr_read_b32 v48, a160
    v_mfma_f32_16x16x32_bf16 a[200:203], a[88:91], a[52:55], a[200:203]
    ds_read_b64_tr_b16 a[84:85], v219 offset:16384
    v_accvgpr_read_b32 v49, a161
    v_mfma_f32_16x16x32_bf16 a[216:219], a[88:91], a[4:7], a[216:219]
    ds_read_b64_tr_b16 a[86:87], v219 offset:17408
    v_accvgpr_read_b32 v50, a162
    v_mfma_f32_16x16x32_bf16 a[216:219], a[72:75], a[0:3], a[216:219]
    ds_read_b64_tr_b16 a[72:73], v218 offset:8192
    v_accvgpr_read_b32 v51, a163
    v_accvgpr_read_b32 v52, a164
    v_accvgpr_read_b32 v53, a165
    v_accvgpr_read_b32 v54, a166
    v_accvgpr_read_b32 v55, a167
    v_accvgpr_read_b32 v56, a168
    v_accvgpr_read_b32 v57, a169
    v_accvgpr_read_b32 v58, a170
    v_accvgpr_read_b32 v59, a171
    v_accvgpr_read_b32 v60, a172
    v_accvgpr_read_b32 v61, a173
    v_accvgpr_read_b32 v62, a174
    v_accvgpr_read_b32 v63, a175
    v_mfma_f32_16x16x32_bf16 a[204:207], a[76:79], a[48:51], a[204:207]
    ds_read_b64_tr_b16 a[74:75], v218 offset:9216
    v_mfma_f32_16x16x32_bf16 a[204:207], a[92:95], a[52:55], a[204:207]
    ds_read_b64_tr_b16 a[88:89], v218 offset:24576
    v_mfma_f32_16x16x32_bf16 a[220:223], a[92:95], a[4:7], a[220:223]
    ds_read_b64_tr_b16 a[90:91], v218 offset:25600
    v_mfma_f32_16x16x32_bf16 a[220:223], a[76:79], a[0:3], a[220:223]
    s_waitcnt lgkmcnt(8)
    v_mfma_f32_16x16x32_bf16 v[92:95], a[64:67], a[8:11], v[92:95]
    ds_read_b64_tr_b16 a[76:77], v219 offset:8192
    v_mfma_f32_16x16x32_bf16 v[92:95], a[80:83], a[12:15], v[92:95]
    ds_read_b64_tr_b16 a[78:79], v219 offset:9216
    v_mfma_f32_16x16x32_bf16 v[108:111], a[80:83], a[20:23], v[108:111]
    ds_read_b64_tr_b16 a[92:93], v219 offset:24576
    v_mfma_f32_16x16x32_bf16 v[108:111], a[64:67], a[16:19], v[108:111]
    s_waitcnt lgkmcnt(7)
    v_mfma_f32_16x16x32_bf16 v[96:99], a[68:71], a[8:11], v[96:99]
    ds_read_b64_tr_b16 a[94:95], v219 offset:25600
    v_mfma_f32_16x16x32_bf16 v[96:99], a[84:87], a[12:15], v[96:99]
    ds_read_b128 a[48:51], v216 offset:43008
    v_mfma_f32_16x16x32_bf16 v[112:115], a[84:87], a[20:23], v[112:115]
    ds_read_b128 a[52:55], v217 offset:43008
    v_cmp_lt_u32 vcc, 23, v221
    v_mfma_f32_16x16x32_bf16 v[112:115], a[68:71], a[16:19], v[112:115]
    v_mov_b32 v236, v222
    s_waitcnt lgkmcnt(6)
    v_mfma_f32_16x16x32_bf16 v[100:103], a[72:75], a[8:11], v[100:103]
    ds_read_b128 a[0:3], v216 offset:45056
    v_add_u32 v237, 128, v222
    v_mfma_f32_16x16x32_bf16 v[100:103], a[88:91], a[12:15], v[100:103]
    ds_read_b128 a[4:7], v217 offset:45056
    v_cndmask_b32 v236, v236, v237, vcc
    v_mfma_f32_16x16x32_bf16 v[116:119], a[88:91], a[20:23], v[116:119]
    v_cmp_lt_u32 vcc, 15, v221
    v_add_u32 v237, 1152, v222
    v_mfma_f32_16x16x32_bf16 v[116:119], a[72:75], a[16:19], v[116:119]
    v_add_u32 v241, 1280, v222
    s_waitcnt lgkmcnt(4)
    v_mfma_f32_16x16x32_bf16 v[104:107], a[76:79], a[8:11], v[104:107]
    v_cndmask_b32 v237, v237, v241, vcc
    v_mfma_f32_16x16x32_bf16 v[104:107], a[92:95], a[12:15], v[104:107]
    s_add_u32 s12, s36, 16777216
    s_addc_u32 s13, s37, 0
    v_mfma_f32_16x16x32_bf16 v[120:123], a[92:95], a[20:23], v[120:123]
    s_cmp_eq_u32 s64, 1
    s_cselect_b32 s14, 0, 22020096
    v_mfma_f32_16x16x32_bf16 v[120:123], a[76:79], a[16:19], v[120:123]
    ds_read_b128 a[8:11], v216 offset:47104
    s_lshl_b32 s41, s22, 2
    v_smfmac_f32_16x16x64_bf16 a[240:243], a[248:251], a[64:71], v220
    s_add_u32 s41, s41, s20
    v_mfma_f32_16x16x32_bf16 v[124:127], a[64:67], a[24:27], v[124:127]
    ds_read_b128 a[12:15], v217 offset:47104
    s_lshr_b32 s40, s65, 1
    v_mfma_f32_16x16x32_bf16 v[124:127], a[80:83], a[28:31], v[124:127]
    ds_read_b128 a[16:19], v216 offset:49152
    s_mul_i32 s40, s40, 112
    v_smfmac_f32_16x16x64_bf16 a[244:247], a[248:251], a[72:79], v220
    ds_read_b128 a[20:23], v217 offset:49152
    s_add_u32 s41, s41, s40
    v_mfma_f32_16x16x32_bf16 v[128:131], a[84:87], a[28:31], v[128:131]
    s_mul_i32 s41, s41, 3072
    v_mfma_f32_16x16x32_bf16 v[128:131], a[68:71], a[24:27], v[128:131]
    s_and_b32 s40, s65, 1
    s_cselect_b32 s46, 344064, 0
    v_smfmac_f32_16x16x64_bf16 a[240:243], a[248:251], a[80:87], v220
    s_sub_u32 s47, 344064, s46
    s_sub_u32 s41, s41, s47
    v_mfma_f32_16x16x32_bf16 v[132:135], a[72:75], a[24:27], v[132:135]
    s_add_u32 s29, s29, 98304
    v_and_b32 v240, 48, v221
    v_mfma_f32_16x16x32_bf16 v[132:135], a[88:91], a[28:31], v[132:135]
    v_lshrrev_b32 v241, 2, v240
    v_add_lshl_u32 v240, v240, v241, 2
    v_smfmac_f32_16x16x64_bf16 a[244:247], a[248:251], a[88:95], v220
    v_and_b32 v223, 15, v221
    v_lshl_add_u32 v223, v223, 4, s29
    v_mfma_f32_16x16x32_bf16 v[136:139], a[92:95], a[28:31], v[136:139]
    s_cmp_eq_u32 s40, 0
    s_cselect_b64 vcc, -1, 0
    v_mfma_f32_16x16x32_bf16 v[136:139], a[76:79], a[24:27], v[136:139]
    ds_read_b128 a[24:27], v216 offset:51200
    v_cndmask_b32 v218, v237, v236, vcc
    v_mfma_f32_16x16x32_bf16 v[152:155], a[76:79], a[32:35], v[152:155]
    ds_read_b128 a[28:31], v217 offset:51200
    v_cndmask_b32 v219, v236, v237, vcc
    v_mfma_f32_16x16x32_bf16 v[152:155], a[92:95], a[36:39], v[152:155]
    v_mfma_f32_16x16x32_bf16 v[148:151], a[88:91], a[36:39], v[148:151]
    v_mfma_f32_16x16x32_bf16 v[148:151], a[72:75], a[32:35], v[148:151]
    v_mfma_f32_16x16x32_bf16 v[144:147], a[68:71], a[32:35], v[144:147]
    v_mfma_f32_16x16x32_bf16 v[144:147], a[84:87], a[36:39], v[144:147]
    v_mfma_f32_16x16x32_bf16 v[140:143], a[80:83], a[36:39], v[140:143]
    v_accvgpr_read_b32 v208, a240
    v_accvgpr_read_b32 v209, a241
    v_mfma_f32_16x16x32_bf16 v[140:143], a[64:67], a[32:35], v[140:143]
    v_accvgpr_read_b32 v210, a242
    s_waitcnt lgkmcnt(8)
    v_mfma_f32_16x16x32_bf16 v[156:159], a[64:67], a[40:43], v[156:159]
    ds_read_b128 a[32:35], v216 offset:53248
    v_accvgpr_read_b32 v211, a243
    v_mfma_f32_16x16x32_bf16 v[156:159], a[80:83], a[44:47], v[156:159]
    ds_read_b128 a[36:39], v217 offset:53248
    v_accvgpr_read_b32 v212, a244
    v_mfma_f32_16x16x32_bf16 v[160:163], a[84:87], a[44:47], v[160:163]
    v_accvgpr_read_b32 v213, a245
    v_accvgpr_read_b32 v214, a246
    v_mfma_f32_16x16x32_bf16 v[160:163], a[68:71], a[40:43], v[160:163]
    v_accvgpr_read_b32 v215, a247
    v_add_f32 v208, v208, v209
    v_mfma_f32_16x16x32_bf16 v[164:167], a[72:75], a[40:43], v[164:167]
    v_add_f32 v210, v210, v211
    v_add_f32 v212, v212, v213
    v_mfma_f32_16x16x32_bf16 v[164:167], a[88:91], a[44:47], v[164:167]
    v_add_f32 v214, v214, v215
    v_mfma_f32_16x16x32_bf16 v[168:171], a[92:95], a[44:47], v[168:171]
    v_mfma_f32_16x16x32_bf16 v[168:171], a[76:79], a[40:43], v[168:171]
    ds_read_b128 a[40:43], v216 offset:55296
    v_mfma_f32_16x16x32_bf16 v[184:187], a[76:79], a[48:51], v[184:187]
    ds_read_b128 a[44:47], v217 offset:55296
    s_mov_b32 s18, 4194304
    v_mfma_f32_16x16x32_bf16 v[184:187], a[92:95], a[52:55], v[184:187]
    s_mul_i32 s60, s20, 8480
    s_add_u32 s60, s60, 114688
    v_mfma_f32_16x16x32_bf16 v[180:183], a[88:91], a[52:55], v[180:183]
    v_and_b32 v245, 3, v221
    v_lshrrev_b32 v246, 4, v221
    v_mfma_f32_16x16x32_bf16 v[180:183], a[72:75], a[48:51], v[180:183]
    v_bfe_u32 v247, v221, 2, 2
    v_lshlrev_b32 v244, 3, v246
    v_mfma_f32_16x16x32_bf16 v[176:179], a[68:71], a[48:51], v[176:179]
    v_add_u32 v244, v244, v247
    v_lshlrev_b32 v246, 2, v245
    v_mfma_f32_16x16x32_bf16 v[176:179], a[84:87], a[52:55], v[176:179]
    v_sub_u32 v246, v246, v244
    s_add_u32 s25, s60, 248
    v_mfma_f32_16x16x32_bf16 v[172:175], a[80:83], a[52:55], v[172:175]
    v_lshl_add_u32 v204, v246, 3, s25
    v_add_u32 v244, v244, v245
    v_mfma_f32_16x16x32_bf16 v[172:175], a[64:67], a[48:51], v[172:175]
    s_add_u32 s25, s60, 4232
    s_waitcnt lgkmcnt(8)
    v_mfma_f32_16x16x32_bf16 v[188:191], a[64:67], a[0:3], v[188:191]
    ds_read_b128 a[48:51], v216 offset:61440
    v_lshl_add_u32 v205, v244, 3, s25
    v_mfma_f32_16x16x32_bf16 v[188:191], a[80:83], a[4:7], v[188:191]
    ds_read_b128 a[52:55], v217 offset:61440
    v_lshl_add_u32 v206, v221, 1, s60
    v_mfma_f32_16x16x32_bf16 v[192:195], a[84:87], a[4:7], v[192:195]
    v_mov_b32 v238, 0
    v_min_u32 v241, 31, v221
    v_mfma_f32_16x16x32_bf16 v[192:195], a[68:71], a[0:3], v[192:195]
    v_lshl_add_u32 v241, v241, 2, s60
    v_min_u32 v242, 39, v221
    v_mfma_f32_16x16x32_bf16 v[196:199], a[72:75], a[0:3], v[196:199]
    v_lshl_add_u32 v242, v242, 2, s60
    v_mfma_f32_16x16x32_bf16 v[196:199], a[88:91], a[4:7], v[196:199]
    v_mfma_f32_16x16x32_bf16 v[200:203], a[92:95], a[4:7], v[200:203]
    v_mfma_f32_16x16x32_bf16 v[200:203], a[76:79], a[0:3], v[200:203]
    ds_read_b128 a[0:3], v216 offset:57344
    v_mfma_f32_16x16x32_bf16 v[12:15], a[76:79], a[8:11], v[12:15]
    ds_read_b128 a[4:7], v217 offset:57344
    v_mfma_f32_16x16x32_bf16 v[12:15], a[92:95], a[12:15], v[12:15]
    v_mfma_f32_16x16x32_bf16 v[8:11], a[88:91], a[12:15], v[8:11]
    v_mfma_f32_16x16x32_bf16 v[8:11], a[72:75], a[8:11], v[8:11]
    v_mfma_f32_16x16x32_bf16 v[4:7], a[68:71], a[8:11], v[4:7]
    v_mfma_f32_16x16x32_bf16 v[4:7], a[84:87], a[12:15], v[4:7]
    v_mfma_f32_16x16x32_bf16 v[0:3], a[80:83], a[12:15], v[0:3]
    v_mfma_f32_16x16x32_bf16 v[0:3], a[64:67], a[8:11], v[0:3]
    s_waitcnt lgkmcnt(8)
    v_mfma_f32_16x16x32_bf16 v[16:19], a[64:67], a[16:19], v[16:19]
    ds_read_b128 a[8:11], v216 offset:59392
    v_mfma_f32_16x16x32_bf16 v[16:19], a[80:83], a[20:23], v[16:19]
    ds_read_b128 a[12:15], v217 offset:59392
    v_mfma_f32_16x16x32_bf16 v[20:23], a[84:87], a[20:23], v[20:23]
    v_mfma_f32_16x16x32_bf16 v[20:23], a[68:71], a[16:19], v[20:23]
    v_mfma_f32_16x16x32_bf16 v[24:27], a[72:75], a[16:19], v[24:27]
    v_mfma_f32_16x16x32_bf16 v[24:27], a[88:91], a[20:23], v[24:27]
    s_waitcnt lgkmcnt(0)
    s_barrier
    v_mfma_f32_16x16x32_bf16 v[28:31], a[92:95], a[20:23], v[28:31]
    s_lshl_b32 s28, s61, 12
    s_add_u32 m0, s60, 128
    v_mfma_f32_16x16x32_bf16 v[28:31], a[76:79], a[16:19], v[28:31]
    buffer_load_dwordx4 v222, s[16:19], s28 offen offset:0 lds
    buffer_load_dwordx4 v222, s[16:19], s28 offen offset:1024 lds
    v_mfma_f32_16x16x32_bf16 v[44:47], a[76:79], a[24:27], v[44:47]
    buffer_load_dwordx4 v222, s[16:19], s28 offen offset:2048 lds
    buffer_load_dwordx4 v222, s[16:19], s28 offen offset:3072 lds
    v_mfma_f32_16x16x32_bf16 v[44:47], a[92:95], a[28:31], v[44:47]
    ds_write_b32 v241, v238
    v_mfma_f32_16x16x32_bf16 v[40:43], a[88:91], a[28:31], v[40:43]
    ds_write_b32 v242, v238 offset:4224
    s_mov_b32 s16, s34
    v_mfma_f32_16x16x32_bf16 v[40:43], a[72:75], a[24:27], v[40:43]
    s_mov_b32 s17, s35
    s_add_u32 m0, s60, 4384
    v_mfma_f32_16x16x32_bf16 v[36:39], a[68:71], a[24:27], v[36:39]
    s_lshr_b32 s28, s2, 4
    s_lshl_b32 s28, s28, 12
    v_mfma_f32_16x16x32_bf16 v[36:39], a[84:87], a[28:31], v[36:39]
    s_and_b32 s42, s2, 15
    s_lshl_b32 s42, s42, 6
    v_mfma_f32_16x16x32_bf16 v[32:35], a[80:83], a[28:31], v[32:35]
    s_add_u32 s28, s28, s42
    s_lshl_b32 s42, s20, 10
    v_mfma_f32_16x16x32_bf16 v[32:35], a[64:67], a[24:27], v[32:35]
    s_add_u32 s28, s28, s42
    v_mfma_f32_16x16x32_bf16 v[48:51], a[64:67], a[32:35], v[48:51]
    v_lshrrev_b32 v254, 2, v221
    v_lshlrev_b32 v254, 16, v254
    v_mfma_f32_16x16x32_bf16 v[48:51], a[80:83], a[36:39], v[48:51]
    v_and_b32 v244, 48, v222
    v_add_u32 v254, v254, v244
    v_mfma_f32_16x16x32_bf16 v[52:55], a[84:87], a[36:39], v[52:55]
    buffer_load_dwordx4 v254, s[16:19], s28 offen offset:0 lds
    s_add_u32 s28, s28, 1047552
    v_mfma_f32_16x16x32_bf16 v[52:55], a[68:71], a[32:35], v[52:55]
    buffer_load_dwordx4 v254, s[16:19], s28 offen offset:1024 lds
    s_add_u32 s28, s28, 1047552
    v_mfma_f32_16x16x32_bf16 v[56:59], a[72:75], a[32:35], v[56:59]
    buffer_load_dwordx4 v254, s[16:19], s28 offen offset:2048 lds
    s_add_u32 s28, s28, 1047552
    v_mfma_f32_16x16x32_bf16 v[56:59], a[88:91], a[36:39], v[56:59]
    buffer_load_dwordx4 v254, s[16:19], s28 offen offset:3072 lds
    s_add_u32 s28, s28, 1047552
    v_mfma_f32_16x16x32_bf16 v[60:63], a[92:95], a[36:39], v[60:63]
    s_mov_b32 s16, s58
    s_mov_b32 s17, s59
    v_mfma_f32_16x16x32_bf16 v[60:63], a[76:79], a[32:35], v[60:63]
    s_mov_b32 s18, 2048
    s_lshl_b32 s28, s61, 1
    v_mfma_f32_16x16x32_bf16 a[188:191], a[76:79], a[40:43], a[188:191]
    v_mov_b32 v253, 0
    buffer_load_ushort v253, v253, s[16:19], s28 offen
    v_mfma_f32_16x16x32_bf16 a[188:191], a[92:95], a[44:47], a[188:191]
    ds_bpermute_b32 v224, v240, v208 offset:0
    v_mfma_f32_16x16x32_bf16 a[184:187], a[88:91], a[44:47], a[184:187]
    ds_bpermute_b32 v225, v240, v208 offset:4
    v_mfma_f32_16x16x32_bf16 a[184:187], a[72:75], a[40:43], a[184:187]
    ds_bpermute_b32 v226, v240, v208 offset:8
    v_mfma_f32_16x16x32_bf16 a[180:183], a[68:71], a[40:43], a[180:183]
    ds_bpermute_b32 v227, v240, v208 offset:12
    v_mfma_f32_16x16x32_bf16 a[180:183], a[84:87], a[44:47], a[180:183]
    ds_bpermute_b32 v228, v240, v210 offset:0
    v_mfma_f32_16x16x32_bf16 a[176:179], a[80:83], a[44:47], a[176:179]
    s_cmp_lt_u32 s21, 7
    v_mfma_f32_16x16x32_bf16 a[176:179], a[64:67], a[40:43], a[176:179]
    s_cbranch_scc1 L_k_sk16
    v_mfma_f32_16x16x32_bf16 a[224:227], a[64:67], a[48:51], a[224:227]
    v_mfma_f32_16x16x32_bf16 a[224:227], a[80:83], a[52:55], a[224:227]
    v_mfma_f32_16x16x32_bf16 a[228:231], a[84:87], a[52:55], a[228:231]
    v_mfma_f32_16x16x32_bf16 a[228:231], a[68:71], a[48:51], a[228:231]
    v_mfma_f32_16x16x32_bf16 a[232:235], a[72:75], a[48:51], a[232:235]
    v_mfma_f32_16x16x32_bf16 a[232:235], a[88:91], a[52:55], a[232:235]
    v_mfma_f32_16x16x32_bf16 a[236:239], a[92:95], a[52:55], a[236:239]
    v_mfma_f32_16x16x32_bf16 a[236:239], a[76:79], a[48:51], a[236:239]
L_k_sk16:
    ds_bpermute_b32 v229, v240, v210 offset:4
    v_mfma_f32_16x16x32_bf16 a[192:195], a[64:67], a[0:3], a[192:195]
    ds_bpermute_b32 v230, v240, v210 offset:8
    v_mfma_f32_16x16x32_bf16 a[192:195], a[80:83], a[4:7], a[192:195]
    ds_bpermute_b32 v231, v240, v210 offset:12
    v_mfma_f32_16x16x32_bf16 a[208:211], a[80:83], a[12:15], a[208:211]
    ds_bpermute_b32 v232, v240, v212 offset:0
    v_mfma_f32_16x16x32_bf16 a[208:211], a[64:67], a[8:11], a[208:211]
    ds_bpermute_b32 v233, v240, v212 offset:4
    v_mfma_f32_16x16x32_bf16 a[196:199], a[68:71], a[0:3], a[196:199]
    ds_bpermute_b32 v234, v240, v212 offset:8
    v_mfma_f32_16x16x32_bf16 a[196:199], a[84:87], a[4:7], a[196:199]
    ds_bpermute_b32 v235, v240, v212 offset:12
    v_mfma_f32_16x16x32_bf16 a[212:215], a[84:87], a[12:15], a[212:215]
    ds_bpermute_b32 v236, v240, v214 offset:0
    v_mfma_f32_16x16x32_bf16 a[212:215], a[68:71], a[8:11], a[212:215]
    ds_bpermute_b32 v237, v240, v214 offset:4
    v_mfma_f32_16x16x32_bf16 a[200:203], a[72:75], a[0:3], a[200:203]
    ds_bpermute_b32 v238, v240, v214 offset:8
    v_accvgpr_read_b32 v64, a176
    v_mfma_f32_16x16x32_bf16 a[200:203], a[88:91], a[4:7], a[200:203]
    ds_bpermute_b32 v239, v240, v214 offset:12
    v_accvgpr_read_b32 v65, a177
    v_mfma_f32_16x16x32_bf16 a[216:219], a[88:91], a[12:15], a[216:219]
    v_accvgpr_read_b32 v66, a178
    v_accvgpr_read_b32 v67, a179
    v_mfma_f32_16x16x32_bf16 a[216:219], a[72:75], a[8:11], a[216:219]
    v_accvgpr_read_b32 v68, a180
    v_accvgpr_read_b32 v69, a181
    v_mfma_f32_16x16x32_bf16 a[204:207], a[76:79], a[0:3], a[204:207]
    v_accvgpr_read_b32 v70, a182
    v_accvgpr_read_b32 v71, a183
    v_mfma_f32_16x16x32_bf16 a[204:207], a[92:95], a[4:7], a[204:207]
    v_accvgpr_read_b32 v72, a184
    v_accvgpr_read_b32 v73, a185
    v_mfma_f32_16x16x32_bf16 a[220:223], a[92:95], a[12:15], a[220:223]
    v_accvgpr_read_b32 v74, a186
    v_accvgpr_read_b32 v75, a187
    v_mfma_f32_16x16x32_bf16 a[220:223], a[76:79], a[8:11], a[220:223]
    v_accvgpr_read_b32 v76, a188
    v_accvgpr_read_b32 v77, a189
    v_accvgpr_read_b32 v78, a190
    v_accvgpr_read_b32 v79, a191
    s_waitcnt vmcnt(9)
    ds_read_b128 v[80:83], v223
    s_waitcnt lgkmcnt(0)
    ds_read_b128 v[84:87], v223 offset:256
    v_pk_fma_f32 v[92:93], v[224:225], v[80:81], v[92:93] op_sel_hi:[1,0,1] neg_lo:[0,1,0] neg_hi:[0,1,0]
    v_pk_fma_f32 v[94:95], v[226:227], v[80:81], v[94:95] op_sel_hi:[1,0,1] neg_lo:[0,1,0] neg_hi:[0,1,0]
    v_pk_fma_f32 v[96:97], v[228:229], v[80:81], v[96:97] op_sel_hi:[1,0,1] neg_lo:[0,1,0] neg_hi:[0,1,0]
    v_pk_fma_f32 v[98:99], v[230:231], v[80:81], v[98:99] op_sel_hi:[1,0,1] neg_lo:[0,1,0] neg_hi:[0,1,0]
    v_pk_fma_f32 v[100:101], v[232:233], v[80:81], v[100:101] op_sel_hi:[1,0,1] neg_lo:[0,1,0] neg_hi:[0,1,0]
    v_pk_fma_f32 v[102:103], v[234:235], v[80:81], v[102:103] op_sel_hi:[1,0,1] neg_lo:[0,1,0] neg_hi:[0,1,0]
    v_pk_fma_f32 v[104:105], v[236:237], v[80:81], v[104:105] op_sel_hi:[1,0,1] neg_lo:[0,1,0] neg_hi:[0,1,0]
    v_pk_fma_f32 v[106:107], v[238:239], v[80:81], v[106:107] op_sel_hi:[1,0,1] neg_lo:[0,1,0] neg_hi:[0,1,0]
    v_pk_mul_f32 v[208:209], v[92:93], v[92:93]
    v_pk_mul_f32 v[210:211], v[94:95], v[94:95]
    v_pk_mul_f32 v[212:213], v[96:97], v[96:97]
    v_pk_mul_f32 v[214:215], v[98:99], v[98:99]
    v_pk_fma_f32 v[208:209], v[208:209], v[82:83], v[80:81] op_sel:[0,0,1] op_sel_hi:[1,0,1]
    v_pk_fma_f32 v[210:211], v[210:211], v[82:83], v[80:81] op_sel:[0,0,1] op_sel_hi:[1,0,1]
    v_pk_fma_f32 v[212:213], v[212:213], v[82:83], v[80:81] op_sel:[0,0,1] op_sel_hi:[1,0,1]
    v_pk_fma_f32 v[214:215], v[214:215], v[82:83], v[80:81] op_sel:[0,0,1] op_sel_hi:[1,0,1]
    v_pk_mul_f32 v[208:209], v[208:209], v[92:93]
    v_pk_mul_f32 v[210:211], v[210:211], v[94:95]
    v_pk_mul_f32 v[212:213], v[212:213], v[96:97]
    v_pk_mul_f32 v[214:215], v[214:215], v[98:99]
    v_exp_f32 v208, v208
    v_exp_f32 v209, v209
    v_exp_f32 v210, v210
    v_exp_f32 v211, v211
    v_exp_f32 v212, v212
    v_exp_f32 v213, v213
    v_exp_f32 v214, v214
    v_exp_f32 v215, v215
    v_pk_mul_f32 v[92:93], v[92:93], v[100:101]
    v_pk_mul_f32 v[94:95], v[94:95], v[102:103]
    v_pk_mul_f32 v[96:97], v[96:97], v[104:105]
    v_pk_mul_f32 v[98:99], v[98:99], v[106:107]
    v_pk_fma_f32 v[208:209], v[208:209], v[82:83], v[82:83] op_sel:[0,1,1] op_sel_hi:[1,1,1]
    v_pk_fma_f32 v[210:211], v[210:211], v[82:83], v[82:83] op_sel:[0,1,1] op_sel_hi:[1,1,1]
    v_pk_fma_f32 v[212:213], v[212:213], v[82:83], v[82:83] op_sel:[0,1,1] op_sel_hi:[1,1,1]
    v_pk_fma_f32 v[214:215], v[214:215], v[82:83], v[82:83] op_sel:[0,1,1] op_sel_hi:[1,1,1]
    v_rcp_f32 v208, v208
    v_rcp_f32 v209, v209
    v_rcp_f32 v210, v210
    v_rcp_f32 v211, v211
    v_rcp_f32 v212, v212
    v_rcp_f32 v213, v213
    v_rcp_f32 v214, v214
    v_rcp_f32 v215, v215
    s_add_u32 s41, s41, s47
    v_pk_mul_f32 v[92:93], v[92:93], v[208:209]
    v_pk_mul_f32 v[94:95], v[94:95], v[210:211]
    v_pk_mul_f32 v[96:97], v[96:97], v[212:213]
    v_pk_mul_f32 v[98:99], v[98:99], v[214:215]
    v_cvt_pk_bf16_f32 v240, v92, v93
    v_cvt_pk_bf16_f32 v241, v94, v95
    v_cvt_pk_bf16_f32 v242, v96, v97
    v_cvt_pk_bf16_f32 v243, v98, v99
    buffer_store_dwordx4 v[240:243], v218, s[12:15], s41 offen sc1
    s_waitcnt lgkmcnt(0)
    ds_read_b128 v[80:83], v223 offset:512
    v_pk_fma_f32 v[108:109], v[224:225], v[84:85], v[108:109] op_sel_hi:[1,0,1] neg_lo:[0,1,0] neg_hi:[0,1,0]
    v_pk_fma_f32 v[110:111], v[226:227], v[84:85], v[110:111] op_sel_hi:[1,0,1] neg_lo:[0,1,0] neg_hi:[0,1,0]
    v_pk_fma_f32 v[112:113], v[228:229], v[84:85], v[112:113] op_sel_hi:[1,0,1] neg_lo:[0,1,0] neg_hi:[0,1,0]
    v_pk_fma_f32 v[114:115], v[230:231], v[84:85], v[114:115] op_sel_hi:[1,0,1] neg_lo:[0,1,0] neg_hi:[0,1,0]
    v_pk_fma_f32 v[116:117], v[232:233], v[84:85], v[116:117] op_sel_hi:[1,0,1] neg_lo:[0,1,0] neg_hi:[0,1,0]
    v_pk_fma_f32 v[118:119], v[234:235], v[84:85], v[118:119] op_sel_hi:[1,0,1] neg_lo:[0,1,0] neg_hi:[0,1,0]
    v_pk_fma_f32 v[120:121], v[236:237], v[84:85], v[120:121] op_sel_hi:[1,0,1] neg_lo:[0,1,0] neg_hi:[0,1,0]
    v_pk_fma_f32 v[122:123], v[238:239], v[84:85], v[122:123] op_sel_hi:[1,0,1] neg_lo:[0,1,0] neg_hi:[0,1,0]
    v_pk_mul_f32 v[208:209], v[108:109], v[108:109]
    v_pk_mul_f32 v[210:211], v[110:111], v[110:111]
    v_pk_mul_f32 v[212:213], v[112:113], v[112:113]
    v_pk_mul_f32 v[214:215], v[114:115], v[114:115]
    v_pk_fma_f32 v[208:209], v[208:209], v[86:87], v[84:85] op_sel:[0,0,1] op_sel_hi:[1,0,1]
    v_pk_fma_f32 v[210:211], v[210:211], v[86:87], v[84:85] op_sel:[0,0,1] op_sel_hi:[1,0,1]
    v_pk_fma_f32 v[212:213], v[212:213], v[86:87], v[84:85] op_sel:[0,0,1] op_sel_hi:[1,0,1]
    v_pk_fma_f32 v[214:215], v[214:215], v[86:87], v[84:85] op_sel:[0,0,1] op_sel_hi:[1,0,1]
    v_pk_mul_f32 v[208:209], v[208:209], v[108:109]
    v_pk_mul_f32 v[210:211], v[210:211], v[110:111]
    v_pk_mul_f32 v[212:213], v[212:213], v[112:113]
    v_pk_mul_f32 v[214:215], v[214:215], v[114:115]
    v_exp_f32 v208, v208
    v_exp_f32 v209, v209
    v_exp_f32 v210, v210
    v_exp_f32 v211, v211
    v_exp_f32 v212, v212
    v_exp_f32 v213, v213
    v_exp_f32 v214, v214
    v_exp_f32 v215, v215
    v_pk_mul_f32 v[108:109], v[108:109], v[116:117]
    v_pk_mul_f32 v[110:111], v[110:111], v[118:119]
    v_pk_mul_f32 v[112:113], v[112:113], v[120:121]
    v_pk_mul_f32 v[114:115], v[114:115], v[122:123]
    v_pk_fma_f32 v[208:209], v[208:209], v[86:87], v[86:87] op_sel:[0,1,1] op_sel_hi:[1,1,1]
    v_pk_fma_f32 v[210:211], v[210:211], v[86:87], v[86:87] op_sel:[0,1,1] op_sel_hi:[1,1,1]
    v_pk_fma_f32 v[212:213], v[212:213], v[86:87], v[86:87] op_sel:[0,1,1] op_sel_hi:[1,1,1]
    v_pk_fma_f32 v[214:215], v[214:215], v[86:87], v[86:87] op_sel:[0,1,1] op_sel_hi:[1,1,1]
    v_rcp_f32 v208, v208
    v_rcp_f32 v209, v209
    v_rcp_f32 v210, v210
    v_rcp_f32 v211, v211
    v_rcp_f32 v212, v212
    v_rcp_f32 v213, v213
    v_rcp_f32 v214, v214
    v_rcp_f32 v215, v215
    s_add_u32 s41, s41, s46
    v_pk_mul_f32 v[108:109], v[108:109], v[208:209]
    v_pk_mul_f32 v[110:111], v[110:111], v[210:211]
    v_pk_mul_f32 v[112:113], v[112:113], v[212:213]
    v_pk_mul_f32 v[114:115], v[114:115], v[214:215]
    v_cvt_pk_bf16_f32 v244, v108, v109
    v_cvt_pk_bf16_f32 v245, v110, v111
    v_cvt_pk_bf16_f32 v246, v112, v113
    v_cvt_pk_bf16_f32 v247, v114, v115
    buffer_store_dwordx4 v[244:247], v219, s[12:15], s41 offen sc1
    s_waitcnt lgkmcnt(0)
    ds_read_b128 v[84:87], v223 offset:768
    v_pk_fma_f32 v[124:125], v[224:225], v[80:81], v[124:125] op_sel_hi:[1,0,1] neg_lo:[0,1,0] neg_hi:[0,1,0]
    v_pk_fma_f32 v[126:127], v[226:227], v[80:81], v[126:127] op_sel_hi:[1,0,1] neg_lo:[0,1,0] neg_hi:[0,1,0]
    v_pk_fma_f32 v[128:129], v[228:229], v[80:81], v[128:129] op_sel_hi:[1,0,1] neg_lo:[0,1,0] neg_hi:[0,1,0]
    v_pk_fma_f32 v[130:131], v[230:231], v[80:81], v[130:131] op_sel_hi:[1,0,1] neg_lo:[0,1,0] neg_hi:[0,1,0]
    v_pk_fma_f32 v[132:133], v[232:233], v[80:81], v[132:133] op_sel_hi:[1,0,1] neg_lo:[0,1,0] neg_hi:[0,1,0]
    v_pk_fma_f32 v[134:135], v[234:235], v[80:81], v[134:135] op_sel_hi:[1,0,1] neg_lo:[0,1,0] neg_hi:[0,1,0]
    v_pk_fma_f32 v[136:137], v[236:237], v[80:81], v[136:137] op_sel_hi:[1,0,1] neg_lo:[0,1,0] neg_hi:[0,1,0]
    v_pk_fma_f32 v[138:139], v[238:239], v[80:81], v[138:139] op_sel_hi:[1,0,1] neg_lo:[0,1,0] neg_hi:[0,1,0]
    v_pk_mul_f32 v[208:209], v[124:125], v[124:125]
    v_pk_mul_f32 v[210:211], v[126:127], v[126:127]
    v_pk_mul_f32 v[212:213], v[128:129], v[128:129]
    v_pk_mul_f32 v[214:215], v[130:131], v[130:131]
    v_pk_fma_f32 v[208:209], v[208:209], v[82:83], v[80:81] op_sel:[0,0,1] op_sel_hi:[1,0,1]
    v_pk_fma_f32 v[210:211], v[210:211], v[82:83], v[80:81] op_sel:[0,0,1] op_sel_hi:[1,0,1]
    v_pk_fma_f32 v[212:213], v[212:213], v[82:83], v[80:81] op_sel:[0,0,1] op_sel_hi:[1,0,1]
    v_pk_fma_f32 v[214:215], v[214:215], v[82:83], v[80:81] op_sel:[0,0,1] op_sel_hi:[1,0,1]
    v_pk_mul_f32 v[208:209], v[208:209], v[124:125]
    v_pk_mul_f32 v[210:211], v[210:211], v[126:127]
    v_pk_mul_f32 v[212:213], v[212:213], v[128:129]
    v_pk_mul_f32 v[214:215], v[214:215], v[130:131]
    v_exp_f32 v208, v208
    v_exp_f32 v209, v209
    v_exp_f32 v210, v210
    v_exp_f32 v211, v211
    v_exp_f32 v212, v212
    v_exp_f32 v213, v213
    v_exp_f32 v214, v214
    v_exp_f32 v215, v215
    v_pk_mul_f32 v[124:125], v[124:125], v[132:133]
    v_pk_mul_f32 v[126:127], v[126:127], v[134:135]
    v_pk_mul_f32 v[128:129], v[128:129], v[136:137]
    v_pk_mul_f32 v[130:131], v[130:131], v[138:139]
    v_pk_fma_f32 v[208:209], v[208:209], v[82:83], v[82:83] op_sel:[0,1,1] op_sel_hi:[1,1,1]
    v_pk_fma_f32 v[210:211], v[210:211], v[82:83], v[82:83] op_sel:[0,1,1] op_sel_hi:[1,1,1]
    v_pk_fma_f32 v[212:213], v[212:213], v[82:83], v[82:83] op_sel:[0,1,1] op_sel_hi:[1,1,1]
    v_pk_fma_f32 v[214:215], v[214:215], v[82:83], v[82:83] op_sel:[0,1,1] op_sel_hi:[1,1,1]
    v_rcp_f32 v208, v208
    v_rcp_f32 v209, v209
    v_rcp_f32 v210, v210
    v_rcp_f32 v211, v211
    v_rcp_f32 v212, v212
    v_rcp_f32 v213, v213
    v_rcp_f32 v214, v214
    v_rcp_f32 v215, v215
    s_add_u32 s41, s41, s47
    v_pk_mul_f32 v[124:125], v[124:125], v[208:209]
    v_pk_mul_f32 v[126:127], v[126:127], v[210:211]
    v_pk_mul_f32 v[128:129], v[128:129], v[212:213]
    v_pk_mul_f32 v[130:131], v[130:131], v[214:215]
    v_cvt_pk_bf16_f32 v240, v124, v125
    v_cvt_pk_bf16_f32 v241, v126, v127
    v_cvt_pk_bf16_f32 v242, v128, v129
    v_cvt_pk_bf16_f32 v243, v130, v131
    buffer_store_dwordx4 v[240:243], v218, s[12:15], s41 offen sc1
    s_waitcnt lgkmcnt(0)
    ds_read_b128 v[80:83], v223 offset:1024
    v_pk_fma_f32 v[140:141], v[224:225], v[84:85], v[140:141] op_sel_hi:[1,0,1] neg_lo:[0,1,0] neg_hi:[0,1,0]
    v_pk_fma_f32 v[142:143], v[226:227], v[84:85], v[142:143] op_sel_hi:[1,0,1] neg_lo:[0,1,0] neg_hi:[0,1,0]
    v_pk_fma_f32 v[144:145], v[228:229], v[84:85], v[144:145] op_sel_hi:[1,0,1] neg_lo:[0,1,0] neg_hi:[0,1,0]
    v_pk_fma_f32 v[146:147], v[230:231], v[84:85], v[146:147] op_sel_hi:[1,0,1] neg_lo:[0,1,0] neg_hi:[0,1,0]
    v_pk_fma_f32 v[148:149], v[232:233], v[84:85], v[148:149] op_sel_hi:[1,0,1] neg_lo:[0,1,0] neg_hi:[0,1,0]
    v_pk_fma_f32 v[150:151], v[234:235], v[84:85], v[150:151] op_sel_hi:[1,0,1] neg_lo:[0,1,0] neg_hi:[0,1,0]
    v_pk_fma_f32 v[152:153], v[236:237], v[84:85], v[152:153] op_sel_hi:[1,0,1] neg_lo:[0,1,0] neg_hi:[0,1,0]
    v_pk_fma_f32 v[154:155], v[238:239], v[84:85], v[154:155] op_sel_hi:[1,0,1] neg_lo:[0,1,0] neg_hi:[0,1,0]
    v_pk_mul_f32 v[208:209], v[140:141], v[140:141]
    v_pk_mul_f32 v[210:211], v[142:143], v[142:143]
    v_pk_mul_f32 v[212:213], v[144:145], v[144:145]
    v_pk_mul_f32 v[214:215], v[146:147], v[146:147]
    v_pk_fma_f32 v[208:209], v[208:209], v[86:87], v[84:85] op_sel:[0,0,1] op_sel_hi:[1,0,1]
L_k_w7:
    s_cbranch_execz L_k_w11
    v_pk_fma_f32 v[210:211], v[210:211], v[86:87], v[84:85] op_sel:[0,0,1] op_sel_hi:[1,0,1]
    v_pk_fma_f32 v[212:213], v[212:213], v[86:87], v[84:85] op_sel:[0,0,1] op_sel_hi:[1,0,1]
    v_pk_fma_f32 v[214:215], v[214:215], v[86:87], v[84:85] op_sel:[0,0,1] op_sel_hi:[1,0,1]
    v_pk_mul_f32 v[208:209], v[208:209], v[140:141]
    v_pk_mul_f32 v[210:211], v[210:211], v[142:143]
    v_pk_mul_f32 v[212:213], v[212:213], v[144:145]
    v_pk_mul_f32 v[214:215], v[214:215], v[146:147]
    v_exp_f32 v208, v208
    v_exp_f32 v209, v209
    v_exp_f32 v210, v210
    v_exp_f32 v211, v211
    v_exp_f32 v212, v212
    v_exp_f32 v213, v213
    v_exp_f32 v214, v214
    v_exp_f32 v215, v215
    v_pk_mul_f32 v[140:141], v[140:141], v[148:149]
    v_pk_mul_f32 v[142:143], v[142:143], v[150:151]
    v_pk_mul_f32 v[144:145], v[144:145], v[152:153]
    v_pk_mul_f32 v[146:147], v[146:147], v[154:155]
    v_pk_fma_f32 v[208:209], v[208:209], v[86:87], v[86:87] op_sel:[0,1,1] op_sel_hi:[1,1,1]
    v_pk_fma_f32 v[210:211], v[210:211], v[86:87], v[86:87] op_sel:[0,1,1] op_sel_hi:[1,1,1]
    v_pk_fma_f32 v[212:213], v[212:213], v[86:87], v[86:87] op_sel:[0,1,1] op_sel_hi:[1,1,1]
    v_pk_fma_f32 v[214:215], v[214:215], v[86:87], v[86:87] op_sel:[0,1,1] op_sel_hi:[1,1,1]
    v_rcp_f32 v208, v208
    v_rcp_f32 v209, v209
    v_rcp_f32 v210, v210
    v_rcp_f32 v211, v211
    v_rcp_f32 v212, v212
    v_rcp_f32 v213, v213
    v_rcp_f32 v214, v214
    v_rcp_f32 v215, v215
    s_add_u32 s41, s41, s46
    v_pk_mul_f32 v[140:141], v[140:141], v[208:209]
    v_pk_mul_f32 v[142:143], v[142:143], v[210:211]
    v_pk_mul_f32 v[144:145], v[144:145], v[212:213]
    v_pk_mul_f32 v[146:147], v[146:147], v[214:215]
    v_cvt_pk_bf16_f32 v244, v140, v141
    v_cvt_pk_bf16_f32 v245, v142, v143
    v_cvt_pk_bf16_f32 v246, v144, v145
    v_cvt_pk_bf16_f32 v247, v146, v147
    buffer_store_dwordx4 v[244:247], v219, s[12:15], s41 offen sc1
    s_waitcnt lgkmcnt(0)
    ds_read_b128 v[84:87], v223 offset:1280
    v_pk_fma_f32 v[156:157], v[224:225], v[80:81], v[156:157] op_sel_hi:[1,0,1] neg_lo:[0,1,0] neg_hi:[0,1,0]
    v_pk_fma_f32 v[158:159], v[226:227], v[80:81], v[158:159] op_sel_hi:[1,0,1] neg_lo:[0,1,0] neg_hi:[0,1,0]
    v_pk_fma_f32 v[160:161], v[228:229], v[80:81], v[160:161] op_sel_hi:[1,0,1] neg_lo:[0,1,0] neg_hi:[0,1,0]
    v_pk_fma_f32 v[162:163], v[230:231], v[80:81], v[162:163] op_sel_hi:[1,0,1] neg_lo:[0,1,0] neg_hi:[0,1,0]
    v_pk_fma_f32 v[164:165], v[232:233], v[80:81], v[164:165] op_sel_hi:[1,0,1] neg_lo:[0,1,0] neg_hi:[0,1,0]
    v_pk_fma_f32 v[166:167], v[234:235], v[80:81], v[166:167] op_sel_hi:[1,0,1] neg_lo:[0,1,0] neg_hi:[0,1,0]
    v_pk_fma_f32 v[168:169], v[236:237], v[80:81], v[168:169] op_sel_hi:[1,0,1] neg_lo:[0,1,0] neg_hi:[0,1,0]
    v_pk_fma_f32 v[170:171], v[238:239], v[80:81], v[170:171] op_sel_hi:[1,0,1] neg_lo:[0,1,0] neg_hi:[0,1,0]
    v_pk_mul_f32 v[208:209], v[156:157], v[156:157]
    v_pk_mul_f32 v[210:211], v[158:159], v[158:159]
    v_pk_mul_f32 v[212:213], v[160:161], v[160:161]
    v_pk_mul_f32 v[214:215], v[162:163], v[162:163]
    v_pk_fma_f32 v[208:209], v[208:209], v[82:83], v[80:81] op_sel:[0,0,1] op_sel_hi:[1,0,1]
    v_pk_fma_f32 v[210:211], v[210:211], v[82:83], v[80:81] op_sel:[0,0,1] op_sel_hi:[1,0,1]
    v_pk_fma_f32 v[212:213], v[212:213], v[82:83], v[80:81] op_sel:[0,0,1] op_sel_hi:[1,0,1]
    v_pk_fma_f32 v[214:215], v[214:215], v[82:83], v[80:81] op_sel:[0,0,1] op_sel_hi:[1,0,1]
    v_pk_mul_f32 v[208:209], v[208:209], v[156:157]
    v_pk_mul_f32 v[210:211], v[210:211], v[158:159]
    v_pk_mul_f32 v[212:213], v[212:213], v[160:161]
    v_pk_mul_f32 v[214:215], v[214:215], v[162:163]
    v_exp_f32 v208, v208
    v_exp_f32 v209, v209
    v_exp_f32 v210, v210
    v_exp_f32 v211, v211
    v_exp_f32 v212, v212
    v_exp_f32 v213, v213
    v_exp_f32 v214, v214
    v_exp_f32 v215, v215
    v_pk_mul_f32 v[156:157], v[156:157], v[164:165]
    v_pk_mul_f32 v[158:159], v[158:159], v[166:167]
    v_pk_mul_f32 v[160:161], v[160:161], v[168:169]
    v_pk_mul_f32 v[162:163], v[162:163], v[170:171]
    v_pk_fma_f32 v[208:209], v[208:209], v[82:83], v[82:83] op_sel:[0,1,1] op_sel_hi:[1,1,1]
    v_pk_fma_f32 v[210:211], v[210:211], v[82:83], v[82:83] op_sel:[0,1,1] op_sel_hi:[1,1,1]
    v_pk_fma_f32 v[212:213], v[212:213], v[82:83], v[82:83] op_sel:[0,1,1] op_sel_hi:[1,1,1]
    v_pk_fma_f32 v[214:215], v[214:215], v[82:83], v[82:83] op_sel:[0,1,1] op_sel_hi:[1,1,1]
    v_rcp_f32 v208, v208
    v_rcp_f32 v209, v209
    v_rcp_f32 v210, v210
    v_rcp_f32 v211, v211
    v_rcp_f32 v212, v212
    v_rcp_f32 v213, v213
    v_rcp_f32 v214, v214
    v_rcp_f32 v215, v215
    s_add_u32 s41, s41, s47
    v_pk_mul_f32 v[156:157], v[156:157], v[208:209]
    v_pk_mul_f32 v[158:159], v[158:159], v[210:211]
    v_pk_mul_f32 v[160:161], v[160:161], v[212:213]
    v_pk_mul_f32 v[162:163], v[162:163], v[214:215]
    v_cvt_pk_bf16_f32 v240, v156, v157
    v_cvt_pk_bf16_f32 v241, v158, v159
    v_cvt_pk_bf16_f32 v242, v160, v161
    v_cvt_pk_bf16_f32 v243, v162, v163
    buffer_store_dwordx4 v[240:243], v218, s[12:15], s41 offen sc1
    s_waitcnt lgkmcnt(0)
    ds_read_b128 v[80:83], v223 offset:1536
    v_pk_fma_f32 v[172:173], v[224:225], v[84:85], v[172:173] op_sel_hi:[1,0,1] neg_lo:[0,1,0] neg_hi:[0,1,0]
    v_pk_fma_f32 v[174:175], v[226:227], v[84:85], v[174:175] op_sel_hi:[1,0,1] neg_lo:[0,1,0] neg_hi:[0,1,0]
    v_pk_fma_f32 v[176:177], v[228:229], v[84:85], v[176:177] op_sel_hi:[1,0,1] neg_lo:[0,1,0] neg_hi:[0,1,0]
    v_pk_fma_f32 v[178:179], v[230:231], v[84:85], v[178:179] op_sel_hi:[1,0,1] neg_lo:[0,1,0] neg_hi:[0,1,0]
    v_pk_fma_f32 v[180:181], v[232:233], v[84:85], v[180:181] op_sel_hi:[1,0,1] neg_lo:[0,1,0] neg_hi:[0,1,0]
    v_pk_fma_f32 v[182:183], v[234:235], v[84:85], v[182:183] op_sel_hi:[1,0,1] neg_lo:[0,1,0] neg_hi:[0,1,0]
    v_pk_fma_f32 v[184:185], v[236:237], v[84:85], v[184:185] op_sel_hi:[1,0,1] neg_lo:[0,1,0] neg_hi:[0,1,0]
    v_pk_fma_f32 v[186:187], v[238:239], v[84:85], v[186:187] op_sel_hi:[1,0,1] neg_lo:[0,1,0] neg_hi:[0,1,0]
    v_pk_mul_f32 v[208:209], v[172:173], v[172:173]
    v_pk_mul_f32 v[210:211], v[174:175], v[174:175]
    v_pk_mul_f32 v[212:213], v[176:177], v[176:177]
    v_pk_mul_f32 v[214:215], v[178:179], v[178:179]
    v_pk_fma_f32 v[208:209], v[208:209], v[86:87], v[84:85] op_sel:[0,0,1] op_sel_hi:[1,0,1]
    v_pk_fma_f32 v[210:211], v[210:211], v[86:87], v[84:85] op_sel:[0,0,1] op_sel_hi:[1,0,1]
    v_pk_fma_f32 v[212:213], v[212:213], v[86:87], v[84:85] op_sel:[0,0,1] op_sel_hi:[1,0,1]
    v_pk_fma_f32 v[214:215], v[214:215], v[86:87], v[84:85] op_sel:[0,0,1] op_sel_hi:[1,0,1]
    v_pk_mul_f32 v[208:209], v[208:209], v[172:173]
    v_pk_mul_f32 v[210:211], v[210:211], v[174:175]
    v_pk_mul_f32 v[212:213], v[212:213], v[176:177]
    v_pk_mul_f32 v[214:215], v[214:215], v[178:179]
    v_exp_f32 v208, v208
    v_exp_f32 v209, v209
    v_exp_f32 v210, v210
    v_exp_f32 v211, v211
    v_exp_f32 v212, v212
    v_exp_f32 v213, v213
    v_exp_f32 v214, v214
    v_exp_f32 v215, v215
    v_pk_mul_f32 v[172:173], v[172:173], v[180:181]
    v_pk_mul_f32 v[174:175], v[174:175], v[182:183]
    v_pk_mul_f32 v[176:177], v[176:177], v[184:185]
    v_pk_mul_f32 v[178:179], v[178:179], v[186:187]
    v_pk_fma_f32 v[208:209], v[208:209], v[86:87], v[86:87] op_sel:[0,1,1] op_sel_hi:[1,1,1]
    v_pk_fma_f32 v[210:211], v[210:211], v[86:87], v[86:87] op_sel:[0,1,1] op_sel_hi:[1,1,1]
    v_pk_fma_f32 v[212:213], v[212:213], v[86:87], v[86:87] op_sel:[0,1,1] op_sel_hi:[1,1,1]
    v_pk_fma_f32 v[214:215], v[214:215], v[86:87], v[86:87] op_sel:[0,1,1] op_sel_hi:[1,1,1]
    v_rcp_f32 v208, v208
    v_rcp_f32 v209, v209
    v_rcp_f32 v210, v210
    v_rcp_f32 v211, v211
    v_rcp_f32 v212, v212
    v_rcp_f32 v213, v213
    v_rcp_f32 v214, v214
    v_rcp_f32 v215, v215
    s_add_u32 s41, s41, s46
    v_pk_mul_f32 v[172:173], v[172:173], v[208:209]
    v_pk_mul_f32 v[174:175], v[174:175], v[210:211]
    v_pk_mul_f32 v[176:177], v[176:177], v[212:213]
    v_pk_mul_f32 v[178:179], v[178:179], v[214:215]
    v_cvt_pk_bf16_f32 v244, v172, v173
    v_cvt_pk_bf16_f32 v245, v174, v175
    v_cvt_pk_bf16_f32 v246, v176, v177
    v_cvt_pk_bf16_f32 v247, v178, v179
    buffer_store_dwordx4 v[244:247], v219, s[12:15], s41 offen sc1
    s_waitcnt lgkmcnt(0)
    ds_read_b128 v[84:87], v223 offset:1792
    v_pk_fma_f32 v[188:189], v[224:225], v[80:81], v[188:189] op_sel_hi:[1,0,1] neg_lo:[0,1,0] neg_hi:[0,1,0]
    v_pk_fma_f32 v[190:191], v[226:227], v[80:81], v[190:191] op_sel_hi:[1,0,1] neg_lo:[0,1,0] neg_hi:[0,1,0]
    v_pk_fma_f32 v[192:193], v[228:229], v[80:81], v[192:193] op_sel_hi:[1,0,1] neg_lo:[0,1,0] neg_hi:[0,1,0]
    v_pk_fma_f32 v[194:195], v[230:231], v[80:81], v[194:195] op_sel_hi:[1,0,1] neg_lo:[0,1,0] neg_hi:[0,1,0]
    v_pk_fma_f32 v[196:197], v[232:233], v[80:81], v[196:197] op_sel_hi:[1,0,1] neg_lo:[0,1,0] neg_hi:[0,1,0]
    v_pk_fma_f32 v[198:199], v[234:235], v[80:81], v[198:199] op_sel_hi:[1,0,1] neg_lo:[0,1,0] neg_hi:[0,1,0]
    v_pk_fma_f32 v[200:201], v[236:237], v[80:81], v[200:201] op_sel_hi:[1,0,1] neg_lo:[0,1,0] neg_hi:[0,1,0]
    v_pk_fma_f32 v[202:203], v[238:239], v[80:81], v[202:203] op_sel_hi:[1,0,1] neg_lo:[0,1,0] neg_hi:[0,1,0]
    v_pk_mul_f32 v[208:209], v[188:189], v[188:189]
    v_pk_mul_f32 v[210:211], v[190:191], v[190:191]
    v_pk_mul_f32 v[212:213], v[192:193], v[192:193]
    v_pk_mul_f32 v[214:215], v[194:195], v[194:195]
    v_pk_fma_f32 v[208:209], v[208:209], v[82:83], v[80:81] op_sel:[0,0,1] op_sel_hi:[1,0,1]
    v_pk_fma_f32 v[210:211], v[210:211], v[82:83], v[80:81] op_sel:[0,0,1] op_sel_hi:[1,0,1]
    v_pk_fma_f32 v[212:213], v[212:213], v[82:83], v[80:81] op_sel:[0,0,1] op_sel_hi:[1,0,1]
    v_pk_fma_f32 v[214:215], v[214:215], v[82:83], v[80:81] op_sel:[0,0,1] op_sel_hi:[1,0,1]
    v_pk_mul_f32 v[208:209], v[208:209], v[188:189]
    v_pk_mul_f32 v[210:211], v[210:211], v[190:191]
    v_pk_mul_f32 v[212:213], v[212:213], v[192:193]
    v_pk_mul_f32 v[214:215], v[214:215], v[194:195]
    v_exp_f32 v208, v208
    v_exp_f32 v209, v209
    v_exp_f32 v210, v210
    v_exp_f32 v211, v211
    v_exp_f32 v212, v212
    v_exp_f32 v213, v213
    v_exp_f32 v214, v214
    v_exp_f32 v215, v215
    v_pk_mul_f32 v[188:189], v[188:189], v[196:197]
    v_pk_mul_f32 v[190:191], v[190:191], v[198:199]
    v_pk_mul_f32 v[192:193], v[192:193], v[200:201]
    v_pk_mul_f32 v[194:195], v[194:195], v[202:203]
    v_pk_fma_f32 v[208:209], v[208:209], v[82:83], v[82:83] op_sel:[0,1,1] op_sel_hi:[1,1,1]
    v_pk_fma_f32 v[210:211], v[210:211], v[82:83], v[82:83] op_sel:[0,1,1] op_sel_hi:[1,1,1]
    v_pk_fma_f32 v[212:213], v[212:213], v[82:83], v[82:83] op_sel:[0,1,1] op_sel_hi:[1,1,1]
    v_pk_fma_f32 v[214:215], v[214:215], v[82:83], v[82:83] op_sel:[0,1,1] op_sel_hi:[1,1,1]
    v_rcp_f32 v208, v208
    v_rcp_f32 v209, v209
    v_rcp_f32 v210, v210
    v_rcp_f32 v211, v211
    v_rcp_f32 v212, v212
    v_rcp_f32 v213, v213
    v_rcp_f32 v214, v214
    v_rcp_f32 v215, v215
    s_add_u32 s41, s41, s47
    v_pk_mul_f32 v[188:189], v[188:189], v[208:209]
    v_pk_mul_f32 v[190:191], v[190:191], v[210:211]
    v_pk_mul_f32 v[192:193], v[192:193], v[212:213]
    v_pk_mul_f32 v[194:195], v[194:195], v[214:215]
    v_cvt_pk_bf16_f32 v240, v188, v189
    v_cvt_pk_bf16_f32 v241, v190, v191
    v_cvt_pk_bf16_f32 v242, v192, v193
    v_cvt_pk_bf16_f32 v243, v194, v195
    buffer_store_dwordx4 v[240:243], v218, s[12:15], s41 offen sc1
    s_waitcnt lgkmcnt(0)
    ds_read_b128 v[80:83], v223 offset:2048
    v_pk_fma_f32 v[0:1], v[224:225], v[84:85], v[0:1] op_sel_hi:[1,0,1] neg_lo:[0,1,0] neg_hi:[0,1,0]
    v_pk_fma_f32 v[2:3], v[226:227], v[84:85], v[2:3] op_sel_hi:[1,0,1] neg_lo:[0,1,0] neg_hi:[0,1,0]
    v_pk_fma_f32 v[4:5], v[228:229], v[84:85], v[4:5] op_sel_hi:[1,0,1] neg_lo:[0,1,0] neg_hi:[0,1,0]
    v_pk_fma_f32 v[6:7], v[230:231], v[84:85], v[6:7] op_sel_hi:[1,0,1] neg_lo:[0,1,0] neg_hi:[0,1,0]
    v_pk_fma_f32 v[8:9], v[232:233], v[84:85], v[8:9] op_sel_hi:[1,0,1] neg_lo:[0,1,0] neg_hi:[0,1,0]
    v_pk_fma_f32 v[10:11], v[234:235], v[84:85], v[10:11] op_sel_hi:[1,0,1] neg_lo:[0,1,0] neg_hi:[0,1,0]
    v_pk_fma_f32 v[12:13], v[236:237], v[84:85], v[12:13] op_sel_hi:[1,0,1] neg_lo:[0,1,0] neg_hi:[0,1,0]
    v_pk_fma_f32 v[14:15], v[238:239], v[84:85], v[14:15] op_sel_hi:[1,0,1] neg_lo:[0,1,0] neg_hi:[0,1,0]
    v_pk_mul_f32 v[208:209], v[0:1], v[0:1]
    v_pk_mul_f32 v[210:211], v[2:3], v[2:3]
    v_pk_mul_f32 v[212:213], v[4:5], v[4:5]
    v_pk_mul_f32 v[214:215], v[6:7], v[6:7]
    v_pk_fma_f32 v[208:209], v[208:209], v[86:87], v[84:85] op_sel:[0,0,1] op_sel_hi:[1,0,1]
    v_pk_fma_f32 v[210:211], v[210:211], v[86:87], v[84:85] op_sel:[0,0,1] op_sel_hi:[1,0,1]
    v_pk_fma_f32 v[212:213], v[212:213], v[86:87], v[84:85] op_sel:[0,0,1] op_sel_hi:[1,0,1]
    v_pk_fma_f32 v[214:215], v[214:215], v[86:87], v[84:85] op_sel:[0,0,1] op_sel_hi:[1,0,1]
    v_pk_mul_f32 v[208:209], v[208:209], v[0:1]
    v_pk_mul_f32 v[210:211], v[210:211], v[2:3]
    v_pk_mul_f32 v[212:213], v[212:213], v[4:5]
    v_pk_mul_f32 v[214:215], v[214:215], v[6:7]
    v_exp_f32 v208, v208
    v_exp_f32 v209, v209
    v_exp_f32 v210, v210
    v_exp_f32 v211, v211
    v_exp_f32 v212, v212
    v_exp_f32 v213, v213
    v_exp_f32 v214, v214
    v_exp_f32 v215, v215
    v_pk_mul_f32 v[0:1], v[0:1], v[8:9]
    v_pk_mul_f32 v[2:3], v[2:3], v[10:11]
    v_pk_mul_f32 v[4:5], v[4:5], v[12:13]
    v_pk_mul_f32 v[6:7], v[6:7], v[14:15]
    v_pk_fma_f32 v[208:209], v[208:209], v[86:87], v[86:87] op_sel:[0,1,1] op_sel_hi:[1,1,1]
    v_pk_fma_f32 v[210:211], v[210:211], v[86:87], v[86:87] op_sel:[0,1,1] op_sel_hi:[1,1,1]
    v_pk_fma_f32 v[212:213], v[212:213], v[86:87], v[86:87] op_sel:[0,1,1] op_sel_hi:[1,1,1]
    v_pk_fma_f32 v[214:215], v[214:215], v[86:87], v[86:87] op_sel:[0,1,1] op_sel_hi:[1,1,1]
    v_rcp_f32 v208, v208
    v_rcp_f32 v209, v209
    v_rcp_f32 v210, v210
    v_rcp_f32 v211, v211
    v_rcp_f32 v212, v212
    v_rcp_f32 v213, v213
    v_rcp_f32 v214, v214
    v_rcp_f32 v215, v215
    s_add_u32 s41, s41, s46
    v_pk_mul_f32 v[0:1], v[0:1], v[208:209]
    v_pk_mul_f32 v[2:3], v[2:3], v[210:211]
    v_pk_mul_f32 v[4:5], v[4:5], v[212:213]
    v_pk_mul_f32 v[6:7], v[6:7], v[214:215]
    v_cvt_pk_bf16_f32 v244, v0, v1
    v_cvt_pk_bf16_f32 v245, v2, v3
    v_cvt_pk_bf16_f32 v246, v4, v5
    v_cvt_pk_bf16_f32 v247, v6, v7
    buffer_store_dwordx4 v[244:247], v219, s[12:15], s41 offen sc1
    s_waitcnt lgkmcnt(0)
    ds_read_b128 v[84:87], v223 offset:2304
    v_pk_fma_f32 v[16:17], v[224:225], v[80:81], v[16:17] op_sel_hi:[1,0,1] neg_lo:[0,1,0] neg_hi:[0,1,0]
    v_pk_fma_f32 v[18:19], v[226:227], v[80:81], v[18:19] op_sel_hi:[1,0,1] neg_lo:[0,1,0] neg_hi:[0,1,0]
    v_pk_fma_f32 v[20:21], v[228:229], v[80:81], v[20:21] op_sel_hi:[1,0,1] neg_lo:[0,1,0] neg_hi:[0,1,0]
    v_pk_fma_f32 v[22:23], v[230:231], v[80:81], v[22:23] op_sel_hi:[1,0,1] neg_lo:[0,1,0] neg_hi:[0,1,0]
    v_pk_fma_f32 v[24:25], v[232:233], v[80:81], v[24:25] op_sel_hi:[1,0,1] neg_lo:[0,1,0] neg_hi:[0,1,0]
    v_pk_fma_f32 v[26:27], v[234:235], v[80:81], v[26:27] op_sel_hi:[1,0,1] neg_lo:[0,1,0] neg_hi:[0,1,0]
    v_pk_fma_f32 v[28:29], v[236:237], v[80:81], v[28:29] op_sel_hi:[1,0,1] neg_lo:[0,1,0] neg_hi:[0,1,0]
    v_pk_fma_f32 v[30:31], v[238:239], v[80:81], v[30:31] op_sel_hi:[1,0,1] neg_lo:[0,1,0] neg_hi:[0,1,0]
    v_pk_mul_f32 v[208:209], v[16:17], v[16:17]
    v_pk_mul_f32 v[210:211], v[18:19], v[18:19]
    v_pk_mul_f32 v[212:213], v[20:21], v[20:21]
    v_pk_mul_f32 v[214:215], v[22:23], v[22:23]
    v_pk_fma_f32 v[208:209], v[208:209], v[82:83], v[80:81] op_sel:[0,0,1] op_sel_hi:[1,0,1]
    v_pk_fma_f32 v[210:211], v[210:211], v[82:83], v[80:81] op_sel:[0,0,1] op_sel_hi:[1,0,1]
    v_pk_fma_f32 v[212:213], v[212:213], v[82:83], v[80:81] op_sel:[0,0,1] op_sel_hi:[1,0,1]
    v_pk_fma_f32 v[214:215], v[214:215], v[82:83], v[80:81] op_sel:[0,0,1] op_sel_hi:[1,0,1]
    v_pk_mul_f32 v[208:209], v[208:209], v[16:17]
    v_pk_mul_f32 v[210:211], v[210:211], v[18:19]
    v_pk_mul_f32 v[212:213], v[212:213], v[20:21]
    v_pk_mul_f32 v[214:215], v[214:215], v[22:23]
    v_exp_f32 v208, v208
    v_exp_f32 v209, v209
    v_exp_f32 v210, v210
    v_exp_f32 v211, v211
    v_exp_f32 v212, v212
    v_exp_f32 v213, v213
    v_exp_f32 v214, v214
    v_exp_f32 v215, v215
    v_pk_mul_f32 v[16:17], v[16:17], v[24:25]
    v_pk_mul_f32 v[18:19], v[18:19], v[26:27]
    v_pk_mul_f32 v[20:21], v[20:21], v[28:29]
    v_pk_mul_f32 v[22:23], v[22:23], v[30:31]
    v_pk_fma_f32 v[208:209], v[208:209], v[82:83], v[82:83] op_sel:[0,1,1] op_sel_hi:[1,1,1]
    v_pk_fma_f32 v[210:211], v[210:211], v[82:83], v[82:83] op_sel:[0,1,1] op_sel_hi:[1,1,1]
    v_pk_fma_f32 v[212:213], v[212:213], v[82:83], v[82:83] op_sel:[0,1,1] op_sel_hi:[1,1,1]
    v_pk_fma_f32 v[214:215], v[214:215], v[82:83], v[82:83] op_sel:[0,1,1] op_sel_hi:[1,1,1]
    v_rcp_f32 v208, v208
    v_rcp_f32 v209, v209
    v_rcp_f32 v210, v210
    v_rcp_f32 v211, v211
    v_rcp_f32 v212, v212
    v_rcp_f32 v213, v213
    v_rcp_f32 v214, v214
    v_rcp_f32 v215, v215
    s_add_u32 s41, s41, s47
    v_pk_mul_f32 v[16:17], v[16:17], v[208:209]
    v_pk_mul_f32 v[18:19], v[18:19], v[210:211]
    v_pk_mul_f32 v[20:21], v[20:21], v[212:213]
    v_pk_mul_f32 v[22:23], v[22:23], v[214:215]
    v_cvt_pk_bf16_f32 v240, v16, v17
    v_cvt_pk_bf16_f32 v241, v18, v19
    v_cvt_pk_bf16_f32 v242, v20, v21
    v_cvt_pk_bf16_f32 v243, v22, v23
    buffer_store_dwordx4 v[240:243], v218, s[12:15], s41 offen sc1
    s_waitcnt lgkmcnt(0)
    ds_read_b128 v[80:83], v223 offset:2560
    s_waitcnt vmcnt(9)
    ds_read_b64_tr_b16 a[64:65], v204 offset:32
    ds_read_b64_tr_b16 a[66:67], v204 offset:0
    ds_read_b64_tr_b16 a[0:1], v205 offset:0
    ds_read_b64_tr_b16 a[2:3], v205 offset:32
    ds_read_b64_tr_b16 a[128:129], v205 offset:128
    ds_read_b64_tr_b16 a[130:131], v205 offset:160
    ds_read_b64_tr_b16 a[68:69], v204 offset:288
    ds_read_b64_tr_b16 a[70:71], v204 offset:256
    v_pk_fma_f32 v[32:33], v[224:225], v[84:85], v[32:33] op_sel_hi:[1,0,1] neg_lo:[0,1,0] neg_hi:[0,1,0]
    v_pk_fma_f32 v[34:35], v[226:227], v[84:85], v[34:35] op_sel_hi:[1,0,1] neg_lo:[0,1,0] neg_hi:[0,1,0]
    v_pk_fma_f32 v[36:37], v[228:229], v[84:85], v[36:37] op_sel_hi:[1,0,1] neg_lo:[0,1,0] neg_hi:[0,1,0]
    v_pk_fma_f32 v[38:39], v[230:231], v[84:85], v[38:39] op_sel_hi:[1,0,1] neg_lo:[0,1,0] neg_hi:[0,1,0]
    v_pk_fma_f32 v[40:41], v[232:233], v[84:85], v[40:41] op_sel_hi:[1,0,1] neg_lo:[0,1,0] neg_hi:[0,1,0]
    v_pk_fma_f32 v[42:43], v[234:235], v[84:85], v[42:43] op_sel_hi:[1,0,1] neg_lo:[0,1,0] neg_hi:[0,1,0]
    v_pk_fma_f32 v[44:45], v[236:237], v[84:85], v[44:45] op_sel_hi:[1,0,1] neg_lo:[0,1,0] neg_hi:[0,1,0]
    v_pk_fma_f32 v[46:47], v[238:239], v[84:85], v[46:47] op_sel_hi:[1,0,1] neg_lo:[0,1,0] neg_hi:[0,1,0]
    v_pk_mul_f32 v[208:209], v[32:33], v[32:33]
    v_pk_mul_f32 v[210:211], v[34:35], v[34:35]
    v_pk_mul_f32 v[212:213], v[36:37], v[36:37]
    v_pk_mul_f32 v[214:215], v[38:39], v[38:39]
    v_pk_fma_f32 v[208:209], v[208:209], v[86:87], v[84:85] op_sel:[0,0,1] op_sel_hi:[1,0,1]
    v_pk_fma_f32 v[210:211], v[210:211], v[86:87], v[84:85] op_sel:[0,0,1] op_sel_hi:[1,0,1]
    v_pk_fma_f32 v[212:213], v[212:213], v[86:87], v[84:85] op_sel:[0,0,1] op_sel_hi:[1,0,1]
    v_pk_fma_f32 v[214:215], v[214:215], v[86:87], v[84:85] op_sel:[0,0,1] op_sel_hi:[1,0,1]
    v_pk_mul_f32 v[208:209], v[208:209], v[32:33]
    v_pk_mul_f32 v[210:211], v[210:211], v[34:35]
    v_pk_mul_f32 v[212:213], v[212:213], v[36:37]
    v_pk_mul_f32 v[214:215], v[214:215], v[38:39]
    v_exp_f32 v208, v208
    v_exp_f32 v209, v209
    v_exp_f32 v210, v210
    v_exp_f32 v211, v211
    v_exp_f32 v212, v212
    v_exp_f32 v213, v213
    v_exp_f32 v214, v214
    v_exp_f32 v215, v215
    v_pk_mul_f32 v[32:33], v[32:33], v[40:41]
    v_pk_mul_f32 v[34:35], v[34:35], v[42:43]
    v_pk_mul_f32 v[36:37], v[36:37], v[44:45]
    v_pk_mul_f32 v[38:39], v[38:39], v[46:47]
    v_pk_fma_f32 v[208:209], v[208:209], v[86:87], v[86:87] op_sel:[0,1,1] op_sel_hi:[1,1,1]
    v_pk_fma_f32 v[210:211], v[210:211], v[86:87], v[86:87] op_sel:[0,1,1] op_sel_hi:[1,1,1]
    v_pk_fma_f32 v[212:213], v[212:213], v[86:87], v[86:87] op_sel:[0,1,1] op_sel_hi:[1,1,1]
    v_pk_fma_f32 v[214:215], v[214:215], v[86:87], v[86:87] op_sel:[0,1,1] op_sel_hi:[1,1,1]
    v_rcp_f32 v208, v208
    v_rcp_f32 v209, v209
    v_rcp_f32 v210, v210
    v_rcp_f32 v211, v211
    v_rcp_f32 v212, v212
    v_rcp_f32 v213, v213
    v_rcp_f32 v214, v214
    v_rcp_f32 v215, v215
    s_add_u32 s41, s41, s46
    v_pk_mul_f32 v[32:33], v[32:33], v[208:209]
    v_pk_mul_f32 v[34:35], v[34:35], v[210:211]
    v_pk_mul_f32 v[36:37], v[36:37], v[212:213]
    v_pk_mul_f32 v[38:39], v[38:39], v[214:215]
    v_cvt_pk_bf16_f32 v244, v32, v33
    v_cvt_pk_bf16_f32 v245, v34, v35
    v_cvt_pk_bf16_f32 v246, v36, v37
    v_cvt_pk_bf16_f32 v247, v38, v39
    buffer_store_dwordx4 v[244:247], v219, s[12:15], s41 offen sc1
    s_waitcnt lgkmcnt(0)
    ds_read_b128 v[84:87], v223 offset:2816
    ds_read_b64_tr_b16 a[4:5], v205 offset:256
    ds_read_b64_tr_b16 a[6:7], v205 offset:288
    ds_read_b64_tr_b16 a[132:133], v205 offset:384
    ds_read_b64_tr_b16 a[134:135], v205 offset:416
    ds_read_b64_tr_b16 a[72:73], v204 offset:544
    ds_read_b64_tr_b16 a[74:75], v204 offset:512
    ds_read_b64_tr_b16 a[8:9], v205 offset:512
    ds_read_b64_tr_b16 a[10:11], v205 offset:544
    v_pk_fma_f32 v[48:49], v[224:225], v[80:81], v[48:49] op_sel_hi:[1,0,1] neg_lo:[0,1,0] neg_hi:[0,1,0]
    v_pk_fma_f32 v[50:51], v[226:227], v[80:81], v[50:51] op_sel_hi:[1,0,1] neg_lo:[0,1,0] neg_hi:[0,1,0]
    v_pk_fma_f32 v[52:53], v[228:229], v[80:81], v[52:53] op_sel_hi:[1,0,1] neg_lo:[0,1,0] neg_hi:[0,1,0]
    v_pk_fma_f32 v[54:55], v[230:231], v[80:81], v[54:55] op_sel_hi:[1,0,1] neg_lo:[0,1,0] neg_hi:[0,1,0]
    v_pk_fma_f32 v[56:57], v[232:233], v[80:81], v[56:57] op_sel_hi:[1,0,1] neg_lo:[0,1,0] neg_hi:[0,1,0]
    v_pk_fma_f32 v[58:59], v[234:235], v[80:81], v[58:59] op_sel_hi:[1,0,1] neg_lo:[0,1,0] neg_hi:[0,1,0]
    v_pk_fma_f32 v[60:61], v[236:237], v[80:81], v[60:61] op_sel_hi:[1,0,1] neg_lo:[0,1,0] neg_hi:[0,1,0]
    v_pk_fma_f32 v[62:63], v[238:239], v[80:81], v[62:63] op_sel_hi:[1,0,1] neg_lo:[0,1,0] neg_hi:[0,1,0]
    v_pk_mul_f32 v[208:209], v[48:49], v[48:49]
    v_pk_mul_f32 v[210:211], v[50:51], v[50:51]
    v_pk_mul_f32 v[212:213], v[52:53], v[52:53]
    v_pk_mul_f32 v[214:215], v[54:55], v[54:55]
    v_pk_fma_f32 v[208:209], v[208:209], v[82:83], v[80:81] op_sel:[0,0,1] op_sel_hi:[1,0,1]
    v_pk_fma_f32 v[210:211], v[210:211], v[82:83], v[80:81] op_sel:[0,0,1] op_sel_hi:[1,0,1]
    v_pk_fma_f32 v[212:213], v[212:213], v[82:83], v[80:81] op_sel:[0,0,1] op_sel_hi:[1,0,1]
    v_pk_fma_f32 v[214:215], v[214:215], v[82:83], v[80:81] op_sel:[0,0,1] op_sel_hi:[1,0,1]
    v_pk_mul_f32 v[208:209], v[208:209], v[48:49]
    v_pk_mul_f32 v[210:211], v[210:211], v[50:51]
    v_pk_mul_f32 v[212:213], v[212:213], v[52:53]
    v_pk_mul_f32 v[214:215], v[214:215], v[54:55]
    v_exp_f32 v208, v208
    v_exp_f32 v209, v209
    v_exp_f32 v210, v210
    v_exp_f32 v211, v211
    v_exp_f32 v212, v212
    v_exp_f32 v213, v213
    v_exp_f32 v214, v214
    v_exp_f32 v215, v215
    v_pk_mul_f32 v[48:49], v[48:49], v[56:57]
    v_pk_mul_f32 v[50:51], v[50:51], v[58:59]
    v_pk_mul_f32 v[52:53], v[52:53], v[60:61]
    v_pk_mul_f32 v[54:55], v[54:55], v[62:63]
    v_pk_fma_f32 v[208:209], v[208:209], v[82:83], v[82:83] op_sel:[0,1,1] op_sel_hi:[1,1,1]
    v_pk_fma_f32 v[210:211], v[210:211], v[82:83], v[82:83] op_sel:[0,1,1] op_sel_hi:[1,1,1]
    v_pk_fma_f32 v[212:213], v[212:213], v[82:83], v[82:83] op_sel:[0,1,1] op_sel_hi:[1,1,1]
    v_pk_fma_f32 v[214:215], v[214:215], v[82:83], v[82:83] op_sel:[0,1,1] op_sel_hi:[1,1,1]
    v_rcp_f32 v208, v208
    v_rcp_f32 v209, v209
    v_rcp_f32 v210, v210
    v_rcp_f32 v211, v211
    v_rcp_f32 v212, v212
    v_rcp_f32 v213, v213
    v_rcp_f32 v214, v214
    v_rcp_f32 v215, v215
    s_add_u32 s41, s41, s47
    v_pk_mul_f32 v[48:49], v[48:49], v[208:209]
    v_pk_mul_f32 v[50:51], v[50:51], v[210:211]
    v_pk_mul_f32 v[52:53], v[52:53], v[212:213]
    v_pk_mul_f32 v[54:55], v[54:55], v[214:215]
    v_cvt_pk_bf16_f32 v240, v48, v49
    v_cvt_pk_bf16_f32 v241, v50, v51
    v_cvt_pk_bf16_f32 v242, v52, v53
    v_cvt_pk_bf16_f32 v243, v54, v55
    buffer_store_dwordx4 v[240:243], v218, s[12:15], s41 offen sc1
    s_waitcnt lgkmcnt(0)
    ds_read_b128 v[80:83], v223 offset:3072
    ds_read_b64_tr_b16 a[136:137], v205 offset:640
    ds_read_b64_tr_b16 a[138:139], v205 offset:672
    ds_read_b64_tr_b16 a[76:77], v204 offset:800
    ds_read_b64_tr_b16 a[78:79], v204 offset:768
    ds_read_b64_tr_b16 a[12:13], v205 offset:768
    ds_read_b64_tr_b16 a[14:15], v205 offset:800
    ds_read_b64_tr_b16 a[140:141], v205 offset:896
    ds_read_b64_tr_b16 a[142:143], v205 offset:928
    v_pk_fma_f32 v[64:65], v[224:225], v[84:85], v[64:65] op_sel_hi:[1,0,1] neg_lo:[0,1,0] neg_hi:[0,1,0]
    v_pk_fma_f32 v[66:67], v[226:227], v[84:85], v[66:67] op_sel_hi:[1,0,1] neg_lo:[0,1,0] neg_hi:[0,1,0]
    v_pk_fma_f32 v[68:69], v[228:229], v[84:85], v[68:69] op_sel_hi:[1,0,1] neg_lo:[0,1,0] neg_hi:[0,1,0]
    v_pk_fma_f32 v[70:71], v[230:231], v[84:85], v[70:71] op_sel_hi:[1,0,1] neg_lo:[0,1,0] neg_hi:[0,1,0]
    v_pk_fma_f32 v[72:73], v[232:233], v[84:85], v[72:73] op_sel_hi:[1,0,1] neg_lo:[0,1,0] neg_hi:[0,1,0]
    v_pk_fma_f32 v[74:75], v[234:235], v[84:85], v[74:75] op_sel_hi:[1,0,1] neg_lo:[0,1,0] neg_hi:[0,1,0]
    v_pk_fma_f32 v[76:77], v[236:237], v[84:85], v[76:77] op_sel_hi:[1,0,1] neg_lo:[0,1,0] neg_hi:[0,1,0]
    v_pk_fma_f32 v[78:79], v[238:239], v[84:85], v[78:79] op_sel_hi:[1,0,1] neg_lo:[0,1,0] neg_hi:[0,1,0]
    v_pk_mul_f32 v[208:209], v[64:65], v[64:65]
    v_pk_mul_f32 v[210:211], v[66:67], v[66:67]
    v_pk_mul_f32 v[212:213], v[68:69], v[68:69]
    v_pk_mul_f32 v[214:215], v[70:71], v[70:71]
    v_pk_fma_f32 v[208:209], v[208:209], v[86:87], v[84:85] op_sel:[0,0,1] op_sel_hi:[1,0,1]
    v_pk_fma_f32 v[210:211], v[210:211], v[86:87], v[84:85] op_sel:[0,0,1] op_sel_hi:[1,0,1]
    v_pk_fma_f32 v[212:213], v[212:213], v[86:87], v[84:85] op_sel:[0,0,1] op_sel_hi:[1,0,1]
    v_pk_fma_f32 v[214:215], v[214:215], v[86:87], v[84:85] op_sel:[0,0,1] op_sel_hi:[1,0,1]
    v_pk_mul_f32 v[208:209], v[208:209], v[64:65]
    v_pk_mul_f32 v[210:211], v[210:211], v[66:67]
    v_pk_mul_f32 v[212:213], v[212:213], v[68:69]
    v_pk_mul_f32 v[214:215], v[214:215], v[70:71]
    v_exp_f32 v208, v208
    v_exp_f32 v209, v209
    v_exp_f32 v210, v210
    v_exp_f32 v211, v211
    v_exp_f32 v212, v212
    v_exp_f32 v213, v213
    v_exp_f32 v214, v214
    v_exp_f32 v215, v215
    v_pk_mul_f32 v[64:65], v[64:65], v[72:73]
    v_pk_mul_f32 v[66:67], v[66:67], v[74:75]
    v_pk_mul_f32 v[68:69], v[68:69], v[76:77]
    v_pk_mul_f32 v[70:71], v[70:71], v[78:79]
    v_pk_fma_f32 v[208:209], v[208:209], v[86:87], v[86:87] op_sel:[0,1,1] op_sel_hi:[1,1,1]
    v_pk_fma_f32 v[210:211], v[210:211], v[86:87], v[86:87] op_sel:[0,1,1] op_sel_hi:[1,1,1]
    v_pk_fma_f32 v[212:213], v[212:213], v[86:87], v[86:87] op_sel:[0,1,1] op_sel_hi:[1,1,1]
    v_pk_fma_f32 v[214:215], v[214:215], v[86:87], v[86:87] op_sel:[0,1,1] op_sel_hi:[1,1,1]
    v_rcp_f32 v208, v208
    v_rcp_f32 v209, v209
    v_rcp_f32 v210, v210
    v_rcp_f32 v211, v211
    v_rcp_f32 v212, v212
    v_rcp_f32 v213, v213
    v_rcp_f32 v214, v214
    v_rcp_f32 v215, v215
    s_add_u32 s41, s41, s46
    v_pk_mul_f32 v[64:65], v[64:65], v[208:209]
    v_pk_mul_f32 v[66:67], v[66:67], v[210:211]
    v_pk_mul_f32 v[68:69], v[68:69], v[212:213]
    v_pk_mul_f32 v[70:71], v[70:71], v[214:215]
    v_cvt_pk_bf16_f32 v244, v64, v65
    v_cvt_pk_bf16_f32 v245, v66, v67
    v_cvt_pk_bf16_f32 v246, v68, v69
    v_cvt_pk_bf16_f32 v247, v70, v71
    buffer_store_dwordx4 v[244:247], v219, s[12:15], s41 offen sc1
    v_accvgpr_read_b32 v92, a192
    v_accvgpr_read_b32 v93, a193
    v_accvgpr_read_b32 v94, a194
    v_accvgpr_read_b32 v95, a195
    v_accvgpr_read_b32 v96, a196
    v_accvgpr_read_b32 v97, a197
    v_accvgpr_read_b32 v98, a198
    v_accvgpr_read_b32 v99, a199
    v_accvgpr_read_b32 v100, a200
    v_accvgpr_read_b32 v101, a201
    v_accvgpr_read_b32 v102, a202
    v_accvgpr_read_b32 v103, a203
    v_accvgpr_read_b32 v104, a204
    v_accvgpr_read_b32 v105, a205
    v_accvgpr_read_b32 v106, a206
    v_accvgpr_read_b32 v107, a207
    s_waitcnt lgkmcnt(0)
    ds_read_b128 v[84:87], v223 offset:3328
    ds_read_b64_tr_b16 a[80:81], v204 offset:1056
    ds_read_b64_tr_b16 a[82:83], v204 offset:1024
    ds_read_b64_tr_b16 a[16:17], v205 offset:1024
    ds_read_b64_tr_b16 a[18:19], v205 offset:1056
    ds_read_b64_tr_b16 a[144:145], v205 offset:1152
    ds_read_b64_tr_b16 a[146:147], v205 offset:1184
    ds_read_b64_tr_b16 a[84:85], v204 offset:1312
    ds_read_b64_tr_b16 a[86:87], v204 offset:1280
    v_pk_fma_f32 v[92:93], v[224:225], v[80:81], v[92:93] op_sel_hi:[1,0,1] neg_lo:[0,1,0] neg_hi:[0,1,0]
    v_pk_fma_f32 v[94:95], v[226:227], v[80:81], v[94:95] op_sel_hi:[1,0,1] neg_lo:[0,1,0] neg_hi:[0,1,0]
    v_pk_fma_f32 v[96:97], v[228:229], v[80:81], v[96:97] op_sel_hi:[1,0,1] neg_lo:[0,1,0] neg_hi:[0,1,0]
    v_pk_fma_f32 v[98:99], v[230:231], v[80:81], v[98:99] op_sel_hi:[1,0,1] neg_lo:[0,1,0] neg_hi:[0,1,0]
    v_pk_fma_f32 v[100:101], v[232:233], v[80:81], v[100:101] op_sel_hi:[1,0,1] neg_lo:[0,1,0] neg_hi:[0,1,0]
    v_pk_fma_f32 v[102:103], v[234:235], v[80:81], v[102:103] op_sel_hi:[1,0,1] neg_lo:[0,1,0] neg_hi:[0,1,0]
    v_pk_fma_f32 v[104:105], v[236:237], v[80:81], v[104:105] op_sel_hi:[1,0,1] neg_lo:[0,1,0] neg_hi:[0,1,0]
    v_pk_fma_f32 v[106:107], v[238:239], v[80:81], v[106:107] op_sel_hi:[1,0,1] neg_lo:[0,1,0] neg_hi:[0,1,0]
    v_pk_mul_f32 v[208:209], v[92:93], v[92:93]
    v_pk_mul_f32 v[210:211], v[94:95], v[94:95]
    v_pk_mul_f32 v[212:213], v[96:97], v[96:97]
    v_pk_mul_f32 v[214:215], v[98:99], v[98:99]
    v_pk_fma_f32 v[208:209], v[208:209], v[82:83], v[80:81] op_sel:[0,0,1] op_sel_hi:[1,0,1]
    v_pk_fma_f32 v[210:211], v[210:211], v[82:83], v[80:81] op_sel:[0,0,1] op_sel_hi:[1,0,1]
    v_pk_fma_f32 v[212:213], v[212:213], v[82:83], v[80:81] op_sel:[0,0,1] op_sel_hi:[1,0,1]
    v_pk_fma_f32 v[214:215], v[214:215], v[82:83], v[80:81] op_sel:[0,0,1] op_sel_hi:[1,0,1]
    v_pk_mul_f32 v[208:209], v[208:209], v[92:93]
    v_pk_mul_f32 v[210:211], v[210:211], v[94:95]
    v_pk_mul_f32 v[212:213], v[212:213], v[96:97]
    v_pk_mul_f32 v[214:215], v[214:215], v[98:99]
    v_exp_f32 v208, v208
    v_exp_f32 v209, v209
    v_exp_f32 v210, v210
    v_exp_f32 v211, v211
    v_exp_f32 v212, v212
    v_exp_f32 v213, v213
    v_exp_f32 v214, v214
    v_exp_f32 v215, v215
    v_pk_mul_f32 v[92:93], v[92:93], v[100:101]
    v_pk_mul_f32 v[94:95], v[94:95], v[102:103]
    v_pk_mul_f32 v[96:97], v[96:97], v[104:105]
    v_pk_mul_f32 v[98:99], v[98:99], v[106:107]
    v_pk_fma_f32 v[208:209], v[208:209], v[82:83], v[82:83] op_sel:[0,1,1] op_sel_hi:[1,1,1]
    v_pk_fma_f32 v[210:211], v[210:211], v[82:83], v[82:83] op_sel:[0,1,1] op_sel_hi:[1,1,1]
    v_pk_fma_f32 v[212:213], v[212:213], v[82:83], v[82:83] op_sel:[0,1,1] op_sel_hi:[1,1,1]
    v_pk_fma_f32 v[214:215], v[214:215], v[82:83], v[82:83] op_sel:[0,1,1] op_sel_hi:[1,1,1]
    v_rcp_f32 v208, v208
    v_rcp_f32 v209, v209
    v_rcp_f32 v210, v210
    v_rcp_f32 v211, v211
    v_rcp_f32 v212, v212
    v_rcp_f32 v213, v213
    v_rcp_f32 v214, v214
    v_rcp_f32 v215, v215
    s_add_u32 s41, s41, s47
    v_pk_mul_f32 v[92:93], v[92:93], v[208:209]
    v_pk_mul_f32 v[94:95], v[94:95], v[210:211]
    v_pk_mul_f32 v[96:97], v[96:97], v[212:213]
    v_pk_mul_f32 v[98:99], v[98:99], v[214:215]
    v_cvt_pk_bf16_f32 v240, v92, v93
    v_cvt_pk_bf16_f32 v241, v94, v95
    v_cvt_pk_bf16_f32 v242, v96, v97
    v_cvt_pk_bf16_f32 v243, v98, v99
    buffer_store_dwordx4 v[240:243], v218, s[12:15], s41 offen sc1
    v_accvgpr_read_b32 v92, a208
    v_accvgpr_read_b32 v93, a209
    v_accvgpr_read_b32 v94, a210
    v_accvgpr_read_b32 v95, a211
    v_accvgpr_read_b32 v96, a212
    v_accvgpr_read_b32 v97, a213
    v_accvgpr_read_b32 v98, a214
    v_accvgpr_read_b32 v99, a215
L_k_w8:
    s_cbranch_execz L_k_w12
    v_accvgpr_read_b32 v100, a216
    v_accvgpr_read_b32 v101, a217
    v_accvgpr_read_b32 v102, a218
    v_accvgpr_read_b32 v103, a219
    v_accvgpr_read_b32 v104, a220
    v_accvgpr_read_b32 v105, a221
    v_accvgpr_read_b32 v106, a222
    v_accvgpr_read_b32 v107, a223
    s_waitcnt lgkmcnt(0)
    ds_read_b128 v[80:83], v223 offset:3584
    v_pk_fma_f32 v[92:93], v[224:225], v[84:85], v[92:93] op_sel_hi:[1,0,1] neg_lo:[0,1,0] neg_hi:[0,1,0]
    v_pk_fma_f32 v[94:95], v[226:227], v[84:85], v[94:95] op_sel_hi:[1,0,1] neg_lo:[0,1,0] neg_hi:[0,1,0]
    v_pk_fma_f32 v[96:97], v[228:229], v[84:85], v[96:97] op_sel_hi:[1,0,1] neg_lo:[0,1,0] neg_hi:[0,1,0]
    v_pk_fma_f32 v[98:99], v[230:231], v[84:85], v[98:99] op_sel_hi:[1,0,1] neg_lo:[0,1,0] neg_hi:[0,1,0]
    v_pk_fma_f32 v[100:101], v[232:233], v[84:85], v[100:101] op_sel_hi:[1,0,1] neg_lo:[0,1,0] neg_hi:[0,1,0]
    v_pk_fma_f32 v[102:103], v[234:235], v[84:85], v[102:103] op_sel_hi:[1,0,1] neg_lo:[0,1,0] neg_hi:[0,1,0]
    v_pk_fma_f32 v[104:105], v[236:237], v[84:85], v[104:105] op_sel_hi:[1,0,1] neg_lo:[0,1,0] neg_hi:[0,1,0]
    v_pk_fma_f32 v[106:107], v[238:239], v[84:85], v[106:107] op_sel_hi:[1,0,1] neg_lo:[0,1,0] neg_hi:[0,1,0]
    v_pk_mul_f32 v[208:209], v[92:93], v[92:93]
    v_pk_mul_f32 v[210:211], v[94:95], v[94:95]
    v_pk_mul_f32 v[212:213], v[96:97], v[96:97]
    v_pk_mul_f32 v[214:215], v[98:99], v[98:99]
    v_pk_fma_f32 v[208:209], v[208:209], v[86:87], v[84:85] op_sel:[0,0,1] op_sel_hi:[1,0,1]
    v_pk_fma_f32 v[210:211], v[210:211], v[86:87], v[84:85] op_sel:[0,0,1] op_sel_hi:[1,0,1]
    v_pk_fma_f32 v[212:213], v[212:213], v[86:87], v[84:85] op_sel:[0,0,1] op_sel_hi:[1,0,1]
    v_pk_fma_f32 v[214:215], v[214:215], v[86:87], v[84:85] op_sel:[0,0,1] op_sel_hi:[1,0,1]
    v_pk_mul_f32 v[208:209], v[208:209], v[92:93]
    v_pk_mul_f32 v[210:211], v[210:211], v[94:95]
    v_pk_mul_f32 v[212:213], v[212:213], v[96:97]
    v_pk_mul_f32 v[214:215], v[214:215], v[98:99]
    v_exp_f32 v208, v208
    v_exp_f32 v209, v209
    v_exp_f32 v210, v210
    v_exp_f32 v211, v211
    v_exp_f32 v212, v212
    v_exp_f32 v213, v213
    v_exp_f32 v214, v214
    v_exp_f32 v215, v215
    v_pk_mul_f32 v[92:93], v[92:93], v[100:101]
    v_pk_mul_f32 v[94:95], v[94:95], v[102:103]
    v_pk_mul_f32 v[96:97], v[96:97], v[104:105]
    v_pk_mul_f32 v[98:99], v[98:99], v[106:107]
    v_pk_fma_f32 v[208:209], v[208:209], v[86:87], v[86:87] op_sel:[0,1,1] op_sel_hi:[1,1,1]
    v_pk_fma_f32 v[210:211], v[210:211], v[86:87], v[86:87] op_sel:[0,1,1] op_sel_hi:[1,1,1]
    v_pk_fma_f32 v[212:213], v[212:213], v[86:87], v[86:87] op_sel:[0,1,1] op_sel_hi:[1,1,1]
    v_pk_fma_f32 v[214:215], v[214:215], v[86:87], v[86:87] op_sel:[0,1,1] op_sel_hi:[1,1,1]
    v_rcp_f32 v208, v208
    v_rcp_f32 v209, v209
    v_rcp_f32 v210, v210
    v_rcp_f32 v211, v211
    v_rcp_f32 v212, v212
    v_rcp_f32 v213, v213
    v_rcp_f32 v214, v214
    v_rcp_f32 v215, v215
    s_add_u32 s41, s41, s46
    v_pk_mul_f32 v[92:93], v[92:93], v[208:209]
    v_pk_mul_f32 v[94:95], v[94:95], v[210:211]
    v_pk_mul_f32 v[96:97], v[96:97], v[212:213]
    v_pk_mul_f32 v[98:99], v[98:99], v[214:215]
    v_cvt_pk_bf16_f32 v244, v92, v93
    v_cvt_pk_bf16_f32 v245, v94, v95
    v_cvt_pk_bf16_f32 v246, v96, v97
    v_cvt_pk_bf16_f32 v247, v98, v99
    buffer_store_dwordx4 v[244:247], v219, s[12:15], s41 offen sc1
    s_cmp_lt_u32 s21, 7
    s_cbranch_scc1 L_k_conv
    v_accvgpr_read_b32 v92, a224
    v_accvgpr_read_b32 v93, a225
    v_accvgpr_read_b32 v94, a226
    v_accvgpr_read_b32 v95, a227
    v_accvgpr_read_b32 v96, a228
    v_accvgpr_read_b32 v97, a229
    v_accvgpr_read_b32 v98, a230
    v_accvgpr_read_b32 v99, a231
    v_accvgpr_read_b32 v100, a232
    v_accvgpr_read_b32 v101, a233
    v_accvgpr_read_b32 v102, a234
    v_accvgpr_read_b32 v103, a235
    v_accvgpr_read_b32 v104, a236
    v_accvgpr_read_b32 v105, a237
    v_accvgpr_read_b32 v106, a238
    v_accvgpr_read_b32 v107, a239
    s_waitcnt lgkmcnt(0)
    v_pk_fma_f32 v[92:93], v[224:225], v[80:81], v[92:93] op_sel_hi:[1,0,1] neg_lo:[0,1,0] neg_hi:[0,1,0]
    v_pk_fma_f32 v[94:95], v[226:227], v[80:81], v[94:95] op_sel_hi:[1,0,1] neg_lo:[0,1,0] neg_hi:[0,1,0]
    v_pk_fma_f32 v[96:97], v[228:229], v[80:81], v[96:97] op_sel_hi:[1,0,1] neg_lo:[0,1,0] neg_hi:[0,1,0]
    v_pk_fma_f32 v[98:99], v[230:231], v[80:81], v[98:99] op_sel_hi:[1,0,1] neg_lo:[0,1,0] neg_hi:[0,1,0]
    v_pk_fma_f32 v[100:101], v[232:233], v[80:81], v[100:101] op_sel_hi:[1,0,1] neg_lo:[0,1,0] neg_hi:[0,1,0]
    v_pk_fma_f32 v[102:103], v[234:235], v[80:81], v[102:103] op_sel_hi:[1,0,1] neg_lo:[0,1,0] neg_hi:[0,1,0]
    v_pk_fma_f32 v[104:105], v[236:237], v[80:81], v[104:105] op_sel_hi:[1,0,1] neg_lo:[0,1,0] neg_hi:[0,1,0]
    v_pk_fma_f32 v[106:107], v[238:239], v[80:81], v[106:107] op_sel_hi:[1,0,1] neg_lo:[0,1,0] neg_hi:[0,1,0]
    v_pk_mul_f32 v[208:209], v[92:93], v[92:93]
    v_pk_mul_f32 v[210:211], v[94:95], v[94:95]
    v_pk_mul_f32 v[212:213], v[96:97], v[96:97]
    v_pk_mul_f32 v[214:215], v[98:99], v[98:99]
    v_pk_fma_f32 v[208:209], v[208:209], v[82:83], v[80:81] op_sel:[0,0,1] op_sel_hi:[1,0,1]
    v_pk_fma_f32 v[210:211], v[210:211], v[82:83], v[80:81] op_sel:[0,0,1] op_sel_hi:[1,0,1]
    v_pk_fma_f32 v[212:213], v[212:213], v[82:83], v[80:81] op_sel:[0,0,1] op_sel_hi:[1,0,1]
    v_pk_fma_f32 v[214:215], v[214:215], v[82:83], v[80:81] op_sel:[0,0,1] op_sel_hi:[1,0,1]
    v_pk_mul_f32 v[208:209], v[208:209], v[92:93]
    v_pk_mul_f32 v[210:211], v[210:211], v[94:95]
    v_pk_mul_f32 v[212:213], v[212:213], v[96:97]
    v_pk_mul_f32 v[214:215], v[214:215], v[98:99]
    v_exp_f32 v208, v208
    v_exp_f32 v209, v209
    v_exp_f32 v210, v210
    v_exp_f32 v211, v211
    v_exp_f32 v212, v212
    v_exp_f32 v213, v213
    v_exp_f32 v214, v214
    v_exp_f32 v215, v215
    v_pk_mul_f32 v[92:93], v[92:93], v[100:101]
    v_pk_mul_f32 v[94:95], v[94:95], v[102:103]
    v_pk_mul_f32 v[96:97], v[96:97], v[104:105]
    v_pk_mul_f32 v[98:99], v[98:99], v[106:107]
    v_pk_fma_f32 v[208:209], v[208:209], v[82:83], v[82:83] op_sel:[0,1,1] op_sel_hi:[1,1,1]
    v_pk_fma_f32 v[210:211], v[210:211], v[82:83], v[82:83] op_sel:[0,1,1] op_sel_hi:[1,1,1]
    v_pk_fma_f32 v[212:213], v[212:213], v[82:83], v[82:83] op_sel:[0,1,1] op_sel_hi:[1,1,1]
    v_pk_fma_f32 v[214:215], v[214:215], v[82:83], v[82:83] op_sel:[0,1,1] op_sel_hi:[1,1,1]
    v_rcp_f32 v208, v208
    v_rcp_f32 v209, v209
    v_rcp_f32 v210, v210
    v_rcp_f32 v211, v211
    v_rcp_f32 v212, v212
    v_rcp_f32 v213, v213
    v_rcp_f32 v214, v214
    v_rcp_f32 v215, v215
    s_add_u32 s41, s41, s47
    v_pk_mul_f32 v[92:93], v[92:93], v[208:209]
    v_pk_mul_f32 v[94:95], v[94:95], v[210:211]
    v_pk_mul_f32 v[96:97], v[96:97], v[212:213]
    v_pk_mul_f32 v[98:99], v[98:99], v[214:215]
    v_cvt_pk_bf16_f32 v240, v92, v93
    v_cvt_pk_bf16_f32 v241, v94, v95
    v_cvt_pk_bf16_f32 v242, v96, v97
    v_cvt_pk_bf16_f32 v243, v98, v99
    buffer_store_dwordx4 v[240:243], v218, s[12:15], s41 offen sc1
L_k_conv:
    s_waitcnt lgkmcnt(15)
    v_mfma_f32_16x16x32_bf16 v[64:67], a[64:67], a[0:3], 0
    ds_read_b64_tr_b16 a[20:21], v205 offset:1280
    s_mov_b32 s16, s52
    v_mfma_f32_16x16x32_bf16 v[68:71], a[64:67], a[128:131], 0
    ds_read_b64_tr_b16 a[22:23], v205 offset:1312
    s_mov_b32 s17, s53
    v_mfma_f32_16x16x32_bf16 v[72:75], a[64:67], a[4:7], 0
    ds_read_b64_tr_b16 a[148:149], v205 offset:1408
    s_and_b32 s42, s22, 3
    v_mfma_f32_16x16x32_bf16 v[72:75], a[68:71], a[0:3], v[72:75]
    ds_read_b64_tr_b16 a[150:151], v205 offset:1440
    s_cmp_eq_u32 s42, 1
    s_cselect_b32 s18, 7340032, 0
    v_mfma_f32_16x16x32_bf16 v[76:79], a[64:67], a[132:135], 0
    ds_read_b64_tr_b16 a[88:89], v204 offset:1568
    s_mov_b32 s28, s45
    v_mfma_f32_16x16x32_bf16 v[76:79], a[68:71], a[128:131], v[76:79]
    ds_read_b64_tr_b16 a[90:91], v204 offset:1536
    v_min_u32 v254, 55, v221
    v_mfma_f32_16x16x32_bf16 v[80:83], a[64:67], a[8:11], 0
    ds_read_b64_tr_b16 a[24:25], v205 offset:1536
    v_lshlrev_b32 v254, 7, v254
    v_mfma_f32_16x16x32_bf16 v[80:83], a[68:71], a[4:7], v[80:83]
    ds_read_b64_tr_b16 a[26:27], v205 offset:1568
    buffer_load_dword v255, v254, s[16:19], s28 offen
    v_mfma_f32_16x16x32_bf16 v[80:83], a[72:75], a[0:3], v[80:83]
    ds_read_b64_tr_b16 a[152:153], v205 offset:1664
    v_lshrrev_b32 v36, 4, v221
    s_waitcnt lgkmcnt(15)
    v_mfma_f32_16x16x32_bf16 v[84:87], a[64:67], a[136:139], 0
    ds_read_b64_tr_b16 a[154:155], v205 offset:1696
    v_add_u32 v36, 0, v36
    v_mfma_f32_16x16x32_bf16 v[84:87], a[68:71], a[132:135], v[84:87]
    ds_read_b64_tr_b16 a[92:93], v204 offset:1824
    v_lshlrev_b32 v37, 1, v36
    v_mfma_f32_16x16x32_bf16 v[84:87], a[72:75], a[128:131], v[84:87]
    ds_read_b64_tr_b16 a[94:95], v204 offset:1792
    v_and_b32 v38, 15, v221
    v_mfma_f32_16x16x32_bf16 v[88:91], a[64:67], a[12:15], 0
    ds_read_b64_tr_b16 a[28:29], v205 offset:1792
    v_xor_b32 v38, v38, v37
    v_mfma_f32_16x16x32_bf16 v[88:91], a[68:71], a[8:11], v[88:91]
    ds_read_b64_tr_b16 a[30:31], v205 offset:1824
    v_lshlrev_b32 v38, 4, v38
    v_mfma_f32_16x16x32_bf16 v[88:91], a[72:75], a[4:7], v[88:91]
    ds_read_b64_tr_b16 a[156:157], v205 offset:1920
    v_lshl_add_u32 v246, v36, 11, v38
    v_mfma_f32_16x16x32_bf16 v[88:91], a[76:79], a[0:3], v[88:91]
    ds_read_b64_tr_b16 a[158:159], v205 offset:1952
    v_lshrrev_b32 v36, 4, v221
    v_mfma_f32_16x16x32_bf16 v[92:95], a[64:67], a[140:143], 0
    ds_read_b64_tr_b16 a[96:97], v204 offset:2080
    v_add_u32 v36, 4, v36
    v_mfma_f32_16x16x32_bf16 v[92:95], a[68:71], a[136:139], v[92:95]
    ds_read_b64_tr_b16 a[98:99], v204 offset:2048
    v_lshlrev_b32 v37, 1, v36
    v_mfma_f32_16x16x32_bf16 v[92:95], a[72:75], a[132:135], v[92:95]
    ds_read_b64_tr_b16 a[32:33], v205 offset:2048
    v_and_b32 v38, 15, v221
    v_mfma_f32_16x16x32_bf16 v[92:95], a[76:79], a[128:131], v[92:95]
    ds_read_b64_tr_b16 a[34:35], v205 offset:2080
    v_xor_b32 v38, v38, v37
    s_waitcnt lgkmcnt(15)
    v_mfma_f32_16x16x32_bf16 v[96:99], a[64:67], a[16:19], 0
    ds_read_b64_tr_b16 a[160:161], v205 offset:2176
    v_lshlrev_b32 v38, 4, v38
    v_mfma_f32_16x16x32_bf16 v[96:99], a[68:71], a[12:15], v[96:99]
    ds_read_b64_tr_b16 a[162:163], v205 offset:2208
    v_lshl_add_u32 v247, v36, 11, v38
    v_mfma_f32_16x16x32_bf16 v[96:99], a[72:75], a[8:11], v[96:99]
    ds_read_b64_tr_b16 a[100:101], v204 offset:2336
    v_subrev_u32 v247, 1024, v247
    v_mfma_f32_16x16x32_bf16 v[96:99], a[76:79], a[4:7], v[96:99]
    ds_read_b64_tr_b16 a[102:103], v204 offset:2304
    v_add_u32 v248, 63488, v246
    v_mfma_f32_16x16x32_bf16 v[96:99], a[80:83], a[0:3], v[96:99]
    ds_read_b64_tr_b16 a[36:37], v205 offset:2304
    v_add_u32 v249, 63488, v247
    v_mfma_f32_16x16x32_bf16 v[100:103], a[64:67], a[144:147], 0
    ds_read_b64_tr_b16 a[38:39], v205 offset:2336
    s_add_u32 m0, s98, 0
    v_mfma_f32_16x16x32_bf16 v[100:103], a[68:71], a[140:143], v[100:103]
    ds_read_b64_tr_b16 a[164:165], v205 offset:2432
    v_cmp_lt_u32 vcc, 23, v221
    v_mfma_f32_16x16x32_bf16 v[100:103], a[72:75], a[136:139], v[100:103]
    ds_read_b64_tr_b16 a[166:167], v205 offset:2464
    v_mov_b32 v232, v222
    v_mfma_f32_16x16x32_bf16 v[100:103], a[76:79], a[132:135], v[100:103]
    ds_read_b64_tr_b16 a[104:105], v204 offset:2592
    v_add_u32 v233, 128, v222
    v_mfma_f32_16x16x32_bf16 v[100:103], a[80:83], a[128:131], v[100:103]
    ds_read_b64_tr_b16 a[106:107], v204 offset:2560
    v_cndmask_b32 v232, v232, v233, vcc
    v_mfma_f32_16x16x32_bf16 v[104:107], a[64:67], a[20:23], 0
    ds_read_b64_tr_b16 a[40:41], v205 offset:2560
    s_mov_b32 s26, 0
    v_mfma_f32_16x16x32_bf16 v[104:107], a[68:71], a[16:19], v[104:107]
    ds_read_b64_tr_b16 a[42:43], v205 offset:2592
    v_cmp_lt_u32 vcc, 15, v221
    v_mfma_f32_16x16x32_bf16 v[104:107], a[72:75], a[12:15], v[104:107]
    ds_read_b64_tr_b16 a[168:169], v205 offset:2688
    v_add_u32 v233, 1152, v222
    v_mfma_f32_16x16x32_bf16 v[104:107], a[76:79], a[8:11], v[104:107]
    ds_read_b64_tr_b16 a[170:171], v205 offset:2720
    v_add_u32 v36, 1280, v222
    v_mfma_f32_16x16x32_bf16 v[104:107], a[80:83], a[4:7], v[104:107]
    ds_read_b64_tr_b16 a[108:109], v204 offset:2848
    v_cndmask_b32 v233, v233, v36, vcc
    v_mfma_f32_16x16x32_bf16 v[104:107], a[84:87], a[0:3], v[104:107]
    ds_read_b64_tr_b16 a[110:111], v204 offset:2816
    buffer_load_dwordx4 v246, s[88:91], s26 offen offset:0  lds
    v_mfma_f32_16x16x32_bf16 v[108:111], a[64:67], a[148:151], 0
    ds_read_b64_tr_b16 a[44:45], v205 offset:2816
    v_bfe_u32 v36, v221, 2, 3
    v_mfma_f32_16x16x32_bf16 v[108:111], a[68:71], a[144:147], v[108:111]
    ds_read_b64_tr_b16 a[46:47], v205 offset:2848
    v_lshlrev_b32 v37, 8, v36
    v_mfma_f32_16x16x32_bf16 v[108:111], a[72:75], a[140:143], v[108:111]
    ds_read_b64_tr_b16 a[172:173], v205 offset:2944
    v_lshrrev_b32 v38, 5, v221
    v_mfma_f32_16x16x32_bf16 v[108:111], a[76:79], a[136:139], v[108:111]
    ds_read_b64_tr_b16 a[174:175], v205 offset:2976
    v_lshl_add_u32 v37, v38, 12, v37
    v_mfma_f32_16x16x32_bf16 v[108:111], a[80:83], a[132:135], v[108:111]
    s_waitcnt vmcnt(2)
    s_barrier
    v_mfma_f32_16x16x32_bf16 v[108:111], a[84:87], a[128:131], v[108:111]
    buffer_store_dword v252, v251, s[48:51], s99 offen sc1
    buffer_load_dwordx4 v247, s[88:91], s26 offen offset:1024  lds
    s_waitcnt lgkmcnt(15)
    v_mfma_f32_16x16x32_bf16 v[112:115], a[64:67], a[24:27], 0
    ds_read_b64_tr_b16 a[112:113], v204 offset:3104
    v_and_b32 v38, 3, v221
    v_mfma_f32_16x16x32_bf16 v[112:115], a[68:71], a[20:23], v[112:115]
    ds_read_b64_tr_b16 a[114:115], v204 offset:3072
    v_lshl_add_u32 v37, v38, 3, v37
    v_mfma_f32_16x16x32_bf16 v[112:115], a[72:75], a[16:19], v[112:115]
    ds_read_b64_tr_b16 a[48:49], v205 offset:3072
    s_lshl_b32 s24, s95, 2
    v_mfma_f32_16x16x32_bf16 v[112:115], a[76:79], a[12:15], v[112:115]
    ds_read_b64_tr_b16 a[50:51], v205 offset:3104
    v_xor_b32 v36, s24, v36
    v_mfma_f32_16x16x32_bf16 v[112:115], a[80:83], a[8:11], v[112:115]
    ds_read_b64_tr_b16 a[176:177], v205 offset:3200
    buffer_load_dwordx4 v248, s[88:91], s26 offen offset:2048  lds
    v_mfma_f32_16x16x32_bf16 v[112:115], a[84:87], a[4:7], v[112:115]
    ds_read_b64_tr_b16 a[178:179], v205 offset:3232
    v_lshl_add_u32 v196, v36, 5, v37
    v_mfma_f32_16x16x32_bf16 v[112:115], a[88:91], a[0:3], v[112:115]
    ds_read_b64_tr_b16 a[116:117], v204 offset:3360
    v_xor_b32 v197, 32, v196
    v_mfma_f32_16x16x32_bf16 v[116:119], a[64:67], a[152:155], 0
    ds_read_b64_tr_b16 a[118:119], v204 offset:3328
    v_xor_b32 v198, 64, v196
    v_mfma_f32_16x16x32_bf16 v[116:119], a[68:71], a[148:151], v[116:119]
    ds_read_b64_tr_b16 a[52:53], v205 offset:3328
    v_xor_b32 v199, 96, v196
    v_mfma_f32_16x16x32_bf16 v[116:119], a[72:75], a[144:147], v[116:119]
    ds_read_b64_tr_b16 a[54:55], v205 offset:3360
    buffer_load_dwordx4 v249, s[88:91], s26 offen offset:3072  lds
    v_mfma_f32_16x16x32_bf16 v[116:119], a[76:79], a[140:143], v[116:119]
    ds_read_b64_tr_b16 a[180:181], v205 offset:3456
    v_xor_b32 v200, 128, v196
    v_mfma_f32_16x16x32_bf16 v[116:119], a[80:83], a[136:139], v[116:119]
    ds_read_b64_tr_b16 a[182:183], v205 offset:3488
    v_xor_b32 v201, 160, v196
    v_mfma_f32_16x16x32_bf16 v[116:119], a[84:87], a[132:135], v[116:119]
    ds_read_b64_tr_b16 a[120:121], v204 offset:3616
    v_xor_b32 v202, 192, v196
    v_mfma_f32_16x16x32_bf16 v[116:119], a[88:91], a[128:131], v[116:119]
    ds_read_b64_tr_b16 a[122:123], v204 offset:3584
    v_xor_b32 v203, 224, v196
    v_mfma_f32_16x16x32_bf16 v[120:123], a[64:67], a[28:31], 0
    ds_read_b64_tr_b16 a[56:57], v205 offset:3584
    v_and_b32 v36, 15, v221
    v_mfma_f32_16x16x32_bf16 v[120:123], a[68:71], a[24:27], v[120:123]
    ds_read_b64_tr_b16 a[58:59], v205 offset:3616
    s_add_u32 m0, s98, 16384
    v_mfma_f32_16x16x32_bf16 v[120:123], a[72:75], a[20:23], v[120:123]
    ds_read_b64_tr_b16 a[184:185], v205 offset:3712
    v_lshrrev_b32 v37, 4, v221
    v_mfma_f32_16x16x32_bf16 v[120:123], a[76:79], a[16:19], v[120:123]
    ds_read_b64_tr_b16 a[186:187], v205 offset:3744
    v_mul_lo_u32 v38, v37, s101
    v_mfma_f32_16x16x32_bf16 v[120:123], a[80:83], a[12:15], v[120:123]
    ds_read_b64_tr_b16 a[124:125], v204 offset:3872
    v_lshl_add_u32 v38, v36, 2, v38
    v_mfma_f32_16x16x32_bf16 v[120:123], a[84:87], a[8:11], v[120:123]
    ds_read_b64_tr_b16 a[126:127], v204 offset:3840
    s_lshl_b32 s24, s20, 2
    v_mfma_f32_16x16x32_bf16 v[120:123], a[88:91], a[4:7], v[120:123]
    ds_read_b64_tr_b16 a[60:61], v205 offset:3840
    s_mov_b32 s26, 131072
    v_mfma_f32_16x16x32_bf16 v[120:123], a[92:95], a[0:3], v[120:123]
    ds_read_b64_tr_b16 a[62:63], v205 offset:3872
    v_add_u32 v37, s24, v37
    v_mfma_f32_16x16x32_bf16 v[124:127], a[64:67], a[156:159], 0
    ds_read_b64_tr_b16 a[188:189], v205 offset:3968
    v_cmp_gt_u32 vcc, 2, v37
    v_mfma_f32_16x16x32_bf16 v[124:127], a[68:71], a[152:155], v[124:127]
    ds_read_b64_tr_b16 a[190:191], v205 offset:4000
    v_mov_b32 v36, 2147483648
    v_mfma_f32_16x16x32_bf16 v[124:127], a[72:75], a[148:151], v[124:127]
    ds_read_u16 v0, v206 offset:4384
    s_lshl_b32 s24, s20, 6
    v_mfma_f32_16x16x32_bf16 v[124:127], a[76:79], a[144:147], v[124:127]
    ds_read_u16 v1, v206 offset:4512
    v_add_u32 v37, s24, v221
    v_mfma_f32_16x16x32_bf16 v[124:127], a[80:83], a[140:143], v[124:127]
    ds_read_u16 v2, v206 offset:4640
    buffer_load_dwordx4 v246, s[88:91], s26 offen offset:0  lds
    v_mfma_f32_16x16x32_bf16 v[124:127], a[84:87], a[136:139], v[124:127]
    ds_read_u16 v3, v206 offset:4768
    v_cndmask_b32 v192, v36, v38, vcc
    v_mfma_f32_16x16x32_bf16 v[124:127], a[88:91], a[132:135], v[124:127]
    ds_read_u16 v4, v206 offset:4896
    v_lshlrev_b32 v38, 2, v37
    v_mfma_f32_16x16x32_bf16 v[124:127], a[92:95], a[128:131], v[124:127]
    ds_read_u16 v5, v206 offset:5024
    v_cmp_gt_u32 vcc, 16, v37
    v_mfma_f32_16x16x32_bf16 v[128:131], a[64:67], a[32:35], 0
    ds_read_u16 v6, v206 offset:5152
    s_lshl_b32 s24, s20, 1
    v_mfma_f32_16x16x32_bf16 v[128:131], a[68:71], a[28:31], v[128:131]
    ds_read_u16 v7, v206 offset:5280
    buffer_load_dwordx4 v247, s[88:91], s26 offen offset:1024  lds
    v_mfma_f32_16x16x32_bf16 v[128:131], a[72:75], a[24:27], v[128:131]
    ds_read_u16 v8, v206 offset:5408
    s_add_u32 s24, s24, 114688
    v_mfma_f32_16x16x32_bf16 v[128:131], a[76:79], a[20:23], v[128:131]
    ds_read_u16 v9, v206 offset:5536
    v_cndmask_b32 v250, v36, v38, vcc
    v_mfma_f32_16x16x32_bf16 v[128:131], a[80:83], a[16:19], v[128:131]
    ds_read_u16 v10, v206 offset:5664
    v_lshl_add_u32 v194, v221, 3, s24
    v_mfma_f32_16x16x32_bf16 v[128:131], a[84:87], a[12:15], v[128:131]
    ds_read_u16 v11, v206 offset:5792
    s_mov_b32 s28, 0
    v_mfma_f32_16x16x32_bf16 v[128:131], a[88:91], a[8:11], v[128:131]
    ds_read_u16 v12, v206 offset:5920
    buffer_load_dwordx4 v248, s[88:91], s26 offen offset:2048  lds
    v_mfma_f32_16x16x32_bf16 v[128:131], a[92:95], a[4:7], v[128:131]
    ds_read_u16 v13, v206 offset:6048
    s_brev_b32 s29, 1
    v_mfma_f32_16x16x32_bf16 v[128:131], a[96:99], a[0:3], v[128:131]
    ds_read_u16 v14, v206 offset:6176
    v_mov_b32 v195, 0
    v_mfma_f32_16x16x32_bf16 v[132:135], a[64:67], a[160:163], 0
    ds_read_u16 v15, v206 offset:6304
    v_mfma_f32_16x16x32_bf16 v[132:135], a[68:71], a[156:159], v[132:135]
    ds_read_u16 v16, v206 offset:6432
    v_mfma_f32_16x16x32_bf16 v[132:135], a[72:75], a[152:155], v[132:135]
    ds_read_u16 v17, v206 offset:6560
    v_mfma_f32_16x16x32_bf16 v[132:135], a[76:79], a[148:151], v[132:135]
    ds_read_u16 v18, v206 offset:6688
    buffer_load_dwordx4 v249, s[88:91], s26 offen offset:3072  lds
    v_mfma_f32_16x16x32_bf16 v[132:135], a[80:83], a[144:147], v[132:135]
    ds_read_u16 v19, v206 offset:6816
    v_mfma_f32_16x16x32_bf16 v[132:135], a[84:87], a[140:143], v[132:135]
    ds_read_u16 v20, v206 offset:6944
    v_mfma_f32_16x16x32_bf16 v[132:135], a[88:91], a[136:139], v[132:135]
    ds_read_u16 v21, v206 offset:7072
    v_mfma_f32_16x16x32_bf16 v[132:135], a[92:95], a[132:135], v[132:135]
    ds_read_u16 v22, v206 offset:7200
    v_mfma_f32_16x16x32_bf16 v[132:135], a[96:99], a[128:131], v[132:135]
    ds_read_u16 v23, v206 offset:7328
    s_add_u32 m0, s98, 32768
    s_waitcnt lgkmcnt(15)
    v_mfma_f32_16x16x32_bf16 v[136:139], a[64:67], a[36:39], 0
    ds_read_u16 v24, v206 offset:7456
    v_mfma_f32_16x16x32_bf16 v[136:139], a[68:71], a[32:35], v[136:139]
    ds_read_u16 v25, v206 offset:7584
    v_mfma_f32_16x16x32_bf16 v[136:139], a[72:75], a[28:31], v[136:139]
    ds_read_u16 v26, v206 offset:7712
    v_mfma_f32_16x16x32_bf16 v[136:139], a[76:79], a[24:27], v[136:139]
    ds_read_u16 v27, v206 offset:7840
    v_mfma_f32_16x16x32_bf16 v[136:139], a[80:83], a[20:23], v[136:139]
    ds_read_u16 v28, v206 offset:7968
    s_mov_b32 s26, 262144
    v_mfma_f32_16x16x32_bf16 v[136:139], a[84:87], a[16:19], v[136:139]
    ds_read_u16 v29, v206 offset:8096
    v_mfma_f32_16x16x32_bf16 v[136:139], a[88:91], a[12:15], v[136:139]
    ds_read_u16 v30, v206 offset:8224
    v_mfma_f32_16x16x32_bf16 v[136:139], a[92:95], a[8:11], v[136:139]
    ds_read_u16 v31, v206 offset:8352
    v_mfma_f32_16x16x32_bf16 v[136:139], a[96:99], a[4:7], v[136:139]
    v_mfma_f32_16x16x32_bf16 v[136:139], a[100:103], a[0:3], v[136:139]
    v_mfma_f32_16x16x32_bf16 v[140:143], a[64:67], a[164:167], 0
    s_waitcnt lgkmcnt(0)
    s_barrier
    v_mfma_f32_16x16x32_bf16 v[140:143], a[68:71], a[160:163], v[140:143]
    buffer_load_dwordx4 v246, s[88:91], s26 offen offset:0  lds
    v_lshlrev_b32 v207, 16, v253
    v_mfma_f32_16x16x32_bf16 v[140:143], a[72:75], a[156:159], v[140:143]
    v_lshlrev_b32 v0, 16, v0
    v_lshlrev_b32 v1, 16, v1
    v_mfma_f32_16x16x32_bf16 v[140:143], a[76:79], a[152:155], v[140:143]
    v_lshlrev_b32 v2, 16, v2
    v_lshlrev_b32 v3, 16, v3
    v_mfma_f32_16x16x32_bf16 v[140:143], a[80:83], a[148:151], v[140:143]
    v_lshlrev_b32 v4, 16, v4
    v_lshlrev_b32 v5, 16, v5
    v_mfma_f32_16x16x32_bf16 v[140:143], a[84:87], a[144:147], v[140:143]
    buffer_load_dwordx4 v247, s[88:91], s26 offen offset:1024  lds
    v_lshlrev_b32 v6, 16, v6
    v_mfma_f32_16x16x32_bf16 v[140:143], a[88:91], a[140:143], v[140:143]
    v_lshlrev_b32 v7, 16, v7
    v_lshlrev_b32 v8, 16, v8
    v_mfma_f32_16x16x32_bf16 v[140:143], a[92:95], a[136:139], v[140:143]
    v_lshlrev_b32 v9, 16, v9
    v_lshlrev_b32 v10, 16, v10
    v_mfma_f32_16x16x32_bf16 v[140:143], a[96:99], a[132:135], v[140:143]
    v_lshlrev_b32 v11, 16, v11
    v_lshlrev_b32 v12, 16, v12
    v_mfma_f32_16x16x32_bf16 v[140:143], a[100:103], a[128:131], v[140:143]
    v_lshlrev_b32 v13, 16, v13
    v_lshlrev_b32 v14, 16, v14
    v_mfma_f32_16x16x32_bf16 v[144:147], a[64:67], a[40:43], 0
    v_lshlrev_b32 v15, 16, v15
    v_lshlrev_b32 v16, 16, v16
    v_mfma_f32_16x16x32_bf16 v[144:147], a[68:71], a[36:39], v[144:147]
    buffer_load_dwordx4 v248, s[88:91], s26 offen offset:2048  lds
    v_lshlrev_b32 v17, 16, v17
    v_mfma_f32_16x16x32_bf16 v[144:147], a[72:75], a[32:35], v[144:147]
    v_lshlrev_b32 v18, 16, v18
    v_lshlrev_b32 v19, 16, v19
    v_mfma_f32_16x16x32_bf16 v[144:147], a[76:79], a[28:31], v[144:147]
    v_lshlrev_b32 v20, 16, v20
    v_lshlrev_b32 v21, 16, v21
    v_mfma_f32_16x16x32_bf16 v[144:147], a[80:83], a[24:27], v[144:147]
    v_lshlrev_b32 v22, 16, v22
    v_lshlrev_b32 v23, 16, v23
    v_mfma_f32_16x16x32_bf16 v[144:147], a[84:87], a[20:23], v[144:147]
    v_lshlrev_b32 v24, 16, v24
    v_lshlrev_b32 v25, 16, v25
    v_mfma_f32_16x16x32_bf16 v[144:147], a[88:91], a[16:19], v[144:147]
    buffer_load_dwordx4 v249, s[88:91], s26 offen offset:3072  lds
    v_lshlrev_b32 v26, 16, v26
    v_mfma_f32_16x16x32_bf16 v[144:147], a[92:95], a[12:15], v[144:147]
    v_lshlrev_b32 v27, 16, v27
    v_lshlrev_b32 v28, 16, v28
    v_mfma_f32_16x16x32_bf16 v[144:147], a[96:99], a[8:11], v[144:147]
    v_lshlrev_b32 v29, 16, v29
    v_lshlrev_b32 v30, 16, v30
    v_mfma_f32_16x16x32_bf16 v[144:147], a[100:103], a[4:7], v[144:147]
    v_lshlrev_b32 v31, 16, v31
    v_cndmask_b32 v32, v67, v195, s[28:29]
    v_mfma_f32_16x16x32_bf16 v[144:147], a[104:107], a[0:3], v[144:147]
    v_cndmask_b32 v33, v71, v67, s[28:29]
    v_cndmask_b32 v34, v75, v71, s[28:29]
    v_mfma_f32_16x16x32_bf16 v[148:151], a[64:67], a[168:171], 0
    s_add_u32 m0, s98, 49152
    v_cndmask_b32 v35, v79, v75, s[28:29]
    v_mfma_f32_16x16x32_bf16 v[148:151], a[68:71], a[164:167], v[148:151]
    v_add_f32_dpp v66, v32, v66 wave_ror:1 row_mask:0xf bank_mask:0xf
    v_add_f32_dpp v70, v33, v70 wave_ror:1 row_mask:0xf bank_mask:0xf
    v_mfma_f32_16x16x32_bf16 v[148:151], a[72:75], a[160:163], v[148:151]
    v_add_f32_dpp v74, v34, v74 wave_ror:1 row_mask:0xf bank_mask:0xf
    v_add_f32_dpp v78, v35, v78 wave_ror:1 row_mask:0xf bank_mask:0xf
    v_mfma_f32_16x16x32_bf16 v[148:151], a[76:79], a[156:159], v[148:151]
    v_cndmask_b32 v32, v66, v195, s[28:29]
    v_cndmask_b32 v33, v70, v66, s[28:29]
    v_mfma_f32_16x16x32_bf16 v[148:151], a[80:83], a[152:155], v[148:151]
    v_cndmask_b32 v34, v74, v70, s[28:29]
    v_cndmask_b32 v35, v78, v74, s[28:29]
    v_mfma_f32_16x16x32_bf16 v[148:151], a[84:87], a[148:151], v[148:151]
    v_add_f32_dpp v65, v32, v65 wave_ror:1 row_mask:0xf bank_mask:0xf
    v_add_f32_dpp v69, v33, v69 wave_ror:1 row_mask:0xf bank_mask:0xf
    v_mfma_f32_16x16x32_bf16 v[148:151], a[88:91], a[144:147], v[148:151]
    s_mov_b32 s26, 393216
    v_add_f32_dpp v73, v34, v73 wave_ror:1 row_mask:0xf bank_mask:0xf
    v_mfma_f32_16x16x32_bf16 v[148:151], a[92:95], a[140:143], v[148:151]
    v_add_f32_dpp v77, v35, v77 wave_ror:1 row_mask:0xf bank_mask:0xf
    v_cndmask_b32 v32, v65, v195, s[28:29]
    v_mfma_f32_16x16x32_bf16 v[148:151], a[96:99], a[136:139], v[148:151]
    v_cndmask_b32 v33, v69, v65, s[28:29]
    v_cndmask_b32 v34, v73, v69, s[28:29]
    v_mfma_f32_16x16x32_bf16 v[148:151], a[100:103], a[132:135], v[148:151]
    v_cndmask_b32 v35, v77, v73, s[28:29]
    v_add_f32_dpp v64, v32, v64 wave_ror:1 row_mask:0xf bank_mask:0xf
    v_mfma_f32_16x16x32_bf16 v[148:151], a[104:107], a[128:131], v[148:151]
    v_add_f32_dpp v68, v33, v68 wave_ror:1 row_mask:0xf bank_mask:0xf
    v_add_f32_dpp v72, v34, v72 wave_ror:1 row_mask:0xf bank_mask:0xf
    v_mfma_f32_16x16x32_bf16 v[152:155], a[64:67], a[44:47], 0
    buffer_load_dwordx4 v246, s[88:91], s26 offen offset:0  lds
    v_add_f32_dpp v76, v35, v76 wave_ror:1 row_mask:0xf bank_mask:0xf
    v_mfma_f32_16x16x32_bf16 v[152:155], a[68:71], a[40:43], v[152:155]
    v_fmac_f32 v64, v207, v0
    v_fmac_f32 v68, v207, v1
    v_mfma_f32_16x16x32_bf16 v[152:155], a[72:75], a[36:39], v[152:155]
    v_fmac_f32 v72, v207, v2
    v_fmac_f32 v76, v207, v3
    v_mfma_f32_16x16x32_bf16 v[152:155], a[76:79], a[32:35], v[152:155]
    v_cvt_pk_bf16_f32 v0, v64, v68
    v_cvt_pk_bf16_f32 v2, v72, v76
    v_mfma_f32_16x16x32_bf16 v[152:155], a[80:83], a[28:31], v[152:155]
    ds_write_b16 v194, v0 offset:0
    v_cndmask_b32 v32, v83, v79, s[28:29]
    v_mfma_f32_16x16x32_bf16 v[152:155], a[84:87], a[24:27], v[152:155]
    ds_write_b16_d16_hi v194, v0 offset:512
    v_cndmask_b32 v33, v87, v83, s[28:29]
    v_mfma_f32_16x16x32_bf16 v[152:155], a[88:91], a[20:23], v[152:155]
    buffer_load_dwordx4 v247, s[88:91], s26 offen offset:1024  lds
    v_cndmask_b32 v34, v91, v87, s[28:29]
    v_mfma_f32_16x16x32_bf16 v[152:155], a[92:95], a[16:19], v[152:155]
    ds_write_b16 v194, v2 offset:1024
    v_cndmask_b32 v35, v95, v91, s[28:29]
    v_mfma_f32_16x16x32_bf16 v[152:155], a[96:99], a[12:15], v[152:155]
    ds_write_b16_d16_hi v194, v2 offset:1536
    v_add_f32_dpp v82, v32, v82 wave_ror:1 row_mask:0xf bank_mask:0xf
    v_mfma_f32_16x16x32_bf16 v[152:155], a[100:103], a[8:11], v[152:155]
    v_add_f32_dpp v86, v33, v86 wave_ror:1 row_mask:0xf bank_mask:0xf
    v_add_f32_dpp v90, v34, v90 wave_ror:1 row_mask:0xf bank_mask:0xf
    v_mfma_f32_16x16x32_bf16 v[152:155], a[104:107], a[4:7], v[152:155]
    v_add_f32_dpp v94, v35, v94 wave_ror:1 row_mask:0xf bank_mask:0xf
    v_cndmask_b32 v32, v82, v78, s[28:29]
    v_mfma_f32_16x16x32_bf16 v[152:155], a[108:111], a[0:3], v[152:155]
    buffer_load_dwordx4 v248, s[88:91], s26 offen offset:2048  lds
    v_cndmask_b32 v33, v86, v82, s[28:29]
    v_mfma_f32_16x16x32_bf16 v[156:159], a[64:67], a[172:175], 0
    v_cndmask_b32 v34, v90, v86, s[28:29]
    v_cndmask_b32 v35, v94, v90, s[28:29]
    v_mfma_f32_16x16x32_bf16 v[156:159], a[68:71], a[168:171], v[156:159]
    v_add_f32_dpp v81, v32, v81 wave_ror:1 row_mask:0xf bank_mask:0xf
    v_add_f32_dpp v85, v33, v85 wave_ror:1 row_mask:0xf bank_mask:0xf
    v_mfma_f32_16x16x32_bf16 v[156:159], a[72:75], a[164:167], v[156:159]
    v_add_f32_dpp v89, v34, v89 wave_ror:1 row_mask:0xf bank_mask:0xf
    v_add_f32_dpp v93, v35, v93 wave_ror:1 row_mask:0xf bank_mask:0xf
    v_mfma_f32_16x16x32_bf16 v[156:159], a[76:79], a[160:163], v[156:159]
    v_cndmask_b32 v32, v81, v77, s[28:29]
    v_cndmask_b32 v33, v85, v81, s[28:29]
    v_mfma_f32_16x16x32_bf16 v[156:159], a[80:83], a[156:159], v[156:159]
    buffer_load_dwordx4 v249, s[88:91], s26 offen offset:3072  lds
    v_cndmask_b32 v34, v89, v85, s[28:29]
    v_mfma_f32_16x16x32_bf16 v[156:159], a[84:87], a[152:155], v[156:159]
    v_cndmask_b32 v35, v93, v89, s[28:29]
    v_add_f32_dpp v80, v32, v80 wave_ror:1 row_mask:0xf bank_mask:0xf
    v_mfma_f32_16x16x32_bf16 v[156:159], a[88:91], a[148:151], v[156:159]
    v_add_f32_dpp v84, v33, v84 wave_ror:1 row_mask:0xf bank_mask:0xf
L_k_w9:
    s_cbranch_execz L_k_w13
    v_add_f32_dpp v88, v34, v88 wave_ror:1 row_mask:0xf bank_mask:0xf
    v_mfma_f32_16x16x32_bf16 v[156:159], a[92:95], a[144:147], v[156:159]
    v_add_f32_dpp v92, v35, v92 wave_ror:1 row_mask:0xf bank_mask:0xf
    v_fmac_f32 v80, v207, v4
    v_mfma_f32_16x16x32_bf16 v[156:159], a[96:99], a[140:143], v[156:159]
    v_fmac_f32 v84, v207, v5
    v_fmac_f32 v88, v207, v6
    v_mfma_f32_16x16x32_bf16 v[156:159], a[100:103], a[136:139], v[156:159]
    v_fmac_f32 v92, v207, v7
    v_cvt_pk_bf16_f32 v4, v80, v84
    v_mfma_f32_16x16x32_bf16 v[156:159], a[104:107], a[132:135], v[156:159]
    s_add_u32 m0, s98, 65536
    v_cvt_pk_bf16_f32 v6, v88, v92
    v_mfma_f32_16x16x32_bf16 v[156:159], a[108:111], a[128:131], v[156:159]
    ds_write_b16 v194, v4 offset:2048
    v_cndmask_b32 v32, v99, v95, s[28:29]
    v_mfma_f32_16x16x32_bf16 v[160:163], a[64:67], a[48:51], 0
    ds_write_b16_d16_hi v194, v4 offset:2560
    v_cndmask_b32 v33, v103, v99, s[28:29]
    v_mfma_f32_16x16x32_bf16 v[160:163], a[68:71], a[44:47], v[160:163]
    ds_write_b16 v194, v6 offset:3072
    v_cndmask_b32 v34, v107, v103, s[28:29]
    v_mfma_f32_16x16x32_bf16 v[160:163], a[72:75], a[40:43], v[160:163]
    ds_write_b16_d16_hi v194, v6 offset:3584
    v_cndmask_b32 v35, v111, v107, s[28:29]
    v_mfma_f32_16x16x32_bf16 v[160:163], a[76:79], a[36:39], v[160:163]
    s_mov_b32 s26, 524288
    v_add_f32_dpp v98, v32, v98 wave_ror:1 row_mask:0xf bank_mask:0xf
    v_mfma_f32_16x16x32_bf16 v[160:163], a[80:83], a[32:35], v[160:163]
    v_add_f32_dpp v102, v33, v102 wave_ror:1 row_mask:0xf bank_mask:0xf
    v_add_f32_dpp v106, v34, v106 wave_ror:1 row_mask:0xf bank_mask:0xf
    v_mfma_f32_16x16x32_bf16 v[160:163], a[84:87], a[28:31], v[160:163]
    v_add_f32_dpp v110, v35, v110 wave_ror:1 row_mask:0xf bank_mask:0xf
    v_cndmask_b32 v32, v98, v94, s[28:29]
    v_mfma_f32_16x16x32_bf16 v[160:163], a[88:91], a[24:27], v[160:163]
    v_cndmask_b32 v33, v102, v98, s[28:29]
    v_cndmask_b32 v34, v106, v102, s[28:29]
    v_mfma_f32_16x16x32_bf16 v[160:163], a[92:95], a[20:23], v[160:163]
    v_cndmask_b32 v35, v110, v106, s[28:29]
    v_add_f32_dpp v97, v32, v97 wave_ror:1 row_mask:0xf bank_mask:0xf
    v_mfma_f32_16x16x32_bf16 v[160:163], a[96:99], a[16:19], v[160:163]
    buffer_load_dwordx4 v246, s[88:91], s26 offen offset:0  lds
    v_add_f32_dpp v101, v33, v101 wave_ror:1 row_mask:0xf bank_mask:0xf
    v_mfma_f32_16x16x32_bf16 v[160:163], a[100:103], a[12:15], v[160:163]
    v_add_f32_dpp v105, v34, v105 wave_ror:1 row_mask:0xf bank_mask:0xf
    v_add_f32_dpp v109, v35, v109 wave_ror:1 row_mask:0xf bank_mask:0xf
    v_mfma_f32_16x16x32_bf16 v[160:163], a[104:107], a[8:11], v[160:163]
    v_cndmask_b32 v32, v97, v93, s[28:29]
    v_cndmask_b32 v33, v101, v97, s[28:29]
    v_mfma_f32_16x16x32_bf16 v[160:163], a[108:111], a[4:7], v[160:163]
    v_cndmask_b32 v34, v105, v101, s[28:29]
    v_cndmask_b32 v35, v109, v105, s[28:29]
    v_mfma_f32_16x16x32_bf16 v[160:163], a[112:115], a[0:3], v[160:163]
    v_add_f32_dpp v96, v32, v96 wave_ror:1 row_mask:0xf bank_mask:0xf
    v_add_f32_dpp v100, v33, v100 wave_ror:1 row_mask:0xf bank_mask:0xf
    v_mfma_f32_16x16x32_bf16 v[164:167], a[64:67], a[176:179], 0
    v_add_f32_dpp v104, v34, v104 wave_ror:1 row_mask:0xf bank_mask:0xf
    v_add_f32_dpp v108, v35, v108 wave_ror:1 row_mask:0xf bank_mask:0xf
    v_mfma_f32_16x16x32_bf16 v[164:167], a[68:71], a[172:175], v[164:167]
    buffer_load_dwordx4 v247, s[88:91], s26 offen offset:1024  lds
    v_fmac_f32 v96, v207, v8
    v_mfma_f32_16x16x32_bf16 v[164:167], a[72:75], a[168:171], v[164:167]
    v_fmac_f32 v100, v207, v9
    v_fmac_f32 v104, v207, v10
    v_mfma_f32_16x16x32_bf16 v[164:167], a[76:79], a[164:167], v[164:167]
    v_fmac_f32 v108, v207, v11
    v_cvt_pk_bf16_f32 v8, v96, v100
    v_mfma_f32_16x16x32_bf16 v[164:167], a[80:83], a[160:163], v[164:167]
    v_cvt_pk_bf16_f32 v10, v104, v108
    v_cndmask_b32 v32, v115, v111, s[28:29]
    v_mfma_f32_16x16x32_bf16 v[164:167], a[84:87], a[156:159], v[164:167]
    ds_write_b16 v194, v8 offset:4096
    v_cndmask_b32 v33, v119, v115, s[28:29]
    v_mfma_f32_16x16x32_bf16 v[164:167], a[88:91], a[152:155], v[164:167]
    buffer_load_dwordx4 v248, s[88:91], s26 offen offset:2048  lds
    v_cndmask_b32 v34, v123, v119, s[28:29]
    v_mfma_f32_16x16x32_bf16 v[164:167], a[92:95], a[148:151], v[164:167]
    ds_write_b16_d16_hi v194, v8 offset:4608
    v_cndmask_b32 v35, v127, v123, s[28:29]
    v_mfma_f32_16x16x32_bf16 v[164:167], a[96:99], a[144:147], v[164:167]
    ds_write_b16 v194, v10 offset:5120
    v_add_f32_dpp v114, v32, v114 wave_ror:1 row_mask:0xf bank_mask:0xf
    v_mfma_f32_16x16x32_bf16 v[164:167], a[100:103], a[140:143], v[164:167]
    ds_write_b16_d16_hi v194, v10 offset:5632
    v_add_f32_dpp v118, v33, v118 wave_ror:1 row_mask:0xf bank_mask:0xf
    v_mfma_f32_16x16x32_bf16 v[164:167], a[104:107], a[136:139], v[164:167]
    v_add_f32_dpp v122, v34, v122 wave_ror:1 row_mask:0xf bank_mask:0xf
    v_add_f32_dpp v126, v35, v126 wave_ror:1 row_mask:0xf bank_mask:0xf
    v_mfma_f32_16x16x32_bf16 v[164:167], a[108:111], a[132:135], v[164:167]
    v_cndmask_b32 v32, v114, v110, s[28:29]
    v_cndmask_b32 v33, v118, v114, s[28:29]
    v_mfma_f32_16x16x32_bf16 v[164:167], a[112:115], a[128:131], v[164:167]
    buffer_load_dwordx4 v249, s[88:91], s26 offen offset:3072  lds
    v_cndmask_b32 v34, v122, v118, s[28:29]
    v_mfma_f32_16x16x32_bf16 v[168:171], a[64:67], a[52:55], 0
    v_cndmask_b32 v35, v126, v122, s[28:29]
    v_add_f32_dpp v113, v32, v113 wave_ror:1 row_mask:0xf bank_mask:0xf
    v_mfma_f32_16x16x32_bf16 v[168:171], a[68:71], a[48:51], v[168:171]
    v_add_f32_dpp v117, v33, v117 wave_ror:1 row_mask:0xf bank_mask:0xf
    v_add_f32_dpp v121, v34, v121 wave_ror:1 row_mask:0xf bank_mask:0xf
    v_mfma_f32_16x16x32_bf16 v[168:171], a[72:75], a[44:47], v[168:171]
    v_add_f32_dpp v125, v35, v125 wave_ror:1 row_mask:0xf bank_mask:0xf
    v_cndmask_b32 v32, v113, v109, s[28:29]
    v_mfma_f32_16x16x32_bf16 v[168:171], a[76:79], a[40:43], v[168:171]
    v_cndmask_b32 v33, v117, v113, s[28:29]
    v_cndmask_b32 v34, v121, v117, s[28:29]
    v_mfma_f32_16x16x32_bf16 v[168:171], a[80:83], a[36:39], v[168:171]
    s_add_u32 m0, s98, 81920
    v_cndmask_b32 v35, v125, v121, s[28:29]
    v_mfma_f32_16x16x32_bf16 v[168:171], a[84:87], a[32:35], v[168:171]
    v_add_f32_dpp v112, v32, v112 wave_ror:1 row_mask:0xf bank_mask:0xf
    v_add_f32_dpp v116, v33, v116 wave_ror:1 row_mask:0xf bank_mask:0xf
    v_mfma_f32_16x16x32_bf16 v[168:171], a[88:91], a[28:31], v[168:171]
    v_add_f32_dpp v120, v34, v120 wave_ror:1 row_mask:0xf bank_mask:0xf
    v_add_f32_dpp v124, v35, v124 wave_ror:1 row_mask:0xf bank_mask:0xf
    v_mfma_f32_16x16x32_bf16 v[168:171], a[92:95], a[24:27], v[168:171]
    v_fmac_f32 v112, v207, v12
    v_fmac_f32 v116, v207, v13
    v_mfma_f32_16x16x32_bf16 v[168:171], a[96:99], a[20:23], v[168:171]
    v_fmac_f32 v120, v207, v14
    v_fmac_f32 v124, v207, v15
    v_mfma_f32_16x16x32_bf16 v[168:171], a[100:103], a[16:19], v[168:171]
    s_mov_b32 s26, 655360
    v_cvt_pk_bf16_f32 v12, v112, v116
    v_mfma_f32_16x16x32_bf16 v[168:171], a[104:107], a[12:15], v[168:171]
    v_cvt_pk_bf16_f32 v14, v120, v124
    v_cndmask_b32 v32, v131, v127, s[28:29]
    v_mfma_f32_16x16x32_bf16 v[168:171], a[108:111], a[8:11], v[168:171]
    ds_write_b16 v194, v12 offset:6144
    v_cndmask_b32 v33, v135, v131, s[28:29]
    v_mfma_f32_16x16x32_bf16 v[168:171], a[112:115], a[4:7], v[168:171]
    ds_write_b16_d16_hi v194, v12 offset:6656
    v_cndmask_b32 v34, v139, v135, s[28:29]
    v_mfma_f32_16x16x32_bf16 v[168:171], a[116:119], a[0:3], v[168:171]
    ds_write_b16 v194, v14 offset:7168
    v_cndmask_b32 v35, v143, v139, s[28:29]
    v_mfma_f32_16x16x32_bf16 v[172:175], a[64:67], a[180:183], 0
    ds_write_b16_d16_hi v194, v14 offset:7680
    v_add_f32_dpp v130, v32, v130 wave_ror:1 row_mask:0xf bank_mask:0xf
    v_mfma_f32_16x16x32_bf16 v[172:175], a[68:71], a[176:179], v[172:175]
    buffer_load_dwordx4 v246, s[88:91], s26 offen offset:0  lds
    v_add_f32_dpp v134, v33, v134 wave_ror:1 row_mask:0xf bank_mask:0xf
    v_mfma_f32_16x16x32_bf16 v[172:175], a[72:75], a[172:175], v[172:175]
    v_add_f32_dpp v138, v34, v138 wave_ror:1 row_mask:0xf bank_mask:0xf
    v_add_f32_dpp v142, v35, v142 wave_ror:1 row_mask:0xf bank_mask:0xf
    v_mfma_f32_16x16x32_bf16 v[172:175], a[76:79], a[168:171], v[172:175]
    v_cndmask_b32 v32, v130, v126, s[28:29]
    v_cndmask_b32 v33, v134, v130, s[28:29]
    v_mfma_f32_16x16x32_bf16 v[172:175], a[80:83], a[164:167], v[172:175]
    buffer_load_dword v193, v192, s[48:51], s100 offen sc1
    v_cndmask_b32 v34, v138, v134, s[28:29]
    v_mfma_f32_16x16x32_bf16 v[172:175], a[84:87], a[160:163], v[172:175]
    v_cndmask_b32 v35, v142, v138, s[28:29]
    v_add_f32_dpp v129, v32, v129 wave_ror:1 row_mask:0xf bank_mask:0xf
    v_mfma_f32_16x16x32_bf16 v[172:175], a[88:91], a[156:159], v[172:175]
    buffer_load_dwordx4 v247, s[88:91], s26 offen offset:1024  lds
    v_add_f32_dpp v133, v33, v133 wave_ror:1 row_mask:0xf bank_mask:0xf
    v_mfma_f32_16x16x32_bf16 v[172:175], a[92:95], a[152:155], v[172:175]
    v_add_f32_dpp v137, v34, v137 wave_ror:1 row_mask:0xf bank_mask:0xf
    v_add_f32_dpp v141, v35, v141 wave_ror:1 row_mask:0xf bank_mask:0xf
    v_mfma_f32_16x16x32_bf16 v[172:175], a[96:99], a[148:151], v[172:175]
    v_cndmask_b32 v32, v129, v125, s[28:29]
    v_cndmask_b32 v33, v133, v129, s[28:29]
    v_mfma_f32_16x16x32_bf16 v[172:175], a[100:103], a[144:147], v[172:175]
    v_cndmask_b32 v34, v137, v133, s[28:29]
    v_cndmask_b32 v35, v141, v137, s[28:29]
    v_mfma_f32_16x16x32_bf16 v[172:175], a[104:107], a[140:143], v[172:175]
    v_add_f32_dpp v128, v32, v128 wave_ror:1 row_mask:0xf bank_mask:0xf
    v_add_f32_dpp v132, v33, v132 wave_ror:1 row_mask:0xf bank_mask:0xf
    v_mfma_f32_16x16x32_bf16 v[172:175], a[108:111], a[136:139], v[172:175]
    buffer_load_dwordx4 v248, s[88:91], s26 offen offset:2048  lds
    v_add_f32_dpp v136, v34, v136 wave_ror:1 row_mask:0xf bank_mask:0xf
    v_mfma_f32_16x16x32_bf16 v[172:175], a[112:115], a[132:135], v[172:175]
    v_add_f32_dpp v140, v35, v140 wave_ror:1 row_mask:0xf bank_mask:0xf
    v_fmac_f32 v128, v207, v16
    v_mfma_f32_16x16x32_bf16 v[172:175], a[116:119], a[128:131], v[172:175]
    v_fmac_f32 v132, v207, v17
    v_fmac_f32 v136, v207, v18
    v_mfma_f32_16x16x32_bf16 v[176:179], a[64:67], a[56:59], 0
    v_fmac_f32 v140, v207, v19
    v_cvt_pk_bf16_f32 v16, v128, v132
    v_mfma_f32_16x16x32_bf16 v[176:179], a[68:71], a[52:55], v[176:179]
    v_cvt_pk_bf16_f32 v18, v136, v140
    v_cndmask_b32 v32, v147, v143, s[28:29]
    v_mfma_f32_16x16x32_bf16 v[176:179], a[72:75], a[48:51], v[176:179]
    ds_write_b16 v194, v16 offset:8192
    v_cndmask_b32 v33, v151, v147, s[28:29]
    v_mfma_f32_16x16x32_bf16 v[176:179], a[76:79], a[44:47], v[176:179]
    buffer_load_dwordx4 v249, s[88:91], s26 offen offset:3072  lds
    v_cndmask_b32 v34, v155, v151, s[28:29]
    v_mfma_f32_16x16x32_bf16 v[176:179], a[80:83], a[40:43], v[176:179]
    ds_write_b16_d16_hi v194, v16 offset:8704
    v_cndmask_b32 v35, v159, v155, s[28:29]
    v_mfma_f32_16x16x32_bf16 v[176:179], a[84:87], a[36:39], v[176:179]
    ds_write_b16 v194, v18 offset:9216
    v_add_f32_dpp v146, v32, v146 wave_ror:1 row_mask:0xf bank_mask:0xf
    v_mfma_f32_16x16x32_bf16 v[176:179], a[88:91], a[32:35], v[176:179]
    ds_write_b16_d16_hi v194, v18 offset:9728
    v_add_f32_dpp v150, v33, v150 wave_ror:1 row_mask:0xf bank_mask:0xf
    v_mfma_f32_16x16x32_bf16 v[176:179], a[92:95], a[28:31], v[176:179]
    v_add_f32_dpp v154, v34, v154 wave_ror:1 row_mask:0xf bank_mask:0xf
    v_add_f32_dpp v158, v35, v158 wave_ror:1 row_mask:0xf bank_mask:0xf
    v_mfma_f32_16x16x32_bf16 v[176:179], a[96:99], a[24:27], v[176:179]
    s_add_u32 m0, s98, 98304
    v_cndmask_b32 v32, v146, v142, s[28:29]
    v_mfma_f32_16x16x32_bf16 v[176:179], a[100:103], a[20:23], v[176:179]
    v_cndmask_b32 v33, v150, v146, s[28:29]
    v_cndmask_b32 v34, v154, v150, s[28:29]
    v_mfma_f32_16x16x32_bf16 v[176:179], a[104:107], a[16:19], v[176:179]
    v_cndmask_b32 v35, v158, v154, s[28:29]
    v_add_f32_dpp v145, v32, v145 wave_ror:1 row_mask:0xf bank_mask:0xf
    v_mfma_f32_16x16x32_bf16 v[176:179], a[108:111], a[12:15], v[176:179]
    v_add_f32_dpp v149, v33, v149 wave_ror:1 row_mask:0xf bank_mask:0xf
    v_add_f32_dpp v153, v34, v153 wave_ror:1 row_mask:0xf bank_mask:0xf
    v_mfma_f32_16x16x32_bf16 v[176:179], a[112:115], a[8:11], v[176:179]
    v_add_f32_dpp v157, v35, v157 wave_ror:1 row_mask:0xf bank_mask:0xf
    v_cndmask_b32 v32, v145, v141, s[28:29]
    v_mfma_f32_16x16x32_bf16 v[176:179], a[116:119], a[4:7], v[176:179]
    v_cndmask_b32 v33, v149, v145, s[28:29]
    v_cndmask_b32 v34, v153, v149, s[28:29]
    v_mfma_f32_16x16x32_bf16 v[176:179], a[120:123], a[0:3], v[176:179]
    s_mov_b32 s26, 786432
    v_cndmask_b32 v35, v157, v153, s[28:29]
    v_mfma_f32_16x16x32_bf16 v[180:183], a[64:67], a[184:187], 0
    v_add_f32_dpp v144, v32, v144 wave_ror:1 row_mask:0xf bank_mask:0xf
    v_add_f32_dpp v148, v33, v148 wave_ror:1 row_mask:0xf bank_mask:0xf
    v_mfma_f32_16x16x32_bf16 v[180:183], a[68:71], a[180:183], v[180:183]
    v_add_f32_dpp v152, v34, v152 wave_ror:1 row_mask:0xf bank_mask:0xf
    v_add_f32_dpp v156, v35, v156 wave_ror:1 row_mask:0xf bank_mask:0xf
    v_mfma_f32_16x16x32_bf16 v[180:183], a[72:75], a[176:179], v[180:183]
    v_fmac_f32 v144, v207, v20
    v_fmac_f32 v148, v207, v21
    v_mfma_f32_16x16x32_bf16 v[180:183], a[76:79], a[172:175], v[180:183]
    v_fmac_f32 v152, v207, v22
    v_fmac_f32 v156, v207, v23
    v_mfma_f32_16x16x32_bf16 v[180:183], a[80:83], a[168:171], v[180:183]
    buffer_load_dwordx4 v246, s[88:91], s26 offen offset:0  lds
    v_cvt_pk_bf16_f32 v20, v144, v148
    v_mfma_f32_16x16x32_bf16 v[180:183], a[84:87], a[164:167], v[180:183]
    v_cvt_pk_bf16_f32 v22, v152, v156
    v_cndmask_b32 v32, v163, v159, s[28:29]
    v_mfma_f32_16x16x32_bf16 v[180:183], a[88:91], a[160:163], v[180:183]
    ds_write_b16 v194, v20 offset:10240
    v_cndmask_b32 v33, v167, v163, s[28:29]
    v_mfma_f32_16x16x32_bf16 v[180:183], a[92:95], a[156:159], v[180:183]
    ds_write_b16_d16_hi v194, v20 offset:10752
    v_cndmask_b32 v34, v171, v167, s[28:29]
    v_mfma_f32_16x16x32_bf16 v[180:183], a[96:99], a[152:155], v[180:183]
    ds_write_b16 v194, v22 offset:11264
    v_cndmask_b32 v35, v175, v171, s[28:29]
    v_mfma_f32_16x16x32_bf16 v[180:183], a[100:103], a[148:151], v[180:183]
    buffer_load_dwordx4 v247, s[88:91], s26 offen offset:1024  lds
    v_add_f32_dpp v162, v32, v162 wave_ror:1 row_mask:0xf bank_mask:0xf
    v_mfma_f32_16x16x32_bf16 v[180:183], a[104:107], a[144:147], v[180:183]
    ds_write_b16_d16_hi v194, v22 offset:11776
    v_add_f32_dpp v166, v33, v166 wave_ror:1 row_mask:0xf bank_mask:0xf
    v_mfma_f32_16x16x32_bf16 v[180:183], a[108:111], a[140:143], v[180:183]
    v_add_f32_dpp v170, v34, v170 wave_ror:1 row_mask:0xf bank_mask:0xf
    v_add_f32_dpp v174, v35, v174 wave_ror:1 row_mask:0xf bank_mask:0xf
    v_mfma_f32_16x16x32_bf16 v[180:183], a[112:115], a[136:139], v[180:183]
    v_cndmask_b32 v32, v162, v158, s[28:29]
    v_cndmask_b32 v33, v166, v162, s[28:29]
    v_mfma_f32_16x16x32_bf16 v[180:183], a[116:119], a[132:135], v[180:183]
    v_cndmask_b32 v34, v170, v166, s[28:29]
    v_cndmask_b32 v35, v174, v170, s[28:29]
    v_mfma_f32_16x16x32_bf16 v[180:183], a[120:123], a[128:131], v[180:183]
    v_add_f32_dpp v161, v32, v161 wave_ror:1 row_mask:0xf bank_mask:0xf
    v_add_f32_dpp v165, v33, v165 wave_ror:1 row_mask:0xf bank_mask:0xf
    v_mfma_f32_16x16x32_bf16 v[184:187], a[64:67], a[60:63], 0
    s_waitcnt vmcnt(5)
    v_cmp_eq_u32 vcc, s44, v193
    v_mov_b32 v37, 163836
    s_lshl_b32 s24, s20, 2
    v_subrev_u32 v38, s24, v37
    s_cmp_eq_u32 vcc_lo, -1
    s_cselect_b32 s24, s86, 0
    v_mov_b32 v36, s24
    ds_write_b32 v38, v36
    s_waitcnt lgkmcnt(0)
    s_barrier
    ds_read_b32 v36, v37
    v_mfma_f32_16x16x32_bf16 v[184:187], a[68:71], a[56:59], v[184:187]
    buffer_load_dword v193, v192, s[48:51], s100 offen sc1
    buffer_load_dwordx4 v248, s[88:91], s26 offen offset:2048  lds
    v_mfma_f32_16x16x32_bf16 v[184:187], a[72:75], a[52:55], v[184:187]
    v_add_f32_dpp v169, v34, v169 wave_ror:1 row_mask:0xf bank_mask:0xf
    v_add_f32_dpp v173, v35, v173 wave_ror:1 row_mask:0xf bank_mask:0xf
    v_mfma_f32_16x16x32_bf16 v[184:187], a[76:79], a[48:51], v[184:187]
    v_cndmask_b32 v32, v161, v157, s[28:29]
    v_cndmask_b32 v33, v165, v161, s[28:29]
    v_mfma_f32_16x16x32_bf16 v[184:187], a[80:83], a[44:47], v[184:187]
    v_cndmask_b32 v34, v169, v165, s[28:29]
    v_cndmask_b32 v35, v173, v169, s[28:29]
    v_mfma_f32_16x16x32_bf16 v[184:187], a[84:87], a[40:43], v[184:187]
    buffer_load_dwordx4 v249, s[88:91], s26 offen offset:3072  lds
    v_add_f32_dpp v160, v32, v160 wave_ror:1 row_mask:0xf bank_mask:0xf
    v_mfma_f32_16x16x32_bf16 v[184:187], a[88:91], a[36:39], v[184:187]
    v_add_f32_dpp v164, v33, v164 wave_ror:1 row_mask:0xf bank_mask:0xf
    v_add_f32_dpp v168, v34, v168 wave_ror:1 row_mask:0xf bank_mask:0xf
    v_mfma_f32_16x16x32_bf16 v[184:187], a[92:95], a[32:35], v[184:187]
    s_waitcnt lgkmcnt(0)
    v_readfirstlane_b32 s86, v36
    s_nop 3
    v_mfma_f32_16x16x32_bf16 v[184:187], a[96:99], a[28:31], v[184:187]
    s_mov_b32 s23, 0
    v_add_f32_dpp v172, v35, v172 wave_ror:1 row_mask:0xf bank_mask:0xf
    v_mfma_f32_16x16x32_bf16 v[184:187], a[100:103], a[24:27], v[184:187]
    buffer_load_dwordx4 a[192:195], v232, s[84:87], s23 offen
    v_fmac_f32 v160, v207, v24
    v_mfma_f32_16x16x32_bf16 v[184:187], a[104:107], a[20:23], v[184:187]
    v_fmac_f32 v164, v207, v25
    v_fmac_f32 v168, v207, v26
    v_mfma_f32_16x16x32_bf16 v[184:187], a[108:111], a[16:19], v[184:187]
    buffer_load_dwordx4 a[196:199], v233, s[84:87], s23 offen
    v_fmac_f32 v172, v207, v27
    v_mfma_f32_16x16x32_bf16 v[184:187], a[112:115], a[12:15], v[184:187]
    s_mov_b32 s23, 3072
    v_cvt_pk_bf16_f32 v24, v160, v164
    v_mfma_f32_16x16x32_bf16 v[184:187], a[116:119], a[8:11], v[184:187]
    v_cvt_pk_bf16_f32 v26, v168, v172
    ds_write_b16 v194, v24 offset:12288
    v_mfma_f32_16x16x32_bf16 v[184:187], a[120:123], a[4:7], v[184:187]
    buffer_load_dwordx4 a[200:203], v232, s[84:87], s23 offen
    ds_write_b16_d16_hi v194, v24 offset:12800
    v_mfma_f32_16x16x32_bf16 v[184:187], a[124:127], a[0:3], v[184:187]
    ds_read_b64_tr_b16 a[0:1], v196 offset:0
    buffer_load_dwordx4 a[204:207], v233, s[84:87], s23 offen
    v_mfma_f32_16x16x32_bf16 v[188:191], a[64:67], a[188:191], 0
    ds_read_b64_tr_b16 a[2:3], v196 offset:8192
    ds_write_b16 v194, v26 offset:13312
    v_mfma_f32_16x16x32_bf16 v[188:191], a[68:71], a[184:187], v[188:191]
    ds_read_b64_tr_b16 a[4:5], v196 offset:2048
    s_mov_b32 s23, 6144
    v_mfma_f32_16x16x32_bf16 v[188:191], a[72:75], a[180:183], v[188:191]
    ds_read_b64_tr_b16 a[6:7], v196 offset:10240
    buffer_load_dwordx4 a[208:211], v232, s[84:87], s23 offen
    v_mfma_f32_16x16x32_bf16 v[188:191], a[76:79], a[176:179], v[188:191]
    ds_read_b64_tr_b16 a[8:9], v196 offset:16384
    ds_write_b16_d16_hi v194, v26 offset:13824
    v_mfma_f32_16x16x32_bf16 v[188:191], a[80:83], a[172:175], v[188:191]
    ds_read_b64_tr_b16 a[10:11], v196 offset:24576
    buffer_load_dwordx4 a[212:215], v233, s[84:87], s23 offen
    v_mfma_f32_16x16x32_bf16 v[188:191], a[84:87], a[168:171], v[188:191]
    ds_read_b64_tr_b16 a[12:13], v196 offset:18432
    s_mov_b32 s23, 9216
    v_mfma_f32_16x16x32_bf16 v[188:191], a[88:91], a[164:167], v[188:191]
    ds_read_b64_tr_b16 a[14:15], v196 offset:26624
    v_cndmask_b32 v32, v179, v175, s[28:29]
    v_mfma_f32_16x16x32_bf16 v[188:191], a[92:95], a[160:163], v[188:191]
    ds_read_b64_tr_b16 a[16:17], v197 offset:0
    buffer_load_dwordx4 a[216:219], v232, s[84:87], s23 offen
    v_mfma_f32_16x16x32_bf16 v[188:191], a[96:99], a[156:159], v[188:191]
    ds_read_b64_tr_b16 a[18:19], v197 offset:8192
    buffer_load_dwordx4 a[220:223], v233, s[84:87], s23 offen
    v_mfma_f32_16x16x32_bf16 v[188:191], a[100:103], a[152:155], v[188:191]
    ds_read_b64_tr_b16 a[20:21], v197 offset:2048
    v_cndmask_b32 v33, v183, v179, s[28:29]
    v_mfma_f32_16x16x32_bf16 v[188:191], a[104:107], a[148:151], v[188:191]
    ds_read_b64_tr_b16 a[22:23], v197 offset:10240
    s_mov_b32 s23, 12288
    v_mfma_f32_16x16x32_bf16 v[188:191], a[108:111], a[144:147], v[188:191]
    ds_read_b64_tr_b16 a[24:25], v197 offset:16384
    buffer_load_dwordx4 a[224:227], v232, s[84:87], s23 offen
    v_mfma_f32_16x16x32_bf16 v[188:191], a[112:115], a[140:143], v[188:191]
    ds_read_b64_tr_b16 a[26:27], v197 offset:24576
    v_add_f32_dpp v178, v32, v178 wave_ror:1 row_mask:0xf bank_mask:0xf
    v_mfma_f32_16x16x32_bf16 v[188:191], a[116:119], a[136:139], v[188:191]
    ds_read_b64_tr_b16 a[28:29], v197 offset:18432
    buffer_load_dwordx4 a[228:231], v233, s[84:87], s23 offen
    v_mfma_f32_16x16x32_bf16 v[188:191], a[120:123], a[132:135], v[188:191]
    ds_read_b64_tr_b16 a[30:31], v197 offset:26624
    s_mov_b32 s23, 15360
    v_mfma_f32_16x16x32_bf16 v[188:191], a[124:127], a[128:131], v[188:191]
    buffer_load_dwordx4 a[232:235], v232, s[84:87], s23 offen
    buffer_load_dwordx4 a[236:239], v233, s[84:87], s23 offen
    s_mov_b32 s23, 18432
    buffer_load_dwordx4 a[240:243], v232, s[84:87], s23 offen
    buffer_load_dwordx4 a[244:247], v233, s[84:87], s23 offen
    s_mov_b32 s23, 21504
    buffer_load_dwordx4 a[248:251], v232, s[84:87], s23 offen
    buffer_load_dwordx4 a[252:255], v233, s[84:87], s23 offen
    v_add_f32_dpp v182, v33, v182 wave_ror:1 row_mask:0xf bank_mask:0xf
    v_cndmask_b32 v32, v178, v174, s[28:29]
    v_cndmask_b32 v33, v182, v178, s[28:29]
    s_nop 0
    v_add_f32_dpp v177, v32, v177 wave_ror:1 row_mask:0xf bank_mask:0xf
    v_add_f32_dpp v181, v33, v181 wave_ror:1 row_mask:0xf bank_mask:0xf
    v_cndmask_b32 v32, v177, v173, s[28:29]
    v_cndmask_b32 v33, v181, v177, s[28:29]
    s_nop 0
    v_add_f32_dpp v176, v32, v176 wave_ror:1 row_mask:0xf bank_mask:0xf
    v_add_f32_dpp v180, v33, v180 wave_ror:1 row_mask:0xf bank_mask:0xf
    v_fmac_f32 v176, v207, v28
    v_fmac_f32 v180, v207, v29
    v_cvt_pk_bf16_f32 v28, v176, v180
    ds_write_b16 v194, v28 offset:14336
    ds_write_b16_d16_hi v194, v28 offset:14848
    v_cndmask_b32 v32, v187, v183, s[28:29]
    v_cndmask_b32 v33, v191, v187, s[28:29]
    s_nop 0
    v_add_f32_dpp v186, v32, v186 wave_ror:1 row_mask:0xf bank_mask:0xf
    v_add_f32_dpp v190, v33, v190 wave_ror:1 row_mask:0xf bank_mask:0xf
    v_cndmask_b32 v32, v186, v182, s[28:29]
    v_cndmask_b32 v33, v190, v186, s[28:29]
    s_nop 0
    v_add_f32_dpp v185, v32, v185 wave_ror:1 row_mask:0xf bank_mask:0xf
    v_add_f32_dpp v189, v33, v189 wave_ror:1 row_mask:0xf bank_mask:0xf
    v_cndmask_b32 v32, v185, v181, s[28:29]
    v_cndmask_b32 v33, v189, v185, s[28:29]
    s_nop 0
    v_add_f32_dpp v184, v32, v184 wave_ror:1 row_mask:0xf bank_mask:0xf
    v_add_f32_dpp v188, v33, v188 wave_ror:1 row_mask:0xf bank_mask:0xf
    v_fmac_f32 v184, v207, v30
    v_fmac_f32 v188, v207, v31
    v_cvt_pk_bf16_f32 v30, v184, v188
    ds_write_b16 v194, v30 offset:15360
    ds_write_b16_d16_hi v194, v30 offset:15872
    v_add_u32 v5, s98, v222
    v_add_u32 v6, 114688, v5
    s_lshl_b32 s24, s2, 14
    s_add_u32 s16, s36, 6291456
    s_addc_u32 s17, s37, 0
    s_mov_b32 s18, 4194304
    s_cmp_lg_u32 s86, 0
    s_cbranch_scc1 L_k_hrdy
    s_waitcnt vmcnt(0)
    s_cmp_eq_u32 s20, 0
    s_cbranch_scc0 L_k_ph_ok
    s_mov_b32 s41, 0
L_k_ph:
    v_cmp_eq_u32 vcc, s44, v193
    s_add_u32 s41, s41, 1
    s_nop 3
    s_andn2_b32 vcc_lo, 4294967295, vcc_lo
    s_andn2_b32 vcc_hi, 0, vcc_hi
    s_cmp_eq_u64 vcc, 0
    s_cbranch_scc1 L_k_ph_ok
    s_cmp_gt_u32 s41, 400000
    s_cbranch_scc1 L_k_ph_ok
    s_sleep 4
    buffer_load_dword v193, v192, s[48:51], s100 offen sc1
    s_waitcnt vmcnt(0)
    s_branch L_k_ph
L_k_ph_ok:
    s_waitcnt lgkmcnt(0)
    s_barrier
    s_mov_b32 s86, 172032
    s_mov_b32 s23, 0
    buffer_load_dwordx4 a[192:195], v232, s[84:87], s23 offen
    buffer_load_dwordx4 a[196:199], v233, s[84:87], s23 offen
    s_mov_b32 s23, 3072
    buffer_load_dwordx4 a[200:203], v232, s[84:87], s23 offen
    buffer_load_dwordx4 a[204:207], v233, s[84:87], s23 offen
    s_mov_b32 s23, 6144
    buffer_load_dwordx4 a[208:211], v232, s[84:87], s23 offen
    buffer_load_dwordx4 a[212:215], v233, s[84:87], s23 offen
    s_mov_b32 s23, 9216
    buffer_load_dwordx4 a[216:219], v232, s[84:87], s23 offen
    buffer_load_dwordx4 a[220:223], v233, s[84:87], s23 offen
    s_mov_b32 s23, 12288
    buffer_load_dwordx4 a[224:227], v232, s[84:87], s23 offen
    buffer_load_dwordx4 a[228:231], v233, s[84:87], s23 offen
    s_mov_b32 s23, 15360
    buffer_load_dwordx4 a[232:235], v232, s[84:87], s23 offen
    buffer_load_dwordx4 a[236:239], v233, s[84:87], s23 offen
    s_mov_b32 s23, 18432
    buffer_load_dwordx4 a[240:243], v232, s[84:87], s23 offen
    buffer_load_dwordx4 a[244:247], v233, s[84:87], s23 offen
    s_mov_b32 s23, 21504
    buffer_load_dwordx4 a[248:251], v232, s[84:87], s23 offen
    buffer_load_dwordx4 a[252:255], v233, s[84:87], s23 offen
    s_branch L_k_hgo
L_k_hrdy:
    s_waitcnt lgkmcnt(0)
    s_barrier
L_k_hgo:
    s_waitcnt vmcnt(8)
    v_mfma_f32_16x16x32_bf16 v[128:131], a[0:3], a[192:195], 0
    ds_read_b64_tr_b16 a[64:65], v198 offset:0
    v_mfma_f32_16x16x32_bf16 v[128:131], a[4:7], a[200:203], v[128:131]
    ds_read_b64_tr_b16 a[66:67], v198 offset:8192
    ds_read_b128 v[24:27], v6 offset:0
    v_mfma_f32_16x16x32_bf16 v[128:131], a[8:11], a[208:211], v[128:131]
    ds_read_b64_tr_b16 a[68:69], v198 offset:2048
    s_mov_b32 s39, 65536
    v_mfma_f32_16x16x32_bf16 v[128:131], a[12:15], a[216:219], v[128:131]
    ds_read_b64_tr_b16 a[70:71], v198 offset:10240
    v_add_u32 v208, s39, v196
    v_mfma_f32_16x16x32_bf16 v[132:135], a[12:15], a[220:223], 0
    ds_read_b64_tr_b16 a[72:73], v198 offset:16384
    ds_read_b128 v[28:31], v6 offset:1024
    v_mfma_f32_16x16x32_bf16 v[132:135], a[8:11], a[212:215], v[132:135]
    ds_read_b64_tr_b16 a[74:75], v198 offset:24576
    v_add_u32 v209, s39, v197
    v_mfma_f32_16x16x32_bf16 v[132:135], a[4:7], a[204:207], v[132:135]
    ds_read_b64_tr_b16 a[76:77], v198 offset:18432
    v_add_u32 v210, s39, v198
    v_mfma_f32_16x16x32_bf16 v[132:135], a[0:3], a[196:199], v[132:135]
    ds_read_b64_tr_b16 a[78:79], v198 offset:26624
    v_mfma_f32_16x16x32_bf16 v[140:143], a[16:19], a[196:199], 0
    ds_read_b64_tr_b16 a[80:81], v199 offset:0
    ds_read_b128 v[32:35], v6 offset:2048
    v_mfma_f32_16x16x32_bf16 v[140:143], a[20:23], a[204:207], v[140:143]
    ds_read_b64_tr_b16 a[82:83], v199 offset:8192
    s_mov_b32 s23, 24576
    v_mfma_f32_16x16x32_bf16 v[140:143], a[24:27], a[212:215], v[140:143]
    ds_read_b64_tr_b16 a[84:85], v199 offset:2048
    ds_read_b128 v[36:39], v6 offset:3072
    v_mfma_f32_16x16x32_bf16 v[140:143], a[28:31], a[220:223], v[140:143]
    ds_read_b64_tr_b16 a[86:87], v199 offset:10240
    v_add_u32 v211, s39, v199
    v_mfma_f32_16x16x32_bf16 v[136:139], a[28:31], a[216:219], 0
    ds_read_b64_tr_b16 a[88:89], v199 offset:16384
    buffer_load_dwordx4 a[128:131], v232, s[84:87], s23 offen
    v_mfma_f32_16x16x32_bf16 v[136:139], a[24:27], a[208:211], v[136:139]
    ds_read_b64_tr_b16 a[90:91], v199 offset:24576
    v_add_u32 v212, s39, v200
    v_mfma_f32_16x16x32_bf16 v[136:139], a[20:23], a[200:203], v[136:139]
    ds_read_b64_tr_b16 a[92:93], v199 offset:18432
    v_add_u32 v213, s39, v201
    v_mfma_f32_16x16x32_bf16 v[136:139], a[16:19], a[192:195], v[136:139]
    ds_read_b64_tr_b16 a[94:95], v199 offset:26624
    s_waitcnt lgkmcnt(10)
    v_mfma_f32_16x16x32_bf16 v[144:147], a[64:67], a[192:195], 0
    ds_read_b64_tr_b16 a[32:33], v200 offset:0
    buffer_load_dwordx4 a[132:135], v233, s[84:87], s23 offen
    v_mfma_f32_16x16x32_bf16 v[144:147], a[68:71], a[200:203], v[144:147]
    ds_read_b64_tr_b16 a[34:35], v200 offset:8192
    s_mov_b32 s23, 27648
    v_mfma_f32_16x16x32_bf16 v[144:147], a[72:75], a[208:211], v[144:147]
    ds_read_b64_tr_b16 a[36:37], v200 offset:2048
    s_waitcnt lgkmcnt(8)
    v_mfma_f32_16x16x32_bf16 v[144:147], a[76:79], a[216:219], v[144:147]
    ds_read_b64_tr_b16 a[38:39], v200 offset:10240
    v_add_u32 v214, s39, v202
    v_mfma_f32_16x16x32_bf16 v[148:151], a[76:79], a[220:223], 0
    ds_read_b64_tr_b16 a[40:41], v200 offset:16384
    buffer_load_dwordx4 a[136:139], v232, s[84:87], s23 offen
    v_mfma_f32_16x16x32_bf16 v[148:151], a[72:75], a[212:215], v[148:151]
    ds_read_b64_tr_b16 a[42:43], v200 offset:24576
    v_add_u32 v215, s39, v203
    v_mfma_f32_16x16x32_bf16 v[148:151], a[68:71], a[204:207], v[148:151]
    ds_read_b64_tr_b16 a[44:45], v200 offset:18432
    buffer_store_dwordx4 v[24:27], v5, s[16:19], s24 offen offset:0 sc1
    v_mfma_f32_16x16x32_bf16 v[148:151], a[64:67], a[196:199], v[148:151]
    ds_read_b64_tr_b16 a[46:47], v200 offset:26624
    s_waitcnt lgkmcnt(8)
    v_mfma_f32_16x16x32_bf16 v[156:159], a[80:83], a[196:199], 0
    ds_read_b64_tr_b16 a[48:49], v201 offset:0
    buffer_load_dwordx4 a[140:143], v233, s[84:87], s23 offen
    v_mfma_f32_16x16x32_bf16 v[156:159], a[84:87], a[204:207], v[156:159]
    ds_read_b64_tr_b16 a[50:51], v201 offset:8192
    s_mov_b32 s23, 30720
    v_mfma_f32_16x16x32_bf16 v[156:159], a[88:91], a[212:215], v[156:159]
    ds_read_b64_tr_b16 a[52:53], v201 offset:2048
    buffer_store_dwordx4 v[28:31], v5, s[16:19], s24 offen offset:1024 sc1
    v_mfma_f32_16x16x32_bf16 v[156:159], a[92:95], a[220:223], v[156:159]
    ds_read_b64_tr_b16 a[54:55], v201 offset:10240
L_k_w10:
    s_cbranch_execz L_k_w14
    v_add_u32 v224, s39, v208
    v_mfma_f32_16x16x32_bf16 v[152:155], a[92:95], a[216:219], 0
    ds_read_b64_tr_b16 a[56:57], v201 offset:16384
    buffer_load_dwordx4 a[144:147], v232, s[84:87], s23 offen
    v_mfma_f32_16x16x32_bf16 v[152:155], a[88:91], a[208:211], v[152:155]
    ds_read_b64_tr_b16 a[58:59], v201 offset:24576
    v_add_u32 v225, s39, v209
    v_mfma_f32_16x16x32_bf16 v[152:155], a[84:87], a[200:203], v[152:155]
    ds_read_b64_tr_b16 a[60:61], v201 offset:18432
    buffer_store_dwordx4 v[32:35], v5, s[16:19], s24 offen offset:2048 sc1
    v_mfma_f32_16x16x32_bf16 v[152:155], a[80:83], a[192:195], v[152:155]
    ds_read_b64_tr_b16 a[62:63], v201 offset:26624
    s_waitcnt lgkmcnt(8)
    v_mfma_f32_16x16x32_bf16 v[160:163], a[32:35], a[192:195], 0
    ds_read_b64_tr_b16 a[96:97], v202 offset:0
    buffer_load_dwordx4 a[148:151], v233, s[84:87], s23 offen
    v_mfma_f32_16x16x32_bf16 v[160:163], a[36:39], a[200:203], v[160:163]
    ds_read_b64_tr_b16 a[98:99], v202 offset:8192
    s_mov_b32 s23, 33792
    v_mfma_f32_16x16x32_bf16 v[160:163], a[40:43], a[208:211], v[160:163]
    ds_read_b64_tr_b16 a[100:101], v202 offset:2048
    buffer_store_dwordx4 v[36:39], v5, s[16:19], s24 offen offset:3072 sc1
    v_mfma_f32_16x16x32_bf16 v[160:163], a[44:47], a[216:219], v[160:163]
    ds_read_b64_tr_b16 a[102:103], v202 offset:10240
    v_add_u32 v226, s39, v210
    v_mfma_f32_16x16x32_bf16 v[164:167], a[44:47], a[220:223], 0
    ds_read_b64_tr_b16 a[104:105], v202 offset:16384
    buffer_load_dwordx4 a[152:155], v232, s[84:87], s23 offen
    v_mfma_f32_16x16x32_bf16 v[164:167], a[40:43], a[212:215], v[164:167]
    ds_read_b64_tr_b16 a[106:107], v202 offset:24576
    v_add_u32 v227, s39, v211
    v_mfma_f32_16x16x32_bf16 v[164:167], a[36:39], a[204:207], v[164:167]
    ds_read_b64_tr_b16 a[108:109], v202 offset:18432
    v_add_u32 v228, s39, v212
    v_mfma_f32_16x16x32_bf16 v[164:167], a[32:35], a[196:199], v[164:167]
    ds_read_b64_tr_b16 a[110:111], v202 offset:26624
    s_waitcnt lgkmcnt(8)
    v_mfma_f32_16x16x32_bf16 v[172:175], a[48:51], a[196:199], 0
    ds_read_b64_tr_b16 a[112:113], v203 offset:0
    buffer_load_dwordx4 a[156:159], v233, s[84:87], s23 offen
    v_mfma_f32_16x16x32_bf16 v[172:175], a[52:55], a[204:207], v[172:175]
    ds_read_b64_tr_b16 a[114:115], v203 offset:8192
    s_lshr_b32 s64, s2, 4
    v_mfma_f32_16x16x32_bf16 v[172:175], a[56:59], a[212:215], v[172:175]
    ds_read_b64_tr_b16 a[116:117], v203 offset:2048
    s_lshl_b32 s64, s64, 8
    v_mfma_f32_16x16x32_bf16 v[172:175], a[60:63], a[220:223], v[172:175]
    ds_read_b64_tr_b16 a[118:119], v203 offset:10240
    v_add_u32 v229, s39, v213
    v_mfma_f32_16x16x32_bf16 v[168:171], a[60:63], a[216:219], 0
    ds_read_b64_tr_b16 a[120:121], v203 offset:16384
    s_and_b32 s65, s2, 15
    v_mfma_f32_16x16x32_bf16 v[168:171], a[56:59], a[208:211], v[168:171]
    ds_read_b64_tr_b16 a[122:123], v203 offset:24576
    v_add_u32 v230, s39, v214
    v_mfma_f32_16x16x32_bf16 v[168:171], a[52:55], a[200:203], v[168:171]
    ds_read_b64_tr_b16 a[124:125], v203 offset:18432
    s_lshl_b32 s65, s65, 2
    v_mfma_f32_16x16x32_bf16 v[168:171], a[48:51], a[192:195], v[168:171]
    ds_read_b64_tr_b16 a[126:127], v203 offset:26624
    s_waitcnt lgkmcnt(8)
    v_mfma_f32_16x16x32_bf16 v[176:179], a[96:99], a[192:195], 0
    s_barrier
    ds_read_b64_tr_b16 a[0:1], v196 offset:32768
    v_mfma_f32_16x16x32_bf16 v[176:179], a[100:103], a[200:203], v[176:179]
    ds_read_b64_tr_b16 a[2:3], v196 offset:40960
    s_add_u32 m0, s98, 114688
    v_mfma_f32_16x16x32_bf16 v[176:179], a[104:107], a[208:211], v[176:179]
    ds_read_b64_tr_b16 a[4:5], v196 offset:34816
    s_add_u32 s64, s64, s65
    v_mfma_f32_16x16x32_bf16 v[176:179], a[108:111], a[216:219], v[176:179]
    ds_read_b64_tr_b16 a[6:7], v196 offset:43008
    s_add_u32 s64, s64, 8192
    v_mfma_f32_16x16x32_bf16 v[180:183], a[108:111], a[220:223], 0
    ds_read_b64_tr_b16 a[8:9], v196 offset:49152
    s_mov_b32 s26, 917504
    v_mfma_f32_16x16x32_bf16 v[180:183], a[104:107], a[212:215], v[180:183]
    ds_read_b64_tr_b16 a[10:11], v196 offset:57344
    v_add_u32 v231, s39, v215
    v_mfma_f32_16x16x32_bf16 v[180:183], a[100:103], a[204:207], v[180:183]
    ds_read_b64_tr_b16 a[12:13], v196 offset:51200
    v_and_b32 v218, 15, v221
    v_mfma_f32_16x16x32_bf16 v[180:183], a[96:99], a[196:199], v[180:183]
    ds_read_b64_tr_b16 a[14:15], v196 offset:59392
    s_waitcnt lgkmcnt(8)
    v_mfma_f32_16x16x32_bf16 v[188:191], a[112:115], a[196:199], 0
    ds_read_b64_tr_b16 a[16:17], v197 offset:32768
    buffer_load_dwordx4 v246, s[88:91], s26 offen offset:0  lds
    v_mfma_f32_16x16x32_bf16 v[188:191], a[116:119], a[204:207], v[188:191]
    ds_read_b64_tr_b16 a[18:19], v197 offset:40960
    v_add_u32 v218, s97, v218
    v_mfma_f32_16x16x32_bf16 v[188:191], a[120:123], a[212:215], v[188:191]
    ds_read_b64_tr_b16 a[20:21], v197 offset:34816
    buffer_load_dwordx4 v247, s[88:91], s26 offen offset:1024  lds
    v_mfma_f32_16x16x32_bf16 v[188:191], a[124:127], a[220:223], v[188:191]
    ds_read_b64_tr_b16 a[22:23], v197 offset:43008
    v_lshrrev_b32 v23, 4, v221
    v_mfma_f32_16x16x32_bf16 v[184:187], a[124:127], a[216:219], 0
    ds_read_b64_tr_b16 a[24:25], v197 offset:49152
    v_lshl_add_u32 v219, v23, 2, s96
    v_mfma_f32_16x16x32_bf16 v[184:187], a[120:123], a[208:211], v[184:187]
    ds_read_b64_tr_b16 a[26:27], v197 offset:57344
    v_lshrrev_b32 v216, 3, v221
    v_mfma_f32_16x16x32_bf16 v[184:187], a[116:119], a[200:203], v[184:187]
    ds_read_b64_tr_b16 a[28:29], v197 offset:51200
    v_add_u32 v216, s97, v216
    v_mfma_f32_16x16x32_bf16 v[184:187], a[112:115], a[192:195], v[184:187]
    ds_read_b64_tr_b16 a[30:31], v197 offset:59392
    s_waitcnt vmcnt(14) lgkmcnt(8)
    v_mfma_f32_16x16x32_bf16 v[128:131], a[0:3], a[224:227], v[128:131]
    ds_read_b64_tr_b16 a[64:65], v198 offset:32768
    v_lshlrev_b32 v216, 11, v216
    v_mfma_f32_16x16x32_bf16 v[128:131], a[4:7], a[232:235], v[128:131]
    ds_read_b64_tr_b16 a[66:67], v198 offset:40960
    buffer_load_dwordx4 v248, s[88:91], s26 offen offset:2048  lds
    v_mfma_f32_16x16x32_bf16 v[128:131], a[8:11], a[240:243], v[128:131]
    ds_read_b64_tr_b16 a[68:69], v198 offset:34816
    v_and_b32 v217, 7, v221
    v_mfma_f32_16x16x32_bf16 v[128:131], a[12:15], a[248:251], v[128:131]
    ds_read_b64_tr_b16 a[70:71], v198 offset:43008
    v_lshl_add_u32 v216, v217, 4, v216
    v_mfma_f32_16x16x32_bf16 v[132:135], a[12:15], a[252:255], v[132:135]
    ds_read_b64_tr_b16 a[72:73], v198 offset:49152
    buffer_load_dwordx4 v249, s[88:91], s26 offen offset:3072  lds
    v_mfma_f32_16x16x32_bf16 v[132:135], a[8:11], a[244:247], v[132:135]
    ds_read_b64_tr_b16 a[74:75], v198 offset:57344
    v_and_b32 v217, 15, v221
    v_mfma_f32_16x16x32_bf16 v[132:135], a[4:7], a[236:239], v[132:135]
    ds_read_b64_tr_b16 a[76:77], v198 offset:51200
    v_lshlrev_b32 v217, 7, v217
    v_mfma_f32_16x16x32_bf16 v[132:135], a[0:3], a[228:231], v[132:135]
    ds_read_b64_tr_b16 a[78:79], v198 offset:59392
    s_waitcnt lgkmcnt(8)
    v_mfma_f32_16x16x32_bf16 v[140:143], a[16:19], a[228:231], v[140:143]
    ds_read_b64_tr_b16 a[80:81], v199 offset:32768
    s_mov_b32 s23, 36864
    v_mfma_f32_16x16x32_bf16 v[140:143], a[20:23], a[236:239], v[140:143]
    ds_read_b64_tr_b16 a[82:83], v199 offset:40960
    v_lshl_add_u32 v217, v23, 3, v217
    v_mfma_f32_16x16x32_bf16 v[140:143], a[24:27], a[244:247], v[140:143]
    ds_read_b64_tr_b16 a[84:85], v199 offset:34816
    s_add_u32 s43, s98, 131072
    v_mfma_f32_16x16x32_bf16 v[140:143], a[28:31], a[252:255], v[140:143]
    ds_read_b64_tr_b16 a[86:87], v199 offset:43008
    buffer_load_dwordx4 a[192:195], v232, s[84:87], s23 offen
    v_mfma_f32_16x16x32_bf16 v[136:139], a[28:31], a[248:251], v[136:139]
    ds_read_b64_tr_b16 a[88:89], v199 offset:49152
    v_add_u32 v217, s43, v217
    v_mfma_f32_16x16x32_bf16 v[136:139], a[24:27], a[240:243], v[136:139]
    ds_read_b64_tr_b16 a[90:91], v199 offset:57344
    v_lshlrev_b32 v22, 4, v218
    v_mfma_f32_16x16x32_bf16 v[136:139], a[20:23], a[232:235], v[136:139]
    ds_read_b64_tr_b16 a[92:93], v199 offset:51200
    buffer_load_dwordx4 a[196:199], v233, s[84:87], s23 offen
    v_mfma_f32_16x16x32_bf16 v[136:139], a[16:19], a[224:227], v[136:139]
    ds_read_b64_tr_b16 a[94:95], v199 offset:59392
    s_waitcnt lgkmcnt(8)
    v_mfma_f32_16x16x32_bf16 v[144:147], a[64:67], a[224:227], v[144:147]
    ds_read_b64_tr_b16 a[32:33], v200 offset:32768
    s_mov_b32 s12, s36
    v_mfma_f32_16x16x32_bf16 v[144:147], a[68:71], a[232:235], v[144:147]
    ds_read_b64_tr_b16 a[34:35], v200 offset:40960
    s_add_u32 m0, s98, 131072
    v_mfma_f32_16x16x32_bf16 v[144:147], a[72:75], a[240:243], v[144:147]
    ds_read_b64_tr_b16 a[36:37], v200 offset:34816
    s_mov_b32 s13, s37
    v_mfma_f32_16x16x32_bf16 v[144:147], a[76:79], a[248:251], v[144:147]
    ds_read_b64_tr_b16 a[38:39], v200 offset:43008
    s_mov_b32 s14, 32768
    v_mfma_f32_16x16x32_bf16 v[148:151], a[76:79], a[252:255], v[148:151]
    ds_read_b64_tr_b16 a[40:41], v200 offset:49152
    s_mov_b32 s26, 1048576
    v_mfma_f32_16x16x32_bf16 v[148:151], a[72:75], a[244:247], v[148:151]
    ds_read_b64_tr_b16 a[42:43], v200 offset:57344
    buffer_load_dwordx2 v[40:41], v22, s[12:15], 0 offen offset:0
    v_mfma_f32_16x16x32_bf16 v[148:151], a[68:71], a[236:239], v[148:151]
    ds_read_b64_tr_b16 a[44:45], v200 offset:51200
    buffer_load_dwordx2 v[42:43], v22, s[12:15], 0 offen offset:256
    v_mfma_f32_16x16x32_bf16 v[148:151], a[64:67], a[228:231], v[148:151]
    ds_read_b64_tr_b16 a[46:47], v200 offset:59392
    s_waitcnt lgkmcnt(8)
    v_mfma_f32_16x16x32_bf16 v[156:159], a[80:83], a[228:231], v[156:159]
    ds_read_b64_tr_b16 a[48:49], v201 offset:32768
    buffer_load_dwordx4 v246, s[88:91], s26 offen offset:0  lds
    v_mfma_f32_16x16x32_bf16 v[156:159], a[84:87], a[236:239], v[156:159]
    ds_read_b64_tr_b16 a[50:51], v201 offset:40960
    v_mfma_f32_16x16x32_bf16 v[156:159], a[88:91], a[244:247], v[156:159]
    ds_read_b64_tr_b16 a[52:53], v201 offset:34816
    buffer_load_dwordx4 v247, s[88:91], s26 offen offset:1024  lds
    v_mfma_f32_16x16x32_bf16 v[156:159], a[92:95], a[252:255], v[156:159]
    ds_read_b64_tr_b16 a[54:55], v201 offset:43008
    s_mov_b32 s23, 39936
    v_mfma_f32_16x16x32_bf16 v[152:155], a[92:95], a[248:251], v[152:155]
    ds_read_b64_tr_b16 a[56:57], v201 offset:49152
    v_mfma_f32_16x16x32_bf16 v[152:155], a[88:91], a[240:243], v[152:155]
    ds_read_b64_tr_b16 a[58:59], v201 offset:57344
    buffer_load_dwordx4 a[200:203], v232, s[84:87], s23 offen
    v_mfma_f32_16x16x32_bf16 v[152:155], a[84:87], a[232:235], v[152:155]
    ds_read_b64_tr_b16 a[60:61], v201 offset:51200
    v_mfma_f32_16x16x32_bf16 v[152:155], a[80:83], a[224:227], v[152:155]
    ds_read_b64_tr_b16 a[62:63], v201 offset:59392
    s_waitcnt lgkmcnt(8)
    v_mfma_f32_16x16x32_bf16 v[160:163], a[32:35], a[224:227], v[160:163]
    ds_read_b64_tr_b16 a[96:97], v202 offset:32768
    buffer_load_dwordx4 a[204:207], v233, s[84:87], s23 offen
    v_mfma_f32_16x16x32_bf16 v[160:163], a[36:39], a[232:235], v[160:163]
    ds_read_b64_tr_b16 a[98:99], v202 offset:40960
    buffer_load_dwordx4 v248, s[88:91], s26 offen offset:2048  lds
    v_mfma_f32_16x16x32_bf16 v[160:163], a[40:43], a[240:243], v[160:163]
    ds_read_b64_tr_b16 a[100:101], v202 offset:34816
    v_mfma_f32_16x16x32_bf16 v[160:163], a[44:47], a[248:251], v[160:163]
    ds_read_b64_tr_b16 a[102:103], v202 offset:43008
    v_mfma_f32_16x16x32_bf16 v[164:167], a[44:47], a[252:255], v[164:167]
    ds_read_b64_tr_b16 a[104:105], v202 offset:49152
    buffer_load_dwordx4 v249, s[88:91], s26 offen offset:3072  lds
    v_mfma_f32_16x16x32_bf16 v[164:167], a[40:43], a[244:247], v[164:167]
    ds_read_b64_tr_b16 a[106:107], v202 offset:57344
    v_mfma_f32_16x16x32_bf16 v[164:167], a[36:39], a[236:239], v[164:167]
    ds_read_b64_tr_b16 a[108:109], v202 offset:51200
    v_mfma_f32_16x16x32_bf16 v[164:167], a[32:35], a[228:231], v[164:167]
    ds_read_b64_tr_b16 a[110:111], v202 offset:59392
    s_waitcnt lgkmcnt(8)
    v_mfma_f32_16x16x32_bf16 v[172:175], a[48:51], a[228:231], v[172:175]
    ds_read_b64_tr_b16 a[112:113], v203 offset:32768
    s_mov_b32 s23, 43008
    v_mfma_f32_16x16x32_bf16 v[172:175], a[52:55], a[236:239], v[172:175]
    ds_read_b64_tr_b16 a[114:115], v203 offset:40960
    v_mfma_f32_16x16x32_bf16 v[172:175], a[56:59], a[244:247], v[172:175]
    ds_read_b64_tr_b16 a[116:117], v203 offset:34816
    v_mfma_f32_16x16x32_bf16 v[172:175], a[60:63], a[252:255], v[172:175]
    ds_read_b64_tr_b16 a[118:119], v203 offset:43008
    buffer_load_dwordx4 a[208:211], v232, s[84:87], s23 offen
    v_mfma_f32_16x16x32_bf16 v[168:171], a[60:63], a[248:251], v[168:171]
    ds_read_b64_tr_b16 a[120:121], v203 offset:49152
    v_mfma_f32_16x16x32_bf16 v[168:171], a[56:59], a[240:243], v[168:171]
    ds_read_b64_tr_b16 a[122:123], v203 offset:57344
    v_mfma_f32_16x16x32_bf16 v[168:171], a[52:55], a[232:235], v[168:171]
    ds_read_b64_tr_b16 a[124:125], v203 offset:51200
    buffer_load_dwordx4 a[212:215], v233, s[84:87], s23 offen
    v_mfma_f32_16x16x32_bf16 v[168:171], a[48:51], a[224:227], v[168:171]
    ds_read_b64_tr_b16 a[126:127], v203 offset:59392
    s_waitcnt lgkmcnt(8)
    v_mfma_f32_16x16x32_bf16 v[176:179], a[96:99], a[224:227], v[176:179]
    s_barrier
    ds_read_b64_tr_b16 a[0:1], v208 offset:0
    v_mfma_f32_16x16x32_bf16 v[176:179], a[100:103], a[232:235], v[176:179]
    ds_read_b64_tr_b16 a[2:3], v208 offset:8192
    s_add_u32 m0, s98, 147456
    v_mfma_f32_16x16x32_bf16 v[176:179], a[104:107], a[240:243], v[176:179]
    ds_read_b64_tr_b16 a[4:5], v208 offset:2048
    v_mfma_f32_16x16x32_bf16 v[176:179], a[108:111], a[248:251], v[176:179]
    ds_read_b64_tr_b16 a[6:7], v208 offset:10240
    v_mfma_f32_16x16x32_bf16 v[180:183], a[108:111], a[252:255], v[180:183]
    ds_read_b64_tr_b16 a[8:9], v208 offset:16384
    s_mov_b32 s26, 1179648
    v_mfma_f32_16x16x32_bf16 v[180:183], a[104:107], a[244:247], v[180:183]
    ds_read_b64_tr_b16 a[10:11], v208 offset:24576
    v_mfma_f32_16x16x32_bf16 v[180:183], a[100:103], a[236:239], v[180:183]
    ds_read_b64_tr_b16 a[12:13], v208 offset:18432
    v_mfma_f32_16x16x32_bf16 v[180:183], a[96:99], a[228:231], v[180:183]
    ds_read_b64_tr_b16 a[14:15], v208 offset:26624
    s_waitcnt lgkmcnt(8)
    v_mfma_f32_16x16x32_bf16 v[188:191], a[112:115], a[228:231], v[188:191]
    ds_read_b64_tr_b16 a[16:17], v209 offset:0
    buffer_load_dwordx4 v246, s[88:91], s26 offen offset:0  lds
    v_mfma_f32_16x16x32_bf16 v[188:191], a[116:119], a[236:239], v[188:191]
    ds_read_b64_tr_b16 a[18:19], v209 offset:8192
    v_mfma_f32_16x16x32_bf16 v[188:191], a[120:123], a[244:247], v[188:191]
    ds_read_b64_tr_b16 a[20:21], v209 offset:2048
    buffer_load_dwordx4 v247, s[88:91], s26 offen offset:1024  lds
    v_mfma_f32_16x16x32_bf16 v[188:191], a[124:127], a[252:255], v[188:191]
    ds_read_b64_tr_b16 a[22:23], v209 offset:10240
    s_mov_b32 s23, 46080
    v_mfma_f32_16x16x32_bf16 v[184:187], a[124:127], a[248:251], v[184:187]
    ds_read_b64_tr_b16 a[24:25], v209 offset:16384
    v_mfma_f32_16x16x32_bf16 v[184:187], a[120:123], a[240:243], v[184:187]
    ds_read_b64_tr_b16 a[26:27], v209 offset:24576
    buffer_load_dwordx4 a[216:219], v232, s[84:87], s23 offen
    v_mfma_f32_16x16x32_bf16 v[184:187], a[116:119], a[232:235], v[184:187]
    ds_read_b64_tr_b16 a[28:29], v209 offset:18432
    v_mfma_f32_16x16x32_bf16 v[184:187], a[112:115], a[224:227], v[184:187]
    ds_read_b64_tr_b16 a[30:31], v209 offset:26624
    s_waitcnt vmcnt(19) lgkmcnt(8)
    v_mfma_f32_16x16x32_bf16 v[128:131], a[0:3], a[128:131], v[128:131]
    ds_read_b64_tr_b16 a[64:65], v210 offset:0
    buffer_load_dwordx4 a[220:223], v233, s[84:87], s23 offen
    v_mfma_f32_16x16x32_bf16 v[128:131], a[4:7], a[136:139], v[128:131]
    ds_read_b64_tr_b16 a[66:67], v210 offset:8192
    buffer_load_dwordx4 v248, s[88:91], s26 offen offset:2048  lds
    v_mfma_f32_16x16x32_bf16 v[128:131], a[8:11], a[144:147], v[128:131]
    ds_read_b64_tr_b16 a[68:69], v210 offset:2048
    v_mfma_f32_16x16x32_bf16 v[128:131], a[12:15], a[152:155], v[128:131]
    ds_read_b64_tr_b16 a[70:71], v210 offset:10240
    v_mfma_f32_16x16x32_bf16 v[132:135], a[12:15], a[156:159], v[132:135]
    ds_read_b64_tr_b16 a[72:73], v210 offset:16384
    buffer_load_dwordx4 v249, s[88:91], s26 offen offset:3072  lds
    v_mfma_f32_16x16x32_bf16 v[132:135], a[8:11], a[148:151], v[132:135]
    ds_read_b64_tr_b16 a[74:75], v210 offset:24576
    v_mfma_f32_16x16x32_bf16 v[132:135], a[4:7], a[140:143], v[132:135]
    ds_read_b64_tr_b16 a[76:77], v210 offset:18432
    v_mfma_f32_16x16x32_bf16 v[132:135], a[0:3], a[132:135], v[132:135]
    ds_read_b64_tr_b16 a[78:79], v210 offset:26624
    s_waitcnt lgkmcnt(8)
    v_mfma_f32_16x16x32_bf16 v[140:143], a[16:19], a[132:135], v[140:143]
    ds_read_b64_tr_b16 a[80:81], v211 offset:0
    s_mov_b32 s23, 49152
    v_mfma_f32_16x16x32_bf16 v[140:143], a[20:23], a[140:143], v[140:143]
    ds_read_b64_tr_b16 a[82:83], v211 offset:8192
    v_mfma_f32_16x16x32_bf16 v[140:143], a[24:27], a[148:151], v[140:143]
    ds_read_b64_tr_b16 a[84:85], v211 offset:2048
    v_mfma_f32_16x16x32_bf16 v[140:143], a[28:31], a[156:159], v[140:143]
    ds_read_b64_tr_b16 a[86:87], v211 offset:10240
    buffer_load_dwordx4 a[224:227], v232, s[84:87], s23 offen
    v_mfma_f32_16x16x32_bf16 v[136:139], a[28:31], a[152:155], v[136:139]
    ds_read_b64_tr_b16 a[88:89], v211 offset:16384
    v_mfma_f32_16x16x32_bf16 v[136:139], a[24:27], a[144:147], v[136:139]
    ds_read_b64_tr_b16 a[90:91], v211 offset:24576
    v_mfma_f32_16x16x32_bf16 v[136:139], a[20:23], a[136:139], v[136:139]
    ds_read_b64_tr_b16 a[92:93], v211 offset:18432
    buffer_load_dwordx4 a[228:231], v233, s[84:87], s23 offen
    v_mfma_f32_16x16x32_bf16 v[136:139], a[16:19], a[128:131], v[136:139]
    ds_read_b64_tr_b16 a[94:95], v211 offset:26624
    s_waitcnt lgkmcnt(8)
    v_mfma_f32_16x16x32_bf16 v[144:147], a[64:67], a[128:131], v[144:147]
    ds_read_b64_tr_b16 a[32:33], v212 offset:0
    v_mfma_f32_16x16x32_bf16 v[144:147], a[68:71], a[136:139], v[144:147]
    ds_read_b64_tr_b16 a[34:35], v212 offset:8192
    s_add_u32 m0, s98, 0
    v_mfma_f32_16x16x32_bf16 v[144:147], a[72:75], a[144:147], v[144:147]
    ds_read_b64_tr_b16 a[36:37], v212 offset:2048
    v_mfma_f32_16x16x32_bf16 v[144:147], a[76:79], a[152:155], v[144:147]
    ds_read_b64_tr_b16 a[38:39], v212 offset:10240
    v_mfma_f32_16x16x32_bf16 v[148:151], a[76:79], a[156:159], v[148:151]
    ds_read_b64_tr_b16 a[40:41], v212 offset:16384
    s_mov_b32 s26, 1310720
    v_mfma_f32_16x16x32_bf16 v[148:151], a[72:75], a[148:151], v[148:151]
    ds_read_b64_tr_b16 a[42:43], v212 offset:24576
    v_mfma_f32_16x16x32_bf16 v[148:151], a[68:71], a[140:143], v[148:151]
    ds_read_b64_tr_b16 a[44:45], v212 offset:18432
    v_mfma_f32_16x16x32_bf16 v[148:151], a[64:67], a[132:135], v[148:151]
    ds_read_b64_tr_b16 a[46:47], v212 offset:26624
    s_waitcnt lgkmcnt(8)
    v_mfma_f32_16x16x32_bf16 v[156:159], a[80:83], a[132:135], v[156:159]
    ds_read_b64_tr_b16 a[48:49], v213 offset:0
    buffer_load_dwordx4 v246, s[88:91], s26 offen offset:0  lds
    v_mfma_f32_16x16x32_bf16 v[156:159], a[84:87], a[140:143], v[156:159]
    ds_read_b64_tr_b16 a[50:51], v213 offset:8192
    v_mfma_f32_16x16x32_bf16 v[156:159], a[88:91], a[148:151], v[156:159]
    ds_read_b64_tr_b16 a[52:53], v213 offset:2048
    buffer_load_dwordx4 v247, s[88:91], s26 offen offset:1024  lds
    v_mfma_f32_16x16x32_bf16 v[156:159], a[92:95], a[156:159], v[156:159]
    ds_read_b64_tr_b16 a[54:55], v213 offset:10240
    s_mov_b32 s23, 52224
    v_mfma_f32_16x16x32_bf16 v[152:155], a[92:95], a[152:155], v[152:155]
    ds_read_b64_tr_b16 a[56:57], v213 offset:16384
    v_mfma_f32_16x16x32_bf16 v[152:155], a[88:91], a[144:147], v[152:155]
    ds_read_b64_tr_b16 a[58:59], v213 offset:24576
    buffer_load_dwordx4 a[232:235], v232, s[84:87], s23 offen
    v_mfma_f32_16x16x32_bf16 v[152:155], a[84:87], a[136:139], v[152:155]
    ds_read_b64_tr_b16 a[60:61], v213 offset:18432
    v_mfma_f32_16x16x32_bf16 v[152:155], a[80:83], a[128:131], v[152:155]
    ds_read_b64_tr_b16 a[62:63], v213 offset:26624
    s_waitcnt lgkmcnt(8)
    v_mfma_f32_16x16x32_bf16 v[160:163], a[32:35], a[128:131], v[160:163]
    ds_read_b64_tr_b16 a[96:97], v214 offset:0
    buffer_load_dwordx4 a[236:239], v233, s[84:87], s23 offen
    v_mfma_f32_16x16x32_bf16 v[160:163], a[36:39], a[136:139], v[160:163]
    ds_read_b64_tr_b16 a[98:99], v214 offset:8192
    buffer_load_dwordx4 v248, s[88:91], s26 offen offset:2048  lds
    v_mfma_f32_16x16x32_bf16 v[160:163], a[40:43], a[144:147], v[160:163]
    ds_read_b64_tr_b16 a[100:101], v214 offset:2048
    v_mfma_f32_16x16x32_bf16 v[160:163], a[44:47], a[152:155], v[160:163]
    ds_read_b64_tr_b16 a[102:103], v214 offset:10240
    v_mfma_f32_16x16x32_bf16 v[164:167], a[44:47], a[156:159], v[164:167]
    ds_read_b64_tr_b16 a[104:105], v214 offset:16384
    buffer_load_dwordx4 v249, s[88:91], s26 offen offset:3072  lds
    v_mfma_f32_16x16x32_bf16 v[164:167], a[40:43], a[148:151], v[164:167]
    ds_read_b64_tr_b16 a[106:107], v214 offset:24576
    v_mfma_f32_16x16x32_bf16 v[164:167], a[36:39], a[140:143], v[164:167]
    ds_read_b64_tr_b16 a[108:109], v214 offset:18432
    v_mfma_f32_16x16x32_bf16 v[164:167], a[32:35], a[132:135], v[164:167]
    ds_read_b64_tr_b16 a[110:111], v214 offset:26624
    s_waitcnt lgkmcnt(8)
    v_mfma_f32_16x16x32_bf16 v[172:175], a[48:51], a[132:135], v[172:175]
    ds_read_b64_tr_b16 a[112:113], v215 offset:0
    s_mov_b32 s23, 55296
    v_mfma_f32_16x16x32_bf16 v[172:175], a[52:55], a[140:143], v[172:175]
    ds_read_b64_tr_b16 a[114:115], v215 offset:8192
    v_mfma_f32_16x16x32_bf16 v[172:175], a[56:59], a[148:151], v[172:175]
    ds_read_b64_tr_b16 a[116:117], v215 offset:2048
    v_mfma_f32_16x16x32_bf16 v[172:175], a[60:63], a[156:159], v[172:175]
    ds_read_b64_tr_b16 a[118:119], v215 offset:10240
    buffer_load_dwordx4 a[240:243], v232, s[84:87], s23 offen
    v_mfma_f32_16x16x32_bf16 v[168:171], a[60:63], a[152:155], v[168:171]
    ds_read_b64_tr_b16 a[120:121], v215 offset:16384
    v_mfma_f32_16x16x32_bf16 v[168:171], a[56:59], a[144:147], v[168:171]
    ds_read_b64_tr_b16 a[122:123], v215 offset:24576
    v_mfma_f32_16x16x32_bf16 v[168:171], a[52:55], a[136:139], v[168:171]
    ds_read_b64_tr_b16 a[124:125], v215 offset:18432
    buffer_load_dwordx4 a[244:247], v233, s[84:87], s23 offen
    v_mfma_f32_16x16x32_bf16 v[168:171], a[48:51], a[128:131], v[168:171]
    ds_read_b64_tr_b16 a[126:127], v215 offset:26624
    s_waitcnt lgkmcnt(8)
    v_mfma_f32_16x16x32_bf16 v[176:179], a[96:99], a[128:131], v[176:179]
    s_waitcnt vmcnt(28)
    s_barrier
    ds_read_b64_tr_b16 a[0:1], v208 offset:32768
    v_mfma_f32_16x16x32_bf16 v[176:179], a[100:103], a[136:139], v[176:179]
    ds_read_b64_tr_b16 a[2:3], v208 offset:40960
    s_add_u32 m0, s98, 16384
    v_mfma_f32_16x16x32_bf16 v[176:179], a[104:107], a[144:147], v[176:179]
    ds_read_b64_tr_b16 a[4:5], v208 offset:34816
    buffer_store_dword v252, v251, s[48:51], s64 offen sc1
    v_mfma_f32_16x16x32_bf16 v[176:179], a[108:111], a[152:155], v[176:179]
    ds_read_b64_tr_b16 a[6:7], v208 offset:43008
    v_mfma_f32_16x16x32_bf16 v[180:183], a[108:111], a[156:159], v[180:183]
    ds_read_b64_tr_b16 a[8:9], v208 offset:49152
    s_mov_b32 s26, 1441792
    v_mfma_f32_16x16x32_bf16 v[180:183], a[104:107], a[148:151], v[180:183]
    ds_read_b64_tr_b16 a[10:11], v208 offset:57344
    v_lshrrev_b32 v13, 4, v221
    v_mfma_f32_16x16x32_bf16 v[180:183], a[100:103], a[140:143], v[180:183]
    ds_read_b64_tr_b16 a[12:13], v208 offset:51200
    v_lshlrev_b32 v16, 12, v219
    v_mfma_f32_16x16x32_bf16 v[180:183], a[96:99], a[132:135], v[180:183]
    ds_read_b64_tr_b16 a[14:15], v208 offset:59392
    s_waitcnt lgkmcnt(8)
    v_mfma_f32_16x16x32_bf16 v[188:191], a[112:115], a[132:135], v[188:191]
    ds_read_b64_tr_b16 a[16:17], v209 offset:32768
    buffer_load_dwordx4 v246, s[88:91], s26 offen offset:0  lds
    v_mfma_f32_16x16x32_bf16 v[188:191], a[116:119], a[140:143], v[188:191]
    ds_read_b64_tr_b16 a[18:19], v209 offset:40960
    v_lshl_add_u32 v16, v218, 3, v16
    v_mfma_f32_16x16x32_bf16 v[188:191], a[120:123], a[148:151], v[188:191]
    ds_read_b64_tr_b16 a[20:21], v209 offset:34816
    buffer_load_dwordx4 v247, s[88:91], s26 offen offset:1024  lds
    v_mfma_f32_16x16x32_bf16 v[188:191], a[124:127], a[156:159], v[188:191]
    ds_read_b64_tr_b16 a[22:23], v209 offset:43008
    s_mov_b32 s23, 58368
    v_mfma_f32_16x16x32_bf16 v[184:187], a[124:127], a[152:155], v[184:187]
    ds_read_b64_tr_b16 a[24:25], v209 offset:49152
    v_and_b32 v19, 1, v13
    v_mfma_f32_16x16x32_bf16 v[184:187], a[120:123], a[144:147], v[184:187]
    ds_read_b64_tr_b16 a[26:27], v209 offset:57344
    buffer_load_dwordx4 a[248:251], v232, s[84:87], s23 offen
    v_mfma_f32_16x16x32_bf16 v[184:187], a[116:119], a[136:139], v[184:187]
    ds_read_b64_tr_b16 a[28:29], v209 offset:51200
    v_lshlrev_b32 v19, 4, v19
    v_mfma_f32_16x16x32_bf16 v[184:187], a[112:115], a[128:131], v[184:187]
    ds_read_b64_tr_b16 a[30:31], v209 offset:59392
    s_waitcnt vmcnt(16) lgkmcnt(8)
    v_mfma_f32_16x16x32_bf16 v[128:131], a[0:3], a[192:195], v[128:131]
    ds_read_b64_tr_b16 a[64:65], v210 offset:32768
    buffer_load_dwordx4 a[252:255], v233, s[84:87], s23 offen
    v_mfma_f32_16x16x32_bf16 v[128:131], a[4:7], a[200:203], v[128:131]
    ds_read_b64_tr_b16 a[66:67], v210 offset:40960
    buffer_load_dwordx4 v248, s[88:91], s26 offen offset:2048  lds
    v_mfma_f32_16x16x32_bf16 v[128:131], a[8:11], a[208:211], v[128:131]
    ds_read_b64_tr_b16 a[68:69], v210 offset:34816
    v_lshrrev_b32 v20, 1, v13
    v_mfma_f32_16x16x32_bf16 v[128:131], a[12:15], a[216:219], v[128:131]
    ds_read_b64_tr_b16 a[70:71], v210 offset:43008
    v_lshl_add_u32 v19, v20, 3, v19
    v_mfma_f32_16x16x32_bf16 v[132:135], a[12:15], a[220:223], v[132:135]
    ds_read_b64_tr_b16 a[72:73], v210 offset:49152
    buffer_load_dwordx4 v249, s[88:91], s26 offen offset:3072  lds
    v_mfma_f32_16x16x32_bf16 v[132:135], a[8:11], a[212:215], v[132:135]
    ds_read_b64_tr_b16 a[74:75], v210 offset:57344
    v_add_u32 v19, s96, v19
    v_mfma_f32_16x16x32_bf16 v[132:135], a[4:7], a[204:207], v[132:135]
    ds_read_b64_tr_b16 a[76:77], v210 offset:51200
    v_lshlrev_b32 v19, 1, v19
    v_mfma_f32_16x16x32_bf16 v[132:135], a[0:3], a[196:199], v[132:135]
    ds_read_b64_tr_b16 a[78:79], v210 offset:59392
    s_waitcnt lgkmcnt(8)
    v_mfma_f32_16x16x32_bf16 v[140:143], a[16:19], a[196:199], v[140:143]
    ds_read_b64_tr_b16 a[80:81], v211 offset:32768
    s_mov_b32 s23, 61440
    v_mfma_f32_16x16x32_bf16 v[140:143], a[20:23], a[204:207], v[140:143]
    ds_read_b64_tr_b16 a[82:83], v211 offset:40960
    v_lshl_add_u32 v19, v218, 11, v19
    v_mfma_f32_16x16x32_bf16 v[140:143], a[24:27], a[212:215], v[140:143]
    ds_read_b64_tr_b16 a[84:85], v211 offset:34816
    v_add_u32 v20, 32768, v19
    v_mfma_f32_16x16x32_bf16 v[140:143], a[28:31], a[220:223], v[140:143]
    ds_read_b64_tr_b16 a[86:87], v211 offset:43008
    buffer_load_dwordx4 a[128:131], v232, s[84:87], s23 offen
    v_mfma_f32_16x16x32_bf16 v[136:139], a[28:31], a[216:219], v[136:139]
    ds_read_b64_tr_b16 a[88:89], v211 offset:49152
    s_lshr_b32 s27, s96, 6
    v_mfma_f32_16x16x32_bf16 v[136:139], a[24:27], a[208:211], v[136:139]
    ds_read_b64_tr_b16 a[90:91], v211 offset:57344
    s_lshl_b32 s27, s27, 8
    v_mfma_f32_16x16x32_bf16 v[136:139], a[20:23], a[200:203], v[136:139]
    ds_read_b64_tr_b16 a[92:93], v211 offset:51200
    buffer_load_dwordx4 a[132:135], v233, s[84:87], s23 offen
    v_mfma_f32_16x16x32_bf16 v[136:139], a[16:19], a[192:195], v[136:139]
    ds_read_b64_tr_b16 a[94:95], v211 offset:59392
    s_waitcnt lgkmcnt(8)
    v_mfma_f32_16x16x32_bf16 v[144:147], a[64:67], a[192:195], v[144:147]
    ds_read_b64_tr_b16 a[32:33], v212 offset:32768
    s_add_u32 s27, s27, 8192
    v_mfma_f32_16x16x32_bf16 v[144:147], a[68:71], a[200:203], v[144:147]
    ds_read_b64_tr_b16 a[34:35], v212 offset:40960
    s_add_u32 m0, s98, 32768
    v_mfma_f32_16x16x32_bf16 v[144:147], a[72:75], a[208:211], v[144:147]
    ds_read_b64_tr_b16 a[36:37], v212 offset:34816
    s_add_u32 s56, s36, 41943040
    s_addc_u32 s57, s37, 0
    v_mfma_f32_16x16x32_bf16 v[144:147], a[76:79], a[216:219], v[144:147]
    ds_read_b64_tr_b16 a[38:39], v212 offset:43008
    s_mov_b32 s58, 8388608
    v_mfma_f32_16x16x32_bf16 v[148:151], a[76:79], a[220:223], v[148:151]
    ds_read_b64_tr_b16 a[40:41], v212 offset:49152
    s_mov_b32 s26, 1572864
    v_mfma_f32_16x16x32_bf16 v[148:151], a[72:75], a[212:215], v[148:151]
    ds_read_b64_tr_b16 a[42:43], v212 offset:57344
    s_mov_b32 s59, 0x20000
    v_mfma_f32_16x16x32_bf16 v[148:151], a[68:71], a[204:207], v[148:151]
    ds_read_b64_tr_b16 a[44:45], v212 offset:51200
    s_mov_b32 s32, s92
    v_mfma_f32_16x16x32_bf16 v[148:151], a[64:67], a[196:199], v[148:151]
    ds_read_b64_tr_b16 a[46:47], v212 offset:59392
    s_waitcnt lgkmcnt(8)
    v_mfma_f32_16x16x32_bf16 v[156:159], a[80:83], a[196:199], v[156:159]
    ds_read_b64_tr_b16 a[48:49], v213 offset:32768
    buffer_load_dwordx4 v246, s[88:91], s26 offen offset:0  lds
    v_mfma_f32_16x16x32_bf16 v[156:159], a[84:87], a[204:207], v[156:159]
    ds_read_b64_tr_b16 a[50:51], v213 offset:40960
    s_add_u32 s33, s32, 4096
    v_mfma_f32_16x16x32_bf16 v[156:159], a[88:91], a[212:215], v[156:159]
    ds_read_b64_tr_b16 a[52:53], v213 offset:34816
    buffer_load_dwordx4 v247, s[88:91], s26 offen offset:1024  lds
    v_mfma_f32_16x16x32_bf16 v[156:159], a[92:95], a[220:223], v[156:159]
    ds_read_b64_tr_b16 a[54:55], v213 offset:43008
    s_mov_b32 s23, 64512
    v_mfma_f32_16x16x32_bf16 v[152:155], a[92:95], a[216:219], v[152:155]
    ds_read_b64_tr_b16 a[56:57], v213 offset:49152
    s_xor_b32 s34, s32, 32768
    v_mfma_f32_16x16x32_bf16 v[152:155], a[88:91], a[208:211], v[152:155]
    ds_read_b64_tr_b16 a[58:59], v213 offset:57344
    buffer_load_dwordx4 a[136:139], v232, s[84:87], s23 offen
    v_mfma_f32_16x16x32_bf16 v[152:155], a[84:87], a[200:203], v[152:155]
    ds_read_b64_tr_b16 a[60:61], v213 offset:51200
L_k_w11:
    s_cbranch_execz L_k_wback
    s_xor_b32 s35, s33, 32768
    v_mfma_f32_16x16x32_bf16 v[152:155], a[80:83], a[192:195], v[152:155]
    ds_read_b64_tr_b16 a[62:63], v213 offset:59392
    s_waitcnt lgkmcnt(8)
    v_mfma_f32_16x16x32_bf16 v[160:163], a[32:35], a[192:195], v[160:163]
    ds_read_b64_tr_b16 a[96:97], v214 offset:32768
    buffer_load_dwordx4 a[140:143], v233, s[84:87], s23 offen
    v_mfma_f32_16x16x32_bf16 v[160:163], a[36:39], a[200:203], v[160:163]
    ds_read_b64_tr_b16 a[98:99], v214 offset:40960
    buffer_load_dwordx4 v248, s[88:91], s26 offen offset:2048  lds
    v_mfma_f32_16x16x32_bf16 v[160:163], a[40:43], a[208:211], v[160:163]
    ds_read_b64_tr_b16 a[100:101], v214 offset:34816
    s_lshr_b32 s29, s44, 8
    v_mfma_f32_16x16x32_bf16 v[160:163], a[44:47], a[216:219], v[160:163]
    ds_read_b64_tr_b16 a[102:103], v214 offset:43008
    s_lshr_b32 s46, s44, 16
    v_mfma_f32_16x16x32_bf16 v[164:167], a[44:47], a[220:223], v[164:167]
    ds_read_b64_tr_b16 a[104:105], v214 offset:49152
    buffer_load_dwordx4 v249, s[88:91], s26 offen offset:3072  lds
    v_mfma_f32_16x16x32_bf16 v[164:167], a[40:43], a[212:215], v[164:167]
    ds_read_b64_tr_b16 a[106:107], v214 offset:57344
    s_lshr_b32 s47, s44, 24
    v_mfma_f32_16x16x32_bf16 v[164:167], a[36:39], a[204:207], v[164:167]
    ds_read_b64_tr_b16 a[108:109], v214 offset:51200
    v_mov_b32 v21, 0xff
    v_mfma_f32_16x16x32_bf16 v[164:167], a[32:35], a[196:199], v[164:167]
    ds_read_b64_tr_b16 a[110:111], v214 offset:59392
    s_waitcnt lgkmcnt(8)
    v_mfma_f32_16x16x32_bf16 v[172:175], a[48:51], a[196:199], v[172:175]
    ds_read_b64_tr_b16 a[112:113], v215 offset:32768
    s_mov_b32 s23, 67584
    v_mfma_f32_16x16x32_bf16 v[172:175], a[52:55], a[204:207], v[172:175]
    ds_read_b64_tr_b16 a[114:115], v215 offset:40960
    v_mfma_f32_16x16x32_bf16 v[172:175], a[56:59], a[212:215], v[172:175]
    ds_read_b64_tr_b16 a[116:117], v215 offset:34816
    v_mfma_f32_16x16x32_bf16 v[172:175], a[60:63], a[220:223], v[172:175]
    ds_read_b64_tr_b16 a[118:119], v215 offset:43008
    buffer_load_dwordx4 a[144:147], v232, s[84:87], s23 offen
    v_mfma_f32_16x16x32_bf16 v[168:171], a[60:63], a[216:219], v[168:171]
    ds_read_b64_tr_b16 a[120:121], v215 offset:49152
    v_mfma_f32_16x16x32_bf16 v[168:171], a[56:59], a[208:211], v[168:171]
    ds_read_b64_tr_b16 a[122:123], v215 offset:57344
    v_mfma_f32_16x16x32_bf16 v[168:171], a[52:55], a[200:203], v[168:171]
    ds_read_b64_tr_b16 a[124:125], v215 offset:51200
    buffer_load_dwordx4 a[148:151], v233, s[84:87], s23 offen
    v_mfma_f32_16x16x32_bf16 v[168:171], a[48:51], a[192:195], v[168:171]
    ds_read_b64_tr_b16 a[126:127], v215 offset:59392
    s_waitcnt lgkmcnt(8)
    v_mfma_f32_16x16x32_bf16 v[176:179], a[96:99], a[192:195], v[176:179]
    s_waitcnt vmcnt(27)
    s_barrier
    ds_read_b64_tr_b16 a[0:1], v224 offset:0
    v_mfma_f32_16x16x32_bf16 v[176:179], a[100:103], a[200:203], v[176:179]
    ds_read_b64_tr_b16 a[2:3], v224 offset:8192
    s_add_u32 m0, s98, 49152
    v_mfma_f32_16x16x32_bf16 v[176:179], a[104:107], a[208:211], v[176:179]
    ds_read_b64_tr_b16 a[4:5], v224 offset:2048
    v_mfma_f32_16x16x32_bf16 v[176:179], a[108:111], a[216:219], v[176:179]
    ds_read_b64_tr_b16 a[6:7], v224 offset:10240
    v_mfma_f32_16x16x32_bf16 v[180:183], a[108:111], a[220:223], v[180:183]
    ds_read_b64_tr_b16 a[8:9], v224 offset:16384
    s_mov_b32 s26, 1703936
    v_mfma_f32_16x16x32_bf16 v[180:183], a[104:107], a[212:215], v[180:183]
    ds_read_b64_tr_b16 a[10:11], v224 offset:24576
    v_mfma_f32_16x16x32_bf16 v[180:183], a[100:103], a[204:207], v[180:183]
    ds_read_b64_tr_b16 a[12:13], v224 offset:18432
    v_mfma_f32_16x16x32_bf16 v[180:183], a[96:99], a[196:199], v[180:183]
    ds_read_b64_tr_b16 a[14:15], v224 offset:26624
    s_waitcnt lgkmcnt(8)
    v_mfma_f32_16x16x32_bf16 v[188:191], a[112:115], a[196:199], v[188:191]
    ds_read_b64_tr_b16 a[16:17], v225 offset:0
    buffer_load_dwordx4 v246, s[88:91], s26 offen offset:0  lds
    v_mfma_f32_16x16x32_bf16 v[188:191], a[116:119], a[204:207], v[188:191]
    ds_read_b64_tr_b16 a[18:19], v225 offset:8192
    v_mfma_f32_16x16x32_bf16 v[188:191], a[120:123], a[212:215], v[188:191]
    ds_read_b64_tr_b16 a[20:21], v225 offset:2048
    buffer_load_dwordx4 v247, s[88:91], s26 offen offset:1024  lds
    v_mfma_f32_16x16x32_bf16 v[188:191], a[124:127], a[220:223], v[188:191]
    ds_read_b64_tr_b16 a[22:23], v225 offset:10240
    s_mov_b32 s23, 70656
    v_mfma_f32_16x16x32_bf16 v[184:187], a[124:127], a[216:219], v[184:187]
    ds_read_b64_tr_b16 a[24:25], v225 offset:16384
    v_mfma_f32_16x16x32_bf16 v[184:187], a[120:123], a[208:211], v[184:187]
    ds_read_b64_tr_b16 a[26:27], v225 offset:24576
    buffer_load_dwordx4 a[152:155], v232, s[84:87], s23 offen
    v_mfma_f32_16x16x32_bf16 v[184:187], a[116:119], a[200:203], v[184:187]
    ds_read_b64_tr_b16 a[28:29], v225 offset:18432
    v_mfma_f32_16x16x32_bf16 v[184:187], a[112:115], a[192:195], v[184:187]
    ds_read_b64_tr_b16 a[30:31], v225 offset:26624
    s_waitcnt vmcnt(15) lgkmcnt(8)
    v_mfma_f32_16x16x32_bf16 v[128:131], a[0:3], a[224:227], v[128:131]
    ds_read_b64_tr_b16 a[64:65], v226 offset:0
    buffer_load_dwordx4 a[156:159], v233, s[84:87], s23 offen
    v_mfma_f32_16x16x32_bf16 v[128:131], a[4:7], a[232:235], v[128:131]
    ds_read_b64_tr_b16 a[66:67], v226 offset:8192
    buffer_load_dwordx4 v248, s[88:91], s26 offen offset:2048  lds
    v_mfma_f32_16x16x32_bf16 v[128:131], a[8:11], a[240:243], v[128:131]
    ds_read_b64_tr_b16 a[68:69], v226 offset:2048
    v_mfma_f32_16x16x32_bf16 v[128:131], a[12:15], a[248:251], v[128:131]
    ds_read_b64_tr_b16 a[70:71], v226 offset:10240
    v_mfma_f32_16x16x32_bf16 v[132:135], a[12:15], a[252:255], v[132:135]
    ds_read_b64_tr_b16 a[72:73], v226 offset:16384
    buffer_load_dwordx4 v249, s[88:91], s26 offen offset:3072  lds
    v_mfma_f32_16x16x32_bf16 v[132:135], a[8:11], a[244:247], v[132:135]
    ds_read_b64_tr_b16 a[74:75], v226 offset:24576
    v_mfma_f32_16x16x32_bf16 v[132:135], a[4:7], a[236:239], v[132:135]
    ds_read_b64_tr_b16 a[76:77], v226 offset:18432
    v_mfma_f32_16x16x32_bf16 v[132:135], a[0:3], a[228:231], v[132:135]
    ds_read_b64_tr_b16 a[78:79], v226 offset:26624
    s_waitcnt lgkmcnt(8)
    v_mfma_f32_16x16x32_bf16 v[140:143], a[16:19], a[228:231], v[140:143]
    ds_read_b64_tr_b16 a[80:81], v227 offset:0
    s_mov_b32 s23, 73728
    v_mfma_f32_16x16x32_bf16 v[140:143], a[20:23], a[236:239], v[140:143]
    ds_read_b64_tr_b16 a[82:83], v227 offset:8192
    v_mfma_f32_16x16x32_bf16 v[140:143], a[24:27], a[244:247], v[140:143]
    ds_read_b64_tr_b16 a[84:85], v227 offset:2048
    v_mfma_f32_16x16x32_bf16 v[140:143], a[28:31], a[252:255], v[140:143]
    ds_read_b64_tr_b16 a[86:87], v227 offset:10240
    buffer_load_dwordx4 a[192:195], v232, s[84:87], s23 offen
    v_mfma_f32_16x16x32_bf16 v[136:139], a[28:31], a[248:251], v[136:139]
    ds_read_b64_tr_b16 a[88:89], v227 offset:16384
    v_mfma_f32_16x16x32_bf16 v[136:139], a[24:27], a[240:243], v[136:139]
    ds_read_b64_tr_b16 a[90:91], v227 offset:24576
    v_mfma_f32_16x16x32_bf16 v[136:139], a[20:23], a[232:235], v[136:139]
    ds_read_b64_tr_b16 a[92:93], v227 offset:18432
    buffer_load_dwordx4 a[196:199], v233, s[84:87], s23 offen
    v_mfma_f32_16x16x32_bf16 v[136:139], a[16:19], a[224:227], v[136:139]
    ds_read_b64_tr_b16 a[94:95], v227 offset:26624
    s_waitcnt lgkmcnt(8)
    v_mfma_f32_16x16x32_bf16 v[144:147], a[64:67], a[224:227], v[144:147]
    ds_read_b64_tr_b16 a[32:33], v228 offset:0
    v_mfma_f32_16x16x32_bf16 v[144:147], a[68:71], a[232:235], v[144:147]
    ds_read_b64_tr_b16 a[34:35], v228 offset:8192
    s_add_u32 m0, s98, 65536
    v_mfma_f32_16x16x32_bf16 v[144:147], a[72:75], a[240:243], v[144:147]
    ds_read_b64_tr_b16 a[36:37], v228 offset:2048
    v_mfma_f32_16x16x32_bf16 v[144:147], a[76:79], a[248:251], v[144:147]
    ds_read_b64_tr_b16 a[38:39], v228 offset:10240
    v_mfma_f32_16x16x32_bf16 v[148:151], a[76:79], a[252:255], v[148:151]
    ds_read_b64_tr_b16 a[40:41], v228 offset:16384
    s_mov_b32 s26, 1835008
    v_mfma_f32_16x16x32_bf16 v[148:151], a[72:75], a[244:247], v[148:151]
    ds_read_b64_tr_b16 a[42:43], v228 offset:24576
    v_mfma_f32_16x16x32_bf16 v[148:151], a[68:71], a[236:239], v[148:151]
    ds_read_b64_tr_b16 a[44:45], v228 offset:18432
    v_mfma_f32_16x16x32_bf16 v[148:151], a[64:67], a[228:231], v[148:151]
    ds_read_b64_tr_b16 a[46:47], v228 offset:26624
    s_waitcnt lgkmcnt(8)
    v_mfma_f32_16x16x32_bf16 v[156:159], a[80:83], a[228:231], v[156:159]
    ds_read_b64_tr_b16 a[48:49], v229 offset:0
    buffer_load_dwordx4 v246, s[88:91], s26 offen offset:0  lds
    v_mfma_f32_16x16x32_bf16 v[156:159], a[84:87], a[236:239], v[156:159]
    ds_read_b64_tr_b16 a[50:51], v229 offset:8192
    v_mfma_f32_16x16x32_bf16 v[156:159], a[88:91], a[244:247], v[156:159]
    ds_read_b64_tr_b16 a[52:53], v229 offset:2048
    buffer_load_dwordx4 v247, s[88:91], s26 offen offset:1024  lds
    v_mfma_f32_16x16x32_bf16 v[156:159], a[92:95], a[252:255], v[156:159]
    ds_read_b64_tr_b16 a[54:55], v229 offset:10240
    s_mov_b32 s23, 76800
    v_mfma_f32_16x16x32_bf16 v[152:155], a[92:95], a[248:251], v[152:155]
    ds_read_b64_tr_b16 a[56:57], v229 offset:16384
    v_mfma_f32_16x16x32_bf16 v[152:155], a[88:91], a[240:243], v[152:155]
    ds_read_b64_tr_b16 a[58:59], v229 offset:24576
    buffer_load_dwordx4 a[200:203], v232, s[84:87], s23 offen
    v_mfma_f32_16x16x32_bf16 v[152:155], a[84:87], a[232:235], v[152:155]
    ds_read_b64_tr_b16 a[60:61], v229 offset:18432
    v_mfma_f32_16x16x32_bf16 v[152:155], a[80:83], a[224:227], v[152:155]
    ds_read_b64_tr_b16 a[62:63], v229 offset:26624
    s_waitcnt lgkmcnt(8)
    v_mfma_f32_16x16x32_bf16 v[160:163], a[32:35], a[224:227], v[160:163]
    ds_read_b64_tr_b16 a[96:97], v230 offset:0
    buffer_load_dwordx4 a[204:207], v233, s[84:87], s23 offen
    v_mfma_f32_16x16x32_bf16 v[160:163], a[36:39], a[232:235], v[160:163]
    ds_read_b64_tr_b16 a[98:99], v230 offset:8192
    buffer_load_dwordx4 v248, s[88:91], s26 offen offset:2048  lds
    v_mfma_f32_16x16x32_bf16 v[160:163], a[40:43], a[240:243], v[160:163]
    ds_read_b64_tr_b16 a[100:101], v230 offset:2048
    v_mfma_f32_16x16x32_bf16 v[160:163], a[44:47], a[248:251], v[160:163]
    ds_read_b64_tr_b16 a[102:103], v230 offset:10240
    v_mfma_f32_16x16x32_bf16 v[164:167], a[44:47], a[252:255], v[164:167]
    ds_read_b64_tr_b16 a[104:105], v230 offset:16384
    buffer_load_dwordx4 v249, s[88:91], s26 offen offset:3072  lds
    v_mfma_f32_16x16x32_bf16 v[164:167], a[40:43], a[244:247], v[164:167]
    ds_read_b64_tr_b16 a[106:107], v230 offset:24576
    v_mfma_f32_16x16x32_bf16 v[164:167], a[36:39], a[236:239], v[164:167]
    ds_read_b64_tr_b16 a[108:109], v230 offset:18432
    v_mfma_f32_16x16x32_bf16 v[164:167], a[32:35], a[228:231], v[164:167]
    ds_read_b64_tr_b16 a[110:111], v230 offset:26624
    s_waitcnt lgkmcnt(8)
    v_mfma_f32_16x16x32_bf16 v[172:175], a[48:51], a[228:231], v[172:175]
    ds_read_b64_tr_b16 a[112:113], v231 offset:0
    s_mov_b32 s23, 79872
    v_mfma_f32_16x16x32_bf16 v[172:175], a[52:55], a[236:239], v[172:175]
    ds_read_b64_tr_b16 a[114:115], v231 offset:8192
    v_mfma_f32_16x16x32_bf16 v[172:175], a[56:59], a[244:247], v[172:175]
    ds_read_b64_tr_b16 a[116:117], v231 offset:2048
    v_mfma_f32_16x16x32_bf16 v[172:175], a[60:63], a[252:255], v[172:175]
    ds_read_b64_tr_b16 a[118:119], v231 offset:10240
    buffer_load_dwordx4 a[208:211], v232, s[84:87], s23 offen
    v_mfma_f32_16x16x32_bf16 v[168:171], a[60:63], a[248:251], v[168:171]
    ds_read_b64_tr_b16 a[120:121], v231 offset:16384
    v_mfma_f32_16x16x32_bf16 v[168:171], a[56:59], a[240:243], v[168:171]
    ds_read_b64_tr_b16 a[122:123], v231 offset:24576
    v_mfma_f32_16x16x32_bf16 v[168:171], a[52:55], a[232:235], v[168:171]
    ds_read_b64_tr_b16 a[124:125], v231 offset:18432
    buffer_load_dwordx4 a[212:215], v233, s[84:87], s23 offen
    v_mfma_f32_16x16x32_bf16 v[168:171], a[48:51], a[224:227], v[168:171]
    ds_read_b64_tr_b16 a[126:127], v231 offset:26624
    s_waitcnt lgkmcnt(8)
    v_mfma_f32_16x16x32_bf16 v[176:179], a[96:99], a[224:227], v[176:179]
    s_waitcnt vmcnt(26)
    s_barrier
    ds_read_b64_tr_b16 a[0:1], v196 offset:0
    v_mfma_f32_16x16x32_bf16 v[176:179], a[100:103], a[232:235], v[176:179]
    ds_read_b64_tr_b16 a[2:3], v196 offset:8192
    s_add_u32 m0, s98, 81920
    v_mfma_f32_16x16x32_bf16 v[176:179], a[104:107], a[240:243], v[176:179]
    ds_read_b64_tr_b16 a[4:5], v196 offset:2048
    v_mfma_f32_16x16x32_bf16 v[176:179], a[108:111], a[248:251], v[176:179]
    ds_read_b64_tr_b16 a[6:7], v196 offset:10240
    v_mfma_f32_16x16x32_bf16 v[180:183], a[108:111], a[252:255], v[180:183]
    ds_read_b64_tr_b16 a[8:9], v196 offset:16384
    s_mov_b32 s26, 1966080
    v_mfma_f32_16x16x32_bf16 v[180:183], a[104:107], a[244:247], v[180:183]
    ds_read_b64_tr_b16 a[10:11], v196 offset:24576
    v_mfma_f32_16x16x32_bf16 v[180:183], a[100:103], a[236:239], v[180:183]
    ds_read_b64_tr_b16 a[12:13], v196 offset:18432
    v_mfma_f32_16x16x32_bf16 v[180:183], a[96:99], a[228:231], v[180:183]
    ds_read_b64_tr_b16 a[14:15], v196 offset:26624
    s_waitcnt lgkmcnt(8)
    v_mfma_f32_16x16x32_bf16 v[188:191], a[112:115], a[228:231], v[188:191]
    ds_read_b64_tr_b16 a[16:17], v197 offset:0
    buffer_load_dwordx4 v246, s[88:91], s26 offen offset:0  lds
    v_mfma_f32_16x16x32_bf16 v[188:191], a[116:119], a[236:239], v[188:191]
    ds_read_b64_tr_b16 a[18:19], v197 offset:8192
    v_mfma_f32_16x16x32_bf16 v[188:191], a[120:123], a[244:247], v[188:191]
    ds_read_b64_tr_b16 a[20:21], v197 offset:2048
    buffer_load_dwordx4 v247, s[88:91], s26 offen offset:1024  lds
    v_mfma_f32_16x16x32_bf16 v[188:191], a[124:127], a[252:255], v[188:191]
    ds_read_b64_tr_b16 a[22:23], v197 offset:10240
    s_mov_b32 s23, 82944
    v_mfma_f32_16x16x32_bf16 v[184:187], a[124:127], a[248:251], v[184:187]
    ds_read_b64_tr_b16 a[24:25], v197 offset:16384
    v_mfma_f32_16x16x32_bf16 v[184:187], a[120:123], a[240:243], v[184:187]
    ds_read_b64_tr_b16 a[26:27], v197 offset:24576
    buffer_load_dwordx4 a[216:219], v232, s[84:87], s23 offen
    v_mfma_f32_16x16x32_bf16 v[184:187], a[116:119], a[232:235], v[184:187]
    ds_read_b64_tr_b16 a[28:29], v197 offset:18432
    v_mfma_f32_16x16x32_bf16 v[184:187], a[112:115], a[224:227], v[184:187]
    ds_read_b64_tr_b16 a[30:31], v197 offset:26624
    s_waitcnt vmcnt(15) lgkmcnt(8)
    v_mfma_f32_16x16x32_bf16 v[128:131], a[0:3], a[128:131], v[128:131]
    ds_read_b64_tr_b16 a[64:65], v198 offset:0
    buffer_load_dwordx4 a[220:223], v233, s[84:87], s23 offen
    v_mfma_f32_16x16x32_bf16 v[128:131], a[4:7], a[136:139], v[128:131]
    ds_read_b64_tr_b16 a[66:67], v198 offset:8192
    buffer_load_dwordx4 v248, s[88:91], s26 offen offset:2048  lds
    v_mfma_f32_16x16x32_bf16 v[128:131], a[8:11], a[144:147], v[128:131]
    ds_read_b64_tr_b16 a[68:69], v198 offset:2048
    v_mfma_f32_16x16x32_bf16 v[128:131], a[12:15], a[152:155], v[128:131]
    ds_read_b64_tr_b16 a[70:71], v198 offset:10240
    v_mfma_f32_16x16x32_bf16 v[132:135], a[12:15], a[156:159], v[132:135]
    ds_read_b64_tr_b16 a[72:73], v198 offset:16384
    buffer_load_dwordx4 v249, s[88:91], s26 offen offset:3072  lds
    v_mfma_f32_16x16x32_bf16 v[132:135], a[8:11], a[148:151], v[132:135]
    ds_read_b64_tr_b16 a[74:75], v198 offset:24576
    v_mfma_f32_16x16x32_bf16 v[132:135], a[4:7], a[140:143], v[132:135]
    ds_read_b64_tr_b16 a[76:77], v198 offset:18432
    v_mfma_f32_16x16x32_bf16 v[132:135], a[0:3], a[132:135], v[132:135]
    ds_read_b64_tr_b16 a[78:79], v198 offset:26624
    s_waitcnt lgkmcnt(8)
    v_mfma_f32_16x16x32_bf16 v[140:143], a[16:19], a[132:135], v[140:143]
    ds_read_b64_tr_b16 a[80:81], v199 offset:0
    s_mov_b32 s23, 86016
    v_mfma_f32_16x16x32_bf16 v[140:143], a[20:23], a[140:143], v[140:143]
    ds_read_b64_tr_b16 a[82:83], v199 offset:8192
    v_mfma_f32_16x16x32_bf16 v[140:143], a[24:27], a[148:151], v[140:143]
    ds_read_b64_tr_b16 a[84:85], v199 offset:2048
    v_mfma_f32_16x16x32_bf16 v[140:143], a[28:31], a[156:159], v[140:143]
    ds_read_b64_tr_b16 a[86:87], v199 offset:10240
    buffer_load_dwordx4 a[224:227], v232, s[84:87], s23 offen
    v_mfma_f32_16x16x32_bf16 v[136:139], a[28:31], a[152:155], v[136:139]
    ds_read_b64_tr_b16 a[88:89], v199 offset:16384
    v_mfma_f32_16x16x32_bf16 v[136:139], a[24:27], a[144:147], v[136:139]
    ds_read_b64_tr_b16 a[90:91], v199 offset:24576
    v_mfma_f32_16x16x32_bf16 v[136:139], a[20:23], a[136:139], v[136:139]
    ds_read_b64_tr_b16 a[92:93], v199 offset:18432
    buffer_load_dwordx4 a[228:231], v233, s[84:87], s23 offen
    v_mfma_f32_16x16x32_bf16 v[136:139], a[16:19], a[128:131], v[136:139]
    ds_read_b64_tr_b16 a[94:95], v199 offset:26624
    s_waitcnt lgkmcnt(8)
    v_mfma_f32_16x16x32_bf16 v[144:147], a[64:67], a[128:131], v[144:147]
    ds_read_b64_tr_b16 a[32:33], v200 offset:0
    v_mfma_f32_16x16x32_bf16 v[144:147], a[68:71], a[136:139], v[144:147]
    ds_read_b64_tr_b16 a[34:35], v200 offset:8192
    s_add_u32 m0, s98, 98304
    v_mfma_f32_16x16x32_bf16 v[144:147], a[72:75], a[144:147], v[144:147]
    ds_read_b64_tr_b16 a[36:37], v200 offset:2048
    v_mfma_f32_16x16x32_bf16 v[144:147], a[76:79], a[152:155], v[144:147]
    ds_read_b64_tr_b16 a[38:39], v200 offset:10240
    v_mfma_f32_16x16x32_bf16 v[148:151], a[76:79], a[156:159], v[148:151]
    ds_read_b64_tr_b16 a[40:41], v200 offset:16384
    s_mov_b32 s26, 2097152
    v_mfma_f32_16x16x32_bf16 v[148:151], a[72:75], a[148:151], v[148:151]
    ds_read_b64_tr_b16 a[42:43], v200 offset:24576
    v_mfma_f32_16x16x32_bf16 v[148:151], a[68:71], a[140:143], v[148:151]
    ds_read_b64_tr_b16 a[44:45], v200 offset:18432
    v_mfma_f32_16x16x32_bf16 v[148:151], a[64:67], a[132:135], v[148:151]
    ds_read_b64_tr_b16 a[46:47], v200 offset:26624
    s_waitcnt lgkmcnt(8)
    v_mfma_f32_16x16x32_bf16 v[156:159], a[80:83], a[132:135], v[156:159]
    ds_read_b64_tr_b16 a[48:49], v201 offset:0
    buffer_load_dwordx4 v246, s[88:91], s26 offen offset:0  lds
    v_mfma_f32_16x16x32_bf16 v[156:159], a[84:87], a[140:143], v[156:159]
    ds_read_b64_tr_b16 a[50:51], v201 offset:8192
    v_mfma_f32_16x16x32_bf16 v[156:159], a[88:91], a[148:151], v[156:159]
    ds_read_b64_tr_b16 a[52:53], v201 offset:2048
    buffer_load_dwordx4 v247, s[88:91], s26 offen offset:1024  lds
    v_mfma_f32_16x16x32_bf16 v[156:159], a[92:95], a[156:159], v[156:159]
    ds_read_b64_tr_b16 a[54:55], v201 offset:10240
    s_mov_b32 s23, 89088
    v_mfma_f32_16x16x32_bf16 v[152:155], a[92:95], a[152:155], v[152:155]
    ds_read_b64_tr_b16 a[56:57], v201 offset:16384
    v_mfma_f32_16x16x32_bf16 v[152:155], a[88:91], a[144:147], v[152:155]
    ds_read_b64_tr_b16 a[58:59], v201 offset:24576
    buffer_load_dwordx4 a[232:235], v232, s[84:87], s23 offen
    v_mfma_f32_16x16x32_bf16 v[152:155], a[84:87], a[136:139], v[152:155]
    ds_read_b64_tr_b16 a[60:61], v201 offset:18432
    v_mfma_f32_16x16x32_bf16 v[152:155], a[80:83], a[128:131], v[152:155]
    ds_read_b64_tr_b16 a[62:63], v201 offset:26624
    s_waitcnt lgkmcnt(8)
    v_mfma_f32_16x16x32_bf16 v[160:163], a[32:35], a[128:131], v[160:163]
    ds_read_b64_tr_b16 a[96:97], v202 offset:0
    buffer_load_dwordx4 a[236:239], v233, s[84:87], s23 offen
    v_mfma_f32_16x16x32_bf16 v[160:163], a[36:39], a[136:139], v[160:163]
    ds_read_b64_tr_b16 a[98:99], v202 offset:8192
    buffer_load_dwordx4 v248, s[88:91], s26 offen offset:2048  lds
    v_mfma_f32_16x16x32_bf16 v[160:163], a[40:43], a[144:147], v[160:163]
    ds_read_b64_tr_b16 a[100:101], v202 offset:2048
    v_mfma_f32_16x16x32_bf16 v[160:163], a[44:47], a[152:155], v[160:163]
    ds_read_b64_tr_b16 a[102:103], v202 offset:10240
    v_mfma_f32_16x16x32_bf16 v[164:167], a[44:47], a[156:159], v[164:167]
    ds_read_b64_tr_b16 a[104:105], v202 offset:16384
    buffer_load_dwordx4 v249, s[88:91], s26 offen offset:3072  lds
    v_mfma_f32_16x16x32_bf16 v[164:167], a[40:43], a[148:151], v[164:167]
    ds_read_b64_tr_b16 a[106:107], v202 offset:24576
    v_mfma_f32_16x16x32_bf16 v[164:167], a[36:39], a[140:143], v[164:167]
    ds_read_b64_tr_b16 a[108:109], v202 offset:18432
    v_mfma_f32_16x16x32_bf16 v[164:167], a[32:35], a[132:135], v[164:167]
    ds_read_b64_tr_b16 a[110:111], v202 offset:26624
    s_waitcnt lgkmcnt(8)
    v_mfma_f32_16x16x32_bf16 v[172:175], a[48:51], a[132:135], v[172:175]
    ds_read_b64_tr_b16 a[112:113], v203 offset:0
    s_mov_b32 s23, 92160
    v_mfma_f32_16x16x32_bf16 v[172:175], a[52:55], a[140:143], v[172:175]
    ds_read_b64_tr_b16 a[114:115], v203 offset:8192
    v_mfma_f32_16x16x32_bf16 v[172:175], a[56:59], a[148:151], v[172:175]
    ds_read_b64_tr_b16 a[116:117], v203 offset:2048
    v_mfma_f32_16x16x32_bf16 v[172:175], a[60:63], a[156:159], v[172:175]
    ds_read_b64_tr_b16 a[118:119], v203 offset:10240
    buffer_load_dwordx4 a[240:243], v232, s[84:87], s23 offen
    v_mfma_f32_16x16x32_bf16 v[168:171], a[60:63], a[152:155], v[168:171]
    ds_read_b64_tr_b16 a[120:121], v203 offset:16384
    v_mfma_f32_16x16x32_bf16 v[168:171], a[56:59], a[144:147], v[168:171]
    ds_read_b64_tr_b16 a[122:123], v203 offset:24576
    v_mfma_f32_16x16x32_bf16 v[168:171], a[52:55], a[136:139], v[168:171]
    ds_read_b64_tr_b16 a[124:125], v203 offset:18432
    buffer_load_dwordx4 a[244:247], v233, s[84:87], s23 offen
    v_mfma_f32_16x16x32_bf16 v[168:171], a[48:51], a[128:131], v[168:171]
    ds_read_b64_tr_b16 a[126:127], v203 offset:26624
    s_waitcnt lgkmcnt(8)
    v_mfma_f32_16x16x32_bf16 v[176:179], a[96:99], a[128:131], v[176:179]
    s_waitcnt vmcnt(26)
    s_barrier
    ds_read_b64_tr_b16 a[0:1], v196 offset:32768
    v_mfma_f32_16x16x32_bf16 v[176:179], a[100:103], a[136:139], v[176:179]
    ds_read_b64_tr_b16 a[2:3], v196 offset:40960
    s_add_u32 m0, s98, 114688
    v_mfma_f32_16x16x32_bf16 v[176:179], a[104:107], a[144:147], v[176:179]
    ds_read_b64_tr_b16 a[4:5], v196 offset:34816
    v_mfma_f32_16x16x32_bf16 v[176:179], a[108:111], a[152:155], v[176:179]
    ds_read_b64_tr_b16 a[6:7], v196 offset:43008
    v_mfma_f32_16x16x32_bf16 v[180:183], a[108:111], a[156:159], v[180:183]
    ds_read_b64_tr_b16 a[8:9], v196 offset:49152
    s_mov_b32 s26, 2228224
    v_mfma_f32_16x16x32_bf16 v[180:183], a[104:107], a[148:151], v[180:183]
    ds_read_b64_tr_b16 a[10:11], v196 offset:57344
    v_mfma_f32_16x16x32_bf16 v[180:183], a[100:103], a[140:143], v[180:183]
    ds_read_b64_tr_b16 a[12:13], v196 offset:51200
    v_mfma_f32_16x16x32_bf16 v[180:183], a[96:99], a[132:135], v[180:183]
    ds_read_b64_tr_b16 a[14:15], v196 offset:59392
    s_waitcnt lgkmcnt(8)
    v_mfma_f32_16x16x32_bf16 v[188:191], a[112:115], a[132:135], v[188:191]
    ds_read_b64_tr_b16 a[16:17], v197 offset:32768
    buffer_load_dwordx4 v246, s[88:91], s26 offen offset:0  lds
    v_mfma_f32_16x16x32_bf16 v[188:191], a[116:119], a[140:143], v[188:191]
    ds_read_b64_tr_b16 a[18:19], v197 offset:40960
    v_mfma_f32_16x16x32_bf16 v[188:191], a[120:123], a[148:151], v[188:191]
    ds_read_b64_tr_b16 a[20:21], v197 offset:34816
    buffer_load_dwordx4 v247, s[88:91], s26 offen offset:1024  lds
    v_mfma_f32_16x16x32_bf16 v[188:191], a[124:127], a[156:159], v[188:191]
    ds_read_b64_tr_b16 a[22:23], v197 offset:43008
    s_mov_b32 s23, 95232
    v_mfma_f32_16x16x32_bf16 v[184:187], a[124:127], a[152:155], v[184:187]
    ds_read_b64_tr_b16 a[24:25], v197 offset:49152
    v_mfma_f32_16x16x32_bf16 v[184:187], a[120:123], a[144:147], v[184:187]
    ds_read_b64_tr_b16 a[26:27], v197 offset:57344
    buffer_load_dwordx4 a[248:251], v232, s[84:87], s23 offen
    v_mfma_f32_16x16x32_bf16 v[184:187], a[116:119], a[136:139], v[184:187]
    ds_read_b64_tr_b16 a[28:29], v197 offset:51200
    v_mfma_f32_16x16x32_bf16 v[184:187], a[112:115], a[128:131], v[184:187]
    ds_read_b64_tr_b16 a[30:31], v197 offset:59392
    s_waitcnt vmcnt(15) lgkmcnt(8)
    v_mfma_f32_16x16x32_bf16 v[128:131], a[0:3], a[192:195], v[128:131]
    ds_read_b64_tr_b16 a[64:65], v198 offset:32768
    buffer_load_dwordx4 a[252:255], v233, s[84:87], s23 offen
    v_mfma_f32_16x16x32_bf16 v[128:131], a[4:7], a[200:203], v[128:131]
    ds_read_b64_tr_b16 a[66:67], v198 offset:40960
    buffer_load_dwordx4 v248, s[88:91], s26 offen offset:2048  lds
    v_mfma_f32_16x16x32_bf16 v[128:131], a[8:11], a[208:211], v[128:131]
    ds_read_b64_tr_b16 a[68:69], v198 offset:34816
    v_mfma_f32_16x16x32_bf16 v[128:131], a[12:15], a[216:219], v[128:131]
    ds_read_b64_tr_b16 a[70:71], v198 offset:43008
    v_mfma_f32_16x16x32_bf16 v[132:135], a[12:15], a[220:223], v[132:135]
    ds_read_b64_tr_b16 a[72:73], v198 offset:49152
    buffer_load_dwordx4 v249, s[88:91], s26 offen offset:3072  lds
    v_mfma_f32_16x16x32_bf16 v[132:135], a[8:11], a[212:215], v[132:135]
    ds_read_b64_tr_b16 a[74:75], v198 offset:57344
    v_mfma_f32_16x16x32_bf16 v[132:135], a[4:7], a[204:207], v[132:135]
    ds_read_b64_tr_b16 a[76:77], v198 offset:51200
    v_mfma_f32_16x16x32_bf16 v[132:135], a[0:3], a[196:199], v[132:135]
    ds_read_b64_tr_b16 a[78:79], v198 offset:59392
    s_waitcnt lgkmcnt(8)
    v_mfma_f32_16x16x32_bf16 v[140:143], a[16:19], a[196:199], v[140:143]
    ds_read_b64_tr_b16 a[80:81], v199 offset:32768
    s_mov_b32 s23, 98304
    v_mfma_f32_16x16x32_bf16 v[140:143], a[20:23], a[204:207], v[140:143]
    ds_read_b64_tr_b16 a[82:83], v199 offset:40960
    v_mfma_f32_16x16x32_bf16 v[140:143], a[24:27], a[212:215], v[140:143]
    ds_read_b64_tr_b16 a[84:85], v199 offset:34816
    v_mfma_f32_16x16x32_bf16 v[140:143], a[28:31], a[220:223], v[140:143]
    ds_read_b64_tr_b16 a[86:87], v199 offset:43008
    buffer_load_dwordx4 a[128:131], v232, s[84:87], s23 offen
    v_mfma_f32_16x16x32_bf16 v[136:139], a[28:31], a[216:219], v[136:139]
    ds_read_b64_tr_b16 a[88:89], v199 offset:49152
    v_mfma_f32_16x16x32_bf16 v[136:139], a[24:27], a[208:211], v[136:139]
    ds_read_b64_tr_b16 a[90:91], v199 offset:57344
    v_mfma_f32_16x16x32_bf16 v[136:139], a[20:23], a[200:203], v[136:139]
    ds_read_b64_tr_b16 a[92:93], v199 offset:51200
    buffer_load_dwordx4 a[132:135], v233, s[84:87], s23 offen
    v_mfma_f32_16x16x32_bf16 v[136:139], a[16:19], a[192:195], v[136:139]
    ds_read_b64_tr_b16 a[94:95], v199 offset:59392
    s_waitcnt lgkmcnt(8)
    v_mfma_f32_16x16x32_bf16 v[144:147], a[64:67], a[192:195], v[144:147]
    ds_read_b64_tr_b16 a[32:33], v200 offset:32768
    v_mfma_f32_16x16x32_bf16 v[144:147], a[68:71], a[200:203], v[144:147]
    ds_read_b64_tr_b16 a[34:35], v200 offset:40960
    s_add_u32 m0, s98, 131072
    v_mfma_f32_16x16x32_bf16 v[144:147], a[72:75], a[208:211], v[144:147]
    ds_read_b64_tr_b16 a[36:37], v200 offset:34816
    v_mfma_f32_16x16x32_bf16 v[144:147], a[76:79], a[216:219], v[144:147]
    ds_read_b64_tr_b16 a[38:39], v200 offset:43008
    v_mfma_f32_16x16x32_bf16 v[148:151], a[76:79], a[220:223], v[148:151]
    ds_read_b64_tr_b16 a[40:41], v200 offset:49152
    s_mov_b32 s26, 2359296
    v_mfma_f32_16x16x32_bf16 v[148:151], a[72:75], a[212:215], v[148:151]
    ds_read_b64_tr_b16 a[42:43], v200 offset:57344
    v_mfma_f32_16x16x32_bf16 v[148:151], a[68:71], a[204:207], v[148:151]
    ds_read_b64_tr_b16 a[44:45], v200 offset:51200
    v_mfma_f32_16x16x32_bf16 v[148:151], a[64:67], a[196:199], v[148:151]
    ds_read_b64_tr_b16 a[46:47], v200 offset:59392
    s_waitcnt lgkmcnt(8)
    v_mfma_f32_16x16x32_bf16 v[156:159], a[80:83], a[196:199], v[156:159]
    ds_read_b64_tr_b16 a[48:49], v201 offset:32768
    buffer_load_dwordx4 v246, s[88:91], s26 offen offset:0  lds
    v_mfma_f32_16x16x32_bf16 v[156:159], a[84:87], a[204:207], v[156:159]
    ds_read_b64_tr_b16 a[50:51], v201 offset:40960
    v_mfma_f32_16x16x32_bf16 v[156:159], a[88:91], a[212:215], v[156:159]
    ds_read_b64_tr_b16 a[52:53], v201 offset:34816
    buffer_load_dwordx4 v247, s[88:91], s26 offen offset:1024  lds
    v_mfma_f32_16x16x32_bf16 v[156:159], a[92:95], a[220:223], v[156:159]
    ds_read_b64_tr_b16 a[54:55], v201 offset:43008
    s_mov_b32 s23, 101376
    v_mfma_f32_16x16x32_bf16 v[152:155], a[92:95], a[216:219], v[152:155]
    ds_read_b64_tr_b16 a[56:57], v201 offset:49152
    v_mfma_f32_16x16x32_bf16 v[152:155], a[88:91], a[208:211], v[152:155]
    ds_read_b64_tr_b16 a[58:59], v201 offset:57344
    buffer_load_dwordx4 a[136:139], v232, s[84:87], s23 offen
    v_mfma_f32_16x16x32_bf16 v[152:155], a[84:87], a[200:203], v[152:155]
    ds_read_b64_tr_b16 a[60:61], v201 offset:51200
    v_mfma_f32_16x16x32_bf16 v[152:155], a[80:83], a[192:195], v[152:155]
    ds_read_b64_tr_b16 a[62:63], v201 offset:59392
    s_waitcnt lgkmcnt(8)
    v_mfma_f32_16x16x32_bf16 v[160:163], a[32:35], a[192:195], v[160:163]
    ds_read_b64_tr_b16 a[96:97], v202 offset:32768
    buffer_load_dwordx4 a[140:143], v233, s[84:87], s23 offen
    v_mfma_f32_16x16x32_bf16 v[160:163], a[36:39], a[200:203], v[160:163]
    ds_read_b64_tr_b16 a[98:99], v202 offset:40960
    buffer_load_dwordx4 v248, s[88:91], s26 offen offset:2048  lds
    v_mfma_f32_16x16x32_bf16 v[160:163], a[40:43], a[208:211], v[160:163]
    ds_read_b64_tr_b16 a[100:101], v202 offset:34816
    v_mfma_f32_16x16x32_bf16 v[160:163], a[44:47], a[216:219], v[160:163]
    ds_read_b64_tr_b16 a[102:103], v202 offset:43008
    v_mfma_f32_16x16x32_bf16 v[164:167], a[44:47], a[220:223], v[164:167]
    ds_read_b64_tr_b16 a[104:105], v202 offset:49152
    buffer_load_dwordx4 v249, s[88:91], s26 offen offset:3072  lds
    v_mfma_f32_16x16x32_bf16 v[164:167], a[40:43], a[212:215], v[164:167]
    ds_read_b64_tr_b16 a[106:107], v202 offset:57344
    v_mfma_f32_16x16x32_bf16 v[164:167], a[36:39], a[204:207], v[164:167]
    ds_read_b64_tr_b16 a[108:109], v202 offset:51200
    v_mfma_f32_16x16x32_bf16 v[164:167], a[32:35], a[196:199], v[164:167]
    ds_read_b64_tr_b16 a[110:111], v202 offset:59392
    s_waitcnt lgkmcnt(8)
    v_mfma_f32_16x16x32_bf16 v[172:175], a[48:51], a[196:199], v[172:175]
    ds_read_b64_tr_b16 a[112:113], v203 offset:32768
    s_mov_b32 s23, 104448
    v_mfma_f32_16x16x32_bf16 v[172:175], a[52:55], a[204:207], v[172:175]
    ds_read_b64_tr_b16 a[114:115], v203 offset:40960
    v_mfma_f32_16x16x32_bf16 v[172:175], a[56:59], a[212:215], v[172:175]
    ds_read_b64_tr_b16 a[116:117], v203 offset:34816
    v_mfma_f32_16x16x32_bf16 v[172:175], a[60:63], a[220:223], v[172:175]
    ds_read_b64_tr_b16 a[118:119], v203 offset:43008
    buffer_load_dwordx4 a[144:147], v232, s[84:87], s23 offen
    v_mfma_f32_16x16x32_bf16 v[168:171], a[60:63], a[216:219], v[168:171]
    ds_read_b64_tr_b16 a[120:121], v203 offset:49152
    v_mfma_f32_16x16x32_bf16 v[168:171], a[56:59], a[208:211], v[168:171]
    ds_read_b64_tr_b16 a[122:123], v203 offset:57344
    v_mfma_f32_16x16x32_bf16 v[168:171], a[52:55], a[200:203], v[168:171]
L_k_w12:
    s_cbranch_execz L_k_wback
    ds_read_b64_tr_b16 a[124:125], v203 offset:51200
    buffer_load_dwordx4 a[148:151], v233, s[84:87], s23 offen
    v_mfma_f32_16x16x32_bf16 v[168:171], a[48:51], a[192:195], v[168:171]
    ds_read_b64_tr_b16 a[126:127], v203 offset:59392
    s_waitcnt lgkmcnt(8)
    v_mfma_f32_16x16x32_bf16 v[176:179], a[96:99], a[192:195], v[176:179]
    s_waitcnt vmcnt(26)
    s_barrier
    ds_read_b64_tr_b16 a[0:1], v208 offset:0
    v_mfma_f32_16x16x32_bf16 v[176:179], a[100:103], a[200:203], v[176:179]
    ds_read_b64_tr_b16 a[2:3], v208 offset:8192
    s_add_u32 m0, s98, 147456
    v_mfma_f32_16x16x32_bf16 v[176:179], a[104:107], a[208:211], v[176:179]
    ds_read_b64_tr_b16 a[4:5], v208 offset:2048
    v_mfma_f32_16x16x32_bf16 v[176:179], a[108:111], a[216:219], v[176:179]
    ds_read_b64_tr_b16 a[6:7], v208 offset:10240
    v_mfma_f32_16x16x32_bf16 v[180:183], a[108:111], a[220:223], v[180:183]
    ds_read_b64_tr_b16 a[8:9], v208 offset:16384
    s_mov_b32 s26, 2490368
    v_mfma_f32_16x16x32_bf16 v[180:183], a[104:107], a[212:215], v[180:183]
    ds_read_b64_tr_b16 a[10:11], v208 offset:24576
    v_mfma_f32_16x16x32_bf16 v[180:183], a[100:103], a[204:207], v[180:183]
    ds_read_b64_tr_b16 a[12:13], v208 offset:18432
    v_mfma_f32_16x16x32_bf16 v[180:183], a[96:99], a[196:199], v[180:183]
    ds_read_b64_tr_b16 a[14:15], v208 offset:26624
    s_waitcnt lgkmcnt(8)
    v_mfma_f32_16x16x32_bf16 v[188:191], a[112:115], a[196:199], v[188:191]
    ds_read_b64_tr_b16 a[16:17], v209 offset:0
    buffer_load_dwordx4 v246, s[88:91], s26 offen offset:0  lds
    v_mfma_f32_16x16x32_bf16 v[188:191], a[116:119], a[204:207], v[188:191]
    ds_read_b64_tr_b16 a[18:19], v209 offset:8192
    v_mfma_f32_16x16x32_bf16 v[188:191], a[120:123], a[212:215], v[188:191]
    ds_read_b64_tr_b16 a[20:21], v209 offset:2048
    buffer_load_dwordx4 v247, s[88:91], s26 offen offset:1024  lds
    v_mfma_f32_16x16x32_bf16 v[188:191], a[124:127], a[220:223], v[188:191]
    ds_read_b64_tr_b16 a[22:23], v209 offset:10240
    s_mov_b32 s23, 107520
    v_mfma_f32_16x16x32_bf16 v[184:187], a[124:127], a[216:219], v[184:187]
    ds_read_b64_tr_b16 a[24:25], v209 offset:16384
    v_mfma_f32_16x16x32_bf16 v[184:187], a[120:123], a[208:211], v[184:187]
    ds_read_b64_tr_b16 a[26:27], v209 offset:24576
    buffer_load_dwordx4 a[152:155], v232, s[84:87], s23 offen
    v_mfma_f32_16x16x32_bf16 v[184:187], a[116:119], a[200:203], v[184:187]
    ds_read_b64_tr_b16 a[28:29], v209 offset:18432
    v_mfma_f32_16x16x32_bf16 v[184:187], a[112:115], a[192:195], v[184:187]
    ds_read_b64_tr_b16 a[30:31], v209 offset:26624
    s_waitcnt vmcnt(15) lgkmcnt(8)
    v_mfma_f32_16x16x32_bf16 v[128:131], a[0:3], a[224:227], v[128:131]
    ds_read_b64_tr_b16 a[64:65], v210 offset:0
    buffer_load_dwordx4 a[156:159], v233, s[84:87], s23 offen
    v_mfma_f32_16x16x32_bf16 v[128:131], a[4:7], a[232:235], v[128:131]
    ds_read_b64_tr_b16 a[66:67], v210 offset:8192
    buffer_load_dwordx4 v248, s[88:91], s26 offen offset:2048  lds
    v_mfma_f32_16x16x32_bf16 v[128:131], a[8:11], a[240:243], v[128:131]
    ds_read_b64_tr_b16 a[68:69], v210 offset:2048
    v_mfma_f32_16x16x32_bf16 v[128:131], a[12:15], a[248:251], v[128:131]
    ds_read_b64_tr_b16 a[70:71], v210 offset:10240
    v_mfma_f32_16x16x32_bf16 v[132:135], a[12:15], a[252:255], v[132:135]
    ds_read_b64_tr_b16 a[72:73], v210 offset:16384
    buffer_load_dwordx4 v249, s[88:91], s26 offen offset:3072  lds
    v_mfma_f32_16x16x32_bf16 v[132:135], a[8:11], a[244:247], v[132:135]
    ds_read_b64_tr_b16 a[74:75], v210 offset:24576
    v_mfma_f32_16x16x32_bf16 v[132:135], a[4:7], a[236:239], v[132:135]
    ds_read_b64_tr_b16 a[76:77], v210 offset:18432
    v_mfma_f32_16x16x32_bf16 v[132:135], a[0:3], a[228:231], v[132:135]
    ds_read_b64_tr_b16 a[78:79], v210 offset:26624
    s_waitcnt lgkmcnt(8)
    v_mfma_f32_16x16x32_bf16 v[140:143], a[16:19], a[228:231], v[140:143]
    ds_read_b64_tr_b16 a[80:81], v211 offset:0
    s_mov_b32 s23, 110592
    v_mfma_f32_16x16x32_bf16 v[140:143], a[20:23], a[236:239], v[140:143]
    ds_read_b64_tr_b16 a[82:83], v211 offset:8192
    v_mfma_f32_16x16x32_bf16 v[140:143], a[24:27], a[244:247], v[140:143]
    ds_read_b64_tr_b16 a[84:85], v211 offset:2048
    v_mfma_f32_16x16x32_bf16 v[140:143], a[28:31], a[252:255], v[140:143]
    ds_read_b64_tr_b16 a[86:87], v211 offset:10240
    buffer_load_dwordx4 a[192:195], v232, s[84:87], s23 offen
    v_mfma_f32_16x16x32_bf16 v[136:139], a[28:31], a[248:251], v[136:139]
    ds_read_b64_tr_b16 a[88:89], v211 offset:16384
    v_mfma_f32_16x16x32_bf16 v[136:139], a[24:27], a[240:243], v[136:139]
    ds_read_b64_tr_b16 a[90:91], v211 offset:24576
    v_mfma_f32_16x16x32_bf16 v[136:139], a[20:23], a[232:235], v[136:139]
    ds_read_b64_tr_b16 a[92:93], v211 offset:18432
    buffer_load_dwordx4 a[196:199], v233, s[84:87], s23 offen
    v_mfma_f32_16x16x32_bf16 v[136:139], a[16:19], a[224:227], v[136:139]
    ds_read_b64_tr_b16 a[94:95], v211 offset:26624
    s_waitcnt lgkmcnt(8)
    v_mfma_f32_16x16x32_bf16 v[144:147], a[64:67], a[224:227], v[144:147]
    ds_read_b64_tr_b16 a[32:33], v212 offset:0
    v_mfma_f32_16x16x32_bf16 v[144:147], a[68:71], a[232:235], v[144:147]
    ds_read_b64_tr_b16 a[34:35], v212 offset:8192
    s_add_u32 m0, s98, 0
    v_mfma_f32_16x16x32_bf16 v[144:147], a[72:75], a[240:243], v[144:147]
    ds_read_b64_tr_b16 a[36:37], v212 offset:2048
    v_mfma_f32_16x16x32_bf16 v[144:147], a[76:79], a[248:251], v[144:147]
    ds_read_b64_tr_b16 a[38:39], v212 offset:10240
    v_mfma_f32_16x16x32_bf16 v[148:151], a[76:79], a[252:255], v[148:151]
    ds_read_b64_tr_b16 a[40:41], v212 offset:16384
    s_mov_b32 s26, 2621440
    v_mfma_f32_16x16x32_bf16 v[148:151], a[72:75], a[244:247], v[148:151]
    ds_read_b64_tr_b16 a[42:43], v212 offset:24576
    v_mfma_f32_16x16x32_bf16 v[148:151], a[68:71], a[236:239], v[148:151]
    ds_read_b64_tr_b16 a[44:45], v212 offset:18432
    v_mfma_f32_16x16x32_bf16 v[148:151], a[64:67], a[228:231], v[148:151]
    ds_read_b64_tr_b16 a[46:47], v212 offset:26624
    s_waitcnt lgkmcnt(8)
    v_mfma_f32_16x16x32_bf16 v[156:159], a[80:83], a[228:231], v[156:159]
    ds_read_b64_tr_b16 a[48:49], v213 offset:0
    buffer_load_dwordx4 v246, s[88:91], s26 offen offset:0  lds
    v_mfma_f32_16x16x32_bf16 v[156:159], a[84:87], a[236:239], v[156:159]
    ds_read_b64_tr_b16 a[50:51], v213 offset:8192
    v_mfma_f32_16x16x32_bf16 v[156:159], a[88:91], a[244:247], v[156:159]
    ds_read_b64_tr_b16 a[52:53], v213 offset:2048
    buffer_load_dwordx4 v247, s[88:91], s26 offen offset:1024  lds
    v_mfma_f32_16x16x32_bf16 v[156:159], a[92:95], a[252:255], v[156:159]
    ds_read_b64_tr_b16 a[54:55], v213 offset:10240
    s_mov_b32 s23, 113664
    v_mfma_f32_16x16x32_bf16 v[152:155], a[92:95], a[248:251], v[152:155]
    ds_read_b64_tr_b16 a[56:57], v213 offset:16384
    v_mfma_f32_16x16x32_bf16 v[152:155], a[88:91], a[240:243], v[152:155]
    ds_read_b64_tr_b16 a[58:59], v213 offset:24576
    buffer_load_dwordx4 a[200:203], v232, s[84:87], s23 offen
    v_mfma_f32_16x16x32_bf16 v[152:155], a[84:87], a[232:235], v[152:155]
    ds_read_b64_tr_b16 a[60:61], v213 offset:18432
    v_mfma_f32_16x16x32_bf16 v[152:155], a[80:83], a[224:227], v[152:155]
    ds_read_b64_tr_b16 a[62:63], v213 offset:26624
    s_waitcnt lgkmcnt(8)
    v_mfma_f32_16x16x32_bf16 v[160:163], a[32:35], a[224:227], v[160:163]
    ds_read_b64_tr_b16 a[96:97], v214 offset:0
    buffer_load_dwordx4 a[204:207], v233, s[84:87], s23 offen
    v_mfma_f32_16x16x32_bf16 v[160:163], a[36:39], a[232:235], v[160:163]
    ds_read_b64_tr_b16 a[98:99], v214 offset:8192
    buffer_load_dwordx4 v248, s[88:91], s26 offen offset:2048  lds
    v_mfma_f32_16x16x32_bf16 v[160:163], a[40:43], a[240:243], v[160:163]
    ds_read_b64_tr_b16 a[100:101], v214 offset:2048
    v_mfma_f32_16x16x32_bf16 v[160:163], a[44:47], a[248:251], v[160:163]
    ds_read_b64_tr_b16 a[102:103], v214 offset:10240
    v_mfma_f32_16x16x32_bf16 v[164:167], a[44:47], a[252:255], v[164:167]
    ds_read_b64_tr_b16 a[104:105], v214 offset:16384
    buffer_load_dwordx4 v249, s[88:91], s26 offen offset:3072  lds
    v_mfma_f32_16x16x32_bf16 v[164:167], a[40:43], a[244:247], v[164:167]
    ds_read_b64_tr_b16 a[106:107], v214 offset:24576
    v_mfma_f32_16x16x32_bf16 v[164:167], a[36:39], a[236:239], v[164:167]
    ds_read_b64_tr_b16 a[108:109], v214 offset:18432
    v_mfma_f32_16x16x32_bf16 v[164:167], a[32:35], a[228:231], v[164:167]
    ds_read_b64_tr_b16 a[110:111], v214 offset:26624
    s_waitcnt lgkmcnt(8)
    v_mfma_f32_16x16x32_bf16 v[172:175], a[48:51], a[228:231], v[172:175]
    ds_read_b64_tr_b16 a[112:113], v215 offset:0
    s_mov_b32 s23, 116736
    v_mfma_f32_16x16x32_bf16 v[172:175], a[52:55], a[236:239], v[172:175]
    ds_read_b64_tr_b16 a[114:115], v215 offset:8192
    v_mfma_f32_16x16x32_bf16 v[172:175], a[56:59], a[244:247], v[172:175]
    ds_read_b64_tr_b16 a[116:117], v215 offset:2048
    v_mfma_f32_16x16x32_bf16 v[172:175], a[60:63], a[252:255], v[172:175]
    ds_read_b64_tr_b16 a[118:119], v215 offset:10240
    buffer_load_dwordx4 a[208:211], v232, s[84:87], s23 offen
    v_mfma_f32_16x16x32_bf16 v[168:171], a[60:63], a[248:251], v[168:171]
    ds_read_b64_tr_b16 a[120:121], v215 offset:16384
    v_mfma_f32_16x16x32_bf16 v[168:171], a[56:59], a[240:243], v[168:171]
    ds_read_b64_tr_b16 a[122:123], v215 offset:24576
    v_mfma_f32_16x16x32_bf16 v[168:171], a[52:55], a[232:235], v[168:171]
    ds_read_b64_tr_b16 a[124:125], v215 offset:18432
    buffer_load_dwordx4 a[212:215], v233, s[84:87], s23 offen
    v_mfma_f32_16x16x32_bf16 v[168:171], a[48:51], a[224:227], v[168:171]
    ds_read_b64_tr_b16 a[126:127], v215 offset:26624
    s_waitcnt lgkmcnt(8)
    v_mfma_f32_16x16x32_bf16 v[176:179], a[96:99], a[224:227], v[176:179]
    s_waitcnt vmcnt(26)
    s_barrier
    ds_read_b64_tr_b16 a[0:1], v208 offset:32768
    v_mfma_f32_16x16x32_bf16 v[176:179], a[100:103], a[232:235], v[176:179]
    ds_read_b64_tr_b16 a[2:3], v208 offset:40960
    s_add_u32 m0, s98, 16384
    v_mfma_f32_16x16x32_bf16 v[176:179], a[104:107], a[240:243], v[176:179]
    ds_read_b64_tr_b16 a[4:5], v208 offset:34816
    v_mfma_f32_16x16x32_bf16 v[176:179], a[108:111], a[248:251], v[176:179]
    ds_read_b64_tr_b16 a[6:7], v208 offset:43008
    v_mfma_f32_16x16x32_bf16 v[180:183], a[108:111], a[252:255], v[180:183]
    ds_read_b64_tr_b16 a[8:9], v208 offset:49152
    s_mov_b32 s26, 2752512
    v_mfma_f32_16x16x32_bf16 v[180:183], a[104:107], a[244:247], v[180:183]
    ds_read_b64_tr_b16 a[10:11], v208 offset:57344
    v_mfma_f32_16x16x32_bf16 v[180:183], a[100:103], a[236:239], v[180:183]
    ds_read_b64_tr_b16 a[12:13], v208 offset:51200
    v_mfma_f32_16x16x32_bf16 v[180:183], a[96:99], a[228:231], v[180:183]
    ds_read_b64_tr_b16 a[14:15], v208 offset:59392
    s_waitcnt lgkmcnt(8)
    v_mfma_f32_16x16x32_bf16 v[188:191], a[112:115], a[228:231], v[188:191]
    ds_read_b64_tr_b16 a[16:17], v209 offset:32768
    buffer_load_dwordx4 v246, s[88:91], s26 offen offset:0  lds
    v_mfma_f32_16x16x32_bf16 v[188:191], a[116:119], a[236:239], v[188:191]
    ds_read_b64_tr_b16 a[18:19], v209 offset:40960
    v_mfma_f32_16x16x32_bf16 v[188:191], a[120:123], a[244:247], v[188:191]
    ds_read_b64_tr_b16 a[20:21], v209 offset:34816
    buffer_load_dwordx4 v247, s[88:91], s26 offen offset:1024  lds
    v_mfma_f32_16x16x32_bf16 v[188:191], a[124:127], a[252:255], v[188:191]
    ds_read_b64_tr_b16 a[22:23], v209 offset:43008
    s_mov_b32 s23, 119808
    v_mfma_f32_16x16x32_bf16 v[184:187], a[124:127], a[248:251], v[184:187]
    ds_read_b64_tr_b16 a[24:25], v209 offset:49152
    v_mfma_f32_16x16x32_bf16 v[184:187], a[120:123], a[240:243], v[184:187]
    ds_read_b64_tr_b16 a[26:27], v209 offset:57344
    buffer_load_dwordx4 a[216:219], v232, s[84:87], s23 offen
    v_mfma_f32_16x16x32_bf16 v[184:187], a[116:119], a[232:235], v[184:187]
    ds_read_b64_tr_b16 a[28:29], v209 offset:51200
    v_mfma_f32_16x16x32_bf16 v[184:187], a[112:115], a[224:227], v[184:187]
    ds_read_b64_tr_b16 a[30:31], v209 offset:59392
    s_waitcnt vmcnt(15) lgkmcnt(8)
    v_mfma_f32_16x16x32_bf16 v[128:131], a[0:3], a[128:131], v[128:131]
    ds_read_b64_tr_b16 a[64:65], v210 offset:32768
    buffer_load_dwordx4 a[220:223], v233, s[84:87], s23 offen
    v_mfma_f32_16x16x32_bf16 v[128:131], a[4:7], a[136:139], v[128:131]
    ds_read_b64_tr_b16 a[66:67], v210 offset:40960
    buffer_load_dwordx4 v248, s[88:91], s26 offen offset:2048  lds
    v_mfma_f32_16x16x32_bf16 v[128:131], a[8:11], a[144:147], v[128:131]
    ds_read_b64_tr_b16 a[68:69], v210 offset:34816
    v_mfma_f32_16x16x32_bf16 v[128:131], a[12:15], a[152:155], v[128:131]
    ds_read_b64_tr_b16 a[70:71], v210 offset:43008
    v_mfma_f32_16x16x32_bf16 v[132:135], a[12:15], a[156:159], v[132:135]
    ds_read_b64_tr_b16 a[72:73], v210 offset:49152
    buffer_load_dwordx4 v249, s[88:91], s26 offen offset:3072  lds
    v_mfma_f32_16x16x32_bf16 v[132:135], a[8:11], a[148:151], v[132:135]
    ds_read_b64_tr_b16 a[74:75], v210 offset:57344
    v_mfma_f32_16x16x32_bf16 v[132:135], a[4:7], a[140:143], v[132:135]
    ds_read_b64_tr_b16 a[76:77], v210 offset:51200
    v_mfma_f32_16x16x32_bf16 v[132:135], a[0:3], a[132:135], v[132:135]
    ds_read_b64_tr_b16 a[78:79], v210 offset:59392
    s_waitcnt lgkmcnt(8)
    v_mfma_f32_16x16x32_bf16 v[140:143], a[16:19], a[132:135], v[140:143]
    ds_read_b64_tr_b16 a[80:81], v211 offset:32768
    s_mov_b32 s23, 122880
    v_mfma_f32_16x16x32_bf16 v[140:143], a[20:23], a[140:143], v[140:143]
    ds_read_b64_tr_b16 a[82:83], v211 offset:40960
    v_mfma_f32_16x16x32_bf16 v[140:143], a[24:27], a[148:151], v[140:143]
    ds_read_b64_tr_b16 a[84:85], v211 offset:34816
    v_mfma_f32_16x16x32_bf16 v[140:143], a[28:31], a[156:159], v[140:143]
    ds_read_b64_tr_b16 a[86:87], v211 offset:43008
    buffer_load_dwordx4 a[224:227], v232, s[84:87], s23 offen
    v_mfma_f32_16x16x32_bf16 v[136:139], a[28:31], a[152:155], v[136:139]
    ds_read_b64_tr_b16 a[88:89], v211 offset:49152
    v_mfma_f32_16x16x32_bf16 v[136:139], a[24:27], a[144:147], v[136:139]
    ds_read_b64_tr_b16 a[90:91], v211 offset:57344
    v_mfma_f32_16x16x32_bf16 v[136:139], a[20:23], a[136:139], v[136:139]
    ds_read_b64_tr_b16 a[92:93], v211 offset:51200
    buffer_load_dwordx4 a[228:231], v233, s[84:87], s23 offen
    v_mfma_f32_16x16x32_bf16 v[136:139], a[16:19], a[128:131], v[136:139]
    ds_read_b64_tr_b16 a[94:95], v211 offset:59392
    s_waitcnt lgkmcnt(8)
    v_mfma_f32_16x16x32_bf16 v[144:147], a[64:67], a[128:131], v[144:147]
    ds_read_b64_tr_b16 a[32:33], v212 offset:32768
    v_mfma_f32_16x16x32_bf16 v[144:147], a[68:71], a[136:139], v[144:147]
    ds_read_b64_tr_b16 a[34:35], v212 offset:40960
    s_add_u32 m0, s98, 32768
    v_mfma_f32_16x16x32_bf16 v[144:147], a[72:75], a[144:147], v[144:147]
    ds_read_b64_tr_b16 a[36:37], v212 offset:34816
    v_mfma_f32_16x16x32_bf16 v[144:147], a[76:79], a[152:155], v[144:147]
    ds_read_b64_tr_b16 a[38:39], v212 offset:43008
    v_mfma_f32_16x16x32_bf16 v[148:151], a[76:79], a[156:159], v[148:151]
    ds_read_b64_tr_b16 a[40:41], v212 offset:49152
    s_mov_b32 s26, 2883584
    v_mfma_f32_16x16x32_bf16 v[148:151], a[72:75], a[148:151], v[148:151]
    ds_read_b64_tr_b16 a[42:43], v212 offset:57344
    v_mfma_f32_16x16x32_bf16 v[148:151], a[68:71], a[140:143], v[148:151]
    ds_read_b64_tr_b16 a[44:45], v212 offset:51200
    v_mfma_f32_16x16x32_bf16 v[148:151], a[64:67], a[132:135], v[148:151]
    ds_read_b64_tr_b16 a[46:47], v212 offset:59392
    s_waitcnt lgkmcnt(8)
    v_mfma_f32_16x16x32_bf16 v[156:159], a[80:83], a[132:135], v[156:159]
    ds_read_b64_tr_b16 a[48:49], v213 offset:32768
    buffer_load_dwordx4 v246, s[88:91], s26 offen offset:0  lds
    v_mfma_f32_16x16x32_bf16 v[156:159], a[84:87], a[140:143], v[156:159]
    ds_read_b64_tr_b16 a[50:51], v213 offset:40960
    v_mfma_f32_16x16x32_bf16 v[156:159], a[88:91], a[148:151], v[156:159]
    ds_read_b64_tr_b16 a[52:53], v213 offset:34816
    buffer_load_dwordx4 v247, s[88:91], s26 offen offset:1024  lds
    v_mfma_f32_16x16x32_bf16 v[156:159], a[92:95], a[156:159], v[156:159]
    ds_read_b64_tr_b16 a[54:55], v213 offset:43008
    s_mov_b32 s23, 125952
    v_mfma_f32_16x16x32_bf16 v[152:155], a[92:95], a[152:155], v[152:155]
    ds_read_b64_tr_b16 a[56:57], v213 offset:49152
    v_mfma_f32_16x16x32_bf16 v[152:155], a[88:91], a[144:147], v[152:155]
    ds_read_b64_tr_b16 a[58:59], v213 offset:57344
    buffer_load_dwordx4 a[232:235], v232, s[84:87], s23 offen
    v_mfma_f32_16x16x32_bf16 v[152:155], a[84:87], a[136:139], v[152:155]
    ds_read_b64_tr_b16 a[60:61], v213 offset:51200
    v_mfma_f32_16x16x32_bf16 v[152:155], a[80:83], a[128:131], v[152:155]
    ds_read_b64_tr_b16 a[62:63], v213 offset:59392
    s_waitcnt lgkmcnt(8)
    v_mfma_f32_16x16x32_bf16 v[160:163], a[32:35], a[128:131], v[160:163]
    ds_read_b64_tr_b16 a[96:97], v214 offset:32768
    buffer_load_dwordx4 a[236:239], v233, s[84:87], s23 offen
    v_mfma_f32_16x16x32_bf16 v[160:163], a[36:39], a[136:139], v[160:163]
    ds_read_b64_tr_b16 a[98:99], v214 offset:40960
    buffer_load_dwordx4 v248, s[88:91], s26 offen offset:2048  lds
    v_mfma_f32_16x16x32_bf16 v[160:163], a[40:43], a[144:147], v[160:163]
    ds_read_b64_tr_b16 a[100:101], v214 offset:34816
    v_mfma_f32_16x16x32_bf16 v[160:163], a[44:47], a[152:155], v[160:163]
    ds_read_b64_tr_b16 a[102:103], v214 offset:43008
    v_mfma_f32_16x16x32_bf16 v[164:167], a[44:47], a[156:159], v[164:167]
    ds_read_b64_tr_b16 a[104:105], v214 offset:49152
    buffer_load_dwordx4 v249, s[88:91], s26 offen offset:3072  lds
    v_mfma_f32_16x16x32_bf16 v[164:167], a[40:43], a[148:151], v[164:167]
    ds_read_b64_tr_b16 a[106:107], v214 offset:57344
    v_mfma_f32_16x16x32_bf16 v[164:167], a[36:39], a[140:143], v[164:167]
    ds_read_b64_tr_b16 a[108:109], v214 offset:51200
    v_mfma_f32_16x16x32_bf16 v[164:167], a[32:35], a[132:135], v[164:167]
    ds_read_b64_tr_b16 a[110:111], v214 offset:59392
    s_waitcnt lgkmcnt(8)
    v_mfma_f32_16x16x32_bf16 v[172:175], a[48:51], a[132:135], v[172:175]
    ds_read_b64_tr_b16 a[112:113], v215 offset:32768
    s_mov_b32 s23, 129024
    v_mfma_f32_16x16x32_bf16 v[172:175], a[52:55], a[140:143], v[172:175]
    ds_read_b64_tr_b16 a[114:115], v215 offset:40960
    v_mfma_f32_16x16x32_bf16 v[172:175], a[56:59], a[148:151], v[172:175]
    ds_read_b64_tr_b16 a[116:117], v215 offset:34816
    v_mfma_f32_16x16x32_bf16 v[172:175], a[60:63], a[156:159], v[172:175]
    ds_read_b64_tr_b16 a[118:119], v215 offset:43008
    buffer_load_dwordx4 a[240:243], v232, s[84:87], s23 offen
    v_mfma_f32_16x16x32_bf16 v[168:171], a[60:63], a[152:155], v[168:171]
    ds_read_b64_tr_b16 a[120:121], v215 offset:49152
    v_mfma_f32_16x16x32_bf16 v[168:171], a[56:59], a[144:147], v[168:171]
    ds_read_b64_tr_b16 a[122:123], v215 offset:57344
    v_mfma_f32_16x16x32_bf16 v[168:171], a[52:55], a[136:139], v[168:171]
    ds_read_b64_tr_b16 a[124:125], v215 offset:51200
    buffer_load_dwordx4 a[244:247], v233, s[84:87], s23 offen
    v_mfma_f32_16x16x32_bf16 v[168:171], a[48:51], a[128:131], v[168:171]
    ds_read_b64_tr_b16 a[126:127], v215 offset:59392
    s_waitcnt lgkmcnt(8)
    v_mfma_f32_16x16x32_bf16 v[176:179], a[96:99], a[128:131], v[176:179]
    s_waitcnt vmcnt(26)
    s_barrier
    ds_read_b64_tr_b16 a[0:1], v224 offset:0
    v_mfma_f32_16x16x32_bf16 v[176:179], a[100:103], a[136:139], v[176:179]
    ds_read_b64_tr_b16 a[2:3], v224 offset:8192
    s_add_u32 m0, s98, 49152
    v_mfma_f32_16x16x32_bf16 v[176:179], a[104:107], a[144:147], v[176:179]
    ds_read_b64_tr_b16 a[4:5], v224 offset:2048
    v_mfma_f32_16x16x32_bf16 v[176:179], a[108:111], a[152:155], v[176:179]
    ds_read_b64_tr_b16 a[6:7], v224 offset:10240
    v_mfma_f32_16x16x32_bf16 v[180:183], a[108:111], a[156:159], v[180:183]
    ds_read_b64_tr_b16 a[8:9], v224 offset:16384
    s_mov_b32 s26, 3014656
    v_mfma_f32_16x16x32_bf16 v[180:183], a[104:107], a[148:151], v[180:183]
    ds_read_b64_tr_b16 a[10:11], v224 offset:24576
    v_mfma_f32_16x16x32_bf16 v[180:183], a[100:103], a[140:143], v[180:183]
    ds_read_b64_tr_b16 a[12:13], v224 offset:18432
    v_mfma_f32_16x16x32_bf16 v[180:183], a[96:99], a[132:135], v[180:183]
    ds_read_b64_tr_b16 a[14:15], v224 offset:26624
    s_waitcnt lgkmcnt(8)
    v_mfma_f32_16x16x32_bf16 v[188:191], a[112:115], a[132:135], v[188:191]
    ds_read_b64_tr_b16 a[16:17], v225 offset:0
    buffer_load_dwordx4 v246, s[88:91], s26 offen offset:0  lds
    v_mfma_f32_16x16x32_bf16 v[188:191], a[116:119], a[140:143], v[188:191]
    ds_read_b64_tr_b16 a[18:19], v225 offset:8192
    v_mfma_f32_16x16x32_bf16 v[188:191], a[120:123], a[148:151], v[188:191]
    ds_read_b64_tr_b16 a[20:21], v225 offset:2048
    buffer_load_dwordx4 v247, s[88:91], s26 offen offset:1024  lds
    v_mfma_f32_16x16x32_bf16 v[188:191], a[124:127], a[156:159], v[188:191]
    ds_read_b64_tr_b16 a[22:23], v225 offset:10240
    s_mov_b32 s23, 132096
    v_mfma_f32_16x16x32_bf16 v[184:187], a[124:127], a[152:155], v[184:187]
    ds_read_b64_tr_b16 a[24:25], v225 offset:16384
    v_mfma_f32_16x16x32_bf16 v[184:187], a[120:123], a[144:147], v[184:187]
    ds_read_b64_tr_b16 a[26:27], v225 offset:24576
    buffer_load_dwordx4 a[248:251], v232, s[84:87], s23 offen
    v_mfma_f32_16x16x32_bf16 v[184:187], a[116:119], a[136:139], v[184:187]
    ds_read_b64_tr_b16 a[28:29], v225 offset:18432
    v_mfma_f32_16x16x32_bf16 v[184:187], a[112:115], a[128:131], v[184:187]
    ds_read_b64_tr_b16 a[30:31], v225 offset:26624
    s_waitcnt vmcnt(15) lgkmcnt(8)
    v_mfma_f32_16x16x32_bf16 v[128:131], a[0:3], a[192:195], v[128:131]
    ds_read_b64_tr_b16 a[64:65], v226 offset:0
    buffer_load_dwordx4 a[252:255], v233, s[84:87], s23 offen
    v_mfma_f32_16x16x32_bf16 v[128:131], a[4:7], a[200:203], v[128:131]
    ds_read_b64_tr_b16 a[66:67], v226 offset:8192
    buffer_load_dwordx4 v248, s[88:91], s26 offen offset:2048  lds
    v_mfma_f32_16x16x32_bf16 v[128:131], a[8:11], a[208:211], v[128:131]
    ds_read_b64_tr_b16 a[68:69], v226 offset:2048
    v_mfma_f32_16x16x32_bf16 v[128:131], a[12:15], a[216:219], v[128:131]
    ds_read_b64_tr_b16 a[70:71], v226 offset:10240
    v_mfma_f32_16x16x32_bf16 v[132:135], a[12:15], a[220:223], v[132:135]
    ds_read_b64_tr_b16 a[72:73], v226 offset:16384
    buffer_load_dwordx4 v249, s[88:91], s26 offen offset:3072  lds
    v_mfma_f32_16x16x32_bf16 v[132:135], a[8:11], a[212:215], v[132:135]
    ds_read_b64_tr_b16 a[74:75], v226 offset:24576
    v_mfma_f32_16x16x32_bf16 v[132:135], a[4:7], a[204:207], v[132:135]
    ds_read_b64_tr_b16 a[76:77], v226 offset:18432
    v_mfma_f32_16x16x32_bf16 v[132:135], a[0:3], a[196:199], v[132:135]
    ds_read_b64_tr_b16 a[78:79], v226 offset:26624
    s_waitcnt lgkmcnt(8)
    v_mfma_f32_16x16x32_bf16 v[140:143], a[16:19], a[196:199], v[140:143]
    ds_read_b64_tr_b16 a[80:81], v227 offset:0
    s_mov_b32 s23, 135168
    v_mfma_f32_16x16x32_bf16 v[140:143], a[20:23], a[204:207], v[140:143]
    ds_read_b64_tr_b16 a[82:83], v227 offset:8192
    v_mfma_f32_16x16x32_bf16 v[140:143], a[24:27], a[212:215], v[140:143]
    ds_read_b64_tr_b16 a[84:85], v227 offset:2048
    v_mfma_f32_16x16x32_bf16 v[140:143], a[28:31], a[220:223], v[140:143]
    ds_read_b64_tr_b16 a[86:87], v227 offset:10240
    buffer_load_dwordx4 a[128:131], v232, s[84:87], s23 offen
    v_mfma_f32_16x16x32_bf16 v[136:139], a[28:31], a[216:219], v[136:139]
    ds_read_b64_tr_b16 a[88:89], v227 offset:16384
    v_mfma_f32_16x16x32_bf16 v[136:139], a[24:27], a[208:211], v[136:139]
    ds_read_b64_tr_b16 a[90:91], v227 offset:24576
    v_mfma_f32_16x16x32_bf16 v[136:139], a[20:23], a[200:203], v[136:139]
    ds_read_b64_tr_b16 a[92:93], v227 offset:18432
    buffer_load_dwordx4 a[132:135], v233, s[84:87], s23 offen
    v_mfma_f32_16x16x32_bf16 v[136:139], a[16:19], a[192:195], v[136:139]
    ds_read_b64_tr_b16 a[94:95], v227 offset:26624
    s_waitcnt lgkmcnt(8)
    v_mfma_f32_16x16x32_bf16 v[144:147], a[64:67], a[192:195], v[144:147]
    ds_read_b64_tr_b16 a[32:33], v228 offset:0
    v_mfma_f32_16x16x32_bf16 v[144:147], a[68:71], a[200:203], v[144:147]
    ds_read_b64_tr_b16 a[34:35], v228 offset:8192
    s_add_u32 m0, s98, 65536
    v_mfma_f32_16x16x32_bf16 v[144:147], a[72:75], a[208:211], v[144:147]
    ds_read_b64_tr_b16 a[36:37], v228 offset:2048
    v_mfma_f32_16x16x32_bf16 v[144:147], a[76:79], a[216:219], v[144:147]
    ds_read_b64_tr_b16 a[38:39], v228 offset:10240
    v_mfma_f32_16x16x32_bf16 v[148:151], a[76:79], a[220:223], v[148:151]
    ds_read_b64_tr_b16 a[40:41], v228 offset:16384
    s_mov_b32 s26, 3145728
    v_mfma_f32_16x16x32_bf16 v[148:151], a[72:75], a[212:215], v[148:151]
    ds_read_b64_tr_b16 a[42:43], v228 offset:24576
    v_mfma_f32_16x16x32_bf16 v[148:151], a[68:71], a[204:207], v[148:151]
    ds_read_b64_tr_b16 a[44:45], v228 offset:18432
    v_mfma_f32_16x16x32_bf16 v[148:151], a[64:67], a[196:199], v[148:151]
    ds_read_b64_tr_b16 a[46:47], v228 offset:26624
    s_waitcnt lgkmcnt(8)
    v_mfma_f32_16x16x32_bf16 v[156:159], a[80:83], a[196:199], v[156:159]
    ds_read_b64_tr_b16 a[48:49], v229 offset:0
    buffer_load_dwordx4 v246, s[88:91], s26 offen offset:0  lds
    v_mfma_f32_16x16x32_bf16 v[156:159], a[84:87], a[204:207], v[156:159]
    ds_read_b64_tr_b16 a[50:51], v229 offset:8192
    v_mfma_f32_16x16x32_bf16 v[156:159], a[88:91], a[212:215], v[156:159]
    ds_read_b64_tr_b16 a[52:53], v229 offset:2048
    buffer_load_dwordx4 v247, s[88:91], s26 offen offset:1024  lds
    v_mfma_f32_16x16x32_bf16 v[156:159], a[92:95], a[220:223], v[156:159]
    ds_read_b64_tr_b16 a[54:55], v229 offset:10240
    s_mov_b32 s23, 138240
    v_mfma_f32_16x16x32_bf16 v[152:155], a[92:95], a[216:219], v[152:155]
    ds_read_b64_tr_b16 a[56:57], v229 offset:16384
    v_mfma_f32_16x16x32_bf16 v[152:155], a[88:91], a[208:211], v[152:155]
    ds_read_b64_tr_b16 a[58:59], v229 offset:24576
    buffer_load_dwordx4 a[136:139], v232, s[84:87], s23 offen
    v_mfma_f32_16x16x32_bf16 v[152:155], a[84:87], a[200:203], v[152:155]
    ds_read_b64_tr_b16 a[60:61], v229 offset:18432
    v_mfma_f32_16x16x32_bf16 v[152:155], a[80:83], a[192:195], v[152:155]
    ds_read_b64_tr_b16 a[62:63], v229 offset:26624
    s_waitcnt lgkmcnt(8)
    v_mfma_f32_16x16x32_bf16 v[160:163], a[32:35], a[192:195], v[160:163]
    ds_read_b64_tr_b16 a[96:97], v230 offset:0
    buffer_load_dwordx4 a[140:143], v233, s[84:87], s23 offen
    v_mfma_f32_16x16x32_bf16 v[160:163], a[36:39], a[200:203], v[160:163]
    ds_read_b64_tr_b16 a[98:99], v230 offset:8192
    buffer_load_dwordx4 v248, s[88:91], s26 offen offset:2048  lds
    v_mfma_f32_16x16x32_bf16 v[160:163], a[40:43], a[208:211], v[160:163]
    ds_read_b64_tr_b16 a[100:101], v230 offset:2048
    v_mfma_f32_16x16x32_bf16 v[160:163], a[44:47], a[216:219], v[160:163]
    ds_read_b64_tr_b16 a[102:103], v230 offset:10240
    v_mfma_f32_16x16x32_bf16 v[164:167], a[44:47], a[220:223], v[164:167]
    ds_read_b64_tr_b16 a[104:105], v230 offset:16384
    buffer_load_dwordx4 v249, s[88:91], s26 offen offset:3072  lds
    v_mfma_f32_16x16x32_bf16 v[164:167], a[40:43], a[212:215], v[164:167]
    ds_read_b64_tr_b16 a[106:107], v230 offset:24576
    v_mfma_f32_16x16x32_bf16 v[164:167], a[36:39], a[204:207], v[164:167]
    ds_read_b64_tr_b16 a[108:109], v230 offset:18432
    v_mfma_f32_16x16x32_bf16 v[164:167], a[32:35], a[196:199], v[164:167]
    ds_read_b64_tr_b16 a[110:111], v230 offset:26624
    s_waitcnt lgkmcnt(8)
    v_mfma_f32_16x16x32_bf16 v[172:175], a[48:51], a[196:199], v[172:175]
    ds_read_b64_tr_b16 a[112:113], v231 offset:0
    s_mov_b32 s23, 141312
    v_mfma_f32_16x16x32_bf16 v[172:175], a[52:55], a[204:207], v[172:175]
    ds_read_b64_tr_b16 a[114:115], v231 offset:8192
    v_mfma_f32_16x16x32_bf16 v[172:175], a[56:59], a[212:215], v[172:175]
    ds_read_b64_tr_b16 a[116:117], v231 offset:2048
    v_mfma_f32_16x16x32_bf16 v[172:175], a[60:63], a[220:223], v[172:175]
    ds_read_b64_tr_b16 a[118:119], v231 offset:10240
    buffer_load_dwordx4 a[144:147], v232, s[84:87], s23 offen
    v_mfma_f32_16x16x32_bf16 v[168:171], a[60:63], a[216:219], v[168:171]
    ds_read_b64_tr_b16 a[120:121], v231 offset:16384
    v_mfma_f32_16x16x32_bf16 v[168:171], a[56:59], a[208:211], v[168:171]
    ds_read_b64_tr_b16 a[122:123], v231 offset:24576
    v_mfma_f32_16x16x32_bf16 v[168:171], a[52:55], a[200:203], v[168:171]
    ds_read_b64_tr_b16 a[124:125], v231 offset:18432
    buffer_load_dwordx4 a[148:151], v233, s[84:87], s23 offen
    v_mfma_f32_16x16x32_bf16 v[168:171], a[48:51], a[192:195], v[168:171]
    ds_read_b64_tr_b16 a[126:127], v231 offset:26624
    s_waitcnt lgkmcnt(8)
    v_mfma_f32_16x16x32_bf16 v[176:179], a[96:99], a[192:195], v[176:179]
    s_waitcnt vmcnt(26)
    s_barrier
    ds_read_b64_tr_b16 a[0:1], v196 offset:0
    v_mfma_f32_16x16x32_bf16 v[176:179], a[100:103], a[200:203], v[176:179]
    ds_read_b64_tr_b16 a[2:3], v196 offset:8192
    s_add_u32 m0, s98, 81920
    v_mfma_f32_16x16x32_bf16 v[176:179], a[104:107], a[208:211], v[176:179]
    ds_read_b64_tr_b16 a[4:5], v196 offset:2048
    v_mfma_f32_16x16x32_bf16 v[176:179], a[108:111], a[216:219], v[176:179]
    ds_read_b64_tr_b16 a[6:7], v196 offset:10240
    v_mfma_f32_16x16x32_bf16 v[180:183], a[108:111], a[220:223], v[180:183]
    ds_read_b64_tr_b16 a[8:9], v196 offset:16384
    s_mov_b32 s26, 3276800
    v_mfma_f32_16x16x32_bf16 v[180:183], a[104:107], a[212:215], v[180:183]
    ds_read_b64_tr_b16 a[10:11], v196 offset:24576
    v_mfma_f32_16x16x32_bf16 v[180:183], a[100:103], a[204:207], v[180:183]
    ds_read_b64_tr_b16 a[12:13], v196 offset:18432
    v_mfma_f32_16x16x32_bf16 v[180:183], a[96:99], a[196:199], v[180:183]
    ds_read_b64_tr_b16 a[14:15], v196 offset:26624
    s_waitcnt lgkmcnt(8)
    v_mfma_f32_16x16x32_bf16 v[188:191], a[112:115], a[196:199], v[188:191]
    ds_read_b64_tr_b16 a[16:17], v197 offset:0
    buffer_load_dwordx4 v246, s[88:91], s26 offen offset:0  lds
    v_mfma_f32_16x16x32_bf16 v[188:191], a[116:119], a[204:207], v[188:191]
    ds_read_b64_tr_b16 a[18:19], v197 offset:8192
    v_mfma_f32_16x16x32_bf16 v[188:191], a[120:123], a[212:215], v[188:191]
    ds_read_b64_tr_b16 a[20:21], v197 offset:2048
    buffer_load_dwordx4 v247, s[88:91], s26 offen offset:1024  lds
    v_mfma_f32_16x16x32_bf16 v[188:191], a[124:127], a[220:223], v[188:191]
    ds_read_b64_tr_b16 a[22:23], v197 offset:10240
    s_mov_b32 s23, 144384
    v_mfma_f32_16x16x32_bf16 v[184:187], a[124:127], a[216:219], v[184:187]
    ds_read_b64_tr_b16 a[24:25], v197 offset:16384
    v_mfma_f32_16x16x32_bf16 v[184:187], a[120:123], a[208:211], v[184:187]
    ds_read_b64_tr_b16 a[26:27], v197 offset:24576
    buffer_load_dwordx4 a[152:155], v232, s[84:87], s23 offen
    v_mfma_f32_16x16x32_bf16 v[184:187], a[116:119], a[200:203], v[184:187]
L_k_w13:
    s_cbranch_execz L_k_wback
    ds_read_b64_tr_b16 a[28:29], v197 offset:18432
    v_mfma_f32_16x16x32_bf16 v[184:187], a[112:115], a[192:195], v[184:187]
    ds_read_b64_tr_b16 a[30:31], v197 offset:26624
    s_waitcnt vmcnt(15) lgkmcnt(8)
    v_mfma_f32_16x16x32_bf16 v[128:131], a[0:3], a[224:227], v[128:131]
    ds_read_b64_tr_b16 a[64:65], v198 offset:0
    buffer_load_dwordx4 a[156:159], v233, s[84:87], s23 offen
    v_mfma_f32_16x16x32_bf16 v[128:131], a[4:7], a[232:235], v[128:131]
    ds_read_b64_tr_b16 a[66:67], v198 offset:8192
    buffer_load_dwordx4 v248, s[88:91], s26 offen offset:2048  lds
    v_mfma_f32_16x16x32_bf16 v[128:131], a[8:11], a[240:243], v[128:131]
    ds_read_b64_tr_b16 a[68:69], v198 offset:2048
    v_mfma_f32_16x16x32_bf16 v[128:131], a[12:15], a[248:251], v[128:131]
    ds_read_b64_tr_b16 a[70:71], v198 offset:10240
    v_mfma_f32_16x16x32_bf16 v[132:135], a[12:15], a[252:255], v[132:135]
    ds_read_b64_tr_b16 a[72:73], v198 offset:16384
    buffer_load_dwordx4 v249, s[88:91], s26 offen offset:3072  lds
    v_mfma_f32_16x16x32_bf16 v[132:135], a[8:11], a[244:247], v[132:135]
    ds_read_b64_tr_b16 a[74:75], v198 offset:24576
    v_mfma_f32_16x16x32_bf16 v[132:135], a[4:7], a[236:239], v[132:135]
    ds_read_b64_tr_b16 a[76:77], v198 offset:18432
    v_mfma_f32_16x16x32_bf16 v[132:135], a[0:3], a[228:231], v[132:135]
    ds_read_b64_tr_b16 a[78:79], v198 offset:26624
    s_waitcnt lgkmcnt(8)
    v_mfma_f32_16x16x32_bf16 v[140:143], a[16:19], a[228:231], v[140:143]
    ds_read_b64_tr_b16 a[80:81], v199 offset:0
    s_mov_b32 s23, 147456
    v_mfma_f32_16x16x32_bf16 v[140:143], a[20:23], a[236:239], v[140:143]
    ds_read_b64_tr_b16 a[82:83], v199 offset:8192
    v_mfma_f32_16x16x32_bf16 v[140:143], a[24:27], a[244:247], v[140:143]
    ds_read_b64_tr_b16 a[84:85], v199 offset:2048
    v_mfma_f32_16x16x32_bf16 v[140:143], a[28:31], a[252:255], v[140:143]
    ds_read_b64_tr_b16 a[86:87], v199 offset:10240
    buffer_load_dwordx4 a[192:195], v232, s[84:87], s23 offen
    v_mfma_f32_16x16x32_bf16 v[136:139], a[28:31], a[248:251], v[136:139]
    ds_read_b64_tr_b16 a[88:89], v199 offset:16384
    v_mfma_f32_16x16x32_bf16 v[136:139], a[24:27], a[240:243], v[136:139]
    ds_read_b64_tr_b16 a[90:91], v199 offset:24576
    v_mfma_f32_16x16x32_bf16 v[136:139], a[20:23], a[232:235], v[136:139]
    ds_read_b64_tr_b16 a[92:93], v199 offset:18432
    buffer_load_dwordx4 a[196:199], v233, s[84:87], s23 offen
    v_mfma_f32_16x16x32_bf16 v[136:139], a[16:19], a[224:227], v[136:139]
    ds_read_b64_tr_b16 a[94:95], v199 offset:26624
    s_waitcnt lgkmcnt(8)
    v_mfma_f32_16x16x32_bf16 v[144:147], a[64:67], a[224:227], v[144:147]
    ds_read_b64_tr_b16 a[32:33], v200 offset:0
    buffer_load_dword v193, v250, s[48:51], s27 offen sc1
    v_mfma_f32_16x16x32_bf16 v[144:147], a[68:71], a[232:235], v[144:147]
    ds_read_b64_tr_b16 a[34:35], v200 offset:8192
    s_add_u32 m0, s98, 98304
    v_mfma_f32_16x16x32_bf16 v[144:147], a[72:75], a[240:243], v[144:147]
    ds_read_b64_tr_b16 a[36:37], v200 offset:2048
    v_mfma_f32_16x16x32_bf16 v[144:147], a[76:79], a[248:251], v[144:147]
    ds_read_b64_tr_b16 a[38:39], v200 offset:10240
    v_mfma_f32_16x16x32_bf16 v[148:151], a[76:79], a[252:255], v[148:151]
    ds_read_b64_tr_b16 a[40:41], v200 offset:16384
    s_mov_b32 s26, 3407872
    v_mfma_f32_16x16x32_bf16 v[148:151], a[72:75], a[244:247], v[148:151]
    ds_read_b64_tr_b16 a[42:43], v200 offset:24576
    v_mfma_f32_16x16x32_bf16 v[148:151], a[68:71], a[236:239], v[148:151]
    ds_read_b64_tr_b16 a[44:45], v200 offset:18432
    v_mfma_f32_16x16x32_bf16 v[148:151], a[64:67], a[228:231], v[148:151]
    ds_read_b64_tr_b16 a[46:47], v200 offset:26624
    s_waitcnt lgkmcnt(8)
    v_mfma_f32_16x16x32_bf16 v[156:159], a[80:83], a[228:231], v[156:159]
    ds_read_b64_tr_b16 a[48:49], v201 offset:0
    buffer_load_dwordx4 v246, s[88:91], s26 offen offset:0  lds
    v_mfma_f32_16x16x32_bf16 v[156:159], a[84:87], a[236:239], v[156:159]
    ds_read_b64_tr_b16 a[50:51], v201 offset:8192
    v_mfma_f32_16x16x32_bf16 v[156:159], a[88:91], a[244:247], v[156:159]
    ds_read_b64_tr_b16 a[52:53], v201 offset:2048
    buffer_load_dwordx4 v247, s[88:91], s26 offen offset:1024  lds
    v_mfma_f32_16x16x32_bf16 v[156:159], a[92:95], a[252:255], v[156:159]
    ds_read_b64_tr_b16 a[54:55], v201 offset:10240
    s_mov_b32 s23, 150528
    v_mfma_f32_16x16x32_bf16 v[152:155], a[92:95], a[248:251], v[152:155]
    ds_read_b64_tr_b16 a[56:57], v201 offset:16384
    v_mfma_f32_16x16x32_bf16 v[152:155], a[88:91], a[240:243], v[152:155]
    ds_read_b64_tr_b16 a[58:59], v201 offset:24576
    buffer_load_dwordx4 a[200:203], v232, s[84:87], s23 offen
    v_mfma_f32_16x16x32_bf16 v[152:155], a[84:87], a[232:235], v[152:155]
    ds_read_b64_tr_b16 a[60:61], v201 offset:18432
    v_mfma_f32_16x16x32_bf16 v[152:155], a[80:83], a[224:227], v[152:155]
    ds_read_b64_tr_b16 a[62:63], v201 offset:26624
    s_waitcnt lgkmcnt(8)
    v_mfma_f32_16x16x32_bf16 v[160:163], a[32:35], a[224:227], v[160:163]
    ds_read_b64_tr_b16 a[96:97], v202 offset:0
    buffer_load_dwordx4 a[204:207], v233, s[84:87], s23 offen
    v_mfma_f32_16x16x32_bf16 v[160:163], a[36:39], a[232:235], v[160:163]
    ds_read_b64_tr_b16 a[98:99], v202 offset:8192
    buffer_load_dwordx4 v248, s[88:91], s26 offen offset:2048  lds
    v_mfma_f32_16x16x32_bf16 v[160:163], a[40:43], a[240:243], v[160:163]
    ds_read_b64_tr_b16 a[100:101], v202 offset:2048
    v_mfma_f32_16x16x32_bf16 v[160:163], a[44:47], a[248:251], v[160:163]
    ds_read_b64_tr_b16 a[102:103], v202 offset:10240
    v_mfma_f32_16x16x32_bf16 v[164:167], a[44:47], a[252:255], v[164:167]
    ds_read_b64_tr_b16 a[104:105], v202 offset:16384
    buffer_load_dwordx4 v249, s[88:91], s26 offen offset:3072  lds
    v_mfma_f32_16x16x32_bf16 v[164:167], a[40:43], a[244:247], v[164:167]
    ds_read_b64_tr_b16 a[106:107], v202 offset:24576
    v_mfma_f32_16x16x32_bf16 v[164:167], a[36:39], a[236:239], v[164:167]
    ds_read_b64_tr_b16 a[108:109], v202 offset:18432
    v_mfma_f32_16x16x32_bf16 v[164:167], a[32:35], a[228:231], v[164:167]
    ds_read_b64_tr_b16 a[110:111], v202 offset:26624
    s_waitcnt lgkmcnt(8)
    v_mfma_f32_16x16x32_bf16 v[172:175], a[48:51], a[228:231], v[172:175]
    ds_read_b64_tr_b16 a[112:113], v203 offset:0
    s_mov_b32 s23, 153600
    v_mfma_f32_16x16x32_bf16 v[172:175], a[52:55], a[236:239], v[172:175]
    ds_read_b64_tr_b16 a[114:115], v203 offset:8192
    v_mfma_f32_16x16x32_bf16 v[172:175], a[56:59], a[244:247], v[172:175]
    ds_read_b64_tr_b16 a[116:117], v203 offset:2048
    v_mfma_f32_16x16x32_bf16 v[172:175], a[60:63], a[252:255], v[172:175]
    ds_read_b64_tr_b16 a[118:119], v203 offset:10240
    buffer_load_dwordx4 a[208:211], v232, s[84:87], s23 offen
    v_mfma_f32_16x16x32_bf16 v[168:171], a[60:63], a[248:251], v[168:171]
    ds_read_b64_tr_b16 a[120:121], v203 offset:16384
    v_mfma_f32_16x16x32_bf16 v[168:171], a[56:59], a[240:243], v[168:171]
    ds_read_b64_tr_b16 a[122:123], v203 offset:24576
    v_mfma_f32_16x16x32_bf16 v[168:171], a[52:55], a[232:235], v[168:171]
    ds_read_b64_tr_b16 a[124:125], v203 offset:18432
    buffer_load_dwordx4 a[212:215], v233, s[84:87], s23 offen
    v_mfma_f32_16x16x32_bf16 v[168:171], a[48:51], a[224:227], v[168:171]
    ds_read_b64_tr_b16 a[126:127], v203 offset:26624
    s_waitcnt lgkmcnt(8)
    v_mfma_f32_16x16x32_bf16 v[176:179], a[96:99], a[224:227], v[176:179]
    s_waitcnt vmcnt(27)
    s_barrier
    ds_read_b64_tr_b16 a[0:1], v196 offset:32768
    v_mfma_f32_16x16x32_bf16 v[176:179], a[100:103], a[232:235], v[176:179]
    ds_read_b64_tr_b16 a[2:3], v196 offset:40960
    s_add_u32 m0, s98, 114688
    v_mfma_f32_16x16x32_bf16 v[176:179], a[104:107], a[240:243], v[176:179]
    ds_read_b64_tr_b16 a[4:5], v196 offset:34816
    v_mfma_f32_16x16x32_bf16 v[176:179], a[108:111], a[248:251], v[176:179]
    ds_read_b64_tr_b16 a[6:7], v196 offset:43008
    v_mfma_f32_16x16x32_bf16 v[180:183], a[108:111], a[252:255], v[180:183]
    ds_read_b64_tr_b16 a[8:9], v196 offset:49152
    s_mov_b32 s26, 3538944
    v_mfma_f32_16x16x32_bf16 v[180:183], a[104:107], a[244:247], v[180:183]
    ds_read_b64_tr_b16 a[10:11], v196 offset:57344
    v_mfma_f32_16x16x32_bf16 v[180:183], a[100:103], a[236:239], v[180:183]
    ds_read_b64_tr_b16 a[12:13], v196 offset:51200
    v_mfma_f32_16x16x32_bf16 v[180:183], a[96:99], a[228:231], v[180:183]
    ds_read_b64_tr_b16 a[14:15], v196 offset:59392
    s_waitcnt lgkmcnt(8)
    v_mfma_f32_16x16x32_bf16 v[188:191], a[112:115], a[228:231], v[188:191]
    ds_read_b64_tr_b16 a[16:17], v197 offset:32768
    buffer_load_dwordx4 v246, s[88:91], s26 offen offset:0  lds
    v_mfma_f32_16x16x32_bf16 v[188:191], a[116:119], a[236:239], v[188:191]
    ds_read_b64_tr_b16 a[18:19], v197 offset:40960
    v_mfma_f32_16x16x32_bf16 v[188:191], a[120:123], a[244:247], v[188:191]
    ds_read_b64_tr_b16 a[20:21], v197 offset:34816
    buffer_load_dwordx4 v247, s[88:91], s26 offen offset:1024  lds
    v_mfma_f32_16x16x32_bf16 v[188:191], a[124:127], a[252:255], v[188:191]
    ds_read_b64_tr_b16 a[22:23], v197 offset:43008
    s_mov_b32 s23, 156672
    v_mfma_f32_16x16x32_bf16 v[184:187], a[124:127], a[248:251], v[184:187]
    ds_read_b64_tr_b16 a[24:25], v197 offset:49152
    v_mfma_f32_16x16x32_bf16 v[184:187], a[120:123], a[240:243], v[184:187]
    ds_read_b64_tr_b16 a[26:27], v197 offset:57344
    buffer_load_dwordx4 a[216:219], v232, s[84:87], s23 offen
    v_mfma_f32_16x16x32_bf16 v[184:187], a[116:119], a[232:235], v[184:187]
    ds_read_b64_tr_b16 a[28:29], v197 offset:51200
    v_mfma_f32_16x16x32_bf16 v[184:187], a[112:115], a[224:227], v[184:187]
    ds_read_b64_tr_b16 a[30:31], v197 offset:59392
    s_waitcnt vmcnt(16) lgkmcnt(8)
    v_mfma_f32_16x16x32_bf16 v[128:131], a[0:3], a[128:131], v[128:131]
    ds_read_b64_tr_b16 a[64:65], v198 offset:32768
    buffer_load_dwordx4 a[220:223], v233, s[84:87], s23 offen
    v_mfma_f32_16x16x32_bf16 v[128:131], a[4:7], a[136:139], v[128:131]
    ds_read_b64_tr_b16 a[66:67], v198 offset:40960
    buffer_load_dwordx4 v248, s[88:91], s26 offen offset:2048  lds
    v_mfma_f32_16x16x32_bf16 v[128:131], a[8:11], a[144:147], v[128:131]
    ds_read_b64_tr_b16 a[68:69], v198 offset:34816
    v_mfma_f32_16x16x32_bf16 v[128:131], a[12:15], a[152:155], v[128:131]
    ds_read_b64_tr_b16 a[70:71], v198 offset:43008
    v_mfma_f32_16x16x32_bf16 v[132:135], a[12:15], a[156:159], v[132:135]
    ds_read_b64_tr_b16 a[72:73], v198 offset:49152
    buffer_load_dwordx4 v249, s[88:91], s26 offen offset:3072  lds
    v_mfma_f32_16x16x32_bf16 v[132:135], a[8:11], a[148:151], v[132:135]
    ds_read_b64_tr_b16 a[74:75], v198 offset:57344
    v_mfma_f32_16x16x32_bf16 v[132:135], a[4:7], a[140:143], v[132:135]
    ds_read_b64_tr_b16 a[76:77], v198 offset:51200
    v_mfma_f32_16x16x32_bf16 v[132:135], a[0:3], a[132:135], v[132:135]
    ds_read_b64_tr_b16 a[78:79], v198 offset:59392
    s_waitcnt lgkmcnt(8)
    v_mfma_f32_16x16x32_bf16 v[140:143], a[16:19], a[132:135], v[140:143]
    ds_read_b64_tr_b16 a[80:81], v199 offset:32768
    s_mov_b32 s23, 159744
    v_mfma_f32_16x16x32_bf16 v[140:143], a[20:23], a[140:143], v[140:143]
    ds_read_b64_tr_b16 a[82:83], v199 offset:40960
    v_mfma_f32_16x16x32_bf16 v[140:143], a[24:27], a[148:151], v[140:143]
    ds_read_b64_tr_b16 a[84:85], v199 offset:34816
    v_mfma_f32_16x16x32_bf16 v[140:143], a[28:31], a[156:159], v[140:143]
    ds_read_b64_tr_b16 a[86:87], v199 offset:43008
    buffer_load_dwordx4 a[224:227], v232, s[84:87], s23 offen
    v_mfma_f32_16x16x32_bf16 v[136:139], a[28:31], a[152:155], v[136:139]
    ds_read_b64_tr_b16 a[88:89], v199 offset:49152
    v_mfma_f32_16x16x32_bf16 v[136:139], a[24:27], a[144:147], v[136:139]
    ds_read_b64_tr_b16 a[90:91], v199 offset:57344
    v_mfma_f32_16x16x32_bf16 v[136:139], a[20:23], a[136:139], v[136:139]
    ds_read_b64_tr_b16 a[92:93], v199 offset:51200
    buffer_load_dwordx4 a[228:231], v233, s[84:87], s23 offen
    v_mfma_f32_16x16x32_bf16 v[136:139], a[16:19], a[128:131], v[136:139]
    ds_read_b64_tr_b16 a[94:95], v199 offset:59392
    s_waitcnt lgkmcnt(8)
    v_mfma_f32_16x16x32_bf16 v[144:147], a[64:67], a[128:131], v[144:147]
    ds_read_b64_tr_b16 a[32:33], v200 offset:32768
    v_mfma_f32_16x16x32_bf16 v[144:147], a[68:71], a[136:139], v[144:147]
    ds_read_b64_tr_b16 a[34:35], v200 offset:40960
    v_mfma_f32_16x16x32_bf16 v[144:147], a[72:75], a[144:147], v[144:147]
    ds_read_b64_tr_b16 a[36:37], v200 offset:34816
    v_mfma_f32_16x16x32_bf16 v[144:147], a[76:79], a[152:155], v[144:147]
    ds_read_b64_tr_b16 a[38:39], v200 offset:43008
    v_mfma_f32_16x16x32_bf16 v[148:151], a[76:79], a[156:159], v[148:151]
    ds_read_b64_tr_b16 a[40:41], v200 offset:49152
    v_mfma_f32_16x16x32_bf16 v[148:151], a[72:75], a[148:151], v[148:151]
    ds_read_b64_tr_b16 a[42:43], v200 offset:57344
    v_mfma_f32_16x16x32_bf16 v[148:151], a[68:71], a[140:143], v[148:151]
    ds_read_b64_tr_b16 a[44:45], v200 offset:51200
    v_mfma_f32_16x16x32_bf16 v[148:151], a[64:67], a[132:135], v[148:151]
    ds_read_b64_tr_b16 a[46:47], v200 offset:59392
    s_waitcnt lgkmcnt(8)
    v_mfma_f32_16x16x32_bf16 v[156:159], a[80:83], a[132:135], v[156:159]
    ds_read_b64_tr_b16 a[48:49], v201 offset:32768
    s_mov_b32 s23, 162816
    v_mfma_f32_16x16x32_bf16 v[156:159], a[84:87], a[140:143], v[156:159]
    ds_read_b64_tr_b16 a[50:51], v201 offset:40960
    v_mfma_f32_16x16x32_bf16 v[156:159], a[88:91], a[148:151], v[156:159]
    ds_read_b64_tr_b16 a[52:53], v201 offset:34816
    v_mfma_f32_16x16x32_bf16 v[156:159], a[92:95], a[156:159], v[156:159]
    ds_read_b64_tr_b16 a[54:55], v201 offset:43008
    buffer_load_dwordx4 a[232:235], v232, s[84:87], s23 offen
    v_mfma_f32_16x16x32_bf16 v[152:155], a[92:95], a[152:155], v[152:155]
    ds_read_b64_tr_b16 a[56:57], v201 offset:49152
    v_mfma_f32_16x16x32_bf16 v[152:155], a[88:91], a[144:147], v[152:155]
    ds_read_b64_tr_b16 a[58:59], v201 offset:57344
    v_mfma_f32_16x16x32_bf16 v[152:155], a[84:87], a[136:139], v[152:155]
    ds_read_b64_tr_b16 a[60:61], v201 offset:51200
    buffer_load_dwordx4 a[236:239], v233, s[84:87], s23 offen
    v_mfma_f32_16x16x32_bf16 v[152:155], a[80:83], a[128:131], v[152:155]
    ds_read_b64_tr_b16 a[62:63], v201 offset:59392
    s_waitcnt lgkmcnt(8)
    v_mfma_f32_16x16x32_bf16 v[160:163], a[32:35], a[128:131], v[160:163]
    ds_read_b64_tr_b16 a[96:97], v202 offset:32768
    v_mfma_f32_16x16x32_bf16 v[160:163], a[36:39], a[136:139], v[160:163]
    ds_read_b64_tr_b16 a[98:99], v202 offset:40960
    v_mfma_f32_16x16x32_bf16 v[160:163], a[40:43], a[144:147], v[160:163]
    ds_read_b64_tr_b16 a[100:101], v202 offset:34816
    v_mfma_f32_16x16x32_bf16 v[160:163], a[44:47], a[152:155], v[160:163]
    ds_read_b64_tr_b16 a[102:103], v202 offset:43008
    v_mfma_f32_16x16x32_bf16 v[164:167], a[44:47], a[156:159], v[164:167]
    ds_read_b64_tr_b16 a[104:105], v202 offset:49152
    v_mfma_f32_16x16x32_bf16 v[164:167], a[40:43], a[148:151], v[164:167]
    ds_read_b64_tr_b16 a[106:107], v202 offset:57344
    v_mfma_f32_16x16x32_bf16 v[164:167], a[36:39], a[140:143], v[164:167]
    ds_read_b64_tr_b16 a[108:109], v202 offset:51200
    v_mfma_f32_16x16x32_bf16 v[164:167], a[32:35], a[132:135], v[164:167]
    ds_read_b64_tr_b16 a[110:111], v202 offset:59392
    s_waitcnt lgkmcnt(8)
    v_mfma_f32_16x16x32_bf16 v[172:175], a[48:51], a[132:135], v[172:175]
    ds_read_b64_tr_b16 a[112:113], v203 offset:32768
    s_mov_b32 s23, 165888
    v_mfma_f32_16x16x32_bf16 v[172:175], a[52:55], a[140:143], v[172:175]
    ds_read_b64_tr_b16 a[114:115], v203 offset:40960
    v_mfma_f32_16x16x32_bf16 v[172:175], a[56:59], a[148:151], v[172:175]
    ds_read_b64_tr_b16 a[116:117], v203 offset:34816
    v_mfma_f32_16x16x32_bf16 v[172:175], a[60:63], a[156:159], v[172:175]
    ds_read_b64_tr_b16 a[118:119], v203 offset:43008
    buffer_load_dwordx4 a[240:243], v232, s[84:87], s23 offen
    v_mfma_f32_16x16x32_bf16 v[168:171], a[60:63], a[152:155], v[168:171]
    ds_read_b64_tr_b16 a[120:121], v203 offset:49152
    v_mfma_f32_16x16x32_bf16 v[168:171], a[56:59], a[144:147], v[168:171]
    ds_read_b64_tr_b16 a[122:123], v203 offset:57344
    v_mfma_f32_16x16x32_bf16 v[168:171], a[52:55], a[136:139], v[168:171]
    ds_read_b64_tr_b16 a[124:125], v203 offset:51200
    buffer_load_dwordx4 a[244:247], v233, s[84:87], s23 offen
    v_mfma_f32_16x16x32_bf16 v[168:171], a[48:51], a[128:131], v[168:171]
    ds_read_b64_tr_b16 a[126:127], v203 offset:59392
    s_waitcnt lgkmcnt(8)
    v_mfma_f32_16x16x32_bf16 v[176:179], a[96:99], a[128:131], v[176:179]
    s_waitcnt vmcnt(23)
    s_barrier
    ds_read_b64_tr_b16 a[32:33], v212 offset:0
    v_mfma_f32_16x16x32_bf16 v[176:179], a[100:103], a[136:139], v[176:179]
    ds_read_b64_tr_b16 a[34:35], v212 offset:8192
    v_mfma_f32_16x16x32_bf16 v[176:179], a[104:107], a[144:147], v[176:179]
    ds_read_b64_tr_b16 a[36:37], v212 offset:2048
    v_mfma_f32_16x16x32_bf16 v[176:179], a[108:111], a[152:155], v[176:179]
    ds_read_b64_tr_b16 a[38:39], v212 offset:10240
    v_mfma_f32_16x16x32_bf16 v[180:183], a[108:111], a[156:159], v[180:183]
    ds_read_b64_tr_b16 a[40:41], v212 offset:16384
    v_mfma_f32_16x16x32_bf16 v[180:183], a[104:107], a[148:151], v[180:183]
    ds_read_b64_tr_b16 a[42:43], v212 offset:24576
    v_mfma_f32_16x16x32_bf16 v[180:183], a[100:103], a[140:143], v[180:183]
    ds_read_b64_tr_b16 a[44:45], v212 offset:18432
    v_mfma_f32_16x16x32_bf16 v[180:183], a[96:99], a[132:135], v[180:183]
    ds_read_b64_tr_b16 a[46:47], v212 offset:26624
    s_waitcnt lgkmcnt(8)
    v_mfma_f32_16x16x32_bf16 v[188:191], a[112:115], a[132:135], v[188:191]
    ds_read_b64_tr_b16 a[48:49], v213 offset:0
    s_mov_b32 s23, 168960
    v_mfma_f32_16x16x32_bf16 v[188:191], a[116:119], a[140:143], v[188:191]
    ds_read_b64_tr_b16 a[50:51], v213 offset:8192
    v_mfma_f32_16x16x32_bf16 v[188:191], a[120:123], a[148:151], v[188:191]
    ds_read_b64_tr_b16 a[52:53], v213 offset:2048
    v_mfma_f32_16x16x32_bf16 v[188:191], a[124:127], a[156:159], v[188:191]
    ds_read_b64_tr_b16 a[54:55], v213 offset:10240
    buffer_load_dwordx4 a[248:251], v232, s[84:87], s23 offen
    v_mfma_f32_16x16x32_bf16 v[184:187], a[124:127], a[152:155], v[184:187]
    ds_read_b64_tr_b16 a[56:57], v213 offset:16384
    v_mfma_f32_16x16x32_bf16 v[184:187], a[120:123], a[144:147], v[184:187]
    ds_read_b64_tr_b16 a[58:59], v213 offset:24576
    v_mfma_f32_16x16x32_bf16 v[184:187], a[116:119], a[136:139], v[184:187]
    ds_read_b64_tr_b16 a[60:61], v213 offset:18432
    buffer_load_dwordx4 a[252:255], v233, s[84:87], s23 offen
    v_mfma_f32_16x16x32_bf16 v[184:187], a[112:115], a[128:131], v[184:187]
    ds_read_b64_tr_b16 a[62:63], v213 offset:26624
    s_waitcnt vmcnt(10) lgkmcnt(8)
    v_mfma_f32_16x16x32_bf16 v[160:163], a[32:35], a[192:195], v[160:163]
    ds_read_b64_tr_b16 a[96:97], v214 offset:0
    s_mov_b32 s12, s30
    v_mfma_f32_16x16x32_bf16 v[160:163], a[36:39], a[200:203], v[160:163]
    ds_read_b64_tr_b16 a[98:99], v214 offset:8192
    s_mov_b32 s13, s31
    v_mfma_f32_16x16x32_bf16 v[160:163], a[40:43], a[208:211], v[160:163]
    ds_read_b64_tr_b16 a[100:101], v214 offset:2048
    v_mfma_f32_16x16x32_bf16 v[160:163], a[44:47], a[216:219], v[160:163]
    ds_read_b64_tr_b16 a[102:103], v214 offset:10240
    s_mov_b32 s14, 4194304
    v_mfma_f32_16x16x32_bf16 v[164:167], a[44:47], a[220:223], v[164:167]
    ds_read_b64_tr_b16 a[104:105], v214 offset:16384
    v_mfma_f32_16x16x32_bf16 v[164:167], a[40:43], a[212:215], v[164:167]
    ds_read_b64_tr_b16 a[106:107], v214 offset:24576
    s_lshl_b32 s24, s96, 1
    v_mfma_f32_16x16x32_bf16 v[164:167], a[36:39], a[204:207], v[164:167]
    ds_read_b64_tr_b16 a[108:109], v214 offset:18432
    v_mfma_f32_16x16x32_bf16 v[164:167], a[32:35], a[196:199], v[164:167]
    ds_read_b64_tr_b16 a[110:111], v214 offset:26624
    s_waitcnt lgkmcnt(8)
    v_mfma_f32_16x16x32_bf16 v[172:175], a[48:51], a[196:199], v[172:175]
    ds_read_b64_tr_b16 a[112:113], v215 offset:0
    s_add_u32 m0, s98, 131072
    v_mfma_f32_16x16x32_bf16 v[172:175], a[52:55], a[204:207], v[172:175]
    ds_read_b64_tr_b16 a[114:115], v215 offset:8192
    buffer_load_dwordx4 v216, s[12:15], s24 offen offset:0 lds
    v_mfma_f32_16x16x32_bf16 v[172:175], a[56:59], a[212:215], v[172:175]
    ds_read_b64_tr_b16 a[116:117], v215 offset:2048
    v_mfma_f32_16x16x32_bf16 v[172:175], a[60:63], a[220:223], v[172:175]
    ds_read_b64_tr_b16 a[118:119], v215 offset:10240
    s_add_u32 s24, s24, 15360
    v_mfma_f32_16x16x32_bf16 v[168:171], a[60:63], a[216:219], v[168:171]
    ds_read_b64_tr_b16 a[120:121], v215 offset:16384
    v_mfma_f32_16x16x32_bf16 v[168:171], a[56:59], a[208:211], v[168:171]
    ds_read_b64_tr_b16 a[122:123], v215 offset:24576
    buffer_load_dwordx4 v216, s[12:15], s24 offen offset:1024 lds
    v_mfma_f32_16x16x32_bf16 v[168:171], a[52:55], a[200:203], v[168:171]
    ds_read_b64_tr_b16 a[124:125], v215 offset:18432
    v_mfma_f32_16x16x32_bf16 v[168:171], a[48:51], a[192:195], v[168:171]
    ds_read_b64_tr_b16 a[126:127], v215 offset:26624
    s_waitcnt lgkmcnt(8)
    v_mfma_f32_16x16x32_bf16 v[176:179], a[96:99], a[192:195], v[176:179]
    s_cmp_eq_u32 s20, 0
    s_cbranch_scc0 L_k_py_ok
    s_mov_b32 s41, 0
L_k_py:
    v_cmp_eq_u32 vcc, s44, v193
    s_add_u32 s41, s41, 1
    s_nop 3
    s_andn2_b32 vcc_lo, 65535, vcc_lo
    s_andn2_b32 vcc_hi, 0, vcc_hi
    s_cmp_eq_u64 vcc, 0
    s_cbranch_scc1 L_k_py_ok
    s_cmp_gt_u32 s41, 400000
    s_cbranch_scc1 L_k_py_ok
    s_sleep 4
    buffer_load_dword v193, v250, s[48:51], s27 offen sc1
    s_waitcnt vmcnt(0)
    s_branch L_k_py
L_k_py_ok:
    s_waitcnt vmcnt(10)
    s_barrier
    ds_read_b64_tr_b16 a[32:33], v212 offset:32768
    v_mfma_f32_16x16x32_bf16 v[176:179], a[100:103], a[200:203], v[176:179]
    ds_read_b64_tr_b16 a[34:35], v212 offset:40960
    s_add_u32 s24, s24, 15360
    v_mfma_f32_16x16x32_bf16 v[176:179], a[104:107], a[208:211], v[176:179]
    ds_read_b64_tr_b16 a[36:37], v212 offset:34816
    buffer_load_dwordx4 v216, s[12:15], s24 offen offset:2048 lds
    v_mfma_f32_16x16x32_bf16 v[176:179], a[108:111], a[216:219], v[176:179]
    ds_read_b64_tr_b16 a[38:39], v212 offset:43008
    s_add_u32 s24, s24, 15360
    v_mfma_f32_16x16x32_bf16 v[180:183], a[108:111], a[220:223], v[180:183]
    ds_read_b64_tr_b16 a[40:41], v212 offset:49152
    s_mov_b32 s43, 0
    v_mfma_f32_16x16x32_bf16 v[180:183], a[104:107], a[212:215], v[180:183]
    ds_read_b64_tr_b16 a[42:43], v212 offset:57344
    buffer_load_dwordx4 v216, s[12:15], s24 offen offset:3072 lds
    v_mfma_f32_16x16x32_bf16 v[180:183], a[100:103], a[204:207], v[180:183]
    ds_read_b64_tr_b16 a[44:45], v212 offset:51200
    buffer_load_dwordx2 v[24:25], v16, s[16:19], s43 offen offset:0
    v_mfma_f32_16x16x32_bf16 v[180:183], a[96:99], a[196:199], v[180:183]
    ds_read_b64_tr_b16 a[46:47], v212 offset:59392
    s_waitcnt lgkmcnt(8)
    v_mfma_f32_16x16x32_bf16 v[188:191], a[112:115], a[196:199], v[188:191]
    ds_read_b64_tr_b16 a[48:49], v213 offset:32768
    buffer_load_dwordx2 v[26:27], v16, s[16:19], s43 offen offset:128
    v_mfma_f32_16x16x32_bf16 v[188:191], a[116:119], a[204:207], v[188:191]
    ds_read_b64_tr_b16 a[50:51], v213 offset:40960
    s_mov_b32 s43, 65536
    v_mfma_f32_16x16x32_bf16 v[188:191], a[120:123], a[212:215], v[188:191]
    ds_read_b64_tr_b16 a[52:53], v213 offset:34816
    v_mfma_f32_16x16x32_bf16 v[188:191], a[124:127], a[220:223], v[188:191]
    ds_read_b64_tr_b16 a[54:55], v213 offset:43008
    buffer_load_dwordx2 v[28:29], v16, s[16:19], s43 offen offset:0
    v_mfma_f32_16x16x32_bf16 v[184:187], a[124:127], a[216:219], v[184:187]
    ds_read_b64_tr_b16 a[56:57], v213 offset:49152
    v_mfma_f32_16x16x32_bf16 v[184:187], a[120:123], a[208:211], v[184:187]
    ds_read_b64_tr_b16 a[58:59], v213 offset:57344
    buffer_load_dwordx2 v[30:31], v16, s[16:19], s43 offen offset:128
    v_mfma_f32_16x16x32_bf16 v[184:187], a[116:119], a[200:203], v[184:187]
    ds_read_b64_tr_b16 a[60:61], v213 offset:51200
    v_mfma_f32_16x16x32_bf16 v[184:187], a[112:115], a[192:195], v[184:187]
    ds_read_b64_tr_b16 a[62:63], v213 offset:59392
    s_waitcnt vmcnt(8) lgkmcnt(8)
    v_mfma_f32_16x16x32_bf16 v[160:163], a[32:35], a[224:227], v[160:163]
    ds_read_b64_tr_b16 a[96:97], v214 offset:32768
    s_mov_b32 s43, 131072
    v_mfma_f32_16x16x32_bf16 v[160:163], a[36:39], a[232:235], v[160:163]
    ds_read_b64_tr_b16 a[98:99], v214 offset:40960
    v_mfma_f32_16x16x32_bf16 v[160:163], a[40:43], a[240:243], v[160:163]
    ds_read_b64_tr_b16 a[100:101], v214 offset:34816
    buffer_load_dwordx2 v[32:33], v16, s[16:19], s43 offen offset:0
    v_mfma_f32_16x16x32_bf16 v[160:163], a[44:47], a[248:251], v[160:163]
    ds_read_b64_tr_b16 a[102:103], v214 offset:43008
    v_mfma_f32_16x16x32_bf16 v[164:167], a[44:47], a[252:255], v[164:167]
    ds_read_b64_tr_b16 a[104:105], v214 offset:49152
    v_mfma_f32_16x16x32_bf16 v[164:167], a[40:43], a[244:247], v[164:167]
    ds_read_b64_tr_b16 a[106:107], v214 offset:57344
    buffer_load_dwordx2 v[34:35], v16, s[16:19], s43 offen offset:128
    v_mfma_f32_16x16x32_bf16 v[164:167], a[36:39], a[236:239], v[164:167]
    ds_read_b64_tr_b16 a[108:109], v214 offset:51200
    v_mfma_f32_16x16x32_bf16 v[164:167], a[32:35], a[228:231], v[164:167]
    ds_read_b64_tr_b16 a[110:111], v214 offset:59392
    s_waitcnt lgkmcnt(8)
    v_mfma_f32_16x16x32_bf16 v[172:175], a[48:51], a[228:231], v[172:175]
    ds_read_b64_tr_b16 a[112:113], v215 offset:32768
    s_mov_b32 s43, 196608
    v_mfma_f32_16x16x32_bf16 v[172:175], a[52:55], a[236:239], v[172:175]
    ds_read_b64_tr_b16 a[114:115], v215 offset:40960
    v_mfma_f32_16x16x32_bf16 v[172:175], a[56:59], a[244:247], v[172:175]
    ds_read_b64_tr_b16 a[116:117], v215 offset:34816
    buffer_load_dwordx2 v[36:37], v16, s[16:19], s43 offen offset:0
    v_mfma_f32_16x16x32_bf16 v[172:175], a[60:63], a[252:255], v[172:175]
    ds_read_b64_tr_b16 a[118:119], v215 offset:43008
    v_mfma_f32_16x16x32_bf16 v[168:171], a[60:63], a[248:251], v[168:171]
    ds_read_b64_tr_b16 a[120:121], v215 offset:49152
    buffer_load_dwordx2 v[38:39], v16, s[16:19], s43 offen offset:128
    v_mfma_f32_16x16x32_bf16 v[168:171], a[56:59], a[240:243], v[168:171]
    ds_read_b64_tr_b16 a[122:123], v215 offset:57344
    v_mfma_f32_16x16x32_bf16 v[168:171], a[52:55], a[232:235], v[168:171]
    ds_read_b64_tr_b16 a[124:125], v215 offset:51200
    v_mfma_f32_16x16x32_bf16 v[168:171], a[48:51], a[224:227], v[168:171]
    ds_read_b64_tr_b16 a[126:127], v215 offset:59392
    s_waitcnt lgkmcnt(8)
    v_mfma_f32_16x16x32_bf16 v[176:179], a[96:99], a[224:227], v[176:179]
    ds_read_b64_tr_b16 a[0:1], v208 offset:0
    v_mfma_f32_16x16x32_bf16 v[176:179], a[100:103], a[232:235], v[176:179]
    ds_read_b64_tr_b16 a[2:3], v208 offset:8192
    v_mfma_f32_16x16x32_bf16 v[176:179], a[104:107], a[240:243], v[176:179]
    ds_read_b64_tr_b16 a[4:5], v208 offset:2048
    v_mfma_f32_16x16x32_bf16 v[176:179], a[108:111], a[248:251], v[176:179]
    ds_read_b64_tr_b16 a[6:7], v208 offset:10240
    v_mfma_f32_16x16x32_bf16 v[180:183], a[108:111], a[252:255], v[180:183]
    ds_read_b64_tr_b16 a[8:9], v208 offset:16384
    v_mfma_f32_16x16x32_bf16 v[180:183], a[104:107], a[244:247], v[180:183]
    ds_read_b64_tr_b16 a[10:11], v208 offset:24576
    v_mfma_f32_16x16x32_bf16 v[180:183], a[100:103], a[236:239], v[180:183]
    ds_read_b64_tr_b16 a[12:13], v208 offset:18432
    v_mfma_f32_16x16x32_bf16 v[180:183], a[96:99], a[228:231], v[180:183]
    ds_read_b64_tr_b16 a[14:15], v208 offset:26624
    s_waitcnt lgkmcnt(8)
    v_mfma_f32_16x16x32_bf16 v[188:191], a[112:115], a[228:231], v[188:191]
    ds_read_b64_tr_b16 a[16:17], v209 offset:0
    v_mfma_f32_16x16x32_bf16 v[188:191], a[116:119], a[236:239], v[188:191]
    ds_read_b64_tr_b16 a[18:19], v209 offset:8192
    v_mfma_f32_16x16x32_bf16 v[188:191], a[120:123], a[244:247], v[188:191]
    ds_read_b64_tr_b16 a[20:21], v209 offset:2048
    v_mfma_f32_16x16x32_bf16 v[188:191], a[124:127], a[252:255], v[188:191]
    ds_read_b64_tr_b16 a[22:23], v209 offset:10240
    v_mfma_f32_16x16x32_bf16 v[184:187], a[124:127], a[248:251], v[184:187]
    ds_read_b64_tr_b16 a[24:25], v209 offset:16384
    v_mfma_f32_16x16x32_bf16 v[184:187], a[120:123], a[240:243], v[184:187]
    ds_read_b64_tr_b16 a[26:27], v209 offset:24576
    v_mfma_f32_16x16x32_bf16 v[184:187], a[116:119], a[232:235], v[184:187]
    ds_read_b64_tr_b16 a[28:29], v209 offset:18432
    v_mfma_f32_16x16x32_bf16 v[184:187], a[112:115], a[224:227], v[184:187]
    ds_read_b64_tr_b16 a[30:31], v209 offset:26624
    s_waitcnt lgkmcnt(8)
    v_mfma_f32_16x16x32_bf16 v[128:131], a[0:3], a[192:195], v[128:131]
    ds_read_b64_tr_b16 a[64:65], v210 offset:0
    v_mfma_f32_16x16x32_bf16 v[128:131], a[4:7], a[200:203], v[128:131]
    ds_read_b64_tr_b16 a[66:67], v210 offset:8192
    v_cvt_pk_bf16_f32 v64, v160, v161
    v_mfma_f32_16x16x32_bf16 v[128:131], a[8:11], a[208:211], v[128:131]
    ds_read_b64_tr_b16 a[68:69], v210 offset:2048
    v_cvt_pk_bf16_f32 v65, v162, v163
    v_mfma_f32_16x16x32_bf16 v[128:131], a[12:15], a[216:219], v[128:131]
    ds_read_b64_tr_b16 a[70:71], v210 offset:10240
    v_cvt_pk_bf16_f32 v66, v164, v165
    v_mfma_f32_16x16x32_bf16 v[132:135], a[12:15], a[220:223], v[132:135]
    ds_read_b64_tr_b16 a[72:73], v210 offset:16384
    v_mov_b32 v67, s44
    v_mfma_f32_16x16x32_bf16 v[132:135], a[8:11], a[212:215], v[132:135]
    ds_read_b64_tr_b16 a[74:75], v210 offset:24576
    buffer_store_dwordx4 v[64:67], v222, s[56:59], s32 offen offset:0 sc1
    v_mfma_f32_16x16x32_bf16 v[132:135], a[4:7], a[204:207], v[132:135]
    ds_read_b64_tr_b16 a[76:77], v210 offset:18432
    v_cvt_pk_bf16_f32 v68, v166, v167
    v_mfma_f32_16x16x32_bf16 v[132:135], a[0:3], a[196:199], v[132:135]
    ds_read_b64_tr_b16 a[78:79], v210 offset:26624
    s_waitcnt lgkmcnt(8)
    v_mfma_f32_16x16x32_bf16 v[140:143], a[16:19], a[196:199], v[140:143]
    ds_read_b64_tr_b16 a[80:81], v211 offset:0
    v_cvt_pk_bf16_f32 v69, v168, v169
    v_mfma_f32_16x16x32_bf16 v[140:143], a[20:23], a[204:207], v[140:143]
    ds_read_b64_tr_b16 a[82:83], v211 offset:8192
    v_cvt_pk_bf16_f32 v70, v170, v171
    v_mfma_f32_16x16x32_bf16 v[140:143], a[24:27], a[212:215], v[140:143]
    ds_read_b64_tr_b16 a[84:85], v211 offset:2048
    v_mov_b32 v71, s44
    v_mfma_f32_16x16x32_bf16 v[140:143], a[28:31], a[220:223], v[140:143]
    ds_read_b64_tr_b16 a[86:87], v211 offset:10240
    buffer_store_dwordx4 v[68:71], v222, s[56:59], s32 offen offset:1024 sc1
    v_mfma_f32_16x16x32_bf16 v[136:139], a[28:31], a[216:219], v[136:139]
    ds_read_b64_tr_b16 a[88:89], v211 offset:16384
    v_cvt_pk_bf16_f32 v72, v172, v173
    v_mfma_f32_16x16x32_bf16 v[136:139], a[24:27], a[208:211], v[136:139]
L_k_w14:
    s_cbranch_execz L_k_wback
    ds_read_b64_tr_b16 a[90:91], v211 offset:24576
    v_cvt_pk_bf16_f32 v73, v174, v175
    v_mfma_f32_16x16x32_bf16 v[136:139], a[20:23], a[200:203], v[136:139]
    ds_read_b64_tr_b16 a[92:93], v211 offset:18432
    v_cvt_pk_bf16_f32 v74, v176, v177
    v_mfma_f32_16x16x32_bf16 v[136:139], a[16:19], a[192:195], v[136:139]
    ds_read_b64_tr_b16 a[94:95], v211 offset:26624
    s_waitcnt lgkmcnt(8)
    v_mfma_f32_16x16x32_bf16 v[144:147], a[64:67], a[192:195], v[144:147]
    ds_read_b64_tr_b16 a[0:1], v208 offset:32768
    v_mov_b32 v75, s44
    v_mfma_f32_16x16x32_bf16 v[144:147], a[68:71], a[200:203], v[144:147]
    ds_read_b64_tr_b16 a[2:3], v208 offset:40960
    buffer_store_dwordx4 v[72:75], v222, s[56:59], s32 offen offset:2048 sc1
    v_mfma_f32_16x16x32_bf16 v[144:147], a[72:75], a[208:211], v[144:147]
    ds_read_b64_tr_b16 a[4:5], v208 offset:34816
    v_cvt_pk_bf16_f32 v76, v178, v179
    v_mfma_f32_16x16x32_bf16 v[144:147], a[76:79], a[216:219], v[144:147]
    ds_read_b64_tr_b16 a[6:7], v208 offset:43008
    v_cvt_pk_bf16_f32 v77, v180, v181
    v_mfma_f32_16x16x32_bf16 v[148:151], a[76:79], a[220:223], v[148:151]
    ds_read_b64_tr_b16 a[8:9], v208 offset:49152
    v_cvt_pk_bf16_f32 v78, v182, v183
    v_mfma_f32_16x16x32_bf16 v[148:151], a[72:75], a[212:215], v[148:151]
    ds_read_b64_tr_b16 a[10:11], v208 offset:57344
    v_mov_b32 v79, s44
    v_mfma_f32_16x16x32_bf16 v[148:151], a[68:71], a[204:207], v[148:151]
    ds_read_b64_tr_b16 a[12:13], v208 offset:51200
    buffer_store_dwordx4 v[76:79], v222, s[56:59], s32 offen offset:3072 sc1
    v_mfma_f32_16x16x32_bf16 v[148:151], a[64:67], a[196:199], v[148:151]
    ds_read_b64_tr_b16 a[14:15], v208 offset:59392
    s_waitcnt lgkmcnt(8)
    v_mfma_f32_16x16x32_bf16 v[156:159], a[80:83], a[196:199], v[156:159]
    ds_read_b64_tr_b16 a[16:17], v209 offset:32768
    v_cvt_pk_bf16_f32 v80, v184, v185
    v_mfma_f32_16x16x32_bf16 v[156:159], a[84:87], a[204:207], v[156:159]
    ds_read_b64_tr_b16 a[18:19], v209 offset:40960
    v_cvt_pk_bf16_f32 v81, v186, v187
    v_mfma_f32_16x16x32_bf16 v[156:159], a[88:91], a[212:215], v[156:159]
    ds_read_b64_tr_b16 a[20:21], v209 offset:34816
    v_cvt_pk_bf16_f32 v82, v188, v189
    v_mfma_f32_16x16x32_bf16 v[156:159], a[92:95], a[220:223], v[156:159]
    ds_read_b64_tr_b16 a[22:23], v209 offset:43008
    v_mov_b32 v83, s44
    v_mfma_f32_16x16x32_bf16 v[152:155], a[92:95], a[216:219], v[152:155]
    ds_read_b64_tr_b16 a[24:25], v209 offset:49152
    buffer_store_dwordx4 v[80:83], v222, s[56:59], s33 offen offset:0 sc1
    v_mfma_f32_16x16x32_bf16 v[152:155], a[88:91], a[208:211], v[152:155]
    ds_read_b64_tr_b16 a[26:27], v209 offset:57344
    v_cvt_pk_bf16_f32 v84, v190, v191
    v_mfma_f32_16x16x32_bf16 v[152:155], a[84:87], a[200:203], v[152:155]
    ds_read_b64_tr_b16 a[28:29], v209 offset:51200
    v_mov_b32 v87, s44
    v_mfma_f32_16x16x32_bf16 v[152:155], a[80:83], a[192:195], v[152:155]
    ds_read_b64_tr_b16 a[30:31], v209 offset:59392
    s_waitcnt lgkmcnt(8)
    v_mfma_f32_16x16x32_bf16 v[128:131], a[0:3], a[224:227], v[128:131]
    ds_read_b64_tr_b16 a[64:65], v210 offset:32768
    buffer_store_dwordx4 v[84:87], v222, s[56:59], s33 offen offset:1024 sc1
    v_mfma_f32_16x16x32_bf16 v[128:131], a[4:7], a[232:235], v[128:131]
    ds_read_b64_tr_b16 a[66:67], v210 offset:40960
    v_mfma_f32_16x16x32_bf16 v[128:131], a[8:11], a[240:243], v[128:131]
    ds_read_b64_tr_b16 a[68:69], v210 offset:34816
    v_mfma_f32_16x16x32_bf16 v[128:131], a[12:15], a[248:251], v[128:131]
    ds_read_b64_tr_b16 a[70:71], v210 offset:43008
    v_mfma_f32_16x16x32_bf16 v[132:135], a[12:15], a[252:255], v[132:135]
    ds_read_b64_tr_b16 a[72:73], v210 offset:49152
    v_mfma_f32_16x16x32_bf16 v[132:135], a[8:11], a[244:247], v[132:135]
    ds_read_b64_tr_b16 a[74:75], v210 offset:57344
    v_mfma_f32_16x16x32_bf16 v[132:135], a[4:7], a[236:239], v[132:135]
    ds_read_b64_tr_b16 a[76:77], v210 offset:51200
    v_mfma_f32_16x16x32_bf16 v[132:135], a[0:3], a[228:231], v[132:135]
    ds_read_b64_tr_b16 a[78:79], v210 offset:59392
    s_waitcnt lgkmcnt(8)
    v_mfma_f32_16x16x32_bf16 v[140:143], a[16:19], a[228:231], v[140:143]
    ds_read_b64_tr_b16 a[80:81], v211 offset:32768
    v_mfma_f32_16x16x32_bf16 v[140:143], a[20:23], a[236:239], v[140:143]
    ds_read_b64_tr_b16 a[82:83], v211 offset:40960
    v_mfma_f32_16x16x32_bf16 v[140:143], a[24:27], a[244:247], v[140:143]
    ds_read_b64_tr_b16 a[84:85], v211 offset:34816
    v_mfma_f32_16x16x32_bf16 v[140:143], a[28:31], a[252:255], v[140:143]
    ds_read_b64_tr_b16 a[86:87], v211 offset:43008
    v_mfma_f32_16x16x32_bf16 v[136:139], a[28:31], a[248:251], v[136:139]
    ds_read_b64_tr_b16 a[88:89], v211 offset:49152
    v_mfma_f32_16x16x32_bf16 v[136:139], a[24:27], a[240:243], v[136:139]
    ds_read_b64_tr_b16 a[90:91], v211 offset:57344
    v_mfma_f32_16x16x32_bf16 v[136:139], a[20:23], a[232:235], v[136:139]
    ds_read_b64_tr_b16 a[92:93], v211 offset:51200
    v_mfma_f32_16x16x32_bf16 v[136:139], a[16:19], a[224:227], v[136:139]
    ds_read_b64_tr_b16 a[94:95], v211 offset:59392
    s_waitcnt lgkmcnt(8)
    v_mfma_f32_16x16x32_bf16 v[144:147], a[64:67], a[224:227], v[144:147]
    v_mfma_f32_16x16x32_bf16 v[144:147], a[68:71], a[232:235], v[144:147]
    v_mfma_f32_16x16x32_bf16 v[144:147], a[72:75], a[240:243], v[144:147]
    v_mfma_f32_16x16x32_bf16 v[144:147], a[76:79], a[248:251], v[144:147]
    v_mfma_f32_16x16x32_bf16 v[148:151], a[76:79], a[252:255], v[148:151]
    v_mfma_f32_16x16x32_bf16 v[148:151], a[72:75], a[244:247], v[148:151]
    v_mfma_f32_16x16x32_bf16 v[148:151], a[68:71], a[236:239], v[148:151]
    v_mfma_f32_16x16x32_bf16 v[148:151], a[64:67], a[228:231], v[148:151]
    s_waitcnt lgkmcnt(0)
    v_mfma_f32_16x16x32_bf16 v[156:159], a[80:83], a[228:231], v[156:159]
    v_mfma_f32_16x16x32_bf16 v[156:159], a[84:87], a[236:239], v[156:159]
    v_mfma_f32_16x16x32_bf16 v[156:159], a[88:91], a[244:247], v[156:159]
    v_mfma_f32_16x16x32_bf16 v[156:159], a[92:95], a[252:255], v[156:159]
    v_mfma_f32_16x16x32_bf16 v[152:155], a[92:95], a[248:251], v[152:155]
    v_mfma_f32_16x16x32_bf16 v[152:155], a[88:91], a[240:243], v[152:155]
    v_mfma_f32_16x16x32_bf16 v[152:155], a[84:87], a[232:235], v[152:155]
    v_mfma_f32_16x16x32_bf16 v[152:155], a[80:83], a[224:227], v[152:155]
    v_mov_b32 v2, v222
    v_cmp_eq_u32 vcc, 0, v221
    v_mov_b32 v3, 2147483648
    v_mov_b32 v4, 1008
    v_cndmask_b32 v3, v3, v4, vcc
    s_waitcnt vmcnt(6)
    ds_read_b64 v[48:49], v217 offset:0
    ds_read_b64 v[50:51], v217 offset:2048
    ds_read_b64 v[52:53], v217 offset:32
    ds_read_b64 v[54:55], v217 offset:2080
    ds_read_b64 v[56:57], v217 offset:64
    ds_read_b64 v[58:59], v217 offset:2112
    ds_read_b64 v[60:61], v217 offset:96
    ds_read_b64 v[62:63], v217 offset:2144
    buffer_load_dword v1, v3, s[56:59], s35 offen offset:1036 sc1
    v_mul_f32 v41, 0xbede652a, v41
    v_mul_f32 v43, 0xbede652a, v43
    s_waitcnt lgkmcnt(0)
    v_lshlrev_b32 v64, 16, v48
    v_and_b32 v65, 0xffff0000, v48
    v_lshlrev_b32 v44, 16, v24
    v_and_b32 v45, 0xffff0000, v24
    v_pk_add_f32 v[96:97], v[64:65], v[40:41] op_sel_hi:[1,0] neg_lo:[0,1] neg_hi:[0,1]
    v_pk_mul_f32 v[44:45], v[44:45], v[40:41] op_sel:[0,1] op_sel_hi:[1,1]
    v_pk_mul_f32 v[96:97], v[96:97], v[44:45]
    v_lshlrev_b32 v66, 16, v49
    v_and_b32 v67, 0xffff0000, v49
    v_lshlrev_b32 v44, 16, v25
    v_and_b32 v45, 0xffff0000, v25
    v_pk_add_f32 v[98:99], v[66:67], v[40:41] op_sel_hi:[1,0] neg_lo:[0,1] neg_hi:[0,1]
    v_pk_mul_f32 v[44:45], v[44:45], v[40:41] op_sel:[0,1] op_sel_hi:[1,1]
    v_pk_mul_f32 v[98:99], v[98:99], v[44:45]
    v_lshlrev_b32 v68, 16, v50
    v_and_b32 v69, 0xffff0000, v50
    v_lshlrev_b32 v44, 16, v26
    v_and_b32 v45, 0xffff0000, v26
    v_pk_add_f32 v[100:101], v[68:69], v[42:43] op_sel_hi:[1,0] neg_lo:[0,1] neg_hi:[0,1]
    v_pk_mul_f32 v[44:45], v[44:45], v[42:43] op_sel:[0,1] op_sel_hi:[1,1]
    v_pk_mul_f32 v[100:101], v[100:101], v[44:45]
    v_lshlrev_b32 v70, 16, v51
    v_and_b32 v71, 0xffff0000, v51
    v_lshlrev_b32 v44, 16, v27
    v_and_b32 v45, 0xffff0000, v27
    v_pk_add_f32 v[102:103], v[70:71], v[42:43] op_sel_hi:[1,0] neg_lo:[0,1] neg_hi:[0,1]
    v_pk_mul_f32 v[44:45], v[44:45], v[42:43] op_sel:[0,1] op_sel_hi:[1,1]
    v_pk_mul_f32 v[102:103], v[102:103], v[44:45]
    v_lshlrev_b32 v72, 16, v52
    v_and_b32 v73, 0xffff0000, v52
    v_lshlrev_b32 v44, 16, v28
    v_and_b32 v45, 0xffff0000, v28
    v_pk_add_f32 v[104:105], v[72:73], v[40:41] op_sel_hi:[1,0] neg_lo:[0,1] neg_hi:[0,1]
    v_pk_mul_f32 v[44:45], v[44:45], v[40:41] op_sel:[0,1] op_sel_hi:[1,1]
    v_pk_mul_f32 v[104:105], v[104:105], v[44:45]
    v_lshlrev_b32 v74, 16, v53
    v_and_b32 v75, 0xffff0000, v53
    v_lshlrev_b32 v44, 16, v29
    v_and_b32 v45, 0xffff0000, v29
    v_pk_add_f32 v[106:107], v[74:75], v[40:41] op_sel_hi:[1,0] neg_lo:[0,1] neg_hi:[0,1]
    v_pk_mul_f32 v[44:45], v[44:45], v[40:41] op_sel:[0,1] op_sel_hi:[1,1]
    v_pk_mul_f32 v[106:107], v[106:107], v[44:45]
    v_lshlrev_b32 v76, 16, v54
    v_and_b32 v77, 0xffff0000, v54
    v_lshlrev_b32 v44, 16, v30
    v_and_b32 v45, 0xffff0000, v30
    v_pk_add_f32 v[108:109], v[76:77], v[42:43] op_sel_hi:[1,0] neg_lo:[0,1] neg_hi:[0,1]
    v_pk_mul_f32 v[44:45], v[44:45], v[42:43] op_sel:[0,1] op_sel_hi:[1,1]
    v_pk_mul_f32 v[108:109], v[108:109], v[44:45]
    v_lshlrev_b32 v78, 16, v55
    v_and_b32 v79, 0xffff0000, v55
    v_lshlrev_b32 v44, 16, v31
    v_and_b32 v45, 0xffff0000, v31
    v_pk_add_f32 v[110:111], v[78:79], v[42:43] op_sel_hi:[1,0] neg_lo:[0,1] neg_hi:[0,1]
    v_pk_mul_f32 v[44:45], v[44:45], v[42:43] op_sel:[0,1] op_sel_hi:[1,1]
    v_pk_mul_f32 v[110:111], v[110:111], v[44:45]
    v_lshlrev_b32 v80, 16, v56
    v_and_b32 v81, 0xffff0000, v56
    v_lshlrev_b32 v44, 16, v32
    v_and_b32 v45, 0xffff0000, v32
    v_pk_add_f32 v[112:113], v[80:81], v[40:41] op_sel_hi:[1,0] neg_lo:[0,1] neg_hi:[0,1]
    v_pk_mul_f32 v[44:45], v[44:45], v[40:41] op_sel:[0,1] op_sel_hi:[1,1]
    v_pk_mul_f32 v[112:113], v[112:113], v[44:45]
    v_lshlrev_b32 v82, 16, v57
    v_and_b32 v83, 0xffff0000, v57
    v_lshlrev_b32 v44, 16, v33
    v_and_b32 v45, 0xffff0000, v33
    v_pk_add_f32 v[114:115], v[82:83], v[40:41] op_sel_hi:[1,0] neg_lo:[0,1] neg_hi:[0,1]
    v_pk_mul_f32 v[44:45], v[44:45], v[40:41] op_sel:[0,1] op_sel_hi:[1,1]
    v_pk_mul_f32 v[114:115], v[114:115], v[44:45]
    v_lshlrev_b32 v84, 16, v58
    v_and_b32 v85, 0xffff0000, v58
    v_lshlrev_b32 v44, 16, v34
    v_and_b32 v45, 0xffff0000, v34
    v_pk_add_f32 v[116:117], v[84:85], v[42:43] op_sel_hi:[1,0] neg_lo:[0,1] neg_hi:[0,1]
    v_pk_mul_f32 v[44:45], v[44:45], v[42:43] op_sel:[0,1] op_sel_hi:[1,1]
    v_pk_mul_f32 v[116:117], v[116:117], v[44:45]
    v_lshlrev_b32 v86, 16, v59
    v_and_b32 v87, 0xffff0000, v59
    v_lshlrev_b32 v44, 16, v35
    v_and_b32 v45, 0xffff0000, v35
    v_pk_add_f32 v[118:119], v[86:87], v[42:43] op_sel_hi:[1,0] neg_lo:[0,1] neg_hi:[0,1]
    v_pk_mul_f32 v[44:45], v[44:45], v[42:43] op_sel:[0,1] op_sel_hi:[1,1]
    v_pk_mul_f32 v[118:119], v[118:119], v[44:45]
    v_lshlrev_b32 v88, 16, v60
    v_and_b32 v89, 0xffff0000, v60
    v_lshlrev_b32 v44, 16, v36
    v_and_b32 v45, 0xffff0000, v36
    v_pk_add_f32 v[120:121], v[88:89], v[40:41] op_sel_hi:[1,0] neg_lo:[0,1] neg_hi:[0,1]
    v_pk_mul_f32 v[44:45], v[44:45], v[40:41] op_sel:[0,1] op_sel_hi:[1,1]
    v_pk_mul_f32 v[120:121], v[120:121], v[44:45]
    v_lshlrev_b32 v90, 16, v61
    v_and_b32 v91, 0xffff0000, v61
    v_lshlrev_b32 v44, 16, v37
    v_and_b32 v45, 0xffff0000, v37
    v_pk_add_f32 v[122:123], v[90:91], v[40:41] op_sel_hi:[1,0] neg_lo:[0,1] neg_hi:[0,1]
    v_pk_mul_f32 v[44:45], v[44:45], v[40:41] op_sel:[0,1] op_sel_hi:[1,1]
    v_pk_mul_f32 v[122:123], v[122:123], v[44:45]
    v_lshlrev_b32 v92, 16, v62
    v_and_b32 v93, 0xffff0000, v62
    v_lshlrev_b32 v44, 16, v38
    v_and_b32 v45, 0xffff0000, v38
    v_pk_add_f32 v[124:125], v[92:93], v[42:43] op_sel_hi:[1,0] neg_lo:[0,1] neg_hi:[0,1]
    v_pk_mul_f32 v[44:45], v[44:45], v[42:43] op_sel:[0,1] op_sel_hi:[1,1]
    v_pk_mul_f32 v[124:125], v[124:125], v[44:45]
    v_lshlrev_b32 v94, 16, v63
    v_and_b32 v95, 0xffff0000, v63
    v_lshlrev_b32 v44, 16, v39
    v_and_b32 v45, 0xffff0000, v39
    v_pk_add_f32 v[126:127], v[94:95], v[42:43] op_sel_hi:[1,0] neg_lo:[0,1] neg_hi:[0,1]
    v_pk_mul_f32 v[44:45], v[44:45], v[42:43] op_sel:[0,1] op_sel_hi:[1,1]
    v_pk_mul_f32 v[126:127], v[126:127], v[44:45]
    s_mov_b32 s16, s54
    s_mov_b32 s17, s55
    s_mov_b32 s24, 0
    s_mov_b32 s42, 0xbfb8aa3b
    s_mov_b32 s43, s42
    s_branch L_k_px3
L_k_px2:
    buffer_load_dword v1, v3, s[56:59], s35 offen offset:1036 sc1
L_k_px3:
    s_add_u32 s24, s24, 1
    s_cmp_gt_u32 s24, 400000
    s_cbranch_scc1 L_k_px_ok
    s_waitcnt vmcnt(0)
    v_xor_b32 v1, s44, v1
    v_cmp_eq_u32 vcc, 0, v1
    s_nop 4
    s_bitcmp1_b32 vcc_lo, 0
    s_cbranch_scc1 L_k_px
    s_sleep 1
    s_branch L_k_px2
L_k_px:
    buffer_load_dwordx4 v[192:195], v2, s[56:59], s34 offen offset:0 sc1
    buffer_load_dwordx4 v[196:199], v2, s[56:59], s34 offen offset:1024 sc1
    buffer_load_dwordx4 v[200:203], v2, s[56:59], s34 offen offset:2048 sc1
    buffer_load_dwordx4 v[204:207], v2, s[56:59], s34 offen offset:3072 sc1
    buffer_load_dwordx4 v[208:211], v2, s[56:59], s35 offen offset:0 sc1
    buffer_load_dwordx4 v[212:215], v2, s[56:59], s35 offen offset:1024 sc1
L_k_px4:
    s_waitcnt vmcnt(5)
    v_xor_b32 v1, s44, v195
    v_lshlrev_b32 v160, 16, v192
    v_and_b32 v161, 0xffff0000, v192
    v_lshlrev_b32 v162, 16, v193
    v_and_b32 v163, 0xffff0000, v193
    v_lshlrev_b32 v164, 16, v194
    v_and_b32 v165, 0xffff0000, v194
    s_waitcnt vmcnt(4)
    v_bitop3_b32 v1, v1, v199, s44 bitop3:0xf6
    v_lshlrev_b32 v166, 16, v196
    v_and_b32 v167, 0xffff0000, v196
    v_lshlrev_b32 v168, 16, v197
    v_and_b32 v169, 0xffff0000, v197
    v_lshlrev_b32 v170, 16, v198
    v_and_b32 v171, 0xffff0000, v198
    s_waitcnt vmcnt(3)
    v_bitop3_b32 v1, v1, v203, s44 bitop3:0xf6
    v_lshlrev_b32 v172, 16, v200
    v_and_b32 v173, 0xffff0000, v200
    v_lshlrev_b32 v174, 16, v201
    v_and_b32 v175, 0xffff0000, v201
    v_lshlrev_b32 v176, 16, v202
    v_and_b32 v177, 0xffff0000, v202
    s_waitcnt vmcnt(2)
    v_bitop3_b32 v1, v1, v207, s44 bitop3:0xf6
    v_lshlrev_b32 v178, 16, v204
    v_and_b32 v179, 0xffff0000, v204
    v_lshlrev_b32 v180, 16, v205
    v_and_b32 v181, 0xffff0000, v205
    v_lshlrev_b32 v182, 16, v206
    v_and_b32 v183, 0xffff0000, v206
    s_waitcnt vmcnt(1)
    v_bitop3_b32 v1, v1, v211, s44 bitop3:0xf6
    v_lshlrev_b32 v184, 16, v208
    v_and_b32 v185, 0xffff0000, v208
    v_lshlrev_b32 v186, 16, v209
    v_and_b32 v187, 0xffff0000, v209
    v_lshlrev_b32 v188, 16, v210
    v_and_b32 v189, 0xffff0000, v210
    s_waitcnt vmcnt(0)
    v_bitop3_b32 v1, v1, v215, s44 bitop3:0xf6
    v_lshlrev_b32 v190, 16, v212
    v_and_b32 v191, 0xffff0000, v212
    v_cmp_ne_u32 vcc, 0, v1
    s_nop 4
    s_cbranch_vccnz L_k_px2
L_k_px_ok:
    v_pk_add_f32 v[128:129], v[128:129], v[160:161]
    v_pk_add_f32 v[130:131], v[130:131], v[162:163]
    v_pk_mul_f32 v[44:45], v[128:129], s[42:43]
    v_pk_mul_f32 v[46:47], v[130:131], s[42:43]
    v_exp_f32 v44, v44
    v_exp_f32 v45, v45
    v_exp_f32 v46, v46
    v_exp_f32 v47, v47
    v_pk_mul_f32 v[96:97], v[96:97], v[128:129]
    v_pk_mul_f32 v[98:99], v[98:99], v[130:131]
    v_pk_add_f32 v[44:45], v[44:45], 1.0 op_sel_hi:[1,0]
    v_pk_add_f32 v[46:47], v[46:47], 1.0 op_sel_hi:[1,0]
    v_rcp_f32 v44, v44
    v_rcp_f32 v45, v45
    v_rcp_f32 v46, v46
    v_rcp_f32 v47, v47
    s_nop 0
    v_pk_fma_f32 v[96:97], v[96:97], v[44:45], v[64:65]
    v_pk_fma_f32 v[98:99], v[98:99], v[46:47], v[66:67]
    v_cvt_pk_bf16_f32 v224, v96, v97
    v_cvt_pk_bf16_f32 v225, v98, v99
    v_pk_add_f32 v[132:133], v[132:133], v[164:165]
    v_pk_add_f32 v[134:135], v[134:135], v[166:167]
    v_pk_mul_f32 v[44:45], v[132:133], s[42:43]
    v_pk_mul_f32 v[46:47], v[134:135], s[42:43]
    v_exp_f32 v44, v44
    v_exp_f32 v45, v45
    v_exp_f32 v46, v46
    v_exp_f32 v47, v47
    v_pk_mul_f32 v[100:101], v[100:101], v[132:133]
    v_pk_mul_f32 v[102:103], v[102:103], v[134:135]
    v_pk_add_f32 v[44:45], v[44:45], 1.0 op_sel_hi:[1,0]
    v_pk_add_f32 v[46:47], v[46:47], 1.0 op_sel_hi:[1,0]
    v_rcp_f32 v44, v44
    v_rcp_f32 v45, v45
    v_rcp_f32 v46, v46
    v_rcp_f32 v47, v47
    s_nop 0
    v_pk_fma_f32 v[100:101], v[100:101], v[44:45], v[68:69]
    v_pk_fma_f32 v[102:103], v[102:103], v[46:47], v[70:71]
    v_cvt_pk_bf16_f32 v228, v100, v101
    v_cvt_pk_bf16_f32 v229, v102, v103
    v_pk_add_f32 v[136:137], v[136:137], v[168:169]
    v_pk_add_f32 v[138:139], v[138:139], v[170:171]
    v_pk_mul_f32 v[44:45], v[136:137], s[42:43]
    v_pk_mul_f32 v[46:47], v[138:139], s[42:43]
    v_exp_f32 v44, v44
    v_exp_f32 v45, v45
    v_exp_f32 v46, v46
    v_exp_f32 v47, v47
    v_pk_mul_f32 v[104:105], v[104:105], v[136:137]
    v_pk_mul_f32 v[106:107], v[106:107], v[138:139]
    v_pk_add_f32 v[44:45], v[44:45], 1.0 op_sel_hi:[1,0]
    v_pk_add_f32 v[46:47], v[46:47], 1.0 op_sel_hi:[1,0]
    v_rcp_f32 v44, v44
    v_rcp_f32 v45, v45
    v_rcp_f32 v46, v46
    v_rcp_f32 v47, v47
    s_nop 0
    v_pk_fma_f32 v[104:105], v[104:105], v[44:45], v[72:73]
    v_pk_fma_f32 v[106:107], v[106:107], v[46:47], v[74:75]
    v_cvt_pk_bf16_f32 v226, v104, v105
    v_cvt_pk_bf16_f32 v227, v106, v107
    v_pk_add_f32 v[140:141], v[140:141], v[172:173]
    v_pk_add_f32 v[142:143], v[142:143], v[174:175]
    v_pk_mul_f32 v[44:45], v[140:141], s[42:43]
    v_pk_mul_f32 v[46:47], v[142:143], s[42:43]
    v_exp_f32 v44, v44
    v_exp_f32 v45, v45
    v_exp_f32 v46, v46
    v_exp_f32 v47, v47
    v_pk_mul_f32 v[108:109], v[108:109], v[140:141]
    v_pk_mul_f32 v[110:111], v[110:111], v[142:143]
    v_pk_add_f32 v[44:45], v[44:45], 1.0 op_sel_hi:[1,0]
    v_pk_add_f32 v[46:47], v[46:47], 1.0 op_sel_hi:[1,0]
    v_rcp_f32 v44, v44
    v_rcp_f32 v45, v45
    v_rcp_f32 v46, v46
    v_rcp_f32 v47, v47
    s_nop 0
    v_pk_fma_f32 v[108:109], v[108:109], v[44:45], v[76:77]
    v_pk_fma_f32 v[110:111], v[110:111], v[46:47], v[78:79]
    v_cvt_pk_bf16_f32 v230, v108, v109
    v_cvt_pk_bf16_f32 v231, v110, v111
    s_nop 1
    v_permlane16_swap_b32 v224, v226
    v_permlane16_swap_b32 v225, v227
    v_permlane16_swap_b32 v228, v230
    v_permlane16_swap_b32 v229, v231
    buffer_store_dwordx4 v[224:227], v19, s[16:19], 0 offen offset:0
    buffer_store_dwordx4 v[228:231], v20, s[16:19], 0 offen offset:0
    v_pk_add_f32 v[144:145], v[144:145], v[176:177]
    v_pk_add_f32 v[146:147], v[146:147], v[178:179]
    v_pk_mul_f32 v[44:45], v[144:145], s[42:43]
    v_pk_mul_f32 v[46:47], v[146:147], s[42:43]
    v_exp_f32 v44, v44
    v_exp_f32 v45, v45
    v_exp_f32 v46, v46
    v_exp_f32 v47, v47
    v_pk_mul_f32 v[112:113], v[112:113], v[144:145]
    v_pk_mul_f32 v[114:115], v[114:115], v[146:147]
    v_pk_add_f32 v[44:45], v[44:45], 1.0 op_sel_hi:[1,0]
    v_pk_add_f32 v[46:47], v[46:47], 1.0 op_sel_hi:[1,0]
    v_rcp_f32 v44, v44
    v_rcp_f32 v45, v45
    v_rcp_f32 v46, v46
    v_rcp_f32 v47, v47
    s_nop 0
    v_pk_fma_f32 v[112:113], v[112:113], v[44:45], v[80:81]
    v_pk_fma_f32 v[114:115], v[114:115], v[46:47], v[82:83]
    v_cvt_pk_bf16_f32 v232, v112, v113
    v_cvt_pk_bf16_f32 v233, v114, v115
    v_pk_add_f32 v[148:149], v[148:149], v[180:181]
    v_pk_add_f32 v[150:151], v[150:151], v[182:183]
    v_pk_mul_f32 v[44:45], v[148:149], s[42:43]
    v_pk_mul_f32 v[46:47], v[150:151], s[42:43]
    v_exp_f32 v44, v44
    v_exp_f32 v45, v45
    v_exp_f32 v46, v46
    v_exp_f32 v47, v47
    v_pk_mul_f32 v[116:117], v[116:117], v[148:149]
    v_pk_mul_f32 v[118:119], v[118:119], v[150:151]
    v_pk_add_f32 v[44:45], v[44:45], 1.0 op_sel_hi:[1,0]
    v_pk_add_f32 v[46:47], v[46:47], 1.0 op_sel_hi:[1,0]
    v_rcp_f32 v44, v44
    v_rcp_f32 v45, v45
    v_rcp_f32 v46, v46
    v_rcp_f32 v47, v47
    s_nop 0
    v_pk_fma_f32 v[116:117], v[116:117], v[44:45], v[84:85]
    v_pk_fma_f32 v[118:119], v[118:119], v[46:47], v[86:87]
    v_cvt_pk_bf16_f32 v236, v116, v117
    v_cvt_pk_bf16_f32 v237, v118, v119
    v_pk_add_f32 v[152:153], v[152:153], v[184:185]
    v_pk_add_f32 v[154:155], v[154:155], v[186:187]
    v_pk_mul_f32 v[44:45], v[152:153], s[42:43]
    v_pk_mul_f32 v[46:47], v[154:155], s[42:43]
    v_exp_f32 v44, v44
    v_exp_f32 v45, v45
    v_exp_f32 v46, v46
    v_exp_f32 v47, v47
    v_pk_mul_f32 v[120:121], v[120:121], v[152:153]
    v_pk_mul_f32 v[122:123], v[122:123], v[154:155]
    v_pk_add_f32 v[44:45], v[44:45], 1.0 op_sel_hi:[1,0]
    v_pk_add_f32 v[46:47], v[46:47], 1.0 op_sel_hi:[1,0]
    v_rcp_f32 v44, v44
    v_rcp_f32 v45, v45
    v_rcp_f32 v46, v46
    v_rcp_f32 v47, v47
    s_nop 0
    v_pk_fma_f32 v[120:121], v[120:121], v[44:45], v[88:89]
    v_pk_fma_f32 v[122:123], v[122:123], v[46:47], v[90:91]
    v_cvt_pk_bf16_f32 v234, v120, v121
    v_cvt_pk_bf16_f32 v235, v122, v123
    v_pk_add_f32 v[156:157], v[156:157], v[188:189]
    v_pk_add_f32 v[158:159], v[158:159], v[190:191]
    v_pk_mul_f32 v[44:45], v[156:157], s[42:43]
    v_pk_mul_f32 v[46:47], v[158:159], s[42:43]
    v_exp_f32 v44, v44
    v_exp_f32 v45, v45
    v_exp_f32 v46, v46
    v_exp_f32 v47, v47
    v_pk_mul_f32 v[124:125], v[124:125], v[156:157]
    v_pk_mul_f32 v[126:127], v[126:127], v[158:159]
    v_pk_add_f32 v[44:45], v[44:45], 1.0 op_sel_hi:[1,0]
    v_pk_add_f32 v[46:47], v[46:47], 1.0 op_sel_hi:[1,0]
    v_rcp_f32 v44, v44
    v_rcp_f32 v45, v45
    v_rcp_f32 v46, v46
    v_rcp_f32 v47, v47
    s_nop 0
    v_pk_fma_f32 v[124:125], v[124:125], v[44:45], v[92:93]
    v_pk_fma_f32 v[126:127], v[126:127], v[46:47], v[94:95]
    v_cvt_pk_bf16_f32 v238, v124, v125
    v_cvt_pk_bf16_f32 v239, v126, v127
    s_nop 1
    v_permlane16_swap_b32 v232, v234
    v_permlane16_swap_b32 v233, v235
    v_permlane16_swap_b32 v236, v238
    v_permlane16_swap_b32 v237, v239
    buffer_store_dwordx4 v[232:235], v19, s[16:19], 0 offen offset:64
    buffer_store_dwordx4 v[236:239], v20, s[16:19], 0 offen offset:64
L_k_end:
    s_endpgm
.section .rodata,"a"
.p2align 6
.amdhsa_kernel recurrent_scan__ssm_conv_h3__geglu_ffn__prompt_kernel
  .amdhsa_next_free_vgpr 512
  .amdhsa_next_free_sgpr 102
  .amdhsa_accum_offset 256
  .amdhsa_group_segment_fixed_size 0
  .amdhsa_kernarg_size 104
  .amdhsa_user_sgpr_count 2
  .amdhsa_user_sgpr_kernarg_segment_ptr 1
  .amdhsa_system_sgpr_workgroup_id_x 1
  .amdhsa_float_denorm_mode_32 3
.end_amdhsa_kernel
```
